```python
import torch

def _softmax(x, axis=-1):
    return torch.softmax(x, dim=axis)

def _gelu(x):
    return torch.nn.functional.gelu(x, approximate='tanh')

def _silu(x):
    return torch.nn.functional.silu(x)

def _sigmoid(x):
    return torch.sigmoid(x)

def _layernorm(x, axis=-1, eps=1e-05):
    m = x.mean(dim=axis, keepdim=True)
    v = x.var(dim=axis, keepdim=True, unbiased=False)
    return (x - m) / torch.sqrt(v + eps)

def _scatter_add(tgt, idx, src, axis=0):
    return tgt.clone().index_add_(axis, idx, src)

def _segment_sum(src, seg, n):
    out = torch.zeros((n,) + src.shape[1:], dtype=src.dtype)
    return out.index_add_(0, seg, src)

def _pad(x, pw):
    flat = tuple((v for pair in reversed(pw) for v in pair))
    return torch.nn.functional.pad(x, flat)
kernel_name = 'adaLN_cond__gqa_block_cached__glu_gated_bilinear__prompt'

def setup_inputs():

    _w = lambda a: (lambda t: t.to(torch.bfloat16) if t.is_floating_point() else t)(torch.as_tensor(a))

    def _A_setup():
        B, Sq, D = (1, 2048, 512)
        Hq, Hkv, Sk, Dh = (32, 32, 2048, 128)
        assert Hq % Hkv == 0, (Hq, Hkv)
        return {'x': _w((lambda *s: torch.randn(*s, dtype=torch.bfloat16) * 0.05)(B, Sq, D)), 'k_cache': _w((lambda *s: torch.randn(*s, dtype=torch.bfloat16) * 0.8)(B, Hkv, Sk, Dh)), 'v_cache': _w((lambda *s: torch.randn(*s, dtype=torch.bfloat16) * 3.2)(B, Hkv, Sk, Dh)), 'wq': _w((lambda *s: torch.randn(*s, dtype=torch.bfloat16) * 0.8)(D, Hq * Dh) * D ** (-0.5)), 'wo': _w((lambda *s: torch.randn(*s, dtype=torch.bfloat16) * 3.2)(Hq * Dh, D) * (Hq * Dh) ** (-0.5))}
    _A_in = _A_setup()

    def _B_setup():
        B, S, D, F = (1, 2048, 512, 1376)
        return {'x': _w((lambda *s: torch.randn(*s, dtype=torch.bfloat16) * 0.05)(B, S, D)), 'w_gate': _w((lambda *s: torch.randn(*s, dtype=torch.bfloat16) * 3.2)(D, F) * D ** (-0.5)), 'w_up': _w((lambda *s: torch.randn(*s, dtype=torch.bfloat16) * 3.2)(D, F) * D ** (-0.5)), 'w_down': _w((lambda *s: torch.randn(*s, dtype=torch.bfloat16) * 3.2)(F, D) * F ** (-0.5))}
    _B_in = _B_setup()
    return {'A_x': _A_in['x'], 'A_k_cache': _A_in['k_cache'], 'A_v_cache': _A_in['v_cache'], 'A_wq': _A_in['wq'], 'A_wo': _A_in['wo'], 'B_x': _B_in['x'], 'B_w_gate': _B_in['w_gate'], 'B_w_up': _B_in['w_up'], 'B_w_down': _B_in['w_down'], 'c': _w((lambda *s: torch.randn(*s, dtype=torch.bfloat16) * 0.4)(1, 512) * 8.0), 'w_mod': _w((lambda *s: torch.randn(*s, dtype=torch.bfloat16) * 0.4)(512, 6 * 512) * 512 ** (-0.5) * 8.0)}

def reference(A_x, A_k_cache, A_v_cache, A_wq, A_wo, B_x, B_w_gate, B_w_up, B_w_down, c, w_mod):

    def _A_ref(x, k_cache, v_cache, wq, wo):
        B, Sq, D = x.shape
        Hq, Dh = (32, 128)
        Hkv = k_cache.shape[1]
        rep = Hq // Hkv
        q = (lambda x, *d: x.permute(*d))((x @ wq).reshape(B, Sq, Hq, Dh), 0, 2, 1, 3)
        k = (lambda x, n, axis: torch.repeat_interleave(x, n, dim=axis))(k_cache, rep, axis=1)
        v = (lambda x, n, axis: torch.repeat_interleave(x, n, dim=axis))(v_cache, rep, axis=1)
        scores = torch.einsum('bhqd,bhkd->bhqk', q, k) * Dh ** (-0.5)
        p = _softmax(scores, axis=-1)
        o = torch.einsum('bhqk,bhkd->bhqd', p, v)
        return (lambda x, *d: x.permute(*d))(o, 0, 2, 1, 3).reshape(B, Sq, Hq * Dh) @ wo

    def _B_ref(x, w_gate, w_up, w_down):
        g = torch.einsum('bsd,df->bsf', x, w_gate)
        u = torch.einsum('bsd,df->bsf', x, w_up)
        h = g * u
        return torch.einsum('bsf,fd->bsd', h, w_down)
    x = A_x
    mod = (_silu(c) @ w_mod).reshape(c.shape[0], 6, 1, -1)
    sa, ca, ga, sb, cb, gb = (mod[:, 0].clone(), mod[:, 1].clone(), mod[:, 2].clone(), mod[:, 3].clone(), mod[:, 4].clone(), mod[:, 5].clone())
    h = _layernorm(x, axis=-1) * (1 + ca) + sa
    x = x + ga * _A_ref(h, A_k_cache, A_v_cache, A_wq, A_wo)
    h = _layernorm(x, axis=-1) * (1 + cb) + sb
    x = x + gb * _B_ref(h, B_w_gate, B_w_up, B_w_down)
    return x
```

```asm
; @launch kernel=k0_prep_kernel grid=(256,1,1) block=(512,1,1) lds=10240
; @launch kernel=k1_attn_kernel grid=(256,1,1) block=(256,1,1) lds=163840
.amdgcn_target "amdgcn-amd-amdhsa--gfx950"
.text
.globl k0_prep_kernel
.p2align 8
.type k0_prep_kernel,@function
k0_prep_kernel:
    s_cmp_ge_u32 s2, 256
    s_cbranch_scc1 k0_end
    s_load_dwordx2 s[4:5], s[0:1], 0
    s_load_dwordx4 s[8:11], s[0:1], 72
    s_load_dwordx2 s[6:7], s[0:1], 104
    s_load_dwordx2 s[28:29], s[0:1], 24
    v_lshrrev_b32 v1, 6, v0
    v_and_b32 v2, 63, v0
    v_readfirstlane_b32 s24, v1
    s_cmp_ge_u32 s24, 4
    s_cbranch_scc1 k0_mod
    v_lshrrev_b32 v3, 5, v0
    v_and_b32 v4, 31, v0
    v_lshlrev_b32 v5, 10, v3
    v_lshl_add_u32 v5, v4, 4, v5
    s_lshl_b32 s3, s2, 13
    v_lshlrev_b32 v6, 8, v4
    v_lshl_add_u32 v6, v3, 4, v6
    s_lshr_b32 s25, s2, 1
    s_lshl_b32 s25, s25, 14
    s_and_b32 s26, s2, 1
    s_lshl_b32 s26, s26, 7
    s_add_u32 s25, s25, s26
    s_add_u32 s26, s25, 8192
    s_waitcnt lgkmcnt(0)
    s_mov_b32 s12, s4
    s_mov_b32 s13, s5
    s_mov_b32 s14, 0x200000
    s_mov_b32 s15, 0x20000
    buffer_load_dwordx4 v[8:11], v5, s[12:15], s3 offen offset:0 nt
    buffer_load_dwordx4 v[12:15], v5, s[12:15], s3 offen offset:512 nt
    s_add_u32 s16, s6, 0x10000
    s_addc_u32 s17, s7, 0
    s_mov_b32 s18, 0x200000
    s_mov_b32 s19, 0x20000
    s_add_u32 s20, s6, 0x640000
    s_addc_u32 s21, s7, 0
    s_mov_b32 s22, 0x20000
    s_mov_b32 s23, 0x20000
    v_lshlrev_b32 v40, 2, v0
    v_mov_b32 v41, 0
    s_lshl_b32 s27, s2, 10
    buffer_store_dword v41, v40, s[20:23], s27 offen
    s_waitcnt vmcnt(2)
    v_lshlrev_b32 v16, 16, v8
    v_and_b32 v17, 0xffff0000, v8
    v_lshlrev_b32 v18, 16, v9
    v_and_b32 v19, 0xffff0000, v9
    v_lshlrev_b32 v20, 16, v10
    v_and_b32 v21, 0xffff0000, v10
    v_lshlrev_b32 v22, 16, v11
    v_and_b32 v23, 0xffff0000, v11
    s_waitcnt vmcnt(1)
    v_lshlrev_b32 v24, 16, v12
    v_and_b32 v25, 0xffff0000, v12
    v_lshlrev_b32 v26, 16, v13
    v_and_b32 v27, 0xffff0000, v13
    v_lshlrev_b32 v28, 16, v14
    v_and_b32 v29, 0xffff0000, v14
    v_lshlrev_b32 v30, 16, v15
    v_and_b32 v31, 0xffff0000, v15
    v_pk_add_f32 v[32:33], v[16:17], v[24:25]
    v_pk_add_f32 v[34:35], v[18:19], v[26:27]
    v_pk_add_f32 v[36:37], v[20:21], v[28:29]
    v_pk_add_f32 v[38:39], v[22:23], v[30:31]
    v_pk_add_f32 v[32:33], v[32:33], v[36:37]
    v_pk_add_f32 v[34:35], v[34:35], v[38:39]
    v_pk_add_f32 v[32:33], v[32:33], v[34:35]
    v_add_f32 v32, v32, v33
    s_nop 1
    v_add_f32 v32, v32, v32 row_ror:8
    s_nop 1
    v_add_f32 v32, v32, v32 row_ror:4
    s_nop 1
    v_add_f32 v32, v32, v32 row_ror:2
    s_nop 1
    v_add_f32 v32, v32, v32 row_ror:1
    v_mov_b32 v33, v32
    s_nop 1
    v_permlane16_swap_b32 v33, v32
    s_nop 1
    v_add_f32 v32, v32, v33
    v_mul_f32 v34, 0xbb000000, v32
    v_pk_add_f32 v[16:17], v[16:17], v[34:35] op_sel_hi:[1,0]
    v_pk_add_f32 v[18:19], v[18:19], v[34:35] op_sel_hi:[1,0]
    v_pk_add_f32 v[20:21], v[20:21], v[34:35] op_sel_hi:[1,0]
    v_pk_add_f32 v[22:23], v[22:23], v[34:35] op_sel_hi:[1,0]
    v_pk_add_f32 v[24:25], v[24:25], v[34:35] op_sel_hi:[1,0]
    v_pk_add_f32 v[26:27], v[26:27], v[34:35] op_sel_hi:[1,0]
    v_pk_add_f32 v[28:29], v[28:29], v[34:35] op_sel_hi:[1,0]
    v_pk_add_f32 v[30:31], v[30:31], v[34:35] op_sel_hi:[1,0]
    v_pk_mul_f32 v[32:33], v[16:17], v[16:17]
    v_pk_mul_f32 v[34:35], v[18:19], v[18:19]
    v_pk_fma_f32 v[32:33], v[20:21], v[20:21], v[32:33]
    v_pk_fma_f32 v[34:35], v[22:23], v[22:23], v[34:35]
    v_pk_fma_f32 v[32:33], v[24:25], v[24:25], v[32:33]
    v_pk_fma_f32 v[34:35], v[26:27], v[26:27], v[34:35]
    v_pk_fma_f32 v[32:33], v[28:29], v[28:29], v[32:33]
    v_pk_fma_f32 v[34:35], v[30:31], v[30:31], v[34:35]
    v_pk_add_f32 v[32:33], v[32:33], v[34:35]
    v_add_f32 v32, v32, v33
    s_nop 1
    v_add_f32 v32, v32, v32 row_ror:8
    s_nop 1
    v_add_f32 v32, v32, v32 row_ror:4
    s_nop 1
    v_add_f32 v32, v32, v32 row_ror:2
    s_nop 1
    v_add_f32 v32, v32, v32 row_ror:1
    v_mov_b32 v33, v32
    s_nop 1
    v_permlane16_swap_b32 v33, v32
    s_nop 1
    v_add_f32 v32, v32, v33
    v_mov_b32 v34, 0x3727c5ac
    v_fmac_f32 v34, 0x3b000000, v32
    v_rsq_f32 v34, v34
    s_nop 0
    v_pk_mul_f32 v[16:17], v[16:17], v[34:35] op_sel_hi:[1,0]
    v_pk_mul_f32 v[18:19], v[18:19], v[34:35] op_sel_hi:[1,0]
    v_pk_mul_f32 v[20:21], v[20:21], v[34:35] op_sel_hi:[1,0]
    v_pk_mul_f32 v[22:23], v[22:23], v[34:35] op_sel_hi:[1,0]
    v_pk_mul_f32 v[24:25], v[24:25], v[34:35] op_sel_hi:[1,0]
    v_pk_mul_f32 v[26:27], v[26:27], v[34:35] op_sel_hi:[1,0]
    v_pk_mul_f32 v[28:29], v[28:29], v[34:35] op_sel_hi:[1,0]
    v_pk_mul_f32 v[30:31], v[30:31], v[34:35] op_sel_hi:[1,0]
    v_cvt_pk_f16_f32 v8, v16, v17
    v_cvt_pk_f16_f32 v9, v18, v19
    v_cvt_pk_f16_f32 v10, v20, v21
    v_cvt_pk_f16_f32 v11, v22, v23
    v_cvt_pk_f16_f32 v12, v24, v25
    v_cvt_pk_f16_f32 v13, v26, v27
    v_cvt_pk_f16_f32 v14, v28, v29
    v_cvt_pk_f16_f32 v15, v30, v31
    v_lshlrev_b32 v7, 7, v4
    v_lshl_add_u32 v7, v3, 4, v7
    ds_write_b128 v7, v[8:11] offset:2048
    ds_write_b128 v7, v[12:15] offset:6144
    v_lshlrev_b32 v7, 4, v0
    v_lshrrev_b32 v6, 3, v0
    v_lshlrev_b32 v6, 8, v6
    v_and_b32 v5, 7, v0
    v_lshl_add_u32 v6, v5, 4, v6
    s_waitcnt lgkmcnt(0)
    s_barrier
    ds_read_b128 v[8:11], v7 offset:2048
    ds_read_b128 v[12:15], v7 offset:6144
    s_waitcnt lgkmcnt(1)
    buffer_store_dwordx4 v[8:11], v6, s[16:19], s25 offen
    s_waitcnt lgkmcnt(0)
    buffer_store_dwordx4 v[12:15], v6, s[16:19], s26 offen
    s_endpgm
k0_mod:
    s_cmp_ge_u32 s2, 192
    s_cbranch_scc1 k0_pf
    s_mul_i32 s25, s2, 0x556
    s_lshr_b32 s25, s25, 16
    s_mul_i32 s26, s25, 48
    s_sub_u32 s26, s2, s26
    v_and_b32 v3, 255, v0
    v_lshrrev_b32 v4, 3, v3
    v_and_b32 v5, 7, v3
    v_mul_u32_u24 v6, 6144, v4
    v_lshl_add_u32 v6, v5, 4, v6
    v_lshlrev_b32 v7, 1, v4
    s_mul_i32 s3, s25, 786432
    s_lshl_b32 s27, s26, 7
    s_add_u32 s3, s3, s27
    s_lshl_b32 s27, s25, 8
    s_waitcnt lgkmcnt(0)
    s_mov_b32 s16, s10
    s_mov_b32 s17, s11
    s_mov_b32 s18, 0x300000
    s_mov_b32 s19, 0x20000
    s_mov_b32 s12, s8
    s_mov_b32 s13, s9
    s_mov_b32 s14, 0x400
    s_mov_b32 s15, 0x20000
    buffer_load_ushort v8, v7, s[12:15], s27 offen offset:0
    buffer_load_ushort v9, v7, s[12:15], s27 offen offset:64
    buffer_load_ushort v10, v7, s[12:15], s27 offen offset:128
    buffer_load_ushort v11, v7, s[12:15], s27 offen offset:192
    buffer_load_dwordx4 v[16:19], v6, s[16:19], s3 offen nt
    s_add_u32 s3, s3, 196608
    buffer_load_dwordx4 v[20:23], v6, s[16:19], s3 offen nt
    s_add_u32 s3, s3, 196608
    buffer_load_dwordx4 v[24:27], v6, s[16:19], s3 offen nt
    s_add_u32 s3, s3, 196608
    buffer_load_dwordx4 v[28:31], v6, s[16:19], s3 offen nt
    s_add_u32 s20, s6, 0x4000
    s_addc_u32 s21, s7, 0
    s_mov_b32 s22, 0xc000
    s_mov_b32 s23, 0x20000
    s_mov_b32 s32, s28
    s_mov_b32 s33, s29
    s_mov_b32 s34, 0x400000
    s_mov_b32 s35, 0x20000
    s_sub_u32 s39, s24, 5
    s_cmp_lt_u32 s39, 1
    s_cselect_b32 s34, s34, 0
    s_cselect_b32 s39, s39, 0
    s_mul_i32 s39, s39, 24
    v_lshrrev_b32 v56, 4, v2
    v_lshlrev_b32 v56, 13, v56
    v_bfe_u32 v57, v2, 1, 3
    v_lshl_add_u32 v56, v57, 10, v56
    v_and_b32 v57, 1, v2
    v_lshl_add_u32 v56, v57, 7, v56
    s_lshr_b32 s37, s2, 3
    s_add_u32 s37, s37, 22
    s_add_u32 s37, s37, s39
    s_lshl_b32 s37, s37, 15
    s_and_b32 s38, s2, 3
    s_lshl_b32 s38, s38, 8
    s_add_u32 s37, s37, s38
    buffer_load_dword v57, v56, s[32:35], s37 offen nt
    s_waitcnt vmcnt(5)
    v_lshlrev_b32 v8, 16, v8
    v_lshlrev_b32 v9, 16, v9
    v_lshlrev_b32 v10, 16, v10
    v_lshlrev_b32 v11, 16, v11
    v_mul_f32 v12, 0xbfb8aa3b, v8
    v_mul_f32 v13, 0xbfb8aa3b, v9
    v_mul_f32 v14, 0xbfb8aa3b, v10
    v_mul_f32 v15, 0xbfb8aa3b, v11
    v_exp_f32 v12, v12
    v_exp_f32 v13, v13
    v_exp_f32 v14, v14
    v_exp_f32 v15, v15
    s_nop 0
    v_add_f32 v12, 1.0, v12
    v_add_f32 v13, 1.0, v13
    v_add_f32 v14, 1.0, v14
    v_add_f32 v15, 1.0, v15
    v_rcp_f32 v12, v12
    v_rcp_f32 v13, v13
    v_rcp_f32 v14, v14
    v_rcp_f32 v15, v15
    s_nop 0
    v_mul_f32 v8, v8, v12
    v_mul_f32 v9, v9, v13
    v_mul_f32 v10, v10, v14
    v_mul_f32 v11, v11, v15
    v_cvt_pk_bf16_f32 v12, v8, v8
    v_cvt_pk_bf16_f32 v13, v9, v9
    v_cvt_pk_bf16_f32 v14, v10, v10
    v_cvt_pk_bf16_f32 v15, v11, v11
    v_and_b32 v48, 0xffff0000, v12
    v_and_b32 v50, 0xffff0000, v13
    v_and_b32 v52, 0xffff0000, v14
    v_and_b32 v54, 0xffff0000, v15
    s_waitcnt vmcnt(4)
    v_lshlrev_b32 v40, 16, v16
    v_and_b32 v41, 0xffff0000, v16
    v_pk_mul_f32 v[32:33], v[40:41], v[48:49] op_sel_hi:[1,0]
    v_lshlrev_b32 v44, 16, v17
    v_and_b32 v45, 0xffff0000, v17
    v_pk_mul_f32 v[34:35], v[44:45], v[48:49] op_sel_hi:[1,0]
    v_lshlrev_b32 v40, 16, v18
    v_and_b32 v41, 0xffff0000, v18
    v_pk_mul_f32 v[36:37], v[40:41], v[48:49] op_sel_hi:[1,0]
    v_lshlrev_b32 v44, 16, v19
    v_and_b32 v45, 0xffff0000, v19
    v_pk_mul_f32 v[38:39], v[44:45], v[48:49] op_sel_hi:[1,0]
    s_waitcnt vmcnt(3)
    v_lshlrev_b32 v40, 16, v20
    v_and_b32 v41, 0xffff0000, v20
    v_pk_fma_f32 v[32:33], v[40:41], v[50:51], v[32:33] op_sel_hi:[1,0,1]
    v_lshlrev_b32 v44, 16, v21
    v_and_b32 v45, 0xffff0000, v21
    v_pk_fma_f32 v[34:35], v[44:45], v[50:51], v[34:35] op_sel_hi:[1,0,1]
    v_lshlrev_b32 v40, 16, v22
    v_and_b32 v41, 0xffff0000, v22
    v_pk_fma_f32 v[36:37], v[40:41], v[50:51], v[36:37] op_sel_hi:[1,0,1]
    v_lshlrev_b32 v44, 16, v23
    v_and_b32 v45, 0xffff0000, v23
    v_pk_fma_f32 v[38:39], v[44:45], v[50:51], v[38:39] op_sel_hi:[1,0,1]
    s_waitcnt vmcnt(2)
    v_lshlrev_b32 v40, 16, v24
    v_and_b32 v41, 0xffff0000, v24
    v_pk_fma_f32 v[32:33], v[40:41], v[52:53], v[32:33] op_sel_hi:[1,0,1]
    v_lshlrev_b32 v44, 16, v25
    v_and_b32 v45, 0xffff0000, v25
    v_pk_fma_f32 v[34:35], v[44:45], v[52:53], v[34:35] op_sel_hi:[1,0,1]
    v_lshlrev_b32 v40, 16, v26
    v_and_b32 v41, 0xffff0000, v26
    v_pk_fma_f32 v[36:37], v[40:41], v[52:53], v[36:37] op_sel_hi:[1,0,1]
    v_lshlrev_b32 v44, 16, v27
    v_and_b32 v45, 0xffff0000, v27
    v_pk_fma_f32 v[38:39], v[44:45], v[52:53], v[38:39] op_sel_hi:[1,0,1]
    s_waitcnt vmcnt(1)
    v_lshlrev_b32 v40, 16, v28
    v_and_b32 v41, 0xffff0000, v28
    v_pk_fma_f32 v[32:33], v[40:41], v[54:55], v[32:33] op_sel_hi:[1,0,1]
    v_lshlrev_b32 v44, 16, v29
    v_and_b32 v45, 0xffff0000, v29
    v_pk_fma_f32 v[34:35], v[44:45], v[54:55], v[34:35] op_sel_hi:[1,0,1]
    v_lshlrev_b32 v40, 16, v30
    v_and_b32 v41, 0xffff0000, v30
    v_pk_fma_f32 v[36:37], v[40:41], v[54:55], v[36:37] op_sel_hi:[1,0,1]
    v_lshlrev_b32 v44, 16, v31
    v_and_b32 v45, 0xffff0000, v31
    v_pk_fma_f32 v[38:39], v[44:45], v[54:55], v[38:39] op_sel_hi:[1,0,1]
    s_nop 1
    v_add_f32 v32, v32, v32 row_ror:8
    v_add_f32 v33, v33, v33 row_ror:8
    v_add_f32 v34, v34, v34 row_ror:8
    v_add_f32 v35, v35, v35 row_ror:8
    v_add_f32 v36, v36, v36 row_ror:8
    v_add_f32 v37, v37, v37 row_ror:8
    v_add_f32 v38, v38, v38 row_ror:8
    v_add_f32 v39, v39, v39 row_ror:8
    s_nop 1
    v_permlane16_swap_b32 v32, v36
    v_permlane16_swap_b32 v33, v37
    v_permlane16_swap_b32 v34, v38
    v_permlane16_swap_b32 v35, v39
    s_nop 1
    v_add_f32 v32, v32, v36
    v_add_f32 v33, v33, v37
    v_add_f32 v34, v34, v38
    v_add_f32 v35, v35, v39
    s_nop 1
    v_permlane32_swap_b32 v32, v34
    v_permlane32_swap_b32 v33, v35
    s_nop 1
    v_add_f32 v32, v32, v34
    v_add_f32 v33, v33, v35
    v_lshlrev_b32 v8, 5, v5
    v_and_b32 v9, 16, v2
    v_add_u32 v8, v8, v9
    v_lshrrev_b32 v9, 2, v2
    v_and_b32 v9, 8, v9
    v_add_u32 v8, v8, v9
    v_and_b32 v9, 3, v1
    v_lshl_add_u32 v8, v9, 8, v8
    ds_write_b64 v8, v[32:33]
    s_waitcnt lgkmcnt(0)
    s_barrier
    s_cmp_lg_u32 s24, 4
    s_cbranch_scc1 k0_end
    v_lshlrev_b32 v8, 2, v2
    ds_read_b32 v16, v8 offset:0
    ds_read_b32 v17, v8 offset:256
    ds_read_b32 v18, v8 offset:512
    ds_read_b32 v19, v8 offset:768
    s_mul_i32 s3, s25, 12288
    s_lshl_b32 s27, s26, 8
    s_add_u32 s3, s3, s27
    s_waitcnt lgkmcnt(0)
    v_add_f32 v16, v16, v17
    v_add_f32 v18, v18, v19
    v_add_f32 v16, v16, v18
    buffer_store_dword v16, v8, s[20:23], s3 offen
    s_endpgm
k0_pf:
    s_bfe_u32 s38, s2, 0x30003
    s_lshl_b32 s38, s38, 2
    s_and_b32 s37, s24, 3
    s_add_u32 s37, s37, s38
    s_waitcnt lgkmcnt(0)
    s_cmp_ge_u32 s37, 10
    s_cbranch_scc1 k0_pfw
    s_getpc_b64 s[40:41]
k0_prep_kernel_pc_1:
    s_add_u32 s40, s40, k1_attn_kernel-k0_prep_kernel_pc_1
    s_addc_u32 s41, s41, 0
    v_and_b32 v4, 63, v0
    v_lshlrev_b32 v4, 7, v4
    s_lshl_b32 s42, s37, 13
    v_add_u32 v4, s42, v4
    v_min_u32 v4, code_end_marker-k1_attn_kernel-4, v4
    v_mov_b32 v5, s41
    v_add_co_u32 v4, vcc, s40, v4
    s_nop 1
    v_addc_co_u32 v5, vcc, 0, v5, vcc
    global_load_dword v6, v[4:5], off
    s_endpgm
k0_pfw:
    s_mov_b32 s32, s28
    s_mov_b32 s33, s29
    s_mov_b32 s34, 0x400000
    s_mov_b32 s35, 0x20000
    v_lshrrev_b32 v4, 4, v2
    v_lshlrev_b32 v4, 13, v4
    v_bfe_u32 v5, v2, 1, 3
    v_lshl_add_u32 v4, v5, 10, v4
    v_and_b32 v5, 1, v2
    v_lshl_add_u32 v4, v5, 7, v4
    s_sub_u32 s37, s37, 10
    s_lshl_b32 s37, s37, 15
    s_and_b32 s38, s2, 3
    s_lshl_b32 s38, s38, 8
    s_add_u32 s37, s37, s38
    buffer_load_dword v6, v4, s[32:35], s37 offen nt
k0_fin:
k0_end:
    s_endpgm
.globl k1_attn_kernel
.p2align 8
.type k1_attn_kernel,@function
k1_attn_kernel:
    s_cmp_ge_u32 s2, 256
    s_cbranch_scc1 k1_end
    s_load_dwordx2 s[52:53], s[0:1], 24
    s_load_dwordx2 s[54:55], s[0:1], 104
    v_lshrrev_b32 v1, 6, v0
    v_and_b32 v2, 63, v0
    v_readfirstlane_b32 s45, v1
    s_and_b32 s4, s2, 3
    s_bfe_u32 s5, s2, 196611
    s_lshl_b32 s5, s5, 2
    s_add_u32 s4, s4, s5
    s_bfe_u32 s5, s2, 65538
    s_lshl_b32 s5, s5, 2
    s_lshr_b32 s6, s2, 6
    s_add_u32 s5, s5, s6
    s_lshl_b32 s32, s45, 12
    s_mov_b32 s44, 0
    s_and_b32 s100, s45, 1
    s_lshl_b32 s100, s100, 1
    s_lshr_b32 s6, s45, 1
    s_add_u32 s100, s100, s6
    s_lshl_b32 s6, s5, 3
    s_add_u32 s100, s100, s6
    s_bfe_u32 s101, s2, 0x10005
    s_lshl_b32 s101, s101, 17
    v_lshrrev_b32 v3, 4, v2
    v_and_b32 v4, 15, v2
    v_lshrrev_b32 v5, 2, v4
    v_and_b32 v6, 3, v2
    v_lshlrev_b32 v26, 4, v2
    v_lshlrev_b32 v7, 2, v3
    v_xor_b32 v7, v7, v4
    v_lshlrev_b32 v7, 4, v7
    v_lshl_add_u32 v124, v1, 2, v3
    v_lshl_add_u32 v124, v124, 13, v7
    s_lshl_b32 s62, s45, 10
    s_waitcnt lgkmcnt(0)
    s_load_dwordx4 s[48:51], s[0:1], 8
    s_load_dwordx2 s[46:47], s[0:1], 32
    s_load_dwordx4 s[56:59], s[0:1], 48
    s_load_dwordx2 s[60:61], s[0:1], 64
    s_load_dwordx2 s[98:99], s[0:1], 88
    s_load_dwordx2 s[0:1], s[0:1], 0
    s_lshl_b32 s6, s4, 8
    s_add_u32 s16, s52, s6
    s_addc_u32 s17, s53, 0
    s_sub_u32 s18, 4194304, s6
    s_mov_b32 s19, 0x20000
    s_add_u32 s24, s54, 0x4000
    s_addc_u32 s25, s55, 0
    s_mov_b32 s26, 0xc000
    s_mov_b32 s27, 0x20000
    s_lshl_b32 s7, s100, 15
    s_add_u32 s7, s7, 0x10000
    s_add_u32 s20, s54, s7
    s_addc_u32 s21, s55, 0
    s_mov_b32 s22, 163840
    s_mov_b32 s23, 0x20000
    v_lshlrev_b32 v31, 4, v0
    s_mov_b32 s36, 0
    buffer_load_dwordx4 v[96:99], v31, s[24:27], s36 offen
    s_mov_b32 s37, 12288
    buffer_load_dwordx4 v[100:103], v31, s[24:27], s37 offen
    s_mov_b32 s38, 24576
    buffer_load_dwordx4 v[104:107], v31, s[24:27], s38 offen
    s_mov_b32 s39, 36864
    buffer_load_dwordx4 v[108:111], v31, s[24:27], s39 offen
    s_add_u32 m0, s62, 16384
    s_mov_b32 s36, 0
    buffer_load_dwordx4 v124, s[16:19], s36 offen nt lds
    s_add_u32 m0, s62, 20480
    s_mov_b32 s37, 131072
    buffer_load_dwordx4 v124, s[16:19], s37 offen nt lds
    s_xor_b32 s40, s101, 0
    buffer_load_dwordx4 v[128:131], v26, s[20:23], s40 offen offset:0
    s_xor_b32 s41, s101, 16384
    buffer_load_dwordx4 v[132:135], v26, s[20:23], s41 offen offset:0
    s_xor_b32 s42, s101, 131072
    buffer_load_dwordx4 v[136:139], v26, s[20:23], s42 offen offset:0
    s_xor_b32 s43, s101, 147456
    buffer_load_dwordx4 v[140:143], v26, s[20:23], s43 offen offset:0
    v_lshl_add_u32 v7, v3, 3, v5
    v_lshlrev_b32 v7, 8, v7
    v_lshl_add_u32 v7, v6, 4, v7
    v_xor_b32 v27, 0, v5
    v_lshl_add_u32 v112, v27, 6, v7
    v_add_u32 v116, 0x10000, v112
    v_add_u32 v120, 0x20000, v112
    v_xor_b32 v27, 1, v5
    v_lshl_add_u32 v113, v27, 6, v7
    v_add_u32 v117, 0x10000, v113
    v_add_u32 v121, 0x20000, v113
    v_xor_b32 v27, 2, v5
    v_lshl_add_u32 v114, v27, 6, v7
    v_add_u32 v118, 0x10000, v114
    v_add_u32 v122, 0x20000, v114
    v_xor_b32 v27, 3, v5
    v_lshl_add_u32 v115, v27, 6, v7
    v_add_u32 v119, 0x10000, v115
    v_add_u32 v123, 0x20000, v115
    v_lshlrev_b32 v125, 5, v3
    v_add_u32 v125, 147456, v125
    v_or_b32 v27, 0, v3
    v_xor_b32 v27, v27, v4
    v_lshlrev_b32 v27, 4, v27
    v_lshl_add_u32 v8, v4, 8, v27
    v_or_b32 v27, 4, v3
    v_xor_b32 v27, v27, v4
    v_lshlrev_b32 v27, 4, v27
    v_lshl_add_u32 v9, v4, 8, v27
    v_or_b32 v27, 8, v3
    v_xor_b32 v27, v27, v4
    v_lshlrev_b32 v27, 4, v27
    v_lshl_add_u32 v10, v4, 8, v27
    v_or_b32 v27, 12, v3
    v_xor_b32 v27, v27, v4
    v_lshlrev_b32 v27, 4, v27
    v_lshl_add_u32 v11, v4, 8, v27
    v_lshl_add_u32 v7, v3, 2, v5
    v_and_b32 v27, 7, v7
    v_lshlrev_b32 v7, 8, v7
    v_lshl_add_u32 v7, v6, 3, v7
    v_add_u32 v7, 65536, v7
    v_xor_b32 v30, 0, v27
    v_lshl_add_u32 v12, v30, 5, v7
    v_xor_b32 v30, 1, v27
    v_lshl_add_u32 v13, v30, 5, v7
    v_xor_b32 v30, 2, v27
    v_lshl_add_u32 v14, v30, 5, v7
    v_xor_b32 v30, 3, v27
    v_lshl_add_u32 v15, v30, 5, v7
    v_xor_b32 v30, 4, v27
    v_lshl_add_u32 v16, v30, 5, v7
    v_xor_b32 v30, 5, v27
    v_lshl_add_u32 v17, v30, 5, v7
    v_xor_b32 v30, 6, v27
    v_lshl_add_u32 v18, v30, 5, v7
    v_xor_b32 v30, 7, v27
    v_lshl_add_u32 v19, v30, 5, v7
    v_lshlrev_b32 v7, 8, v3
    v_lshl_add_u32 v7, v1, 12, v7
    v_or_b32 v27, 0, v3
    v_xor_b32 v27, v27, v4
    v_lshl_add_u32 v20, v27, 4, v7
    v_or_b32 v27, 4, v3
    v_xor_b32 v27, v27, v4
    v_lshl_add_u32 v21, v27, 4, v7
    v_or_b32 v27, 8, v3
    v_xor_b32 v27, v27, v4
    v_lshl_add_u32 v22, v27, 4, v7
    v_or_b32 v27, 12, v3
    v_xor_b32 v27, v27, v4
    v_lshl_add_u32 v23, v27, 4, v7
    v_or_b32 v27, 0, v3
    v_lshlrev_b32 v27, 1, v27
    v_xor_b32 v27, v27, v4
    v_lshl_add_u32 v24, v27, 4, v7
    v_or_b32 v27, 4, v3
    v_lshlrev_b32 v27, 1, v27
    v_xor_b32 v27, v27, v4
    v_lshl_add_u32 v25, v27, 4, v7
    v_mov_b32 v27, 0x3f803f80
    v_accvgpr_write_b32 a240, v27
    v_accvgpr_write_b32 a241, v27
    v_accvgpr_write_b32 a242, v27
    v_accvgpr_write_b32 a243, v27
    s_waitcnt lgkmcnt(0)
    s_lshl_b32 s6, s4, 19
    s_add_u32 s8, s48, s6
    s_addc_u32 s9, s49, 0
    s_mov_b32 s10, 0x80000
    s_mov_b32 s11, 0x20000
    s_add_u32 s12, s50, s6
    s_addc_u32 s13, s51, 0
    s_mov_b32 s14, 0x80000
    s_mov_b32 s15, 0x20000
    s_lshl_b32 s6, s100, 18
    s_lshl_b32 s7, s4, 12
    s_add_u32 s6, s6, s7
    s_add_u32 s6, s6, 0x800000
    s_add_u32 s28, s54, s6
    s_addc_u32 s29, s55, 0
    s_mov_b32 s30, 1183744
    s_mov_b32 s31, 0x20000
    s_cmp_ge_u32 s45, 2
    s_cselect_b32 s6, 1.0, 0
    v_add_u32 v31, 147456, v31
    s_waitcnt vmcnt(6)
    v_pk_add_f32 v[96:97], v[96:97], v[100:101]
    v_pk_add_f32 v[104:105], v[104:105], v[108:109]
    v_pk_add_f32 v[98:99], v[98:99], v[102:103]
    v_pk_add_f32 v[106:107], v[106:107], v[110:111]
    v_pk_add_f32 v[96:97], v[96:97], v[104:105]
    v_pk_add_f32 v[98:99], v[98:99], v[106:107]
    v_cvt_pk_bf16_f32 v100, v96, v97
    v_cvt_pk_bf16_f32 v101, v98, v99
    v_lshlrev_b32 v96, 16, v100
    v_and_b32 v97, 0xffff0000, v100
    v_lshlrev_b32 v98, 16, v101
    v_and_b32 v99, 0xffff0000, v101
    v_add_f32 v96, s6, v96
    v_add_f32 v97, s6, v97
    v_add_f32 v98, s6, v98
    v_add_f32 v99, s6, v99
    v_cvt_pk_bf16_f32 v100, v96, v97
    v_cvt_pk_bf16_f32 v101, v98, v99
    v_lshlrev_b32 v96, 16, v100
    v_and_b32 v97, 0xffff0000, v100
    v_lshlrev_b32 v98, 16, v101
    v_and_b32 v99, 0xffff0000, v101
    v_mul_f32 v96, 0x3e0293ee, v96
    v_mul_f32 v97, 0x3e0293ee, v97
    v_mul_f32 v98, 0x3e0293ee, v98
    v_mul_f32 v99, 0x3e0293ee, v99
    ds_write_b128 v31, v[96:99]
    s_xor_b32 s40, s101, 0
    buffer_load_dwordx4 v[144:147], v26, s[20:23], s40 offen offset:1024
    s_xor_b32 s41, s101, 16384
    buffer_load_dwordx4 v[148:151], v26, s[20:23], s41 offen offset:1024
    s_xor_b32 s42, s101, 131072
    buffer_load_dwordx4 v[152:155], v26, s[20:23], s42 offen offset:1024
    s_xor_b32 s43, s101, 147456
    buffer_load_dwordx4 v[156:159], v26, s[20:23], s43 offen offset:1024
    s_add_u32 m0, s62, 24576
    s_mov_b32 s36, 262144
    buffer_load_dwordx4 v124, s[16:19], s36 offen nt lds
    s_add_u32 m0, s62, 28672
    s_mov_b32 s37, 393216
    buffer_load_dwordx4 v124, s[16:19], s37 offen nt lds
    s_waitcnt vmcnt(10) lgkmcnt(0)
    s_barrier
    ds_read_b128 v[64:67], v125 offset:0
    ds_read_b128 v[68:71], v125 offset:16
    ds_read_b128 v[72:75], v125 offset:2048
    ds_read_b128 v[76:79], v125 offset:2064
    ds_read_b128 v[80:83], v125 offset:128
    ds_read_b128 v[84:87], v125 offset:144
    ds_read_b128 v[88:91], v125 offset:2176
    ds_read_b128 v[92:95], v125 offset:2192
    ds_read_b64_tr_b16 a[128:129], v112 offset:16384
    ds_read_b64_tr_b16 a[130:131], v112 offset:17408
    ds_read_b64_tr_b16 a[132:133], v112 offset:16392
    ds_read_b64_tr_b16 a[134:135], v112 offset:17416
    ds_read_b64_tr_b16 a[136:137], v113 offset:16384
    ds_read_b64_tr_b16 a[138:139], v113 offset:17408
    ds_read_b64_tr_b16 a[140:141], v113 offset:16392
    ds_read_b64_tr_b16 a[142:143], v113 offset:17416
    ds_read_b64_tr_b16 a[144:145], v114 offset:16384
    ds_read_b64_tr_b16 a[146:147], v114 offset:17408
    ds_read_b64_tr_b16 a[148:149], v114 offset:16392
    ds_read_b64_tr_b16 a[150:151], v114 offset:17416
    ds_read_b64_tr_b16 a[152:153], v115 offset:16384
    ds_read_b64_tr_b16 a[154:155], v115 offset:17408
    ds_read_b64_tr_b16 a[156:157], v115 offset:16392
    ds_read_b64_tr_b16 a[158:159], v115 offset:17416
    s_waitcnt lgkmcnt(15)
    s_waitcnt vmcnt(9)
    s_xor_b32 s40, s101, 0
    buffer_load_dwordx4 v[160:163], v26, s[20:23], s40 offen offset:2048
    v_fma_mix_f32 v96, v128, v72, v64 op_sel:[0,0,0] op_sel_hi:[1,0,0]
    v_fma_mix_f32 v97, v128, v73, v65 op_sel:[1,0,0] op_sel_hi:[1,0,0]
    v_fma_mix_f32 v98, v129, v74, v66 op_sel:[0,0,0] op_sel_hi:[1,0,0]
    v_fma_mix_f32 v99, v129, v75, v67 op_sel:[1,0,0] op_sel_hi:[1,0,0]
    v_fma_mix_f32 v100, v130, v76, v68 op_sel:[0,0,0] op_sel_hi:[1,0,0]
    v_fma_mix_f32 v101, v130, v77, v69 op_sel:[1,0,0] op_sel_hi:[1,0,0]
    s_xor_b32 s41, s101, 16384
    buffer_load_dwordx4 v[164:167], v26, s[20:23], s41 offen offset:2048
    v_fma_mix_f32 v102, v131, v78, v70 op_sel:[0,0,0] op_sel_hi:[1,0,0]
    v_fma_mix_f32 v103, v131, v79, v71 op_sel:[1,0,0] op_sel_hi:[1,0,0]
    v_cvt_pk_bf16_f32 v32, v96, v97
    v_cvt_pk_bf16_f32 v33, v98, v99
    v_cvt_pk_bf16_f32 v34, v100, v101
    v_cvt_pk_bf16_f32 v35, v102, v103
    s_waitcnt vmcnt(10)
    s_xor_b32 s42, s101, 131072
    buffer_load_dwordx4 v[168:171], v26, s[20:23], s42 offen offset:2048
    v_fma_mix_f32 v104, v132, v72, v64 op_sel:[0,0,0] op_sel_hi:[1,0,0]
    v_fma_mix_f32 v105, v132, v73, v65 op_sel:[1,0,0] op_sel_hi:[1,0,0]
    v_fma_mix_f32 v106, v133, v74, v66 op_sel:[0,0,0] op_sel_hi:[1,0,0]
    v_fma_mix_f32 v107, v133, v75, v67 op_sel:[1,0,0] op_sel_hi:[1,0,0]
    v_fma_mix_f32 v108, v134, v76, v68 op_sel:[0,0,0] op_sel_hi:[1,0,0]
    v_fma_mix_f32 v109, v134, v77, v69 op_sel:[1,0,0] op_sel_hi:[1,0,0]
    s_xor_b32 s43, s101, 147456
    buffer_load_dwordx4 v[172:175], v26, s[20:23], s43 offen offset:2048
    v_fma_mix_f32 v110, v135, v78, v70 op_sel:[0,0,0] op_sel_hi:[1,0,0]
    v_fma_mix_f32 v111, v135, v79, v71 op_sel:[1,0,0] op_sel_hi:[1,0,0]
    v_cvt_pk_bf16_f32 v36, v104, v105
    v_cvt_pk_bf16_f32 v37, v106, v107
    v_cvt_pk_bf16_f32 v38, v108, v109
    v_cvt_pk_bf16_f32 v39, v110, v111
    s_waitcnt vmcnt(11)
    s_add_u32 m0, s62, 65536
    s_mov_b32 s36, 524288
    buffer_load_dwordx4 v124, s[16:19], s36 offen nt lds
    v_fma_mix_f32 v96, v136, v72, v64 op_sel:[0,0,0] op_sel_hi:[1,0,0]
    v_fma_mix_f32 v97, v136, v73, v65 op_sel:[1,0,0] op_sel_hi:[1,0,0]
    v_fma_mix_f32 v98, v137, v74, v66 op_sel:[0,0,0] op_sel_hi:[1,0,0]
    v_fma_mix_f32 v99, v137, v75, v67 op_sel:[1,0,0] op_sel_hi:[1,0,0]
    v_fma_mix_f32 v100, v138, v76, v68 op_sel:[0,0,0] op_sel_hi:[1,0,0]
    v_fma_mix_f32 v101, v138, v77, v69 op_sel:[1,0,0] op_sel_hi:[1,0,0]
    s_add_u32 m0, s62, 69632
    s_mov_b32 s37, 655360
    buffer_load_dwordx4 v124, s[16:19], s37 offen nt lds
    v_fma_mix_f32 v102, v139, v78, v70 op_sel:[0,0,0] op_sel_hi:[1,0,0]
    v_fma_mix_f32 v103, v139, v79, v71 op_sel:[1,0,0] op_sel_hi:[1,0,0]
    v_cvt_pk_bf16_f32 v40, v96, v97
    v_cvt_pk_bf16_f32 v41, v98, v99
    v_cvt_pk_bf16_f32 v42, v100, v101
    v_cvt_pk_bf16_f32 v43, v102, v103
    s_waitcnt vmcnt(12)
    s_xor_b32 s40, s101, 0
    buffer_load_dwordx4 v[176:179], v26, s[20:23], s40 offen offset:3072
    v_fma_mix_f32 v104, v140, v72, v64 op_sel:[0,0,0] op_sel_hi:[1,0,0]
    v_fma_mix_f32 v105, v140, v73, v65 op_sel:[1,0,0] op_sel_hi:[1,0,0]
    v_fma_mix_f32 v106, v141, v74, v66 op_sel:[0,0,0] op_sel_hi:[1,0,0]
    v_fma_mix_f32 v107, v141, v75, v67 op_sel:[1,0,0] op_sel_hi:[1,0,0]
    v_fma_mix_f32 v108, v142, v76, v68 op_sel:[0,0,0] op_sel_hi:[1,0,0]
    v_fma_mix_f32 v109, v142, v77, v69 op_sel:[1,0,0] op_sel_hi:[1,0,0]
    s_xor_b32 s41, s101, 16384
    buffer_load_dwordx4 v[180:183], v26, s[20:23], s41 offen offset:3072
    v_fma_mix_f32 v110, v143, v78, v70 op_sel:[0,0,0] op_sel_hi:[1,0,0]
    v_fma_mix_f32 v111, v143, v79, v71 op_sel:[1,0,0] op_sel_hi:[1,0,0]
    v_cvt_pk_bf16_f32 v44, v104, v105
    v_cvt_pk_bf16_f32 v45, v106, v107
    v_cvt_pk_bf16_f32 v46, v108, v109
    v_cvt_pk_bf16_f32 v47, v110, v111
    s_waitcnt lgkmcnt(8)
    v_mfma_f32_16x16x32_bf16 v[192:195], a[128:131], v[32:35], 0
    s_waitcnt vmcnt(8)
    s_barrier
    v_mfma_f32_16x16x32_bf16 v[224:227], a[128:131], v[36:39], 0
    ds_read_b128 v[64:67], v125 offset:256
    v_fma_mix_f32 v96, v144, v88, v80 op_sel:[0,0,0] op_sel_hi:[1,0,0]
    v_fma_mix_f32 v97, v144, v89, v81 op_sel:[1,0,0] op_sel_hi:[1,0,0]
    v_mfma_f32_16x16x32_bf16 a[0:3], a[128:131], v[40:43], 0
    s_xor_b32 s42, s101, 131072
    buffer_load_dwordx4 v[184:187], v26, s[20:23], s42 offen offset:3072
    v_fma_mix_f32 v98, v145, v90, v82 op_sel:[0,0,0] op_sel_hi:[1,0,0]
    v_mfma_f32_16x16x32_bf16 a[32:35], a[128:131], v[44:47], 0
    ds_read_b128 v[68:71], v125 offset:272
    v_fma_mix_f32 v99, v145, v91, v83 op_sel:[1,0,0] op_sel_hi:[1,0,0]
    v_mfma_f32_16x16x32_bf16 a[36:39], a[132:135], v[44:47], 0
    ds_read_b128 v[72:75], v125 offset:2304
    v_fma_mix_f32 v100, v146, v92, v84 op_sel:[0,0,0] op_sel_hi:[1,0,0]
    v_fma_mix_f32 v101, v146, v93, v85 op_sel:[1,0,0] op_sel_hi:[1,0,0]
    v_mfma_f32_16x16x32_bf16 a[4:7], a[132:135], v[40:43], 0
    ds_read_b128 v[76:79], v125 offset:2320
    v_fma_mix_f32 v102, v147, v94, v86 op_sel:[0,0,0] op_sel_hi:[1,0,0]
    v_fma_mix_f32 v103, v147, v95, v87 op_sel:[1,0,0] op_sel_hi:[1,0,0]
    v_mfma_f32_16x16x32_bf16 v[228:231], a[132:135], v[36:39], 0
    s_xor_b32 s43, s101, 147456
    buffer_load_dwordx4 v[188:191], v26, s[20:23], s43 offen offset:3072
    v_cvt_pk_bf16_f32 v48, v96, v97
    v_mfma_f32_16x16x32_bf16 v[196:199], a[132:135], v[32:35], 0
    ds_read_b64_tr_b16 a[160:161], v112 offset:24576
    v_cvt_pk_bf16_f32 v49, v98, v99
    v_cvt_pk_bf16_f32 v50, v100, v101
    v_mfma_f32_16x16x32_bf16 v[200:203], a[136:139], v[32:35], 0
    ds_read_b64_tr_b16 a[162:163], v112 offset:25600
    v_cvt_pk_bf16_f32 v51, v102, v103
    v_mfma_f32_16x16x32_bf16 v[232:235], a[136:139], v[36:39], 0
    ds_read_b64_tr_b16 a[164:165], v112 offset:24584
    v_fma_mix_f32 v104, v148, v88, v80 op_sel:[0,0,0] op_sel_hi:[1,0,0]
    v_fma_mix_f32 v105, v148, v89, v81 op_sel:[1,0,0] op_sel_hi:[1,0,0]
    v_mfma_f32_16x16x32_bf16 a[8:11], a[136:139], v[40:43], 0
    s_add_u32 m0, s62, 73728
    s_mov_b32 s36, 786432
    buffer_load_dwordx4 v124, s[16:19], s36 offen nt lds
    v_fma_mix_f32 v106, v149, v90, v82 op_sel:[0,0,0] op_sel_hi:[1,0,0]
    v_mfma_f32_16x16x32_bf16 a[40:43], a[136:139], v[44:47], 0
    ds_read_b64_tr_b16 a[166:167], v112 offset:25608
    v_fma_mix_f32 v107, v149, v91, v83 op_sel:[1,0,0] op_sel_hi:[1,0,0]
    v_fma_mix_f32 v108, v150, v92, v84 op_sel:[0,0,0] op_sel_hi:[1,0,0]
    v_mfma_f32_16x16x32_bf16 a[44:47], a[140:143], v[44:47], 0
    s_waitcnt lgkmcnt(8)
    ds_read_b64_tr_b16 a[168:169], v113 offset:24576
    v_fma_mix_f32 v109, v150, v93, v85 op_sel:[1,0,0] op_sel_hi:[1,0,0]
    v_fma_mix_f32 v110, v151, v94, v86 op_sel:[0,0,0] op_sel_hi:[1,0,0]
    v_mfma_f32_16x16x32_bf16 a[12:15], a[140:143], v[40:43], 0
    ds_read_b64_tr_b16 a[170:171], v113 offset:25600
    v_fma_mix_f32 v111, v151, v95, v87 op_sel:[1,0,0] op_sel_hi:[1,0,0]
    v_mfma_f32_16x16x32_bf16 v[236:239], a[140:143], v[36:39], 0
    s_add_u32 m0, s62, 77824
    s_mov_b32 s37, 917504
    buffer_load_dwordx4 v124, s[16:19], s37 offen nt lds
    v_cvt_pk_bf16_f32 v52, v104, v105
    v_mfma_f32_16x16x32_bf16 v[204:207], a[140:143], v[32:35], 0
    ds_read_b64_tr_b16 a[172:173], v113 offset:24584
    v_cvt_pk_bf16_f32 v53, v106, v107
    v_cvt_pk_bf16_f32 v54, v108, v109
    v_mfma_f32_16x16x32_bf16 v[208:211], a[144:147], v[32:35], 0
    ds_read_b64_tr_b16 a[174:175], v113 offset:25608
    v_cvt_pk_bf16_f32 v55, v110, v111
    v_fma_mix_f32 v96, v152, v88, v80 op_sel:[0,0,0] op_sel_hi:[1,0,0]
    v_mfma_f32_16x16x32_bf16 v[240:243], a[144:147], v[36:39], 0
    ds_read_b64_tr_b16 a[176:177], v114 offset:24576
    v_fma_mix_f32 v97, v152, v89, v81 op_sel:[1,0,0] op_sel_hi:[1,0,0]
    v_fma_mix_f32 v98, v153, v90, v82 op_sel:[0,0,0] op_sel_hi:[1,0,0]
    v_mfma_f32_16x16x32_bf16 a[16:19], a[144:147], v[40:43], 0
    s_xor_b32 s40, s101, 4096
    buffer_load_dwordx4 v[128:131], v26, s[20:23], s40 offen offset:0
    v_mfma_f32_16x16x32_bf16 a[48:51], a[144:147], v[44:47], 0
    ds_read_b64_tr_b16 a[178:179], v114 offset:25600
    v_fma_mix_f32 v99, v153, v91, v83 op_sel:[1,0,0] op_sel_hi:[1,0,0]
    v_fma_mix_f32 v100, v154, v92, v84 op_sel:[0,0,0] op_sel_hi:[1,0,0]
    v_mfma_f32_16x16x32_bf16 a[52:55], a[148:151], v[44:47], 0
    ds_read_b64_tr_b16 a[180:181], v114 offset:24584
    v_fma_mix_f32 v101, v154, v93, v85 op_sel:[1,0,0] op_sel_hi:[1,0,0]
    v_fma_mix_f32 v102, v155, v94, v86 op_sel:[0,0,0] op_sel_hi:[1,0,0]
    v_mfma_f32_16x16x32_bf16 a[20:23], a[148:151], v[40:43], 0
    ds_read_b64_tr_b16 a[182:183], v114 offset:25608
    v_fma_mix_f32 v103, v155, v95, v87 op_sel:[1,0,0] op_sel_hi:[1,0,0]
    v_cvt_pk_bf16_f32 v56, v96, v97
    v_mfma_f32_16x16x32_bf16 v[244:247], a[148:151], v[36:39], 0
    s_xor_b32 s41, s101, 20480
    buffer_load_dwordx4 v[132:135], v26, s[20:23], s41 offen offset:0
    v_cvt_pk_bf16_f32 v57, v98, v99
    v_mfma_f32_16x16x32_bf16 v[212:215], a[148:151], v[32:35], 0
    ds_read_b64_tr_b16 a[184:185], v115 offset:24576
    v_cvt_pk_bf16_f32 v58, v100, v101
    v_mfma_f32_16x16x32_bf16 v[216:219], a[152:155], v[32:35], 0
    ds_read_b64_tr_b16 a[186:187], v115 offset:25600
    v_cvt_pk_bf16_f32 v59, v102, v103
    v_fma_mix_f32 v104, v156, v88, v80 op_sel:[0,0,0] op_sel_hi:[1,0,0]
    v_mfma_f32_16x16x32_bf16 v[248:251], a[152:155], v[36:39], 0
    ds_read_b64_tr_b16 a[188:189], v115 offset:24584
    v_fma_mix_f32 v105, v156, v89, v81 op_sel:[1,0,0] op_sel_hi:[1,0,0]
    v_fma_mix_f32 v106, v157, v90, v82 op_sel:[0,0,0] op_sel_hi:[1,0,0]
    v_mfma_f32_16x16x32_bf16 a[24:27], a[152:155], v[40:43], 0
    s_xor_b32 s42, s101, 135168
    buffer_load_dwordx4 v[136:139], v26, s[20:23], s42 offen offset:0
    v_fma_mix_f32 v107, v157, v91, v83 op_sel:[1,0,0] op_sel_hi:[1,0,0]
    v_mfma_f32_16x16x32_bf16 a[56:59], a[152:155], v[44:47], 0
    ds_read_b64_tr_b16 a[190:191], v115 offset:25608
    v_fma_mix_f32 v108, v158, v92, v84 op_sel:[0,0,0] op_sel_hi:[1,0,0]
    v_fma_mix_f32 v109, v158, v93, v85 op_sel:[1,0,0] op_sel_hi:[1,0,0]
    v_mfma_f32_16x16x32_bf16 a[60:63], a[156:159], v[44:47], 0
    v_fma_mix_f32 v110, v159, v94, v86 op_sel:[0,0,0] op_sel_hi:[1,0,0]
    v_fma_mix_f32 v111, v159, v95, v87 op_sel:[1,0,0] op_sel_hi:[1,0,0]
    v_mfma_f32_16x16x32_bf16 a[28:31], a[156:159], v[40:43], 0
    v_cvt_pk_bf16_f32 v60, v104, v105
    v_cvt_pk_bf16_f32 v61, v106, v107
    v_cvt_pk_bf16_f32 v62, v108, v109
    v_mfma_f32_16x16x32_bf16 v[252:255], a[156:159], v[36:39], 0
    s_xor_b32 s43, s101, 151552
    buffer_load_dwordx4 v[140:143], v26, s[20:23], s43 offen offset:0
    v_cvt_pk_bf16_f32 v63, v110, v111
    v_mfma_f32_16x16x32_bf16 v[220:223], a[156:159], v[32:35], 0
    s_waitcnt lgkmcnt(8)
    v_mfma_f32_16x16x32_bf16 v[192:195], a[160:163], v[48:51], v[192:195]
    s_waitcnt vmcnt(10)
    s_barrier
    v_mfma_f32_16x16x32_bf16 v[224:227], a[160:163], v[52:55], v[224:227]
    ds_read_b128 v[80:83], v125 offset:384
    v_fma_mix_f32 v96, v160, v72, v64 op_sel:[0,0,0] op_sel_hi:[1,0,0]
    v_fma_mix_f32 v97, v160, v73, v65 op_sel:[1,0,0] op_sel_hi:[1,0,0]
    v_mfma_f32_16x16x32_bf16 a[0:3], a[160:163], v[56:59], a[0:3]
    s_add_u32 m0, s62, 32768
    s_mov_b32 s36, 1048576
    buffer_load_dwordx4 v124, s[16:19], s36 offen nt lds
    v_fma_mix_f32 v98, v161, v74, v66 op_sel:[0,0,0] op_sel_hi:[1,0,0]
    v_mfma_f32_16x16x32_bf16 a[32:35], a[160:163], v[60:63], a[32:35]
    ds_read_b128 v[84:87], v125 offset:400
    v_fma_mix_f32 v99, v161, v75, v67 op_sel:[1,0,0] op_sel_hi:[1,0,0]
    v_mfma_f32_16x16x32_bf16 a[36:39], a[164:167], v[60:63], a[36:39]
    ds_read_b128 v[88:91], v125 offset:2432
    v_fma_mix_f32 v100, v162, v76, v68 op_sel:[0,0,0] op_sel_hi:[1,0,0]
    v_fma_mix_f32 v101, v162, v77, v69 op_sel:[1,0,0] op_sel_hi:[1,0,0]
    v_mfma_f32_16x16x32_bf16 a[4:7], a[164:167], v[56:59], a[4:7]
    ds_read_b128 v[92:95], v125 offset:2448
    v_fma_mix_f32 v102, v163, v78, v70 op_sel:[0,0,0] op_sel_hi:[1,0,0]
    v_fma_mix_f32 v103, v163, v79, v71 op_sel:[1,0,0] op_sel_hi:[1,0,0]
    v_mfma_f32_16x16x32_bf16 v[228:231], a[164:167], v[52:55], v[228:231]
    s_add_u32 m0, s62, 36864
    s_mov_b32 s37, 1179648
    buffer_load_dwordx4 v124, s[16:19], s37 offen nt lds
    v_cvt_pk_bf16_f32 v32, v96, v97
    v_mfma_f32_16x16x32_bf16 v[196:199], a[164:167], v[48:51], v[196:199]
    ds_read_b64_tr_b16 a[128:129], v116 offset:0
    v_cvt_pk_bf16_f32 v33, v98, v99
    v_cvt_pk_bf16_f32 v34, v100, v101
    v_mfma_f32_16x16x32_bf16 v[200:203], a[168:171], v[48:51], v[200:203]
    ds_read_b64_tr_b16 a[130:131], v116 offset:1024
    v_cvt_pk_bf16_f32 v35, v102, v103
    v_mfma_f32_16x16x32_bf16 v[232:235], a[168:171], v[52:55], v[232:235]
    ds_read_b64_tr_b16 a[132:133], v116 offset:8
    v_fma_mix_f32 v104, v164, v72, v64 op_sel:[0,0,0] op_sel_hi:[1,0,0]
    v_fma_mix_f32 v105, v164, v73, v65 op_sel:[1,0,0] op_sel_hi:[1,0,0]
    v_mfma_f32_16x16x32_bf16 a[8:11], a[168:171], v[56:59], a[8:11]
    s_xor_b32 s40, s101, 4096
    buffer_load_dwordx4 v[144:147], v26, s[20:23], s40 offen offset:1024
    v_fma_mix_f32 v106, v165, v74, v66 op_sel:[0,0,0] op_sel_hi:[1,0,0]
    v_mfma_f32_16x16x32_bf16 a[40:43], a[168:171], v[60:63], a[40:43]
    ds_read_b64_tr_b16 a[134:135], v116 offset:1032
    v_fma_mix_f32 v107, v165, v75, v67 op_sel:[1,0,0] op_sel_hi:[1,0,0]
    v_fma_mix_f32 v108, v166, v76, v68 op_sel:[0,0,0] op_sel_hi:[1,0,0]
    v_mfma_f32_16x16x32_bf16 a[44:47], a[172:175], v[60:63], a[44:47]
    s_waitcnt lgkmcnt(8)
    ds_read_b64_tr_b16 a[136:137], v117 offset:0
    v_fma_mix_f32 v109, v166, v77, v69 op_sel:[1,0,0] op_sel_hi:[1,0,0]
    v_fma_mix_f32 v110, v167, v78, v70 op_sel:[0,0,0] op_sel_hi:[1,0,0]
    v_mfma_f32_16x16x32_bf16 a[12:15], a[172:175], v[56:59], a[12:15]
    ds_read_b64_tr_b16 a[138:139], v117 offset:1024
    v_fma_mix_f32 v111, v167, v79, v71 op_sel:[1,0,0] op_sel_hi:[1,0,0]
    v_mfma_f32_16x16x32_bf16 v[236:239], a[172:175], v[52:55], v[236:239]
    s_xor_b32 s41, s101, 20480
    buffer_load_dwordx4 v[148:151], v26, s[20:23], s41 offen offset:1024
    v_cvt_pk_bf16_f32 v36, v104, v105
    v_mfma_f32_16x16x32_bf16 v[204:207], a[172:175], v[48:51], v[204:207]
    ds_read_b64_tr_b16 a[140:141], v117 offset:8
    v_cvt_pk_bf16_f32 v37, v106, v107
    v_cvt_pk_bf16_f32 v38, v108, v109
    v_mfma_f32_16x16x32_bf16 v[208:211], a[176:179], v[48:51], v[208:211]
    ds_read_b64_tr_b16 a[142:143], v117 offset:1032
    v_cvt_pk_bf16_f32 v39, v110, v111
    v_fma_mix_f32 v96, v168, v72, v64 op_sel:[0,0,0] op_sel_hi:[1,0,0]
    v_mfma_f32_16x16x32_bf16 v[240:243], a[176:179], v[52:55], v[240:243]
    ds_read_b64_tr_b16 a[144:145], v118 offset:0
    v_fma_mix_f32 v97, v168, v73, v65 op_sel:[1,0,0] op_sel_hi:[1,0,0]
    v_fma_mix_f32 v98, v169, v74, v66 op_sel:[0,0,0] op_sel_hi:[1,0,0]
    v_mfma_f32_16x16x32_bf16 a[16:19], a[176:179], v[56:59], a[16:19]
    s_xor_b32 s42, s101, 135168
    buffer_load_dwordx4 v[152:155], v26, s[20:23], s42 offen offset:1024
    v_mfma_f32_16x16x32_bf16 a[48:51], a[176:179], v[60:63], a[48:51]
    ds_read_b64_tr_b16 a[146:147], v118 offset:1024
    v_fma_mix_f32 v99, v169, v75, v67 op_sel:[1,0,0] op_sel_hi:[1,0,0]
    v_fma_mix_f32 v100, v170, v76, v68 op_sel:[0,0,0] op_sel_hi:[1,0,0]
    v_mfma_f32_16x16x32_bf16 a[52:55], a[180:183], v[60:63], a[52:55]
    ds_read_b64_tr_b16 a[148:149], v118 offset:8
    v_fma_mix_f32 v101, v170, v77, v69 op_sel:[1,0,0] op_sel_hi:[1,0,0]
    v_fma_mix_f32 v102, v171, v78, v70 op_sel:[0,0,0] op_sel_hi:[1,0,0]
    v_mfma_f32_16x16x32_bf16 a[20:23], a[180:183], v[56:59], a[20:23]
    ds_read_b64_tr_b16 a[150:151], v118 offset:1032
    v_fma_mix_f32 v103, v171, v79, v71 op_sel:[1,0,0] op_sel_hi:[1,0,0]
    v_cvt_pk_bf16_f32 v40, v96, v97
    v_mfma_f32_16x16x32_bf16 v[244:247], a[180:183], v[52:55], v[244:247]
    s_xor_b32 s43, s101, 151552
    buffer_load_dwordx4 v[156:159], v26, s[20:23], s43 offen offset:1024
    v_cvt_pk_bf16_f32 v41, v98, v99
    v_mfma_f32_16x16x32_bf16 v[212:215], a[180:183], v[48:51], v[212:215]
    ds_read_b64_tr_b16 a[152:153], v119 offset:0
    v_cvt_pk_bf16_f32 v42, v100, v101
    v_mfma_f32_16x16x32_bf16 v[216:219], a[184:187], v[48:51], v[216:219]
    ds_read_b64_tr_b16 a[154:155], v119 offset:1024
    v_cvt_pk_bf16_f32 v43, v102, v103
    v_fma_mix_f32 v104, v172, v72, v64 op_sel:[0,0,0] op_sel_hi:[1,0,0]
    v_mfma_f32_16x16x32_bf16 v[248:251], a[184:187], v[52:55], v[248:251]
    ds_read_b64_tr_b16 a[156:157], v119 offset:8
    v_fma_mix_f32 v105, v172, v73, v65 op_sel:[1,0,0] op_sel_hi:[1,0,0]
    v_fma_mix_f32 v106, v173, v74, v66 op_sel:[0,0,0] op_sel_hi:[1,0,0]
    v_mfma_f32_16x16x32_bf16 a[24:27], a[184:187], v[56:59], a[24:27]
    s_add_u32 m0, s62, 40960
    s_mov_b32 s36, 1310720
    buffer_load_dwordx4 v124, s[16:19], s36 offen nt lds
    v_fma_mix_f32 v107, v173, v75, v67 op_sel:[1,0,0] op_sel_hi:[1,0,0]
    v_mfma_f32_16x16x32_bf16 a[56:59], a[184:187], v[60:63], a[56:59]
    ds_read_b64_tr_b16 a[158:159], v119 offset:1032
    v_fma_mix_f32 v108, v174, v76, v68 op_sel:[0,0,0] op_sel_hi:[1,0,0]
    v_fma_mix_f32 v109, v174, v77, v69 op_sel:[1,0,0] op_sel_hi:[1,0,0]
    v_mfma_f32_16x16x32_bf16 a[60:63], a[188:191], v[60:63], a[60:63]
    v_fma_mix_f32 v110, v175, v78, v70 op_sel:[0,0,0] op_sel_hi:[1,0,0]
    v_fma_mix_f32 v111, v175, v79, v71 op_sel:[1,0,0] op_sel_hi:[1,0,0]
    v_mfma_f32_16x16x32_bf16 a[28:31], a[188:191], v[56:59], a[28:31]
    v_cvt_pk_bf16_f32 v44, v104, v105
    v_cvt_pk_bf16_f32 v45, v106, v107
    v_cvt_pk_bf16_f32 v46, v108, v109
    v_mfma_f32_16x16x32_bf16 v[252:255], a[188:191], v[52:55], v[252:255]
    s_add_u32 m0, s62, 45056
    s_mov_b32 s37, 1441792
    buffer_load_dwordx4 v124, s[16:19], s37 offen nt lds
    v_cvt_pk_bf16_f32 v47, v110, v111
    v_mfma_f32_16x16x32_bf16 v[220:223], a[188:191], v[48:51], v[220:223]
    s_waitcnt lgkmcnt(8)
    v_mfma_f32_16x16x32_bf16 v[192:195], a[128:131], v[32:35], v[192:195]
    s_waitcnt vmcnt(12)
    s_barrier
    v_mfma_f32_16x16x32_bf16 v[224:227], a[128:131], v[36:39], v[224:227]
    ds_read_b128 v[64:67], v125 offset:512
    v_fma_mix_f32 v96, v176, v88, v80 op_sel:[0,0,0] op_sel_hi:[1,0,0]
    v_fma_mix_f32 v97, v176, v89, v81 op_sel:[1,0,0] op_sel_hi:[1,0,0]
    v_mfma_f32_16x16x32_bf16 a[0:3], a[128:131], v[40:43], a[0:3]
    ds_read_b128 v[68:71], v125 offset:528
    v_fma_mix_f32 v98, v177, v90, v82 op_sel:[0,0,0] op_sel_hi:[1,0,0]
    v_mfma_f32_16x16x32_bf16 a[32:35], a[128:131], v[44:47], a[32:35]
    s_xor_b32 s40, s101, 4096
    buffer_load_dwordx4 v[160:163], v26, s[20:23], s40 offen offset:2048
    v_fma_mix_f32 v99, v177, v91, v83 op_sel:[1,0,0] op_sel_hi:[1,0,0]
    v_mfma_f32_16x16x32_bf16 a[36:39], a[132:135], v[44:47], a[36:39]
    ds_read_b128 v[72:75], v125 offset:2560
    v_fma_mix_f32 v100, v178, v92, v84 op_sel:[0,0,0] op_sel_hi:[1,0,0]
    v_fma_mix_f32 v101, v178, v93, v85 op_sel:[1,0,0] op_sel_hi:[1,0,0]
    v_mfma_f32_16x16x32_bf16 a[4:7], a[132:135], v[40:43], a[4:7]
    ds_read_b128 v[76:79], v125 offset:2576
    v_fma_mix_f32 v102, v179, v94, v86 op_sel:[0,0,0] op_sel_hi:[1,0,0]
    v_mfma_f32_16x16x32_bf16 v[228:231], a[132:135], v[36:39], v[228:231]
    ds_read_b64_tr_b16 a[160:161], v116 offset:8192
    v_fma_mix_f32 v103, v179, v95, v87 op_sel:[1,0,0] op_sel_hi:[1,0,0]
    v_cvt_pk_bf16_f32 v48, v96, v97
    v_mfma_f32_16x16x32_bf16 v[196:199], a[132:135], v[32:35], v[196:199]
    ds_read_b64_tr_b16 a[162:163], v116 offset:9216
    v_cvt_pk_bf16_f32 v49, v98, v99
    v_cvt_pk_bf16_f32 v50, v100, v101
    v_mfma_f32_16x16x32_bf16 v[200:203], a[136:139], v[32:35], v[200:203]
    s_xor_b32 s41, s101, 20480
    buffer_load_dwordx4 v[164:167], v26, s[20:23], s41 offen offset:2048
    v_mfma_f32_16x16x32_bf16 v[232:235], a[136:139], v[36:39], v[232:235]
    ds_read_b64_tr_b16 a[164:165], v116 offset:8200
    v_cvt_pk_bf16_f32 v51, v102, v103
    v_fma_mix_f32 v104, v180, v88, v80 op_sel:[0,0,0] op_sel_hi:[1,0,0]
    v_mfma_f32_16x16x32_bf16 a[8:11], a[136:139], v[40:43], a[8:11]
    ds_read_b64_tr_b16 a[166:167], v116 offset:9224
    v_fma_mix_f32 v105, v180, v89, v81 op_sel:[1,0,0] op_sel_hi:[1,0,0]
    v_fma_mix_f32 v106, v181, v90, v82 op_sel:[0,0,0] op_sel_hi:[1,0,0]
    v_mfma_f32_16x16x32_bf16 a[40:43], a[136:139], v[44:47], a[40:43]
    ds_read_b64_tr_b16 a[168:169], v117 offset:8192
    v_fma_mix_f32 v107, v181, v91, v83 op_sel:[1,0,0] op_sel_hi:[1,0,0]
    v_mfma_f32_16x16x32_bf16 a[44:47], a[140:143], v[44:47], a[44:47]
    s_waitcnt lgkmcnt(9)
    ds_read_b64_tr_b16 a[170:171], v117 offset:9216
    v_fma_mix_f32 v108, v182, v92, v84 op_sel:[0,0,0] op_sel_hi:[1,0,0]
    v_fma_mix_f32 v109, v182, v93, v85 op_sel:[1,0,0] op_sel_hi:[1,0,0]
    v_mfma_f32_16x16x32_bf16 a[12:15], a[140:143], v[40:43], a[12:15]
    s_xor_b32 s42, s101, 135168
    buffer_load_dwordx4 v[168:171], v26, s[20:23], s42 offen offset:2048
    v_fma_mix_f32 v110, v183, v94, v86 op_sel:[0,0,0] op_sel_hi:[1,0,0]
    v_mfma_f32_16x16x32_bf16 v[236:239], a[140:143], v[36:39], v[236:239]
    ds_read_b64_tr_b16 a[172:173], v117 offset:8200
    v_fma_mix_f32 v111, v183, v95, v87 op_sel:[1,0,0] op_sel_hi:[1,0,0]
    v_mfma_f32_16x16x32_bf16 v[204:207], a[140:143], v[32:35], v[204:207]
    ds_read_b64_tr_b16 a[174:175], v117 offset:9224
    v_cvt_pk_bf16_f32 v52, v104, v105
    v_cvt_pk_bf16_f32 v53, v106, v107
    v_mfma_f32_16x16x32_bf16 v[208:211], a[144:147], v[32:35], v[208:211]
    ds_read_b64_tr_b16 a[176:177], v118 offset:8192
    v_cvt_pk_bf16_f32 v54, v108, v109
    v_cvt_pk_bf16_f32 v55, v110, v111
    v_mfma_f32_16x16x32_bf16 v[240:243], a[144:147], v[36:39], v[240:243]
    ds_read_b64_tr_b16 a[178:179], v118 offset:9216
    v_fma_mix_f32 v96, v184, v88, v80 op_sel:[0,0,0] op_sel_hi:[1,0,0]
    v_mfma_f32_16x16x32_bf16 a[16:19], a[144:147], v[40:43], a[16:19]
    ds_read_b64_tr_b16 a[180:181], v118 offset:8200
    v_fma_mix_f32 v97, v184, v89, v81 op_sel:[1,0,0] op_sel_hi:[1,0,0]
    v_fma_mix_f32 v98, v185, v90, v82 op_sel:[0,0,0] op_sel_hi:[1,0,0]
    v_mfma_f32_16x16x32_bf16 a[48:51], a[144:147], v[44:47], a[48:51]
    s_xor_b32 s43, s101, 151552
    buffer_load_dwordx4 v[172:175], v26, s[20:23], s43 offen offset:2048
    v_fma_mix_f32 v99, v185, v91, v83 op_sel:[1,0,0] op_sel_hi:[1,0,0]
    v_mfma_f32_16x16x32_bf16 a[52:55], a[148:151], v[44:47], a[52:55]
    ds_read_b64_tr_b16 a[182:183], v118 offset:9224
    v_fma_mix_f32 v100, v186, v92, v84 op_sel:[0,0,0] op_sel_hi:[1,0,0]
    v_mfma_f32_16x16x32_bf16 a[20:23], a[148:151], v[40:43], a[20:23]
    ds_read_b64_tr_b16 a[184:185], v119 offset:8192
    v_fma_mix_f32 v101, v186, v93, v85 op_sel:[1,0,0] op_sel_hi:[1,0,0]
    v_fma_mix_f32 v102, v187, v94, v86 op_sel:[0,0,0] op_sel_hi:[1,0,0]
    v_mfma_f32_16x16x32_bf16 v[244:247], a[148:151], v[36:39], v[244:247]
    ds_read_b64_tr_b16 a[186:187], v119 offset:9216
    v_fma_mix_f32 v103, v187, v95, v87 op_sel:[1,0,0] op_sel_hi:[1,0,0]
    v_cvt_pk_bf16_f32 v56, v96, v97
    v_mfma_f32_16x16x32_bf16 v[212:215], a[148:151], v[32:35], v[212:215]
    ds_read_b64_tr_b16 a[188:189], v119 offset:8200
    v_cvt_pk_bf16_f32 v57, v98, v99
    v_mfma_f32_16x16x32_bf16 v[216:219], a[152:155], v[32:35], v[216:219]
    s_add_u32 m0, s62, 81920
    s_mov_b32 s36, 1572864
    buffer_load_dwordx4 v124, s[16:19], s36 offen nt lds
    v_cvt_pk_bf16_f32 v58, v100, v101
    v_mfma_f32_16x16x32_bf16 v[248:251], a[152:155], v[36:39], v[248:251]
    ds_read_b64_tr_b16 a[190:191], v119 offset:9224
    v_cvt_pk_bf16_f32 v59, v102, v103
    v_fma_mix_f32 v104, v188, v88, v80 op_sel:[0,0,0] op_sel_hi:[1,0,0]
    v_mfma_f32_16x16x32_bf16 a[24:27], a[152:155], v[40:43], a[24:27]
    v_fma_mix_f32 v105, v188, v89, v81 op_sel:[1,0,0] op_sel_hi:[1,0,0]
    v_fma_mix_f32 v106, v189, v90, v82 op_sel:[0,0,0] op_sel_hi:[1,0,0]
    v_mfma_f32_16x16x32_bf16 a[56:59], a[152:155], v[44:47], a[56:59]
    v_fma_mix_f32 v107, v189, v91, v83 op_sel:[1,0,0] op_sel_hi:[1,0,0]
    v_fma_mix_f32 v108, v190, v92, v84 op_sel:[0,0,0] op_sel_hi:[1,0,0]
    v_fma_mix_f32 v109, v190, v93, v85 op_sel:[1,0,0] op_sel_hi:[1,0,0]
    v_mfma_f32_16x16x32_bf16 a[60:63], a[156:159], v[44:47], a[60:63]
    v_fma_mix_f32 v110, v191, v94, v86 op_sel:[0,0,0] op_sel_hi:[1,0,0]
    v_fma_mix_f32 v111, v191, v95, v87 op_sel:[1,0,0] op_sel_hi:[1,0,0]
    v_cvt_pk_bf16_f32 v60, v104, v105
    v_mfma_f32_16x16x32_bf16 a[28:31], a[156:159], v[40:43], a[28:31]
    s_add_u32 m0, s62, 86016
    s_mov_b32 s37, 1703936
    buffer_load_dwordx4 v124, s[16:19], s37 offen nt lds
    v_mfma_f32_16x16x32_bf16 v[252:255], a[156:159], v[36:39], v[252:255]
    v_cvt_pk_bf16_f32 v61, v106, v107
    v_cvt_pk_bf16_f32 v62, v108, v109
    v_cvt_pk_bf16_f32 v63, v110, v111
    v_mfma_f32_16x16x32_bf16 v[220:223], a[156:159], v[32:35], v[220:223]
    s_waitcnt lgkmcnt(8)
    v_mfma_f32_16x16x32_bf16 v[192:195], a[160:163], v[48:51], v[192:195]
    s_waitcnt vmcnt(12)
    s_barrier
    v_mfma_f32_16x16x32_bf16 v[224:227], a[160:163], v[52:55], v[224:227]
    ds_read_b128 v[80:83], v125 offset:640
    v_fma_mix_f32 v96, v128, v72, v64 op_sel:[0,0,0] op_sel_hi:[1,0,0]
    v_fma_mix_f32 v97, v128, v73, v65 op_sel:[1,0,0] op_sel_hi:[1,0,0]
    v_mfma_f32_16x16x32_bf16 a[0:3], a[160:163], v[56:59], a[0:3]
    ds_read_b128 v[84:87], v125 offset:656
    v_fma_mix_f32 v98, v129, v74, v66 op_sel:[0,0,0] op_sel_hi:[1,0,0]
    v_mfma_f32_16x16x32_bf16 a[32:35], a[160:163], v[60:63], a[32:35]
    s_xor_b32 s40, s101, 4096
    buffer_load_dwordx4 v[176:179], v26, s[20:23], s40 offen offset:3072
    v_fma_mix_f32 v99, v129, v75, v67 op_sel:[1,0,0] op_sel_hi:[1,0,0]
    v_mfma_f32_16x16x32_bf16 a[36:39], a[164:167], v[60:63], a[36:39]
    ds_read_b128 v[88:91], v125 offset:2688
    v_fma_mix_f32 v100, v130, v76, v68 op_sel:[0,0,0] op_sel_hi:[1,0,0]
    v_fma_mix_f32 v101, v130, v77, v69 op_sel:[1,0,0] op_sel_hi:[1,0,0]
    v_mfma_f32_16x16x32_bf16 a[4:7], a[164:167], v[56:59], a[4:7]
    ds_read_b128 v[92:95], v125 offset:2704
    v_fma_mix_f32 v102, v131, v78, v70 op_sel:[0,0,0] op_sel_hi:[1,0,0]
    v_mfma_f32_16x16x32_bf16 v[228:231], a[164:167], v[52:55], v[228:231]
    ds_read_b64_tr_b16 a[128:129], v112 offset:32768
    v_fma_mix_f32 v103, v131, v79, v71 op_sel:[1,0,0] op_sel_hi:[1,0,0]
    v_cvt_pk_bf16_f32 v32, v96, v97
    v_mfma_f32_16x16x32_bf16 v[196:199], a[164:167], v[48:51], v[196:199]
    ds_read_b64_tr_b16 a[130:131], v112 offset:33792
    v_cvt_pk_bf16_f32 v33, v98, v99
    v_cvt_pk_bf16_f32 v34, v100, v101
    v_mfma_f32_16x16x32_bf16 v[200:203], a[168:171], v[48:51], v[200:203]
    s_xor_b32 s41, s101, 20480
    buffer_load_dwordx4 v[180:183], v26, s[20:23], s41 offen offset:3072
    v_mfma_f32_16x16x32_bf16 v[232:235], a[168:171], v[52:55], v[232:235]
    ds_read_b64_tr_b16 a[132:133], v112 offset:32776
    v_cvt_pk_bf16_f32 v35, v102, v103
    v_fma_mix_f32 v104, v132, v72, v64 op_sel:[0,0,0] op_sel_hi:[1,0,0]
    v_mfma_f32_16x16x32_bf16 a[8:11], a[168:171], v[56:59], a[8:11]
    ds_read_b64_tr_b16 a[134:135], v112 offset:33800
    v_fma_mix_f32 v105, v132, v73, v65 op_sel:[1,0,0] op_sel_hi:[1,0,0]
    v_fma_mix_f32 v106, v133, v74, v66 op_sel:[0,0,0] op_sel_hi:[1,0,0]
    v_mfma_f32_16x16x32_bf16 a[40:43], a[168:171], v[60:63], a[40:43]
    ds_read_b64_tr_b16 a[136:137], v113 offset:32768
    v_fma_mix_f32 v107, v133, v75, v67 op_sel:[1,0,0] op_sel_hi:[1,0,0]
    v_mfma_f32_16x16x32_bf16 a[44:47], a[172:175], v[60:63], a[44:47]
    s_waitcnt lgkmcnt(9)
    ds_read_b64_tr_b16 a[138:139], v113 offset:33792
    v_fma_mix_f32 v108, v134, v76, v68 op_sel:[0,0,0] op_sel_hi:[1,0,0]
    v_fma_mix_f32 v109, v134, v77, v69 op_sel:[1,0,0] op_sel_hi:[1,0,0]
    v_mfma_f32_16x16x32_bf16 a[12:15], a[172:175], v[56:59], a[12:15]
    s_xor_b32 s42, s101, 135168
    buffer_load_dwordx4 v[184:187], v26, s[20:23], s42 offen offset:3072
    v_fma_mix_f32 v110, v135, v78, v70 op_sel:[0,0,0] op_sel_hi:[1,0,0]
    v_mfma_f32_16x16x32_bf16 v[236:239], a[172:175], v[52:55], v[236:239]
    ds_read_b64_tr_b16 a[140:141], v113 offset:32776
    v_fma_mix_f32 v111, v135, v79, v71 op_sel:[1,0,0] op_sel_hi:[1,0,0]
    v_mfma_f32_16x16x32_bf16 v[204:207], a[172:175], v[48:51], v[204:207]
    ds_read_b64_tr_b16 a[142:143], v113 offset:33800
    v_cvt_pk_bf16_f32 v36, v104, v105
    v_cvt_pk_bf16_f32 v37, v106, v107
    v_mfma_f32_16x16x32_bf16 v[208:211], a[176:179], v[48:51], v[208:211]
    ds_read_b64_tr_b16 a[144:145], v114 offset:32768
    v_cvt_pk_bf16_f32 v38, v108, v109
    v_cvt_pk_bf16_f32 v39, v110, v111
    v_mfma_f32_16x16x32_bf16 v[240:243], a[176:179], v[52:55], v[240:243]
    ds_read_b64_tr_b16 a[146:147], v114 offset:33792
    v_fma_mix_f32 v96, v136, v72, v64 op_sel:[0,0,0] op_sel_hi:[1,0,0]
    v_mfma_f32_16x16x32_bf16 a[16:19], a[176:179], v[56:59], a[16:19]
    ds_read_b64_tr_b16 a[148:149], v114 offset:32776
    v_fma_mix_f32 v97, v136, v73, v65 op_sel:[1,0,0] op_sel_hi:[1,0,0]
    v_fma_mix_f32 v98, v137, v74, v66 op_sel:[0,0,0] op_sel_hi:[1,0,0]
    v_mfma_f32_16x16x32_bf16 a[48:51], a[176:179], v[60:63], a[48:51]
    s_xor_b32 s43, s101, 151552
    buffer_load_dwordx4 v[188:191], v26, s[20:23], s43 offen offset:3072
    v_fma_mix_f32 v99, v137, v75, v67 op_sel:[1,0,0] op_sel_hi:[1,0,0]
    v_mfma_f32_16x16x32_bf16 a[52:55], a[180:183], v[60:63], a[52:55]
    ds_read_b64_tr_b16 a[150:151], v114 offset:33800
    v_fma_mix_f32 v100, v138, v76, v68 op_sel:[0,0,0] op_sel_hi:[1,0,0]
    v_mfma_f32_16x16x32_bf16 a[20:23], a[180:183], v[56:59], a[20:23]
    ds_read_b64_tr_b16 a[152:153], v115 offset:32768
    v_fma_mix_f32 v101, v138, v77, v69 op_sel:[1,0,0] op_sel_hi:[1,0,0]
    v_fma_mix_f32 v102, v139, v78, v70 op_sel:[0,0,0] op_sel_hi:[1,0,0]
    v_mfma_f32_16x16x32_bf16 v[244:247], a[180:183], v[52:55], v[244:247]
    ds_read_b64_tr_b16 a[154:155], v115 offset:33792
    v_fma_mix_f32 v103, v139, v79, v71 op_sel:[1,0,0] op_sel_hi:[1,0,0]
    v_cvt_pk_bf16_f32 v40, v96, v97
    v_mfma_f32_16x16x32_bf16 v[212:215], a[180:183], v[48:51], v[212:215]
    ds_read_b64_tr_b16 a[156:157], v115 offset:32776
    v_cvt_pk_bf16_f32 v41, v98, v99
    v_mfma_f32_16x16x32_bf16 v[216:219], a[184:187], v[48:51], v[216:219]
    s_add_u32 m0, s62, 90112
    s_mov_b32 s36, 1835008
    buffer_load_dwordx4 v124, s[16:19], s36 offen nt lds
    v_cvt_pk_bf16_f32 v42, v100, v101
    v_mfma_f32_16x16x32_bf16 v[248:251], a[184:187], v[52:55], v[248:251]
    ds_read_b64_tr_b16 a[158:159], v115 offset:33800
    v_cvt_pk_bf16_f32 v43, v102, v103
    v_fma_mix_f32 v104, v140, v72, v64 op_sel:[0,0,0] op_sel_hi:[1,0,0]
    v_mfma_f32_16x16x32_bf16 a[24:27], a[184:187], v[56:59], a[24:27]
    v_fma_mix_f32 v105, v140, v73, v65 op_sel:[1,0,0] op_sel_hi:[1,0,0]
    v_fma_mix_f32 v106, v141, v74, v66 op_sel:[0,0,0] op_sel_hi:[1,0,0]
    v_mfma_f32_16x16x32_bf16 a[56:59], a[184:187], v[60:63], a[56:59]
    v_fma_mix_f32 v107, v141, v75, v67 op_sel:[1,0,0] op_sel_hi:[1,0,0]
    v_fma_mix_f32 v108, v142, v76, v68 op_sel:[0,0,0] op_sel_hi:[1,0,0]
    v_fma_mix_f32 v109, v142, v77, v69 op_sel:[1,0,0] op_sel_hi:[1,0,0]
    v_mfma_f32_16x16x32_bf16 a[60:63], a[188:191], v[60:63], a[60:63]
    v_fma_mix_f32 v110, v143, v78, v70 op_sel:[0,0,0] op_sel_hi:[1,0,0]
    v_fma_mix_f32 v111, v143, v79, v71 op_sel:[1,0,0] op_sel_hi:[1,0,0]
    v_cvt_pk_bf16_f32 v44, v104, v105
    v_mfma_f32_16x16x32_bf16 a[28:31], a[188:191], v[56:59], a[28:31]
    s_add_u32 m0, s62, 94208
    s_mov_b32 s37, 1966080
    buffer_load_dwordx4 v124, s[16:19], s37 offen nt lds
    v_mfma_f32_16x16x32_bf16 v[252:255], a[188:191], v[52:55], v[252:255]
    v_cvt_pk_bf16_f32 v45, v106, v107
    v_cvt_pk_bf16_f32 v46, v108, v109
    v_cvt_pk_bf16_f32 v47, v110, v111
    v_mfma_f32_16x16x32_bf16 v[220:223], a[188:191], v[48:51], v[220:223]
    s_waitcnt lgkmcnt(8)
    v_mfma_f32_16x16x32_bf16 v[192:195], a[128:131], v[32:35], v[192:195]
    s_waitcnt vmcnt(12)
    s_barrier
    v_mfma_f32_16x16x32_bf16 v[224:227], a[128:131], v[36:39], v[224:227]
    ds_read_b128 v[64:67], v125 offset:768
    v_fma_mix_f32 v96, v144, v88, v80 op_sel:[0,0,0] op_sel_hi:[1,0,0]
    v_fma_mix_f32 v97, v144, v89, v81 op_sel:[1,0,0] op_sel_hi:[1,0,0]
    v_mfma_f32_16x16x32_bf16 a[0:3], a[128:131], v[40:43], a[0:3]
    ds_read_b128 v[68:71], v125 offset:784
    v_fma_mix_f32 v98, v145, v90, v82 op_sel:[0,0,0] op_sel_hi:[1,0,0]
    v_mfma_f32_16x16x32_bf16 a[32:35], a[128:131], v[44:47], a[32:35]
    s_xor_b32 s40, s101, 8192
    buffer_load_dwordx4 v[128:131], v26, s[20:23], s40 offen offset:0
    v_fma_mix_f32 v99, v145, v91, v83 op_sel:[1,0,0] op_sel_hi:[1,0,0]
    v_mfma_f32_16x16x32_bf16 a[36:39], a[132:135], v[44:47], a[36:39]
    ds_read_b128 v[72:75], v125 offset:2816
    v_fma_mix_f32 v100, v146, v92, v84 op_sel:[0,0,0] op_sel_hi:[1,0,0]
    v_fma_mix_f32 v101, v146, v93, v85 op_sel:[1,0,0] op_sel_hi:[1,0,0]
    v_mfma_f32_16x16x32_bf16 a[4:7], a[132:135], v[40:43], a[4:7]
    ds_read_b128 v[76:79], v125 offset:2832
    v_fma_mix_f32 v102, v147, v94, v86 op_sel:[0,0,0] op_sel_hi:[1,0,0]
    v_mfma_f32_16x16x32_bf16 v[228:231], a[132:135], v[36:39], v[228:231]
    ds_read_b64_tr_b16 a[160:161], v112 offset:40960
    v_fma_mix_f32 v103, v147, v95, v87 op_sel:[1,0,0] op_sel_hi:[1,0,0]
    v_cvt_pk_bf16_f32 v48, v96, v97
    v_mfma_f32_16x16x32_bf16 v[196:199], a[132:135], v[32:35], v[196:199]
    ds_read_b64_tr_b16 a[162:163], v112 offset:41984
    v_cvt_pk_bf16_f32 v49, v98, v99
    v_cvt_pk_bf16_f32 v50, v100, v101
    v_mfma_f32_16x16x32_bf16 v[200:203], a[136:139], v[32:35], v[200:203]
    s_xor_b32 s41, s101, 24576
    buffer_load_dwordx4 v[132:135], v26, s[20:23], s41 offen offset:0
    v_mfma_f32_16x16x32_bf16 v[232:235], a[136:139], v[36:39], v[232:235]
    ds_read_b64_tr_b16 a[164:165], v112 offset:40968
    v_cvt_pk_bf16_f32 v51, v102, v103
    v_fma_mix_f32 v104, v148, v88, v80 op_sel:[0,0,0] op_sel_hi:[1,0,0]
    v_mfma_f32_16x16x32_bf16 a[8:11], a[136:139], v[40:43], a[8:11]
    ds_read_b64_tr_b16 a[166:167], v112 offset:41992
    v_fma_mix_f32 v105, v148, v89, v81 op_sel:[1,0,0] op_sel_hi:[1,0,0]
    v_fma_mix_f32 v106, v149, v90, v82 op_sel:[0,0,0] op_sel_hi:[1,0,0]
    v_mfma_f32_16x16x32_bf16 a[40:43], a[136:139], v[44:47], a[40:43]
    ds_read_b64_tr_b16 a[168:169], v113 offset:40960
    v_fma_mix_f32 v107, v149, v91, v83 op_sel:[1,0,0] op_sel_hi:[1,0,0]
    v_mfma_f32_16x16x32_bf16 a[44:47], a[140:143], v[44:47], a[44:47]
    s_waitcnt lgkmcnt(9)
    ds_read_b64_tr_b16 a[170:171], v113 offset:41984
    v_fma_mix_f32 v108, v150, v92, v84 op_sel:[0,0,0] op_sel_hi:[1,0,0]
    v_fma_mix_f32 v109, v150, v93, v85 op_sel:[1,0,0] op_sel_hi:[1,0,0]
    v_mfma_f32_16x16x32_bf16 a[12:15], a[140:143], v[40:43], a[12:15]
    s_xor_b32 s42, s101, 139264
    buffer_load_dwordx4 v[136:139], v26, s[20:23], s42 offen offset:0
    v_fma_mix_f32 v110, v151, v94, v86 op_sel:[0,0,0] op_sel_hi:[1,0,0]
    v_mfma_f32_16x16x32_bf16 v[236:239], a[140:143], v[36:39], v[236:239]
    ds_read_b64_tr_b16 a[172:173], v113 offset:40968
    v_fma_mix_f32 v111, v151, v95, v87 op_sel:[1,0,0] op_sel_hi:[1,0,0]
    v_mfma_f32_16x16x32_bf16 v[204:207], a[140:143], v[32:35], v[204:207]
    ds_read_b64_tr_b16 a[174:175], v113 offset:41992
    v_cvt_pk_bf16_f32 v52, v104, v105
    v_cvt_pk_bf16_f32 v53, v106, v107
    v_mfma_f32_16x16x32_bf16 v[208:211], a[144:147], v[32:35], v[208:211]
    ds_read_b64_tr_b16 a[176:177], v114 offset:40960
    v_cvt_pk_bf16_f32 v54, v108, v109
    v_cvt_pk_bf16_f32 v55, v110, v111
    v_mfma_f32_16x16x32_bf16 v[240:243], a[144:147], v[36:39], v[240:243]
    ds_read_b64_tr_b16 a[178:179], v114 offset:41984
    v_fma_mix_f32 v96, v152, v88, v80 op_sel:[0,0,0] op_sel_hi:[1,0,0]
    v_mfma_f32_16x16x32_bf16 a[16:19], a[144:147], v[40:43], a[16:19]
    ds_read_b64_tr_b16 a[180:181], v114 offset:40968
    v_fma_mix_f32 v97, v152, v89, v81 op_sel:[1,0,0] op_sel_hi:[1,0,0]
    v_fma_mix_f32 v98, v153, v90, v82 op_sel:[0,0,0] op_sel_hi:[1,0,0]
    v_mfma_f32_16x16x32_bf16 a[48:51], a[144:147], v[44:47], a[48:51]
    s_xor_b32 s43, s101, 155648
    buffer_load_dwordx4 v[140:143], v26, s[20:23], s43 offen offset:0
    v_fma_mix_f32 v99, v153, v91, v83 op_sel:[1,0,0] op_sel_hi:[1,0,0]
    v_mfma_f32_16x16x32_bf16 a[52:55], a[148:151], v[44:47], a[52:55]
    ds_read_b64_tr_b16 a[182:183], v114 offset:41992
    v_fma_mix_f32 v100, v154, v92, v84 op_sel:[0,0,0] op_sel_hi:[1,0,0]
    v_mfma_f32_16x16x32_bf16 a[20:23], a[148:151], v[40:43], a[20:23]
    ds_read_b64_tr_b16 a[184:185], v115 offset:40960
    v_fma_mix_f32 v101, v154, v93, v85 op_sel:[1,0,0] op_sel_hi:[1,0,0]
    v_fma_mix_f32 v102, v155, v94, v86 op_sel:[0,0,0] op_sel_hi:[1,0,0]
    v_mfma_f32_16x16x32_bf16 v[244:247], a[148:151], v[36:39], v[244:247]
    ds_read_b64_tr_b16 a[186:187], v115 offset:41984
    v_fma_mix_f32 v103, v155, v95, v87 op_sel:[1,0,0] op_sel_hi:[1,0,0]
    v_cvt_pk_bf16_f32 v56, v96, v97
    v_mfma_f32_16x16x32_bf16 v[212:215], a[148:151], v[32:35], v[212:215]
    ds_read_b64_tr_b16 a[188:189], v115 offset:40968
    v_cvt_pk_bf16_f32 v57, v98, v99
    v_mfma_f32_16x16x32_bf16 v[216:219], a[152:155], v[32:35], v[216:219]
    s_add_u32 m0, s62, 49152
    s_mov_b32 s36, 2097152
    buffer_load_dwordx4 v124, s[16:19], s36 offen nt lds
    v_cvt_pk_bf16_f32 v58, v100, v101
    v_mfma_f32_16x16x32_bf16 v[248:251], a[152:155], v[36:39], v[248:251]
    ds_read_b64_tr_b16 a[190:191], v115 offset:41992
    v_cvt_pk_bf16_f32 v59, v102, v103
    v_fma_mix_f32 v104, v156, v88, v80 op_sel:[0,0,0] op_sel_hi:[1,0,0]
    v_mfma_f32_16x16x32_bf16 a[24:27], a[152:155], v[40:43], a[24:27]
    v_fma_mix_f32 v105, v156, v89, v81 op_sel:[1,0,0] op_sel_hi:[1,0,0]
    v_fma_mix_f32 v106, v157, v90, v82 op_sel:[0,0,0] op_sel_hi:[1,0,0]
    v_mfma_f32_16x16x32_bf16 a[56:59], a[152:155], v[44:47], a[56:59]
    v_fma_mix_f32 v107, v157, v91, v83 op_sel:[1,0,0] op_sel_hi:[1,0,0]
    v_fma_mix_f32 v108, v158, v92, v84 op_sel:[0,0,0] op_sel_hi:[1,0,0]
    v_fma_mix_f32 v109, v158, v93, v85 op_sel:[1,0,0] op_sel_hi:[1,0,0]
    v_mfma_f32_16x16x32_bf16 a[60:63], a[156:159], v[44:47], a[60:63]
    v_fma_mix_f32 v110, v159, v94, v86 op_sel:[0,0,0] op_sel_hi:[1,0,0]
    v_fma_mix_f32 v111, v159, v95, v87 op_sel:[1,0,0] op_sel_hi:[1,0,0]
    v_cvt_pk_bf16_f32 v60, v104, v105
    v_mfma_f32_16x16x32_bf16 a[28:31], a[156:159], v[40:43], a[28:31]
    s_add_u32 m0, s62, 53248
    s_mov_b32 s37, 2228224
    buffer_load_dwordx4 v124, s[16:19], s37 offen nt lds
    v_mfma_f32_16x16x32_bf16 v[252:255], a[156:159], v[36:39], v[252:255]
    v_cvt_pk_bf16_f32 v61, v106, v107
    v_cvt_pk_bf16_f32 v62, v108, v109
    v_cvt_pk_bf16_f32 v63, v110, v111
    v_mfma_f32_16x16x32_bf16 v[220:223], a[156:159], v[32:35], v[220:223]
    s_waitcnt lgkmcnt(8)
    v_mfma_f32_16x16x32_bf16 v[192:195], a[160:163], v[48:51], v[192:195]
    s_waitcnt vmcnt(12)
    s_barrier
    v_mfma_f32_16x16x32_bf16 v[224:227], a[160:163], v[52:55], v[224:227]
    ds_read_b128 v[80:83], v125 offset:896
    v_fma_mix_f32 v96, v160, v72, v64 op_sel:[0,0,0] op_sel_hi:[1,0,0]
    v_fma_mix_f32 v97, v160, v73, v65 op_sel:[1,0,0] op_sel_hi:[1,0,0]
    v_mfma_f32_16x16x32_bf16 a[0:3], a[160:163], v[56:59], a[0:3]
    ds_read_b128 v[84:87], v125 offset:912
    v_fma_mix_f32 v98, v161, v74, v66 op_sel:[0,0,0] op_sel_hi:[1,0,0]
    v_mfma_f32_16x16x32_bf16 a[32:35], a[160:163], v[60:63], a[32:35]
    s_xor_b32 s40, s101, 8192
    buffer_load_dwordx4 v[144:147], v26, s[20:23], s40 offen offset:1024
    v_fma_mix_f32 v99, v161, v75, v67 op_sel:[1,0,0] op_sel_hi:[1,0,0]
    v_mfma_f32_16x16x32_bf16 a[36:39], a[164:167], v[60:63], a[36:39]
    ds_read_b128 v[88:91], v125 offset:2944
    v_fma_mix_f32 v100, v162, v76, v68 op_sel:[0,0,0] op_sel_hi:[1,0,0]
    v_fma_mix_f32 v101, v162, v77, v69 op_sel:[1,0,0] op_sel_hi:[1,0,0]
    v_mfma_f32_16x16x32_bf16 a[4:7], a[164:167], v[56:59], a[4:7]
    ds_read_b128 v[92:95], v125 offset:2960
    v_fma_mix_f32 v102, v163, v78, v70 op_sel:[0,0,0] op_sel_hi:[1,0,0]
    v_mfma_f32_16x16x32_bf16 v[228:231], a[164:167], v[52:55], v[228:231]
    ds_read_b64_tr_b16 a[128:129], v116 offset:16384
    v_fma_mix_f32 v103, v163, v79, v71 op_sel:[1,0,0] op_sel_hi:[1,0,0]
    v_cvt_pk_bf16_f32 v32, v96, v97
    v_mfma_f32_16x16x32_bf16 v[196:199], a[164:167], v[48:51], v[196:199]
    ds_read_b64_tr_b16 a[130:131], v116 offset:17408
    v_cvt_pk_bf16_f32 v33, v98, v99
    v_cvt_pk_bf16_f32 v34, v100, v101
    v_mfma_f32_16x16x32_bf16 v[200:203], a[168:171], v[48:51], v[200:203]
    s_xor_b32 s41, s101, 24576
    buffer_load_dwordx4 v[148:151], v26, s[20:23], s41 offen offset:1024
    v_mfma_f32_16x16x32_bf16 v[232:235], a[168:171], v[52:55], v[232:235]
    ds_read_b64_tr_b16 a[132:133], v116 offset:16392
    v_cvt_pk_bf16_f32 v35, v102, v103
    v_fma_mix_f32 v104, v164, v72, v64 op_sel:[0,0,0] op_sel_hi:[1,0,0]
    v_mfma_f32_16x16x32_bf16 a[8:11], a[168:171], v[56:59], a[8:11]
    ds_read_b64_tr_b16 a[134:135], v116 offset:17416
    v_fma_mix_f32 v105, v164, v73, v65 op_sel:[1,0,0] op_sel_hi:[1,0,0]
    v_fma_mix_f32 v106, v165, v74, v66 op_sel:[0,0,0] op_sel_hi:[1,0,0]
    v_mfma_f32_16x16x32_bf16 a[40:43], a[168:171], v[60:63], a[40:43]
    ds_read_b64_tr_b16 a[136:137], v117 offset:16384
    v_fma_mix_f32 v107, v165, v75, v67 op_sel:[1,0,0] op_sel_hi:[1,0,0]
    v_mfma_f32_16x16x32_bf16 a[44:47], a[172:175], v[60:63], a[44:47]
    s_waitcnt lgkmcnt(9)
    ds_read_b64_tr_b16 a[138:139], v117 offset:17408
    v_fma_mix_f32 v108, v166, v76, v68 op_sel:[0,0,0] op_sel_hi:[1,0,0]
    v_fma_mix_f32 v109, v166, v77, v69 op_sel:[1,0,0] op_sel_hi:[1,0,0]
    v_mfma_f32_16x16x32_bf16 a[12:15], a[172:175], v[56:59], a[12:15]
    s_xor_b32 s42, s101, 139264
    buffer_load_dwordx4 v[152:155], v26, s[20:23], s42 offen offset:1024
    v_fma_mix_f32 v110, v167, v78, v70 op_sel:[0,0,0] op_sel_hi:[1,0,0]
    v_mfma_f32_16x16x32_bf16 v[236:239], a[172:175], v[52:55], v[236:239]
    ds_read_b64_tr_b16 a[140:141], v117 offset:16392
    v_fma_mix_f32 v111, v167, v79, v71 op_sel:[1,0,0] op_sel_hi:[1,0,0]
    v_mfma_f32_16x16x32_bf16 v[204:207], a[172:175], v[48:51], v[204:207]
    ds_read_b64_tr_b16 a[142:143], v117 offset:17416
    v_cvt_pk_bf16_f32 v36, v104, v105
    v_cvt_pk_bf16_f32 v37, v106, v107
    v_mfma_f32_16x16x32_bf16 v[208:211], a[176:179], v[48:51], v[208:211]
    ds_read_b64_tr_b16 a[144:145], v118 offset:16384
    v_cvt_pk_bf16_f32 v38, v108, v109
    v_cvt_pk_bf16_f32 v39, v110, v111
    v_mfma_f32_16x16x32_bf16 v[240:243], a[176:179], v[52:55], v[240:243]
    ds_read_b64_tr_b16 a[146:147], v118 offset:17408
    v_fma_mix_f32 v96, v168, v72, v64 op_sel:[0,0,0] op_sel_hi:[1,0,0]
    v_mfma_f32_16x16x32_bf16 a[16:19], a[176:179], v[56:59], a[16:19]
    ds_read_b64_tr_b16 a[148:149], v118 offset:16392
    v_fma_mix_f32 v97, v168, v73, v65 op_sel:[1,0,0] op_sel_hi:[1,0,0]
    v_fma_mix_f32 v98, v169, v74, v66 op_sel:[0,0,0] op_sel_hi:[1,0,0]
    v_mfma_f32_16x16x32_bf16 a[48:51], a[176:179], v[60:63], a[48:51]
    s_xor_b32 s43, s101, 155648
    buffer_load_dwordx4 v[156:159], v26, s[20:23], s43 offen offset:1024
    v_fma_mix_f32 v99, v169, v75, v67 op_sel:[1,0,0] op_sel_hi:[1,0,0]
    v_mfma_f32_16x16x32_bf16 a[52:55], a[180:183], v[60:63], a[52:55]
    ds_read_b64_tr_b16 a[150:151], v118 offset:17416
    v_fma_mix_f32 v100, v170, v76, v68 op_sel:[0,0,0] op_sel_hi:[1,0,0]
    v_mfma_f32_16x16x32_bf16 a[20:23], a[180:183], v[56:59], a[20:23]
    ds_read_b64_tr_b16 a[152:153], v119 offset:16384
    v_fma_mix_f32 v101, v170, v77, v69 op_sel:[1,0,0] op_sel_hi:[1,0,0]
    v_fma_mix_f32 v102, v171, v78, v70 op_sel:[0,0,0] op_sel_hi:[1,0,0]
    v_mfma_f32_16x16x32_bf16 v[244:247], a[180:183], v[52:55], v[244:247]
    ds_read_b64_tr_b16 a[154:155], v119 offset:17408
    v_fma_mix_f32 v103, v171, v79, v71 op_sel:[1,0,0] op_sel_hi:[1,0,0]
    v_cvt_pk_bf16_f32 v40, v96, v97
    v_mfma_f32_16x16x32_bf16 v[212:215], a[180:183], v[48:51], v[212:215]
    ds_read_b64_tr_b16 a[156:157], v119 offset:16392
    v_cvt_pk_bf16_f32 v41, v98, v99
    v_mfma_f32_16x16x32_bf16 v[216:219], a[184:187], v[48:51], v[216:219]
    s_add_u32 m0, s62, 57344
    s_mov_b32 s36, 2359296
    buffer_load_dwordx4 v124, s[16:19], s36 offen nt lds
    v_cvt_pk_bf16_f32 v42, v100, v101
    v_mfma_f32_16x16x32_bf16 v[248:251], a[184:187], v[52:55], v[248:251]
    ds_read_b64_tr_b16 a[158:159], v119 offset:17416
    v_cvt_pk_bf16_f32 v43, v102, v103
    v_fma_mix_f32 v104, v172, v72, v64 op_sel:[0,0,0] op_sel_hi:[1,0,0]
    v_mfma_f32_16x16x32_bf16 a[24:27], a[184:187], v[56:59], a[24:27]
    v_fma_mix_f32 v105, v172, v73, v65 op_sel:[1,0,0] op_sel_hi:[1,0,0]
    v_fma_mix_f32 v106, v173, v74, v66 op_sel:[0,0,0] op_sel_hi:[1,0,0]
    v_mfma_f32_16x16x32_bf16 a[56:59], a[184:187], v[60:63], a[56:59]
    v_fma_mix_f32 v107, v173, v75, v67 op_sel:[1,0,0] op_sel_hi:[1,0,0]
    v_fma_mix_f32 v108, v174, v76, v68 op_sel:[0,0,0] op_sel_hi:[1,0,0]
    v_fma_mix_f32 v109, v174, v77, v69 op_sel:[1,0,0] op_sel_hi:[1,0,0]
    v_mfma_f32_16x16x32_bf16 a[60:63], a[188:191], v[60:63], a[60:63]
    v_fma_mix_f32 v110, v175, v78, v70 op_sel:[0,0,0] op_sel_hi:[1,0,0]
    v_fma_mix_f32 v111, v175, v79, v71 op_sel:[1,0,0] op_sel_hi:[1,0,0]
    v_cvt_pk_bf16_f32 v44, v104, v105
    v_mfma_f32_16x16x32_bf16 a[28:31], a[188:191], v[56:59], a[28:31]
    s_add_u32 m0, s62, 61440
    s_mov_b32 s37, 2490368
    buffer_load_dwordx4 v124, s[16:19], s37 offen nt lds
    v_mfma_f32_16x16x32_bf16 v[252:255], a[188:191], v[52:55], v[252:255]
    v_cvt_pk_bf16_f32 v45, v106, v107
    v_cvt_pk_bf16_f32 v46, v108, v109
    v_cvt_pk_bf16_f32 v47, v110, v111
    v_mfma_f32_16x16x32_bf16 v[220:223], a[188:191], v[48:51], v[220:223]
    s_waitcnt lgkmcnt(8)
    v_mfma_f32_16x16x32_bf16 v[192:195], a[128:131], v[32:35], v[192:195]
    s_waitcnt vmcnt(12)
    s_barrier
    v_mfma_f32_16x16x32_bf16 v[224:227], a[128:131], v[36:39], v[224:227]
    ds_read_b128 v[64:67], v125 offset:1024
    v_fma_mix_f32 v96, v176, v88, v80 op_sel:[0,0,0] op_sel_hi:[1,0,0]
    v_fma_mix_f32 v97, v176, v89, v81 op_sel:[1,0,0] op_sel_hi:[1,0,0]
    v_mfma_f32_16x16x32_bf16 a[0:3], a[128:131], v[40:43], a[0:3]
    ds_read_b128 v[68:71], v125 offset:1040
    v_fma_mix_f32 v98, v177, v90, v82 op_sel:[0,0,0] op_sel_hi:[1,0,0]
    v_mfma_f32_16x16x32_bf16 a[32:35], a[128:131], v[44:47], a[32:35]
    s_xor_b32 s40, s101, 8192
    buffer_load_dwordx4 v[160:163], v26, s[20:23], s40 offen offset:2048
    v_fma_mix_f32 v99, v177, v91, v83 op_sel:[1,0,0] op_sel_hi:[1,0,0]
    v_mfma_f32_16x16x32_bf16 a[36:39], a[132:135], v[44:47], a[36:39]
    ds_read_b128 v[72:75], v125 offset:3072
    v_fma_mix_f32 v100, v178, v92, v84 op_sel:[0,0,0] op_sel_hi:[1,0,0]
    v_fma_mix_f32 v101, v178, v93, v85 op_sel:[1,0,0] op_sel_hi:[1,0,0]
    v_mfma_f32_16x16x32_bf16 a[4:7], a[132:135], v[40:43], a[4:7]
    ds_read_b128 v[76:79], v125 offset:3088
    v_fma_mix_f32 v102, v179, v94, v86 op_sel:[0,0,0] op_sel_hi:[1,0,0]
    v_mfma_f32_16x16x32_bf16 v[228:231], a[132:135], v[36:39], v[228:231]
    ds_read_b64_tr_b16 a[160:161], v116 offset:24576
    v_fma_mix_f32 v103, v179, v95, v87 op_sel:[1,0,0] op_sel_hi:[1,0,0]
    v_cvt_pk_bf16_f32 v48, v96, v97
    v_mfma_f32_16x16x32_bf16 v[196:199], a[132:135], v[32:35], v[196:199]
    ds_read_b64_tr_b16 a[162:163], v116 offset:25600
    v_cvt_pk_bf16_f32 v49, v98, v99
    v_cvt_pk_bf16_f32 v50, v100, v101
    v_mfma_f32_16x16x32_bf16 v[200:203], a[136:139], v[32:35], v[200:203]
    s_xor_b32 s41, s101, 24576
    buffer_load_dwordx4 v[164:167], v26, s[20:23], s41 offen offset:2048
    v_mfma_f32_16x16x32_bf16 v[232:235], a[136:139], v[36:39], v[232:235]
    ds_read_b64_tr_b16 a[164:165], v116 offset:24584
    v_cvt_pk_bf16_f32 v51, v102, v103
    v_fma_mix_f32 v104, v180, v88, v80 op_sel:[0,0,0] op_sel_hi:[1,0,0]
    v_mfma_f32_16x16x32_bf16 a[8:11], a[136:139], v[40:43], a[8:11]
    ds_read_b64_tr_b16 a[166:167], v116 offset:25608
    v_fma_mix_f32 v105, v180, v89, v81 op_sel:[1,0,0] op_sel_hi:[1,0,0]
    v_fma_mix_f32 v106, v181, v90, v82 op_sel:[0,0,0] op_sel_hi:[1,0,0]
    v_mfma_f32_16x16x32_bf16 a[40:43], a[136:139], v[44:47], a[40:43]
    ds_read_b64_tr_b16 a[168:169], v117 offset:24576
    v_fma_mix_f32 v107, v181, v91, v83 op_sel:[1,0,0] op_sel_hi:[1,0,0]
    v_mfma_f32_16x16x32_bf16 a[44:47], a[140:143], v[44:47], a[44:47]
    s_waitcnt lgkmcnt(9)
    ds_read_b64_tr_b16 a[170:171], v117 offset:25600
    v_fma_mix_f32 v108, v182, v92, v84 op_sel:[0,0,0] op_sel_hi:[1,0,0]
    v_fma_mix_f32 v109, v182, v93, v85 op_sel:[1,0,0] op_sel_hi:[1,0,0]
    v_mfma_f32_16x16x32_bf16 a[12:15], a[140:143], v[40:43], a[12:15]
    s_xor_b32 s42, s101, 139264
    buffer_load_dwordx4 v[168:171], v26, s[20:23], s42 offen offset:2048
    v_fma_mix_f32 v110, v183, v94, v86 op_sel:[0,0,0] op_sel_hi:[1,0,0]
    v_mfma_f32_16x16x32_bf16 v[236:239], a[140:143], v[36:39], v[236:239]
    ds_read_b64_tr_b16 a[172:173], v117 offset:24584
    v_fma_mix_f32 v111, v183, v95, v87 op_sel:[1,0,0] op_sel_hi:[1,0,0]
    v_mfma_f32_16x16x32_bf16 v[204:207], a[140:143], v[32:35], v[204:207]
    ds_read_b64_tr_b16 a[174:175], v117 offset:25608
    v_cvt_pk_bf16_f32 v52, v104, v105
    v_cvt_pk_bf16_f32 v53, v106, v107
    v_mfma_f32_16x16x32_bf16 v[208:211], a[144:147], v[32:35], v[208:211]
    ds_read_b64_tr_b16 a[176:177], v118 offset:24576
    v_cvt_pk_bf16_f32 v54, v108, v109
    v_cvt_pk_bf16_f32 v55, v110, v111
    v_mfma_f32_16x16x32_bf16 v[240:243], a[144:147], v[36:39], v[240:243]
    ds_read_b64_tr_b16 a[178:179], v118 offset:25600
    v_fma_mix_f32 v96, v184, v88, v80 op_sel:[0,0,0] op_sel_hi:[1,0,0]
    v_mfma_f32_16x16x32_bf16 a[16:19], a[144:147], v[40:43], a[16:19]
    ds_read_b64_tr_b16 a[180:181], v118 offset:24584
    v_fma_mix_f32 v97, v184, v89, v81 op_sel:[1,0,0] op_sel_hi:[1,0,0]
    v_fma_mix_f32 v98, v185, v90, v82 op_sel:[0,0,0] op_sel_hi:[1,0,0]
    v_mfma_f32_16x16x32_bf16 a[48:51], a[144:147], v[44:47], a[48:51]
    s_xor_b32 s43, s101, 155648
    buffer_load_dwordx4 v[172:175], v26, s[20:23], s43 offen offset:2048
    v_fma_mix_f32 v99, v185, v91, v83 op_sel:[1,0,0] op_sel_hi:[1,0,0]
    v_mfma_f32_16x16x32_bf16 a[52:55], a[148:151], v[44:47], a[52:55]
    ds_read_b64_tr_b16 a[182:183], v118 offset:25608
    v_fma_mix_f32 v100, v186, v92, v84 op_sel:[0,0,0] op_sel_hi:[1,0,0]
    v_mfma_f32_16x16x32_bf16 a[20:23], a[148:151], v[40:43], a[20:23]
    ds_read_b64_tr_b16 a[184:185], v119 offset:24576
    v_fma_mix_f32 v101, v186, v93, v85 op_sel:[1,0,0] op_sel_hi:[1,0,0]
    v_fma_mix_f32 v102, v187, v94, v86 op_sel:[0,0,0] op_sel_hi:[1,0,0]
    v_mfma_f32_16x16x32_bf16 v[244:247], a[148:151], v[36:39], v[244:247]
    ds_read_b64_tr_b16 a[186:187], v119 offset:25600
    v_fma_mix_f32 v103, v187, v95, v87 op_sel:[1,0,0] op_sel_hi:[1,0,0]
    v_cvt_pk_bf16_f32 v56, v96, v97
    v_mfma_f32_16x16x32_bf16 v[212:215], a[148:151], v[32:35], v[212:215]
    ds_read_b64_tr_b16 a[188:189], v119 offset:24584
    v_cvt_pk_bf16_f32 v57, v98, v99
    v_mfma_f32_16x16x32_bf16 v[216:219], a[152:155], v[32:35], v[216:219]
    s_add_u32 m0, s62, 98304
    s_mov_b32 s36, 2621440
    buffer_load_dwordx4 v124, s[16:19], s36 offen nt lds
    v_cvt_pk_bf16_f32 v58, v100, v101
    v_mfma_f32_16x16x32_bf16 v[248:251], a[152:155], v[36:39], v[248:251]
    ds_read_b64_tr_b16 a[190:191], v119 offset:25608
    v_cvt_pk_bf16_f32 v59, v102, v103
    v_fma_mix_f32 v104, v188, v88, v80 op_sel:[0,0,0] op_sel_hi:[1,0,0]
    v_mfma_f32_16x16x32_bf16 a[24:27], a[152:155], v[40:43], a[24:27]
    v_fma_mix_f32 v105, v188, v89, v81 op_sel:[1,0,0] op_sel_hi:[1,0,0]
    v_fma_mix_f32 v106, v189, v90, v82 op_sel:[0,0,0] op_sel_hi:[1,0,0]
    v_mfma_f32_16x16x32_bf16 a[56:59], a[152:155], v[44:47], a[56:59]
    v_fma_mix_f32 v107, v189, v91, v83 op_sel:[1,0,0] op_sel_hi:[1,0,0]
    v_fma_mix_f32 v108, v190, v92, v84 op_sel:[0,0,0] op_sel_hi:[1,0,0]
    v_fma_mix_f32 v109, v190, v93, v85 op_sel:[1,0,0] op_sel_hi:[1,0,0]
    v_mfma_f32_16x16x32_bf16 a[60:63], a[156:159], v[44:47], a[60:63]
    v_fma_mix_f32 v110, v191, v94, v86 op_sel:[0,0,0] op_sel_hi:[1,0,0]
    v_fma_mix_f32 v111, v191, v95, v87 op_sel:[1,0,0] op_sel_hi:[1,0,0]
    v_cvt_pk_bf16_f32 v60, v104, v105
    v_mfma_f32_16x16x32_bf16 a[28:31], a[156:159], v[40:43], a[28:31]
    s_add_u32 m0, s62, 102400
    s_mov_b32 s37, 2752512
    buffer_load_dwordx4 v124, s[16:19], s37 offen nt lds
    v_mfma_f32_16x16x32_bf16 v[252:255], a[156:159], v[36:39], v[252:255]
    v_cvt_pk_bf16_f32 v61, v106, v107
    v_cvt_pk_bf16_f32 v62, v108, v109
    v_cvt_pk_bf16_f32 v63, v110, v111
    v_mfma_f32_16x16x32_bf16 v[220:223], a[156:159], v[32:35], v[220:223]
    s_waitcnt lgkmcnt(8)
    v_mfma_f32_16x16x32_bf16 v[192:195], a[160:163], v[48:51], v[192:195]
    s_waitcnt vmcnt(12)
    s_barrier
    v_mfma_f32_16x16x32_bf16 v[224:227], a[160:163], v[52:55], v[224:227]
    ds_read_b128 v[80:83], v125 offset:1152
    v_fma_mix_f32 v96, v128, v72, v64 op_sel:[0,0,0] op_sel_hi:[1,0,0]
    v_fma_mix_f32 v97, v128, v73, v65 op_sel:[1,0,0] op_sel_hi:[1,0,0]
    v_mfma_f32_16x16x32_bf16 a[0:3], a[160:163], v[56:59], a[0:3]
    ds_read_b128 v[84:87], v125 offset:1168
    v_fma_mix_f32 v98, v129, v74, v66 op_sel:[0,0,0] op_sel_hi:[1,0,0]
    v_mfma_f32_16x16x32_bf16 a[32:35], a[160:163], v[60:63], a[32:35]
    s_xor_b32 s40, s101, 8192
    buffer_load_dwordx4 v[176:179], v26, s[20:23], s40 offen offset:3072
    v_fma_mix_f32 v99, v129, v75, v67 op_sel:[1,0,0] op_sel_hi:[1,0,0]
    v_mfma_f32_16x16x32_bf16 a[36:39], a[164:167], v[60:63], a[36:39]
    ds_read_b128 v[88:91], v125 offset:3200
    v_fma_mix_f32 v100, v130, v76, v68 op_sel:[0,0,0] op_sel_hi:[1,0,0]
    v_fma_mix_f32 v101, v130, v77, v69 op_sel:[1,0,0] op_sel_hi:[1,0,0]
    v_mfma_f32_16x16x32_bf16 a[4:7], a[164:167], v[56:59], a[4:7]
    ds_read_b128 v[92:95], v125 offset:3216
    v_fma_mix_f32 v102, v131, v78, v70 op_sel:[0,0,0] op_sel_hi:[1,0,0]
    v_mfma_f32_16x16x32_bf16 v[228:231], a[164:167], v[52:55], v[228:231]
    ds_read_b64_tr_b16 a[128:129], v112 offset:49152
    v_fma_mix_f32 v103, v131, v79, v71 op_sel:[1,0,0] op_sel_hi:[1,0,0]
    v_cvt_pk_bf16_f32 v32, v96, v97
    v_mfma_f32_16x16x32_bf16 v[196:199], a[164:167], v[48:51], v[196:199]
    ds_read_b64_tr_b16 a[130:131], v112 offset:50176
    v_cvt_pk_bf16_f32 v33, v98, v99
    v_cvt_pk_bf16_f32 v34, v100, v101
    v_mfma_f32_16x16x32_bf16 v[200:203], a[168:171], v[48:51], v[200:203]
    s_xor_b32 s41, s101, 24576
    buffer_load_dwordx4 v[180:183], v26, s[20:23], s41 offen offset:3072
    v_mfma_f32_16x16x32_bf16 v[232:235], a[168:171], v[52:55], v[232:235]
    ds_read_b64_tr_b16 a[132:133], v112 offset:49160
    v_cvt_pk_bf16_f32 v35, v102, v103
    v_fma_mix_f32 v104, v132, v72, v64 op_sel:[0,0,0] op_sel_hi:[1,0,0]
    v_mfma_f32_16x16x32_bf16 a[8:11], a[168:171], v[56:59], a[8:11]
    ds_read_b64_tr_b16 a[134:135], v112 offset:50184
    v_fma_mix_f32 v105, v132, v73, v65 op_sel:[1,0,0] op_sel_hi:[1,0,0]
    v_fma_mix_f32 v106, v133, v74, v66 op_sel:[0,0,0] op_sel_hi:[1,0,0]
    v_mfma_f32_16x16x32_bf16 a[40:43], a[168:171], v[60:63], a[40:43]
    ds_read_b64_tr_b16 a[136:137], v113 offset:49152
    v_fma_mix_f32 v107, v133, v75, v67 op_sel:[1,0,0] op_sel_hi:[1,0,0]
    v_mfma_f32_16x16x32_bf16 a[44:47], a[172:175], v[60:63], a[44:47]
    s_waitcnt lgkmcnt(9)
    ds_read_b64_tr_b16 a[138:139], v113 offset:50176
    v_fma_mix_f32 v108, v134, v76, v68 op_sel:[0,0,0] op_sel_hi:[1,0,0]
    v_fma_mix_f32 v109, v134, v77, v69 op_sel:[1,0,0] op_sel_hi:[1,0,0]
    v_mfma_f32_16x16x32_bf16 a[12:15], a[172:175], v[56:59], a[12:15]
    s_xor_b32 s42, s101, 139264
    buffer_load_dwordx4 v[184:187], v26, s[20:23], s42 offen offset:3072
    v_fma_mix_f32 v110, v135, v78, v70 op_sel:[0,0,0] op_sel_hi:[1,0,0]
    v_mfma_f32_16x16x32_bf16 v[236:239], a[172:175], v[52:55], v[236:239]
    ds_read_b64_tr_b16 a[140:141], v113 offset:49160
    v_fma_mix_f32 v111, v135, v79, v71 op_sel:[1,0,0] op_sel_hi:[1,0,0]
    v_mfma_f32_16x16x32_bf16 v[204:207], a[172:175], v[48:51], v[204:207]
    ds_read_b64_tr_b16 a[142:143], v113 offset:50184
    v_cvt_pk_bf16_f32 v36, v104, v105
    v_cvt_pk_bf16_f32 v37, v106, v107
    v_mfma_f32_16x16x32_bf16 v[208:211], a[176:179], v[48:51], v[208:211]
    ds_read_b64_tr_b16 a[144:145], v114 offset:49152
    v_cvt_pk_bf16_f32 v38, v108, v109
    v_cvt_pk_bf16_f32 v39, v110, v111
    v_mfma_f32_16x16x32_bf16 v[240:243], a[176:179], v[52:55], v[240:243]
    ds_read_b64_tr_b16 a[146:147], v114 offset:50176
    v_fma_mix_f32 v96, v136, v72, v64 op_sel:[0,0,0] op_sel_hi:[1,0,0]
    v_mfma_f32_16x16x32_bf16 a[16:19], a[176:179], v[56:59], a[16:19]
    ds_read_b64_tr_b16 a[148:149], v114 offset:49160
    v_fma_mix_f32 v97, v136, v73, v65 op_sel:[1,0,0] op_sel_hi:[1,0,0]
    v_fma_mix_f32 v98, v137, v74, v66 op_sel:[0,0,0] op_sel_hi:[1,0,0]
    v_mfma_f32_16x16x32_bf16 a[48:51], a[176:179], v[60:63], a[48:51]
    s_xor_b32 s43, s101, 155648
    buffer_load_dwordx4 v[188:191], v26, s[20:23], s43 offen offset:3072
    v_fma_mix_f32 v99, v137, v75, v67 op_sel:[1,0,0] op_sel_hi:[1,0,0]
    v_mfma_f32_16x16x32_bf16 a[52:55], a[180:183], v[60:63], a[52:55]
    ds_read_b64_tr_b16 a[150:151], v114 offset:50184
    v_fma_mix_f32 v100, v138, v76, v68 op_sel:[0,0,0] op_sel_hi:[1,0,0]
    v_mfma_f32_16x16x32_bf16 a[20:23], a[180:183], v[56:59], a[20:23]
    ds_read_b64_tr_b16 a[152:153], v115 offset:49152
    v_fma_mix_f32 v101, v138, v77, v69 op_sel:[1,0,0] op_sel_hi:[1,0,0]
    v_fma_mix_f32 v102, v139, v78, v70 op_sel:[0,0,0] op_sel_hi:[1,0,0]
    v_mfma_f32_16x16x32_bf16 v[244:247], a[180:183], v[52:55], v[244:247]
    ds_read_b64_tr_b16 a[154:155], v115 offset:50176
    v_fma_mix_f32 v103, v139, v79, v71 op_sel:[1,0,0] op_sel_hi:[1,0,0]
    v_cvt_pk_bf16_f32 v40, v96, v97
    v_mfma_f32_16x16x32_bf16 v[212:215], a[180:183], v[48:51], v[212:215]
    ds_read_b64_tr_b16 a[156:157], v115 offset:49160
    v_cvt_pk_bf16_f32 v41, v98, v99
    v_mfma_f32_16x16x32_bf16 v[216:219], a[184:187], v[48:51], v[216:219]
    s_add_u32 m0, s62, 106496
    s_mov_b32 s36, 2883584
    buffer_load_dwordx4 v124, s[16:19], s36 offen nt lds
    v_cvt_pk_bf16_f32 v42, v100, v101
    v_mfma_f32_16x16x32_bf16 v[248:251], a[184:187], v[52:55], v[248:251]
    ds_read_b64_tr_b16 a[158:159], v115 offset:50184
    v_cvt_pk_bf16_f32 v43, v102, v103
    v_fma_mix_f32 v104, v140, v72, v64 op_sel:[0,0,0] op_sel_hi:[1,0,0]
    v_mfma_f32_16x16x32_bf16 a[24:27], a[184:187], v[56:59], a[24:27]
    v_fma_mix_f32 v105, v140, v73, v65 op_sel:[1,0,0] op_sel_hi:[1,0,0]
    v_fma_mix_f32 v106, v141, v74, v66 op_sel:[0,0,0] op_sel_hi:[1,0,0]
    v_mfma_f32_16x16x32_bf16 a[56:59], a[184:187], v[60:63], a[56:59]
    v_fma_mix_f32 v107, v141, v75, v67 op_sel:[1,0,0] op_sel_hi:[1,0,0]
    v_fma_mix_f32 v108, v142, v76, v68 op_sel:[0,0,0] op_sel_hi:[1,0,0]
    v_fma_mix_f32 v109, v142, v77, v69 op_sel:[1,0,0] op_sel_hi:[1,0,0]
    v_mfma_f32_16x16x32_bf16 a[60:63], a[188:191], v[60:63], a[60:63]
    v_fma_mix_f32 v110, v143, v78, v70 op_sel:[0,0,0] op_sel_hi:[1,0,0]
    v_fma_mix_f32 v111, v143, v79, v71 op_sel:[1,0,0] op_sel_hi:[1,0,0]
    v_cvt_pk_bf16_f32 v44, v104, v105
    v_mfma_f32_16x16x32_bf16 a[28:31], a[188:191], v[56:59], a[28:31]
    s_add_u32 m0, s62, 110592
    s_mov_b32 s37, 3014656
    buffer_load_dwordx4 v124, s[16:19], s37 offen nt lds
    v_mfma_f32_16x16x32_bf16 v[252:255], a[188:191], v[52:55], v[252:255]
    v_cvt_pk_bf16_f32 v45, v106, v107
    v_cvt_pk_bf16_f32 v46, v108, v109
    v_cvt_pk_bf16_f32 v47, v110, v111
    v_mfma_f32_16x16x32_bf16 v[220:223], a[188:191], v[48:51], v[220:223]
    s_waitcnt lgkmcnt(8)
    v_mfma_f32_16x16x32_bf16 v[192:195], a[128:131], v[32:35], v[192:195]
    s_waitcnt vmcnt(12)
    s_barrier
    v_mfma_f32_16x16x32_bf16 v[224:227], a[128:131], v[36:39], v[224:227]
    ds_read_b128 v[64:67], v125 offset:1280
    v_fma_mix_f32 v96, v144, v88, v80 op_sel:[0,0,0] op_sel_hi:[1,0,0]
    v_fma_mix_f32 v97, v144, v89, v81 op_sel:[1,0,0] op_sel_hi:[1,0,0]
    v_mfma_f32_16x16x32_bf16 a[0:3], a[128:131], v[40:43], a[0:3]
    ds_read_b128 v[68:71], v125 offset:1296
    v_fma_mix_f32 v98, v145, v90, v82 op_sel:[0,0,0] op_sel_hi:[1,0,0]
    v_mfma_f32_16x16x32_bf16 a[32:35], a[128:131], v[44:47], a[32:35]
    s_xor_b32 s40, s101, 12288
    buffer_load_dwordx4 v[128:131], v26, s[20:23], s40 offen offset:0
    v_fma_mix_f32 v99, v145, v91, v83 op_sel:[1,0,0] op_sel_hi:[1,0,0]
    v_mfma_f32_16x16x32_bf16 a[36:39], a[132:135], v[44:47], a[36:39]
    ds_read_b128 v[72:75], v125 offset:3328
    v_fma_mix_f32 v100, v146, v92, v84 op_sel:[0,0,0] op_sel_hi:[1,0,0]
    v_fma_mix_f32 v101, v146, v93, v85 op_sel:[1,0,0] op_sel_hi:[1,0,0]
    v_mfma_f32_16x16x32_bf16 a[4:7], a[132:135], v[40:43], a[4:7]
    ds_read_b128 v[76:79], v125 offset:3344
    v_fma_mix_f32 v102, v147, v94, v86 op_sel:[0,0,0] op_sel_hi:[1,0,0]
    v_mfma_f32_16x16x32_bf16 v[228:231], a[132:135], v[36:39], v[228:231]
    ds_read_b64_tr_b16 a[160:161], v112 offset:57344
    v_fma_mix_f32 v103, v147, v95, v87 op_sel:[1,0,0] op_sel_hi:[1,0,0]
    v_cvt_pk_bf16_f32 v48, v96, v97
    v_mfma_f32_16x16x32_bf16 v[196:199], a[132:135], v[32:35], v[196:199]
    ds_read_b64_tr_b16 a[162:163], v112 offset:58368
    v_cvt_pk_bf16_f32 v49, v98, v99
    v_cvt_pk_bf16_f32 v50, v100, v101
    v_mfma_f32_16x16x32_bf16 v[200:203], a[136:139], v[32:35], v[200:203]
    s_xor_b32 s41, s101, 28672
    buffer_load_dwordx4 v[132:135], v26, s[20:23], s41 offen offset:0
    v_mfma_f32_16x16x32_bf16 v[232:235], a[136:139], v[36:39], v[232:235]
    ds_read_b64_tr_b16 a[164:165], v112 offset:57352
    v_cvt_pk_bf16_f32 v51, v102, v103
    v_fma_mix_f32 v104, v148, v88, v80 op_sel:[0,0,0] op_sel_hi:[1,0,0]
    v_mfma_f32_16x16x32_bf16 a[8:11], a[136:139], v[40:43], a[8:11]
    ds_read_b64_tr_b16 a[166:167], v112 offset:58376
    v_fma_mix_f32 v105, v148, v89, v81 op_sel:[1,0,0] op_sel_hi:[1,0,0]
    v_fma_mix_f32 v106, v149, v90, v82 op_sel:[0,0,0] op_sel_hi:[1,0,0]
    v_mfma_f32_16x16x32_bf16 a[40:43], a[136:139], v[44:47], a[40:43]
    ds_read_b64_tr_b16 a[168:169], v113 offset:57344
    v_fma_mix_f32 v107, v149, v91, v83 op_sel:[1,0,0] op_sel_hi:[1,0,0]
    v_mfma_f32_16x16x32_bf16 a[44:47], a[140:143], v[44:47], a[44:47]
    s_waitcnt lgkmcnt(9)
    ds_read_b64_tr_b16 a[170:171], v113 offset:58368
    v_fma_mix_f32 v108, v150, v92, v84 op_sel:[0,0,0] op_sel_hi:[1,0,0]
    v_fma_mix_f32 v109, v150, v93, v85 op_sel:[1,0,0] op_sel_hi:[1,0,0]
    v_mfma_f32_16x16x32_bf16 a[12:15], a[140:143], v[40:43], a[12:15]
    s_xor_b32 s42, s101, 143360
    buffer_load_dwordx4 v[136:139], v26, s[20:23], s42 offen offset:0
    v_fma_mix_f32 v110, v151, v94, v86 op_sel:[0,0,0] op_sel_hi:[1,0,0]
    v_mfma_f32_16x16x32_bf16 v[236:239], a[140:143], v[36:39], v[236:239]
    ds_read_b64_tr_b16 a[172:173], v113 offset:57352
    v_fma_mix_f32 v111, v151, v95, v87 op_sel:[1,0,0] op_sel_hi:[1,0,0]
    v_mfma_f32_16x16x32_bf16 v[204:207], a[140:143], v[32:35], v[204:207]
    ds_read_b64_tr_b16 a[174:175], v113 offset:58376
    v_cvt_pk_bf16_f32 v52, v104, v105
    v_cvt_pk_bf16_f32 v53, v106, v107
    v_mfma_f32_16x16x32_bf16 v[208:211], a[144:147], v[32:35], v[208:211]
    ds_read_b64_tr_b16 a[176:177], v114 offset:57344
    v_cvt_pk_bf16_f32 v54, v108, v109
    v_cvt_pk_bf16_f32 v55, v110, v111
    v_mfma_f32_16x16x32_bf16 v[240:243], a[144:147], v[36:39], v[240:243]
    ds_read_b64_tr_b16 a[178:179], v114 offset:58368
    v_fma_mix_f32 v96, v152, v88, v80 op_sel:[0,0,0] op_sel_hi:[1,0,0]
    v_mfma_f32_16x16x32_bf16 a[16:19], a[144:147], v[40:43], a[16:19]
    ds_read_b64_tr_b16 a[180:181], v114 offset:57352
    v_fma_mix_f32 v97, v152, v89, v81 op_sel:[1,0,0] op_sel_hi:[1,0,0]
    v_fma_mix_f32 v98, v153, v90, v82 op_sel:[0,0,0] op_sel_hi:[1,0,0]
    v_mfma_f32_16x16x32_bf16 a[48:51], a[144:147], v[44:47], a[48:51]
    s_xor_b32 s43, s101, 159744
    buffer_load_dwordx4 v[140:143], v26, s[20:23], s43 offen offset:0
    v_fma_mix_f32 v99, v153, v91, v83 op_sel:[1,0,0] op_sel_hi:[1,0,0]
    v_mfma_f32_16x16x32_bf16 a[52:55], a[148:151], v[44:47], a[52:55]
    ds_read_b64_tr_b16 a[182:183], v114 offset:58376
    v_fma_mix_f32 v100, v154, v92, v84 op_sel:[0,0,0] op_sel_hi:[1,0,0]
    v_mfma_f32_16x16x32_bf16 a[20:23], a[148:151], v[40:43], a[20:23]
    ds_read_b64_tr_b16 a[184:185], v115 offset:57344
    v_fma_mix_f32 v101, v154, v93, v85 op_sel:[1,0,0] op_sel_hi:[1,0,0]
    v_fma_mix_f32 v102, v155, v94, v86 op_sel:[0,0,0] op_sel_hi:[1,0,0]
    v_mfma_f32_16x16x32_bf16 v[244:247], a[148:151], v[36:39], v[244:247]
    ds_read_b64_tr_b16 a[186:187], v115 offset:58368
    v_fma_mix_f32 v103, v155, v95, v87 op_sel:[1,0,0] op_sel_hi:[1,0,0]
    v_cvt_pk_bf16_f32 v56, v96, v97
    v_mfma_f32_16x16x32_bf16 v[212:215], a[148:151], v[32:35], v[212:215]
    ds_read_b64_tr_b16 a[188:189], v115 offset:57352
    v_cvt_pk_bf16_f32 v57, v98, v99
    v_mfma_f32_16x16x32_bf16 v[216:219], a[152:155], v[32:35], v[216:219]
    s_add_u32 m0, s62, 114688
    s_mov_b32 s36, 3145728
    buffer_load_dwordx4 v124, s[16:19], s36 offen nt lds
    v_cvt_pk_bf16_f32 v58, v100, v101
    v_mfma_f32_16x16x32_bf16 v[248:251], a[152:155], v[36:39], v[248:251]
    ds_read_b64_tr_b16 a[190:191], v115 offset:58376
    v_cvt_pk_bf16_f32 v59, v102, v103
    v_fma_mix_f32 v104, v156, v88, v80 op_sel:[0,0,0] op_sel_hi:[1,0,0]
    v_mfma_f32_16x16x32_bf16 a[24:27], a[152:155], v[40:43], a[24:27]
    v_fma_mix_f32 v105, v156, v89, v81 op_sel:[1,0,0] op_sel_hi:[1,0,0]
    v_fma_mix_f32 v106, v157, v90, v82 op_sel:[0,0,0] op_sel_hi:[1,0,0]
    v_mfma_f32_16x16x32_bf16 a[56:59], a[152:155], v[44:47], a[56:59]
    v_fma_mix_f32 v107, v157, v91, v83 op_sel:[1,0,0] op_sel_hi:[1,0,0]
    v_fma_mix_f32 v108, v158, v92, v84 op_sel:[0,0,0] op_sel_hi:[1,0,0]
    v_fma_mix_f32 v109, v158, v93, v85 op_sel:[1,0,0] op_sel_hi:[1,0,0]
    v_mfma_f32_16x16x32_bf16 a[60:63], a[156:159], v[44:47], a[60:63]
    v_fma_mix_f32 v110, v159, v94, v86 op_sel:[0,0,0] op_sel_hi:[1,0,0]
    v_fma_mix_f32 v111, v159, v95, v87 op_sel:[1,0,0] op_sel_hi:[1,0,0]
    v_cvt_pk_bf16_f32 v60, v104, v105
    v_mfma_f32_16x16x32_bf16 a[28:31], a[156:159], v[40:43], a[28:31]
    s_add_u32 m0, s62, 118784
    s_mov_b32 s37, 3276800
    buffer_load_dwordx4 v124, s[16:19], s37 offen nt lds
    v_mfma_f32_16x16x32_bf16 v[252:255], a[156:159], v[36:39], v[252:255]
    v_cvt_pk_bf16_f32 v61, v106, v107
    v_cvt_pk_bf16_f32 v62, v108, v109
    v_cvt_pk_bf16_f32 v63, v110, v111
    v_mfma_f32_16x16x32_bf16 v[220:223], a[156:159], v[32:35], v[220:223]
    s_waitcnt lgkmcnt(8)
    v_mfma_f32_16x16x32_bf16 v[192:195], a[160:163], v[48:51], v[192:195]
    s_waitcnt vmcnt(12)
    s_barrier
    v_mfma_f32_16x16x32_bf16 v[224:227], a[160:163], v[52:55], v[224:227]
    ds_read_b128 v[80:83], v125 offset:1408
    v_fma_mix_f32 v96, v160, v72, v64 op_sel:[0,0,0] op_sel_hi:[1,0,0]
    v_fma_mix_f32 v97, v160, v73, v65 op_sel:[1,0,0] op_sel_hi:[1,0,0]
    v_mfma_f32_16x16x32_bf16 a[0:3], a[160:163], v[56:59], a[0:3]
    ds_read_b128 v[84:87], v125 offset:1424
    v_fma_mix_f32 v98, v161, v74, v66 op_sel:[0,0,0] op_sel_hi:[1,0,0]
    v_mfma_f32_16x16x32_bf16 a[32:35], a[160:163], v[60:63], a[32:35]
    s_xor_b32 s40, s101, 12288
    buffer_load_dwordx4 v[144:147], v26, s[20:23], s40 offen offset:1024
    v_fma_mix_f32 v99, v161, v75, v67 op_sel:[1,0,0] op_sel_hi:[1,0,0]
    v_mfma_f32_16x16x32_bf16 a[36:39], a[164:167], v[60:63], a[36:39]
    ds_read_b128 v[88:91], v125 offset:3456
    v_fma_mix_f32 v100, v162, v76, v68 op_sel:[0,0,0] op_sel_hi:[1,0,0]
    v_fma_mix_f32 v101, v162, v77, v69 op_sel:[1,0,0] op_sel_hi:[1,0,0]
    v_mfma_f32_16x16x32_bf16 a[4:7], a[164:167], v[56:59], a[4:7]
    ds_read_b128 v[92:95], v125 offset:3472
    v_fma_mix_f32 v102, v163, v78, v70 op_sel:[0,0,0] op_sel_hi:[1,0,0]
    v_mfma_f32_16x16x32_bf16 v[228:231], a[164:167], v[52:55], v[228:231]
    ds_read_b64_tr_b16 a[128:129], v116 offset:32768
    v_fma_mix_f32 v103, v163, v79, v71 op_sel:[1,0,0] op_sel_hi:[1,0,0]
    v_cvt_pk_bf16_f32 v32, v96, v97
    v_mfma_f32_16x16x32_bf16 v[196:199], a[164:167], v[48:51], v[196:199]
    ds_read_b64_tr_b16 a[130:131], v116 offset:33792
    v_cvt_pk_bf16_f32 v33, v98, v99
    v_cvt_pk_bf16_f32 v34, v100, v101
    v_mfma_f32_16x16x32_bf16 v[200:203], a[168:171], v[48:51], v[200:203]
    s_xor_b32 s41, s101, 28672
    buffer_load_dwordx4 v[148:151], v26, s[20:23], s41 offen offset:1024
    v_mfma_f32_16x16x32_bf16 v[232:235], a[168:171], v[52:55], v[232:235]
    ds_read_b64_tr_b16 a[132:133], v116 offset:32776
    v_cvt_pk_bf16_f32 v35, v102, v103
    v_fma_mix_f32 v104, v164, v72, v64 op_sel:[0,0,0] op_sel_hi:[1,0,0]
    v_mfma_f32_16x16x32_bf16 a[8:11], a[168:171], v[56:59], a[8:11]
    ds_read_b64_tr_b16 a[134:135], v116 offset:33800
    v_fma_mix_f32 v105, v164, v73, v65 op_sel:[1,0,0] op_sel_hi:[1,0,0]
    v_fma_mix_f32 v106, v165, v74, v66 op_sel:[0,0,0] op_sel_hi:[1,0,0]
    v_mfma_f32_16x16x32_bf16 a[40:43], a[168:171], v[60:63], a[40:43]
    ds_read_b64_tr_b16 a[136:137], v117 offset:32768
    v_fma_mix_f32 v107, v165, v75, v67 op_sel:[1,0,0] op_sel_hi:[1,0,0]
    v_mfma_f32_16x16x32_bf16 a[44:47], a[172:175], v[60:63], a[44:47]
    s_waitcnt lgkmcnt(9)
    ds_read_b64_tr_b16 a[138:139], v117 offset:33792
    v_fma_mix_f32 v108, v166, v76, v68 op_sel:[0,0,0] op_sel_hi:[1,0,0]
    v_fma_mix_f32 v109, v166, v77, v69 op_sel:[1,0,0] op_sel_hi:[1,0,0]
    v_mfma_f32_16x16x32_bf16 a[12:15], a[172:175], v[56:59], a[12:15]
    s_xor_b32 s42, s101, 143360
    buffer_load_dwordx4 v[152:155], v26, s[20:23], s42 offen offset:1024
    v_fma_mix_f32 v110, v167, v78, v70 op_sel:[0,0,0] op_sel_hi:[1,0,0]
    v_mfma_f32_16x16x32_bf16 v[236:239], a[172:175], v[52:55], v[236:239]
    ds_read_b64_tr_b16 a[140:141], v117 offset:32776
    v_fma_mix_f32 v111, v167, v79, v71 op_sel:[1,0,0] op_sel_hi:[1,0,0]
    v_mfma_f32_16x16x32_bf16 v[204:207], a[172:175], v[48:51], v[204:207]
    ds_read_b64_tr_b16 a[142:143], v117 offset:33800
    v_cvt_pk_bf16_f32 v36, v104, v105
    v_cvt_pk_bf16_f32 v37, v106, v107
    v_mfma_f32_16x16x32_bf16 v[208:211], a[176:179], v[48:51], v[208:211]
    ds_read_b64_tr_b16 a[144:145], v118 offset:32768
    v_cvt_pk_bf16_f32 v38, v108, v109
    v_cvt_pk_bf16_f32 v39, v110, v111
    v_mfma_f32_16x16x32_bf16 v[240:243], a[176:179], v[52:55], v[240:243]
    ds_read_b64_tr_b16 a[146:147], v118 offset:33792
    v_fma_mix_f32 v96, v168, v72, v64 op_sel:[0,0,0] op_sel_hi:[1,0,0]
    v_mfma_f32_16x16x32_bf16 a[16:19], a[176:179], v[56:59], a[16:19]
    ds_read_b64_tr_b16 a[148:149], v118 offset:32776
    v_fma_mix_f32 v97, v168, v73, v65 op_sel:[1,0,0] op_sel_hi:[1,0,0]
    v_fma_mix_f32 v98, v169, v74, v66 op_sel:[0,0,0] op_sel_hi:[1,0,0]
    v_mfma_f32_16x16x32_bf16 a[48:51], a[176:179], v[60:63], a[48:51]
    s_xor_b32 s43, s101, 159744
    buffer_load_dwordx4 v[156:159], v26, s[20:23], s43 offen offset:1024
    v_fma_mix_f32 v99, v169, v75, v67 op_sel:[1,0,0] op_sel_hi:[1,0,0]
    v_mfma_f32_16x16x32_bf16 a[52:55], a[180:183], v[60:63], a[52:55]
    ds_read_b64_tr_b16 a[150:151], v118 offset:33800
    v_fma_mix_f32 v100, v170, v76, v68 op_sel:[0,0,0] op_sel_hi:[1,0,0]
    v_mfma_f32_16x16x32_bf16 a[20:23], a[180:183], v[56:59], a[20:23]
    ds_read_b64_tr_b16 a[152:153], v119 offset:32768
    v_fma_mix_f32 v101, v170, v77, v69 op_sel:[1,0,0] op_sel_hi:[1,0,0]
    v_fma_mix_f32 v102, v171, v78, v70 op_sel:[0,0,0] op_sel_hi:[1,0,0]
    v_mfma_f32_16x16x32_bf16 v[244:247], a[180:183], v[52:55], v[244:247]
    ds_read_b64_tr_b16 a[154:155], v119 offset:33792
    v_fma_mix_f32 v103, v171, v79, v71 op_sel:[1,0,0] op_sel_hi:[1,0,0]
    v_cvt_pk_bf16_f32 v40, v96, v97
    v_mfma_f32_16x16x32_bf16 v[212:215], a[180:183], v[48:51], v[212:215]
    ds_read_b64_tr_b16 a[156:157], v119 offset:32776
    v_cvt_pk_bf16_f32 v41, v98, v99
    v_mfma_f32_16x16x32_bf16 v[216:219], a[184:187], v[48:51], v[216:219]
    s_add_u32 m0, s62, 122880
    s_mov_b32 s36, 3407872
    buffer_load_dwordx4 v124, s[16:19], s36 offen nt lds
    v_cvt_pk_bf16_f32 v42, v100, v101
    v_mfma_f32_16x16x32_bf16 v[248:251], a[184:187], v[52:55], v[248:251]
    ds_read_b64_tr_b16 a[158:159], v119 offset:33800
    v_cvt_pk_bf16_f32 v43, v102, v103
    v_fma_mix_f32 v104, v172, v72, v64 op_sel:[0,0,0] op_sel_hi:[1,0,0]
    v_mfma_f32_16x16x32_bf16 a[24:27], a[184:187], v[56:59], a[24:27]
    v_fma_mix_f32 v105, v172, v73, v65 op_sel:[1,0,0] op_sel_hi:[1,0,0]
    v_fma_mix_f32 v106, v173, v74, v66 op_sel:[0,0,0] op_sel_hi:[1,0,0]
    v_mfma_f32_16x16x32_bf16 a[56:59], a[184:187], v[60:63], a[56:59]
    v_fma_mix_f32 v107, v173, v75, v67 op_sel:[1,0,0] op_sel_hi:[1,0,0]
    v_fma_mix_f32 v108, v174, v76, v68 op_sel:[0,0,0] op_sel_hi:[1,0,0]
    v_fma_mix_f32 v109, v174, v77, v69 op_sel:[1,0,0] op_sel_hi:[1,0,0]
    v_mfma_f32_16x16x32_bf16 a[60:63], a[188:191], v[60:63], a[60:63]
    v_fma_mix_f32 v110, v175, v78, v70 op_sel:[0,0,0] op_sel_hi:[1,0,0]
    v_fma_mix_f32 v111, v175, v79, v71 op_sel:[1,0,0] op_sel_hi:[1,0,0]
    v_cvt_pk_bf16_f32 v44, v104, v105
    v_mfma_f32_16x16x32_bf16 a[28:31], a[188:191], v[56:59], a[28:31]
    s_add_u32 m0, s62, 126976
    s_mov_b32 s37, 3538944
    buffer_load_dwordx4 v124, s[16:19], s37 offen nt lds
    v_mfma_f32_16x16x32_bf16 v[252:255], a[188:191], v[52:55], v[252:255]
    v_cvt_pk_bf16_f32 v45, v106, v107
    v_cvt_pk_bf16_f32 v46, v108, v109
    v_cvt_pk_bf16_f32 v47, v110, v111
    v_mfma_f32_16x16x32_bf16 v[220:223], a[188:191], v[48:51], v[220:223]
    s_waitcnt lgkmcnt(8)
    v_mfma_f32_16x16x32_bf16 v[192:195], a[128:131], v[32:35], v[192:195]
    s_waitcnt vmcnt(12)
    s_barrier
    v_mfma_f32_16x16x32_bf16 v[224:227], a[128:131], v[36:39], v[224:227]
    ds_read_b128 v[64:67], v125 offset:1536
    v_fma_mix_f32 v96, v176, v88, v80 op_sel:[0,0,0] op_sel_hi:[1,0,0]
    v_fma_mix_f32 v97, v176, v89, v81 op_sel:[1,0,0] op_sel_hi:[1,0,0]
    v_mfma_f32_16x16x32_bf16 a[0:3], a[128:131], v[40:43], a[0:3]
    ds_read_b128 v[68:71], v125 offset:1552
    v_fma_mix_f32 v98, v177, v90, v82 op_sel:[0,0,0] op_sel_hi:[1,0,0]
    v_mfma_f32_16x16x32_bf16 a[32:35], a[128:131], v[44:47], a[32:35]
    s_xor_b32 s40, s101, 12288
    buffer_load_dwordx4 v[160:163], v26, s[20:23], s40 offen offset:2048
    v_fma_mix_f32 v99, v177, v91, v83 op_sel:[1,0,0] op_sel_hi:[1,0,0]
    v_mfma_f32_16x16x32_bf16 a[36:39], a[132:135], v[44:47], a[36:39]
    ds_read_b128 v[72:75], v125 offset:3584
    v_fma_mix_f32 v100, v178, v92, v84 op_sel:[0,0,0] op_sel_hi:[1,0,0]
    v_fma_mix_f32 v101, v178, v93, v85 op_sel:[1,0,0] op_sel_hi:[1,0,0]
    v_mfma_f32_16x16x32_bf16 a[4:7], a[132:135], v[40:43], a[4:7]
    ds_read_b128 v[76:79], v125 offset:3600
    v_fma_mix_f32 v102, v179, v94, v86 op_sel:[0,0,0] op_sel_hi:[1,0,0]
    v_mfma_f32_16x16x32_bf16 v[228:231], a[132:135], v[36:39], v[228:231]
    ds_read_b64_tr_b16 a[160:161], v116 offset:40960
    v_fma_mix_f32 v103, v179, v95, v87 op_sel:[1,0,0] op_sel_hi:[1,0,0]
    v_cvt_pk_bf16_f32 v48, v96, v97
    v_mfma_f32_16x16x32_bf16 v[196:199], a[132:135], v[32:35], v[196:199]
    ds_read_b64_tr_b16 a[162:163], v116 offset:41984
    v_cvt_pk_bf16_f32 v49, v98, v99
    v_cvt_pk_bf16_f32 v50, v100, v101
    v_mfma_f32_16x16x32_bf16 v[200:203], a[136:139], v[32:35], v[200:203]
    s_xor_b32 s41, s101, 28672
    buffer_load_dwordx4 v[164:167], v26, s[20:23], s41 offen offset:2048
    v_mfma_f32_16x16x32_bf16 v[232:235], a[136:139], v[36:39], v[232:235]
    ds_read_b64_tr_b16 a[164:165], v116 offset:40968
    v_cvt_pk_bf16_f32 v51, v102, v103
    v_fma_mix_f32 v104, v180, v88, v80 op_sel:[0,0,0] op_sel_hi:[1,0,0]
    v_mfma_f32_16x16x32_bf16 a[8:11], a[136:139], v[40:43], a[8:11]
    ds_read_b64_tr_b16 a[166:167], v116 offset:41992
    v_fma_mix_f32 v105, v180, v89, v81 op_sel:[1,0,0] op_sel_hi:[1,0,0]
    v_fma_mix_f32 v106, v181, v90, v82 op_sel:[0,0,0] op_sel_hi:[1,0,0]
    v_mfma_f32_16x16x32_bf16 a[40:43], a[136:139], v[44:47], a[40:43]
    ds_read_b64_tr_b16 a[168:169], v117 offset:40960
    v_fma_mix_f32 v107, v181, v91, v83 op_sel:[1,0,0] op_sel_hi:[1,0,0]
    v_mfma_f32_16x16x32_bf16 a[44:47], a[140:143], v[44:47], a[44:47]
    s_waitcnt lgkmcnt(9)
    ds_read_b64_tr_b16 a[170:171], v117 offset:41984
    v_fma_mix_f32 v108, v182, v92, v84 op_sel:[0,0,0] op_sel_hi:[1,0,0]
    v_fma_mix_f32 v109, v182, v93, v85 op_sel:[1,0,0] op_sel_hi:[1,0,0]
    v_mfma_f32_16x16x32_bf16 a[12:15], a[140:143], v[40:43], a[12:15]
    s_xor_b32 s42, s101, 143360
    buffer_load_dwordx4 v[168:171], v26, s[20:23], s42 offen offset:2048
    v_fma_mix_f32 v110, v183, v94, v86 op_sel:[0,0,0] op_sel_hi:[1,0,0]
    v_mfma_f32_16x16x32_bf16 v[236:239], a[140:143], v[36:39], v[236:239]
    ds_read_b64_tr_b16 a[172:173], v117 offset:40968
    v_fma_mix_f32 v111, v183, v95, v87 op_sel:[1,0,0] op_sel_hi:[1,0,0]
    v_mfma_f32_16x16x32_bf16 v[204:207], a[140:143], v[32:35], v[204:207]
    ds_read_b64_tr_b16 a[174:175], v117 offset:41992
    v_cvt_pk_bf16_f32 v52, v104, v105
    v_cvt_pk_bf16_f32 v53, v106, v107
    v_mfma_f32_16x16x32_bf16 v[208:211], a[144:147], v[32:35], v[208:211]
    ds_read_b64_tr_b16 a[176:177], v118 offset:40960
    v_cvt_pk_bf16_f32 v54, v108, v109
    v_cvt_pk_bf16_f32 v55, v110, v111
    v_mfma_f32_16x16x32_bf16 v[240:243], a[144:147], v[36:39], v[240:243]
    ds_read_b64_tr_b16 a[178:179], v118 offset:41984
    v_fma_mix_f32 v96, v184, v88, v80 op_sel:[0,0,0] op_sel_hi:[1,0,0]
    v_mfma_f32_16x16x32_bf16 a[16:19], a[144:147], v[40:43], a[16:19]
    ds_read_b64_tr_b16 a[180:181], v118 offset:40968
    v_fma_mix_f32 v97, v184, v89, v81 op_sel:[1,0,0] op_sel_hi:[1,0,0]
    v_fma_mix_f32 v98, v185, v90, v82 op_sel:[0,0,0] op_sel_hi:[1,0,0]
    v_mfma_f32_16x16x32_bf16 a[48:51], a[144:147], v[44:47], a[48:51]
    s_xor_b32 s43, s101, 159744
    buffer_load_dwordx4 v[172:175], v26, s[20:23], s43 offen offset:2048
    v_fma_mix_f32 v99, v185, v91, v83 op_sel:[1,0,0] op_sel_hi:[1,0,0]
    v_mfma_f32_16x16x32_bf16 a[52:55], a[148:151], v[44:47], a[52:55]
    ds_read_b64_tr_b16 a[182:183], v118 offset:41992
    v_fma_mix_f32 v100, v186, v92, v84 op_sel:[0,0,0] op_sel_hi:[1,0,0]
    v_mfma_f32_16x16x32_bf16 a[20:23], a[148:151], v[40:43], a[20:23]
    ds_read_b64_tr_b16 a[184:185], v119 offset:40960
    v_fma_mix_f32 v101, v186, v93, v85 op_sel:[1,0,0] op_sel_hi:[1,0,0]
    v_fma_mix_f32 v102, v187, v94, v86 op_sel:[0,0,0] op_sel_hi:[1,0,0]
    v_mfma_f32_16x16x32_bf16 v[244:247], a[148:151], v[36:39], v[244:247]
    ds_read_b64_tr_b16 a[186:187], v119 offset:41984
    v_fma_mix_f32 v103, v187, v95, v87 op_sel:[1,0,0] op_sel_hi:[1,0,0]
    v_cvt_pk_bf16_f32 v56, v96, v97
    v_mfma_f32_16x16x32_bf16 v[212:215], a[148:151], v[32:35], v[212:215]
    ds_read_b64_tr_b16 a[188:189], v119 offset:40968
    v_cvt_pk_bf16_f32 v57, v98, v99
    v_mfma_f32_16x16x32_bf16 v[216:219], a[152:155], v[32:35], v[216:219]
    s_add_u32 m0, s62, 131072
    s_mov_b32 s36, 3670016
    buffer_load_dwordx4 v124, s[16:19], s36 offen nt lds
    v_cvt_pk_bf16_f32 v58, v100, v101
    v_mfma_f32_16x16x32_bf16 v[248:251], a[152:155], v[36:39], v[248:251]
    ds_read_b64_tr_b16 a[190:191], v119 offset:41992
    v_cvt_pk_bf16_f32 v59, v102, v103
    v_fma_mix_f32 v104, v188, v88, v80 op_sel:[0,0,0] op_sel_hi:[1,0,0]
    v_mfma_f32_16x16x32_bf16 a[24:27], a[152:155], v[40:43], a[24:27]
    v_fma_mix_f32 v105, v188, v89, v81 op_sel:[1,0,0] op_sel_hi:[1,0,0]
    v_fma_mix_f32 v106, v189, v90, v82 op_sel:[0,0,0] op_sel_hi:[1,0,0]
    v_mfma_f32_16x16x32_bf16 a[56:59], a[152:155], v[44:47], a[56:59]
    v_fma_mix_f32 v107, v189, v91, v83 op_sel:[1,0,0] op_sel_hi:[1,0,0]
    v_fma_mix_f32 v108, v190, v92, v84 op_sel:[0,0,0] op_sel_hi:[1,0,0]
    v_fma_mix_f32 v109, v190, v93, v85 op_sel:[1,0,0] op_sel_hi:[1,0,0]
    v_mfma_f32_16x16x32_bf16 a[60:63], a[156:159], v[44:47], a[60:63]
    v_fma_mix_f32 v110, v191, v94, v86 op_sel:[0,0,0] op_sel_hi:[1,0,0]
    v_fma_mix_f32 v111, v191, v95, v87 op_sel:[1,0,0] op_sel_hi:[1,0,0]
    v_cvt_pk_bf16_f32 v60, v104, v105
    v_mfma_f32_16x16x32_bf16 a[28:31], a[156:159], v[40:43], a[28:31]
    s_add_u32 m0, s62, 135168
    s_mov_b32 s37, 3801088
    buffer_load_dwordx4 v124, s[16:19], s37 offen nt lds
    v_mfma_f32_16x16x32_bf16 v[252:255], a[156:159], v[36:39], v[252:255]
    v_cvt_pk_bf16_f32 v61, v106, v107
    v_cvt_pk_bf16_f32 v62, v108, v109
    v_cvt_pk_bf16_f32 v63, v110, v111
    v_mfma_f32_16x16x32_bf16 v[220:223], a[156:159], v[32:35], v[220:223]
    s_waitcnt lgkmcnt(8)
    v_mfma_f32_16x16x32_bf16 v[192:195], a[160:163], v[48:51], v[192:195]
    s_waitcnt vmcnt(12)
    s_barrier
    v_mfma_f32_16x16x32_bf16 v[224:227], a[160:163], v[52:55], v[224:227]
    ds_read_b128 v[80:83], v125 offset:1664
    v_fma_mix_f32 v96, v128, v72, v64 op_sel:[0,0,0] op_sel_hi:[1,0,0]
    v_fma_mix_f32 v97, v128, v73, v65 op_sel:[1,0,0] op_sel_hi:[1,0,0]
    v_mfma_f32_16x16x32_bf16 a[0:3], a[160:163], v[56:59], a[0:3]
    ds_read_b128 v[84:87], v125 offset:1680
    v_fma_mix_f32 v98, v129, v74, v66 op_sel:[0,0,0] op_sel_hi:[1,0,0]
    v_mfma_f32_16x16x32_bf16 a[32:35], a[160:163], v[60:63], a[32:35]
    s_xor_b32 s40, s101, 12288
    buffer_load_dwordx4 v[176:179], v26, s[20:23], s40 offen offset:3072
    v_fma_mix_f32 v99, v129, v75, v67 op_sel:[1,0,0] op_sel_hi:[1,0,0]
    v_mfma_f32_16x16x32_bf16 a[36:39], a[164:167], v[60:63], a[36:39]
    ds_read_b128 v[88:91], v125 offset:3712
    v_fma_mix_f32 v100, v130, v76, v68 op_sel:[0,0,0] op_sel_hi:[1,0,0]
    v_fma_mix_f32 v101, v130, v77, v69 op_sel:[1,0,0] op_sel_hi:[1,0,0]
    v_mfma_f32_16x16x32_bf16 a[4:7], a[164:167], v[56:59], a[4:7]
    ds_read_b128 v[92:95], v125 offset:3728
    v_fma_mix_f32 v102, v131, v78, v70 op_sel:[0,0,0] op_sel_hi:[1,0,0]
    v_mfma_f32_16x16x32_bf16 v[228:231], a[164:167], v[52:55], v[228:231]
    ds_read_b64_tr_b16 a[128:129], v116 offset:49152
    v_fma_mix_f32 v103, v131, v79, v71 op_sel:[1,0,0] op_sel_hi:[1,0,0]
    v_cvt_pk_bf16_f32 v32, v96, v97
    v_mfma_f32_16x16x32_bf16 v[196:199], a[164:167], v[48:51], v[196:199]
    ds_read_b64_tr_b16 a[130:131], v116 offset:50176
    v_cvt_pk_bf16_f32 v33, v98, v99
    v_cvt_pk_bf16_f32 v34, v100, v101
    v_mfma_f32_16x16x32_bf16 v[200:203], a[168:171], v[48:51], v[200:203]
    s_xor_b32 s41, s101, 28672
    buffer_load_dwordx4 v[180:183], v26, s[20:23], s41 offen offset:3072
    v_mfma_f32_16x16x32_bf16 v[232:235], a[168:171], v[52:55], v[232:235]
    ds_read_b64_tr_b16 a[132:133], v116 offset:49160
    v_cvt_pk_bf16_f32 v35, v102, v103
    v_fma_mix_f32 v104, v132, v72, v64 op_sel:[0,0,0] op_sel_hi:[1,0,0]
    v_mfma_f32_16x16x32_bf16 a[8:11], a[168:171], v[56:59], a[8:11]
    ds_read_b64_tr_b16 a[134:135], v116 offset:50184
    v_fma_mix_f32 v105, v132, v73, v65 op_sel:[1,0,0] op_sel_hi:[1,0,0]
    v_fma_mix_f32 v106, v133, v74, v66 op_sel:[0,0,0] op_sel_hi:[1,0,0]
    v_mfma_f32_16x16x32_bf16 a[40:43], a[168:171], v[60:63], a[40:43]
    ds_read_b64_tr_b16 a[136:137], v117 offset:49152
    v_fma_mix_f32 v107, v133, v75, v67 op_sel:[1,0,0] op_sel_hi:[1,0,0]
    v_mfma_f32_16x16x32_bf16 a[44:47], a[172:175], v[60:63], a[44:47]
    s_waitcnt lgkmcnt(9)
    ds_read_b64_tr_b16 a[138:139], v117 offset:50176
    v_fma_mix_f32 v108, v134, v76, v68 op_sel:[0,0,0] op_sel_hi:[1,0,0]
    v_fma_mix_f32 v109, v134, v77, v69 op_sel:[1,0,0] op_sel_hi:[1,0,0]
    v_mfma_f32_16x16x32_bf16 a[12:15], a[172:175], v[56:59], a[12:15]
    s_xor_b32 s42, s101, 143360
    buffer_load_dwordx4 v[184:187], v26, s[20:23], s42 offen offset:3072
    v_fma_mix_f32 v110, v135, v78, v70 op_sel:[0,0,0] op_sel_hi:[1,0,0]
    v_mfma_f32_16x16x32_bf16 v[236:239], a[172:175], v[52:55], v[236:239]
    ds_read_b64_tr_b16 a[140:141], v117 offset:49160
    v_fma_mix_f32 v111, v135, v79, v71 op_sel:[1,0,0] op_sel_hi:[1,0,0]
    v_mfma_f32_16x16x32_bf16 v[204:207], a[172:175], v[48:51], v[204:207]
    ds_read_b64_tr_b16 a[142:143], v117 offset:50184
    v_cvt_pk_bf16_f32 v36, v104, v105
    v_cvt_pk_bf16_f32 v37, v106, v107
    v_mfma_f32_16x16x32_bf16 v[208:211], a[176:179], v[48:51], v[208:211]
    ds_read_b64_tr_b16 a[144:145], v118 offset:49152
    v_cvt_pk_bf16_f32 v38, v108, v109
    v_cvt_pk_bf16_f32 v39, v110, v111
    v_mfma_f32_16x16x32_bf16 v[240:243], a[176:179], v[52:55], v[240:243]
    ds_read_b64_tr_b16 a[146:147], v118 offset:50176
    v_fma_mix_f32 v96, v136, v72, v64 op_sel:[0,0,0] op_sel_hi:[1,0,0]
    v_mfma_f32_16x16x32_bf16 a[16:19], a[176:179], v[56:59], a[16:19]
    ds_read_b64_tr_b16 a[148:149], v118 offset:49160
    v_fma_mix_f32 v97, v136, v73, v65 op_sel:[1,0,0] op_sel_hi:[1,0,0]
    v_fma_mix_f32 v98, v137, v74, v66 op_sel:[0,0,0] op_sel_hi:[1,0,0]
    v_mfma_f32_16x16x32_bf16 a[48:51], a[176:179], v[60:63], a[48:51]
    s_xor_b32 s43, s101, 159744
    buffer_load_dwordx4 v[188:191], v26, s[20:23], s43 offen offset:3072
    v_fma_mix_f32 v99, v137, v75, v67 op_sel:[1,0,0] op_sel_hi:[1,0,0]
    v_mfma_f32_16x16x32_bf16 a[52:55], a[180:183], v[60:63], a[52:55]
    ds_read_b64_tr_b16 a[150:151], v118 offset:50184
    v_fma_mix_f32 v100, v138, v76, v68 op_sel:[0,0,0] op_sel_hi:[1,0,0]
    v_mfma_f32_16x16x32_bf16 a[20:23], a[180:183], v[56:59], a[20:23]
    ds_read_b64_tr_b16 a[152:153], v119 offset:49152
    v_fma_mix_f32 v101, v138, v77, v69 op_sel:[1,0,0] op_sel_hi:[1,0,0]
    v_fma_mix_f32 v102, v139, v78, v70 op_sel:[0,0,0] op_sel_hi:[1,0,0]
    v_mfma_f32_16x16x32_bf16 v[244:247], a[180:183], v[52:55], v[244:247]
    ds_read_b64_tr_b16 a[154:155], v119 offset:50176
    v_fma_mix_f32 v103, v139, v79, v71 op_sel:[1,0,0] op_sel_hi:[1,0,0]
    v_cvt_pk_bf16_f32 v40, v96, v97
    v_mfma_f32_16x16x32_bf16 v[212:215], a[180:183], v[48:51], v[212:215]
    ds_read_b64_tr_b16 a[156:157], v119 offset:49160
    v_cvt_pk_bf16_f32 v41, v98, v99
    v_mfma_f32_16x16x32_bf16 v[216:219], a[184:187], v[48:51], v[216:219]
    s_add_u32 m0, s62, 139264
    s_mov_b32 s36, 3932160
    buffer_load_dwordx4 v124, s[16:19], s36 offen nt lds
    v_cvt_pk_bf16_f32 v42, v100, v101
    v_mfma_f32_16x16x32_bf16 v[248:251], a[184:187], v[52:55], v[248:251]
    ds_read_b64_tr_b16 a[158:159], v119 offset:50184
    v_cvt_pk_bf16_f32 v43, v102, v103
    v_fma_mix_f32 v104, v140, v72, v64 op_sel:[0,0,0] op_sel_hi:[1,0,0]
    v_mfma_f32_16x16x32_bf16 a[24:27], a[184:187], v[56:59], a[24:27]
    v_fma_mix_f32 v105, v140, v73, v65 op_sel:[1,0,0] op_sel_hi:[1,0,0]
    v_fma_mix_f32 v106, v141, v74, v66 op_sel:[0,0,0] op_sel_hi:[1,0,0]
    v_mfma_f32_16x16x32_bf16 a[56:59], a[184:187], v[60:63], a[56:59]
    v_fma_mix_f32 v107, v141, v75, v67 op_sel:[1,0,0] op_sel_hi:[1,0,0]
    v_fma_mix_f32 v108, v142, v76, v68 op_sel:[0,0,0] op_sel_hi:[1,0,0]
    v_fma_mix_f32 v109, v142, v77, v69 op_sel:[1,0,0] op_sel_hi:[1,0,0]
    v_mfma_f32_16x16x32_bf16 a[60:63], a[188:191], v[60:63], a[60:63]
    v_fma_mix_f32 v110, v143, v78, v70 op_sel:[0,0,0] op_sel_hi:[1,0,0]
    v_fma_mix_f32 v111, v143, v79, v71 op_sel:[1,0,0] op_sel_hi:[1,0,0]
    v_cvt_pk_bf16_f32 v44, v104, v105
    v_mfma_f32_16x16x32_bf16 a[28:31], a[188:191], v[56:59], a[28:31]
    s_add_u32 m0, s62, 143360
    s_mov_b32 s37, 4063232
    buffer_load_dwordx4 v124, s[16:19], s37 offen nt lds
    v_mfma_f32_16x16x32_bf16 v[252:255], a[188:191], v[52:55], v[252:255]
    v_cvt_pk_bf16_f32 v45, v106, v107
    v_cvt_pk_bf16_f32 v46, v108, v109
    v_cvt_pk_bf16_f32 v47, v110, v111
    v_mfma_f32_16x16x32_bf16 v[220:223], a[188:191], v[48:51], v[220:223]
    s_waitcnt lgkmcnt(8)
    v_mfma_f32_16x16x32_bf16 v[192:195], a[128:131], v[32:35], v[192:195]
    s_waitcnt vmcnt(12)
    s_barrier
    v_mfma_f32_16x16x32_bf16 v[224:227], a[128:131], v[36:39], v[224:227]
    ds_read_b128 v[64:67], v125 offset:1792
    v_fma_mix_f32 v96, v144, v88, v80 op_sel:[0,0,0] op_sel_hi:[1,0,0]
    v_fma_mix_f32 v97, v144, v89, v81 op_sel:[1,0,0] op_sel_hi:[1,0,0]
    v_mfma_f32_16x16x32_bf16 a[0:3], a[128:131], v[40:43], a[0:3]
    ds_read_b128 v[68:71], v125 offset:1808
    v_fma_mix_f32 v98, v145, v90, v82 op_sel:[0,0,0] op_sel_hi:[1,0,0]
    v_mfma_f32_16x16x32_bf16 a[32:35], a[128:131], v[44:47], a[32:35]
    ds_read_b128 v[72:75], v125 offset:3840
    v_fma_mix_f32 v99, v145, v91, v83 op_sel:[1,0,0] op_sel_hi:[1,0,0]
    v_fma_mix_f32 v100, v146, v92, v84 op_sel:[0,0,0] op_sel_hi:[1,0,0]
    v_mfma_f32_16x16x32_bf16 a[36:39], a[132:135], v[44:47], a[36:39]
    s_add_u32 m0, s32, 0
    s_mov_b32 s33, 0
    buffer_load_dwordx4 v20, s[8:11], s33 offen offset:0 nt lds
    v_mfma_f32_16x16x32_bf16 a[4:7], a[132:135], v[40:43], a[4:7]
    ds_read_b128 v[76:79], v125 offset:3856
    v_fma_mix_f32 v101, v146, v93, v85 op_sel:[1,0,0] op_sel_hi:[1,0,0]
    v_fma_mix_f32 v102, v147, v94, v86 op_sel:[0,0,0] op_sel_hi:[1,0,0]
    v_mfma_f32_16x16x32_bf16 v[228:231], a[132:135], v[36:39], v[228:231]
    ds_read_b64_tr_b16 a[160:161], v116 offset:57344
    v_fma_mix_f32 v103, v147, v95, v87 op_sel:[1,0,0] op_sel_hi:[1,0,0]
    v_mfma_f32_16x16x32_bf16 v[196:199], a[132:135], v[32:35], v[196:199]
    ds_read_b64_tr_b16 a[162:163], v116 offset:58368
    v_cvt_pk_bf16_f32 v48, v96, v97
    v_cvt_pk_bf16_f32 v49, v98, v99
    v_mfma_f32_16x16x32_bf16 v[200:203], a[136:139], v[32:35], v[200:203]
    ds_read_b64_tr_b16 a[164:165], v116 offset:57352
    v_cvt_pk_bf16_f32 v50, v100, v101
    v_mfma_f32_16x16x32_bf16 v[232:235], a[136:139], v[36:39], v[232:235]
    ds_read_b64_tr_b16 a[166:167], v116 offset:58376
    v_cvt_pk_bf16_f32 v51, v102, v103
    v_fma_mix_f32 v104, v148, v88, v80 op_sel:[0,0,0] op_sel_hi:[1,0,0]
    v_mfma_f32_16x16x32_bf16 a[8:11], a[136:139], v[40:43], a[8:11]
    ds_read_b64_tr_b16 a[168:169], v117 offset:57344
    v_fma_mix_f32 v105, v148, v89, v81 op_sel:[1,0,0] op_sel_hi:[1,0,0]
    v_mfma_f32_16x16x32_bf16 a[40:43], a[136:139], v[44:47], a[40:43]
    ds_read_b64_tr_b16 a[170:171], v117 offset:58368
    v_fma_mix_f32 v106, v149, v90, v82 op_sel:[0,0,0] op_sel_hi:[1,0,0]
    v_fma_mix_f32 v107, v149, v91, v83 op_sel:[1,0,0] op_sel_hi:[1,0,0]
    v_mfma_f32_16x16x32_bf16 a[44:47], a[140:143], v[44:47], a[44:47]
    s_waitcnt lgkmcnt(10)
    s_add_u32 m0, s32, 0
    s_mov_b32 s33, 0
    buffer_load_dwordx4 v21, s[8:11], s33 offen offset:1024 nt lds
    v_mfma_f32_16x16x32_bf16 a[12:15], a[140:143], v[40:43], a[12:15]
    ds_read_b64_tr_b16 a[172:173], v117 offset:57352
    v_fma_mix_f32 v108, v150, v92, v84 op_sel:[0,0,0] op_sel_hi:[1,0,0]
    v_fma_mix_f32 v109, v150, v93, v85 op_sel:[1,0,0] op_sel_hi:[1,0,0]
    v_mfma_f32_16x16x32_bf16 v[236:239], a[140:143], v[36:39], v[236:239]
    ds_read_b64_tr_b16 a[174:175], v117 offset:58376
    v_fma_mix_f32 v110, v151, v94, v86 op_sel:[0,0,0] op_sel_hi:[1,0,0]
    v_mfma_f32_16x16x32_bf16 v[204:207], a[140:143], v[32:35], v[204:207]
    ds_read_b64_tr_b16 a[176:177], v118 offset:57344
    v_fma_mix_f32 v111, v151, v95, v87 op_sel:[1,0,0] op_sel_hi:[1,0,0]
    v_cvt_pk_bf16_f32 v52, v104, v105
    v_mfma_f32_16x16x32_bf16 v[208:211], a[144:147], v[32:35], v[208:211]
    ds_read_b64_tr_b16 a[178:179], v118 offset:58368
    v_cvt_pk_bf16_f32 v53, v106, v107
    v_cvt_pk_bf16_f32 v54, v108, v109
    v_mfma_f32_16x16x32_bf16 v[240:243], a[144:147], v[36:39], v[240:243]
    ds_read_b64_tr_b16 a[180:181], v118 offset:57352
    v_cvt_pk_bf16_f32 v55, v110, v111
    v_mfma_f32_16x16x32_bf16 a[16:19], a[144:147], v[40:43], a[16:19]
    ds_read_b64_tr_b16 a[182:183], v118 offset:58376
    v_fma_mix_f32 v96, v152, v88, v80 op_sel:[0,0,0] op_sel_hi:[1,0,0]
    v_fma_mix_f32 v97, v152, v89, v81 op_sel:[1,0,0] op_sel_hi:[1,0,0]
    v_mfma_f32_16x16x32_bf16 a[48:51], a[144:147], v[44:47], a[48:51]
    ds_read_b64_tr_b16 a[184:185], v119 offset:57344
    v_fma_mix_f32 v98, v153, v90, v82 op_sel:[0,0,0] op_sel_hi:[1,0,0]
    v_mfma_f32_16x16x32_bf16 a[52:55], a[148:151], v[44:47], a[52:55]
    s_add_u32 m0, s32, 0
    s_mov_b32 s33, 0
    buffer_load_dwordx4 v22, s[8:11], s33 offen offset:2048 nt lds
    v_fma_mix_f32 v99, v153, v91, v83 op_sel:[1,0,0] op_sel_hi:[1,0,0]
    v_mfma_f32_16x16x32_bf16 a[20:23], a[148:151], v[40:43], a[20:23]
    ds_read_b64_tr_b16 a[186:187], v119 offset:58368
    v_fma_mix_f32 v100, v154, v92, v84 op_sel:[0,0,0] op_sel_hi:[1,0,0]
    v_mfma_f32_16x16x32_bf16 v[244:247], a[148:151], v[36:39], v[244:247]
    ds_read_b64_tr_b16 a[188:189], v119 offset:57352
    v_fma_mix_f32 v101, v154, v93, v85 op_sel:[1,0,0] op_sel_hi:[1,0,0]
    v_fma_mix_f32 v102, v155, v94, v86 op_sel:[0,0,0] op_sel_hi:[1,0,0]
    v_mfma_f32_16x16x32_bf16 v[212:215], a[148:151], v[32:35], v[212:215]
    ds_read_b64_tr_b16 a[190:191], v119 offset:58376
    v_fma_mix_f32 v103, v155, v95, v87 op_sel:[1,0,0] op_sel_hi:[1,0,0]
    v_mfma_f32_16x16x32_bf16 v[216:219], a[152:155], v[32:35], v[216:219]
    v_cvt_pk_bf16_f32 v56, v96, v97
    v_cvt_pk_bf16_f32 v57, v98, v99
    v_cvt_pk_bf16_f32 v58, v100, v101
    v_mfma_f32_16x16x32_bf16 v[248:251], a[152:155], v[36:39], v[248:251]
    v_cvt_pk_bf16_f32 v59, v102, v103
    v_fma_mix_f32 v104, v156, v88, v80 op_sel:[0,0,0] op_sel_hi:[1,0,0]
    v_mfma_f32_16x16x32_bf16 a[24:27], a[152:155], v[40:43], a[24:27]
    v_fma_mix_f32 v105, v156, v89, v81 op_sel:[1,0,0] op_sel_hi:[1,0,0]
    v_fma_mix_f32 v106, v157, v90, v82 op_sel:[0,0,0] op_sel_hi:[1,0,0]
    v_fma_mix_f32 v107, v157, v91, v83 op_sel:[1,0,0] op_sel_hi:[1,0,0]
    v_mfma_f32_16x16x32_bf16 a[56:59], a[152:155], v[44:47], a[56:59]
    v_fma_mix_f32 v108, v158, v92, v84 op_sel:[0,0,0] op_sel_hi:[1,0,0]
    v_fma_mix_f32 v109, v158, v93, v85 op_sel:[1,0,0] op_sel_hi:[1,0,0]
    v_mfma_f32_16x16x32_bf16 a[60:63], a[156:159], v[44:47], a[60:63]
    s_add_u32 m0, s32, 0
    s_mov_b32 s33, 0
    buffer_load_dwordx4 v23, s[8:11], s33 offen offset:3072 nt lds
    v_fma_mix_f32 v110, v159, v94, v86 op_sel:[0,0,0] op_sel_hi:[1,0,0]
    v_mfma_f32_16x16x32_bf16 a[28:31], a[156:159], v[40:43], a[28:31]
    v_fma_mix_f32 v111, v159, v95, v87 op_sel:[1,0,0] op_sel_hi:[1,0,0]
    v_cvt_pk_bf16_f32 v60, v104, v105
    v_mfma_f32_16x16x32_bf16 v[252:255], a[156:159], v[36:39], v[252:255]
    v_cvt_pk_bf16_f32 v61, v106, v107
    v_cvt_pk_bf16_f32 v62, v108, v109
    v_cvt_pk_bf16_f32 v63, v110, v111
    v_mfma_f32_16x16x32_bf16 v[220:223], a[156:159], v[32:35], v[220:223]
    s_waitcnt lgkmcnt(8)
    v_mfma_f32_16x16x32_bf16 v[192:195], a[160:163], v[48:51], v[192:195]
    s_waitcnt vmcnt(10)
    s_barrier
    v_mfma_f32_16x16x32_bf16 v[224:227], a[160:163], v[52:55], v[224:227]
    ds_read_b128 v[80:83], v125 offset:1920
    v_fma_mix_f32 v96, v160, v72, v64 op_sel:[0,0,0] op_sel_hi:[1,0,0]
    v_fma_mix_f32 v97, v160, v73, v65 op_sel:[1,0,0] op_sel_hi:[1,0,0]
    v_mfma_f32_16x16x32_bf16 a[0:3], a[160:163], v[56:59], a[0:3]
    ds_read_b128 v[84:87], v125 offset:1936
    v_fma_mix_f32 v98, v161, v74, v66 op_sel:[0,0,0] op_sel_hi:[1,0,0]
    v_mfma_f32_16x16x32_bf16 a[32:35], a[160:163], v[60:63], a[32:35]
    ds_read_b128 v[88:91], v125 offset:3968
    v_fma_mix_f32 v99, v161, v75, v67 op_sel:[1,0,0] op_sel_hi:[1,0,0]
    v_fma_mix_f32 v100, v162, v76, v68 op_sel:[0,0,0] op_sel_hi:[1,0,0]
    v_mfma_f32_16x16x32_bf16 a[36:39], a[164:167], v[60:63], a[36:39]
    s_add_u32 m0, s32, 16384
    s_mov_b32 s33, 16384
    buffer_load_dwordx4 v20, s[8:11], s33 offen offset:0 nt lds
    v_mfma_f32_16x16x32_bf16 a[4:7], a[164:167], v[56:59], a[4:7]
    ds_read_b128 v[92:95], v125 offset:3984
    v_fma_mix_f32 v101, v162, v77, v69 op_sel:[1,0,0] op_sel_hi:[1,0,0]
    v_fma_mix_f32 v102, v163, v78, v70 op_sel:[0,0,0] op_sel_hi:[1,0,0]
    v_mfma_f32_16x16x32_bf16 v[228:231], a[164:167], v[52:55], v[228:231]
    ds_read_b64_tr_b16 a[128:129], v120 offset:0
    v_fma_mix_f32 v103, v163, v79, v71 op_sel:[1,0,0] op_sel_hi:[1,0,0]
    v_mfma_f32_16x16x32_bf16 v[196:199], a[164:167], v[48:51], v[196:199]
    ds_read_b64_tr_b16 a[130:131], v120 offset:1024
    v_cvt_pk_bf16_f32 v32, v96, v97
    v_cvt_pk_bf16_f32 v33, v98, v99
    v_mfma_f32_16x16x32_bf16 v[200:203], a[168:171], v[48:51], v[200:203]
    ds_read_b64_tr_b16 a[132:133], v120 offset:8
    v_cvt_pk_bf16_f32 v34, v100, v101
    v_mfma_f32_16x16x32_bf16 v[232:235], a[168:171], v[52:55], v[232:235]
    ds_read_b64_tr_b16 a[134:135], v120 offset:1032
    v_cvt_pk_bf16_f32 v35, v102, v103
    v_fma_mix_f32 v104, v164, v72, v64 op_sel:[0,0,0] op_sel_hi:[1,0,0]
    v_mfma_f32_16x16x32_bf16 a[8:11], a[168:171], v[56:59], a[8:11]
    ds_read_b64_tr_b16 a[136:137], v121 offset:0
    v_fma_mix_f32 v105, v164, v73, v65 op_sel:[1,0,0] op_sel_hi:[1,0,0]
    v_mfma_f32_16x16x32_bf16 a[40:43], a[168:171], v[60:63], a[40:43]
    ds_read_b64_tr_b16 a[138:139], v121 offset:1024
    v_fma_mix_f32 v106, v165, v74, v66 op_sel:[0,0,0] op_sel_hi:[1,0,0]
    v_fma_mix_f32 v107, v165, v75, v67 op_sel:[1,0,0] op_sel_hi:[1,0,0]
    v_mfma_f32_16x16x32_bf16 a[44:47], a[172:175], v[60:63], a[44:47]
    s_waitcnt lgkmcnt(10)
    s_add_u32 m0, s32, 16384
    s_mov_b32 s33, 16384
    buffer_load_dwordx4 v21, s[8:11], s33 offen offset:1024 nt lds
    v_mfma_f32_16x16x32_bf16 a[12:15], a[172:175], v[56:59], a[12:15]
    ds_read_b64_tr_b16 a[140:141], v121 offset:8
    v_fma_mix_f32 v108, v166, v76, v68 op_sel:[0,0,0] op_sel_hi:[1,0,0]
    v_fma_mix_f32 v109, v166, v77, v69 op_sel:[1,0,0] op_sel_hi:[1,0,0]
    v_mfma_f32_16x16x32_bf16 v[236:239], a[172:175], v[52:55], v[236:239]
    ds_read_b64_tr_b16 a[142:143], v121 offset:1032
    v_fma_mix_f32 v110, v167, v78, v70 op_sel:[0,0,0] op_sel_hi:[1,0,0]
    v_mfma_f32_16x16x32_bf16 v[204:207], a[172:175], v[48:51], v[204:207]
    ds_read_b64_tr_b16 a[144:145], v122 offset:0
    v_fma_mix_f32 v111, v167, v79, v71 op_sel:[1,0,0] op_sel_hi:[1,0,0]
    v_cvt_pk_bf16_f32 v36, v104, v105
    v_mfma_f32_16x16x32_bf16 v[208:211], a[176:179], v[48:51], v[208:211]
    ds_read_b64_tr_b16 a[146:147], v122 offset:1024
    v_cvt_pk_bf16_f32 v37, v106, v107
    v_cvt_pk_bf16_f32 v38, v108, v109
    v_mfma_f32_16x16x32_bf16 v[240:243], a[176:179], v[52:55], v[240:243]
    ds_read_b64_tr_b16 a[148:149], v122 offset:8
    v_cvt_pk_bf16_f32 v39, v110, v111
    v_mfma_f32_16x16x32_bf16 a[16:19], a[176:179], v[56:59], a[16:19]
    ds_read_b64_tr_b16 a[150:151], v122 offset:1032
    v_fma_mix_f32 v96, v168, v72, v64 op_sel:[0,0,0] op_sel_hi:[1,0,0]
    v_fma_mix_f32 v97, v168, v73, v65 op_sel:[1,0,0] op_sel_hi:[1,0,0]
    v_mfma_f32_16x16x32_bf16 a[48:51], a[176:179], v[60:63], a[48:51]
    ds_read_b64_tr_b16 a[152:153], v123 offset:0
    v_fma_mix_f32 v98, v169, v74, v66 op_sel:[0,0,0] op_sel_hi:[1,0,0]
    v_mfma_f32_16x16x32_bf16 a[52:55], a[180:183], v[60:63], a[52:55]
    s_add_u32 m0, s32, 16384
    s_mov_b32 s33, 16384
    buffer_load_dwordx4 v22, s[8:11], s33 offen offset:2048 nt lds
    v_fma_mix_f32 v99, v169, v75, v67 op_sel:[1,0,0] op_sel_hi:[1,0,0]
    v_mfma_f32_16x16x32_bf16 a[20:23], a[180:183], v[56:59], a[20:23]
    ds_read_b64_tr_b16 a[154:155], v123 offset:1024
    v_fma_mix_f32 v100, v170, v76, v68 op_sel:[0,0,0] op_sel_hi:[1,0,0]
    v_mfma_f32_16x16x32_bf16 v[244:247], a[180:183], v[52:55], v[244:247]
    ds_read_b64_tr_b16 a[156:157], v123 offset:8
    v_fma_mix_f32 v101, v170, v77, v69 op_sel:[1,0,0] op_sel_hi:[1,0,0]
    v_fma_mix_f32 v102, v171, v78, v70 op_sel:[0,0,0] op_sel_hi:[1,0,0]
    v_mfma_f32_16x16x32_bf16 v[212:215], a[180:183], v[48:51], v[212:215]
    ds_read_b64_tr_b16 a[158:159], v123 offset:1032
    v_fma_mix_f32 v103, v171, v79, v71 op_sel:[1,0,0] op_sel_hi:[1,0,0]
    v_mfma_f32_16x16x32_bf16 v[216:219], a[184:187], v[48:51], v[216:219]
    v_cvt_pk_bf16_f32 v40, v96, v97
    v_cvt_pk_bf16_f32 v41, v98, v99
    v_cvt_pk_bf16_f32 v42, v100, v101
    v_mfma_f32_16x16x32_bf16 v[248:251], a[184:187], v[52:55], v[248:251]
    v_cvt_pk_bf16_f32 v43, v102, v103
    v_fma_mix_f32 v104, v172, v72, v64 op_sel:[0,0,0] op_sel_hi:[1,0,0]
    v_mfma_f32_16x16x32_bf16 a[24:27], a[184:187], v[56:59], a[24:27]
    v_fma_mix_f32 v105, v172, v73, v65 op_sel:[1,0,0] op_sel_hi:[1,0,0]
    v_fma_mix_f32 v106, v173, v74, v66 op_sel:[0,0,0] op_sel_hi:[1,0,0]
    v_fma_mix_f32 v107, v173, v75, v67 op_sel:[1,0,0] op_sel_hi:[1,0,0]
    v_mfma_f32_16x16x32_bf16 a[56:59], a[184:187], v[60:63], a[56:59]
    v_fma_mix_f32 v108, v174, v76, v68 op_sel:[0,0,0] op_sel_hi:[1,0,0]
    v_fma_mix_f32 v109, v174, v77, v69 op_sel:[1,0,0] op_sel_hi:[1,0,0]
    v_mfma_f32_16x16x32_bf16 a[60:63], a[188:191], v[60:63], a[60:63]
    s_add_u32 m0, s32, 16384
    s_mov_b32 s33, 16384
    buffer_load_dwordx4 v23, s[8:11], s33 offen offset:3072 nt lds
    v_fma_mix_f32 v110, v175, v78, v70 op_sel:[0,0,0] op_sel_hi:[1,0,0]
    v_mfma_f32_16x16x32_bf16 a[28:31], a[188:191], v[56:59], a[28:31]
    v_fma_mix_f32 v111, v175, v79, v71 op_sel:[1,0,0] op_sel_hi:[1,0,0]
    v_cvt_pk_bf16_f32 v44, v104, v105
    v_mfma_f32_16x16x32_bf16 v[252:255], a[188:191], v[52:55], v[252:255]
    v_cvt_pk_bf16_f32 v45, v106, v107
    v_cvt_pk_bf16_f32 v46, v108, v109
    v_cvt_pk_bf16_f32 v47, v110, v111
    v_mfma_f32_16x16x32_bf16 v[220:223], a[188:191], v[48:51], v[220:223]
    s_waitcnt lgkmcnt(8)
    v_mfma_f32_16x16x32_bf16 v[192:195], a[128:131], v[32:35], v[192:195]
    s_waitcnt vmcnt(8)
    s_barrier
    v_mfma_f32_16x16x32_bf16 v[224:227], a[128:131], v[36:39], v[224:227]
    ds_read_b64_tr_b16 a[160:161], v120 offset:8192
    v_fma_mix_f32 v96, v176, v88, v80 op_sel:[0,0,0] op_sel_hi:[1,0,0]
    v_mfma_f32_16x16x32_bf16 a[0:3], a[128:131], v[40:43], a[0:3]
    ds_read_b64_tr_b16 a[162:163], v120 offset:9216
    v_fma_mix_f32 v97, v176, v89, v81 op_sel:[1,0,0] op_sel_hi:[1,0,0]
    v_fma_mix_f32 v98, v177, v90, v82 op_sel:[0,0,0] op_sel_hi:[1,0,0]
    v_mfma_f32_16x16x32_bf16 a[32:35], a[128:131], v[44:47], a[32:35]
    ds_read_b64_tr_b16 a[164:165], v120 offset:8200
    v_fma_mix_f32 v99, v177, v91, v83 op_sel:[1,0,0] op_sel_hi:[1,0,0]
    v_mfma_f32_16x16x32_bf16 a[36:39], a[132:135], v[44:47], a[36:39]
    s_add_u32 m0, s32, 65536
    s_mov_b32 s34, 0
    buffer_load_dwordx4 v24, s[12:15], s34 offen offset:0 nt lds
    v_fma_mix_f32 v100, v178, v92, v84 op_sel:[0,0,0] op_sel_hi:[1,0,0]
    v_mfma_f32_16x16x32_bf16 a[4:7], a[132:135], v[40:43], a[4:7]
    ds_read_b64_tr_b16 a[166:167], v120 offset:9224
    v_fma_mix_f32 v101, v178, v93, v85 op_sel:[1,0,0] op_sel_hi:[1,0,0]
    v_mfma_f32_16x16x32_bf16 v[228:231], a[132:135], v[36:39], v[228:231]
    ds_read_b64_tr_b16 a[168:169], v121 offset:8192
    v_fma_mix_f32 v102, v179, v94, v86 op_sel:[0,0,0] op_sel_hi:[1,0,0]
    v_mfma_f32_16x16x32_bf16 v[196:199], a[132:135], v[32:35], v[196:199]
    ds_read_b64_tr_b16 a[170:171], v121 offset:9216
    v_fma_mix_f32 v103, v179, v95, v87 op_sel:[1,0,0] op_sel_hi:[1,0,0]
    v_cvt_pk_bf16_f32 v48, v96, v97
    v_mfma_f32_16x16x32_bf16 v[200:203], a[136:139], v[32:35], v[200:203]
    ds_read_b64_tr_b16 a[172:173], v121 offset:8200
    v_cvt_pk_bf16_f32 v49, v98, v99
    v_mfma_f32_16x16x32_bf16 v[232:235], a[136:139], v[36:39], v[232:235]
    ds_read_b64_tr_b16 a[174:175], v121 offset:9224
    v_cvt_pk_bf16_f32 v50, v100, v101
    v_cvt_pk_bf16_f32 v51, v102, v103
    v_mfma_f32_16x16x32_bf16 a[8:11], a[136:139], v[40:43], a[8:11]
    ds_read_b64_tr_b16 a[176:177], v122 offset:8192
    v_fma_mix_f32 v104, v180, v88, v80 op_sel:[0,0,0] op_sel_hi:[1,0,0]
    v_mfma_f32_16x16x32_bf16 a[40:43], a[136:139], v[44:47], a[40:43]
    ds_read_b64_tr_b16 a[178:179], v122 offset:9216
    v_fma_mix_f32 v105, v180, v89, v81 op_sel:[1,0,0] op_sel_hi:[1,0,0]
    v_mfma_f32_16x16x32_bf16 a[44:47], a[140:143], v[44:47], a[44:47]
    s_waitcnt lgkmcnt(10)
    s_add_u32 m0, s32, 65536
    s_mov_b32 s34, 0
    buffer_load_dwordx4 v25, s[12:15], s34 offen offset:1024 nt lds
    v_fma_mix_f32 v106, v181, v90, v82 op_sel:[0,0,0] op_sel_hi:[1,0,0]
    v_mfma_f32_16x16x32_bf16 a[12:15], a[140:143], v[40:43], a[12:15]
    ds_read_b64_tr_b16 a[180:181], v122 offset:8200
    v_fma_mix_f32 v107, v181, v91, v83 op_sel:[1,0,0] op_sel_hi:[1,0,0]
    v_mfma_f32_16x16x32_bf16 v[236:239], a[140:143], v[36:39], v[236:239]
    ds_read_b64_tr_b16 a[182:183], v122 offset:9224
    v_fma_mix_f32 v108, v182, v92, v84 op_sel:[0,0,0] op_sel_hi:[1,0,0]
    v_fma_mix_f32 v109, v182, v93, v85 op_sel:[1,0,0] op_sel_hi:[1,0,0]
    v_mfma_f32_16x16x32_bf16 v[204:207], a[140:143], v[32:35], v[204:207]
    ds_read_b64_tr_b16 a[184:185], v123 offset:8192
    v_fma_mix_f32 v110, v183, v94, v86 op_sel:[0,0,0] op_sel_hi:[1,0,0]
    v_mfma_f32_16x16x32_bf16 v[208:211], a[144:147], v[32:35], v[208:211]
    ds_read_b64_tr_b16 a[186:187], v123 offset:9216
    v_fma_mix_f32 v111, v183, v95, v87 op_sel:[1,0,0] op_sel_hi:[1,0,0]
    v_mfma_f32_16x16x32_bf16 v[240:243], a[144:147], v[36:39], v[240:243]
    ds_read_b64_tr_b16 a[188:189], v123 offset:8200
    v_cvt_pk_bf16_f32 v52, v104, v105
    v_cvt_pk_bf16_f32 v53, v106, v107
    v_mfma_f32_16x16x32_bf16 a[16:19], a[144:147], v[40:43], a[16:19]
    ds_read_b64_tr_b16 a[190:191], v123 offset:9224
    v_cvt_pk_bf16_f32 v54, v108, v109
    v_mfma_f32_16x16x32_bf16 a[48:51], a[144:147], v[44:47], a[48:51]
    v_cvt_pk_bf16_f32 v55, v110, v111
    v_fma_mix_f32 v96, v184, v88, v80 op_sel:[0,0,0] op_sel_hi:[1,0,0]
    v_fma_mix_f32 v97, v184, v89, v81 op_sel:[1,0,0] op_sel_hi:[1,0,0]
    v_mfma_f32_16x16x32_bf16 a[52:55], a[148:151], v[44:47], a[52:55]
    s_add_u32 m0, s32, 65536
    s_mov_b32 s34, 0
    buffer_load_dwordx4 v24, s[12:15], s34 offen offset:2048 nt lds
    v_mfma_f32_16x16x32_bf16 a[20:23], a[148:151], v[40:43], a[20:23]
    v_fma_mix_f32 v98, v185, v90, v82 op_sel:[0,0,0] op_sel_hi:[1,0,0]
    v_fma_mix_f32 v99, v185, v91, v83 op_sel:[1,0,0] op_sel_hi:[1,0,0]
    v_mfma_f32_16x16x32_bf16 v[244:247], a[148:151], v[36:39], v[244:247]
    v_fma_mix_f32 v100, v186, v92, v84 op_sel:[0,0,0] op_sel_hi:[1,0,0]
    v_fma_mix_f32 v101, v186, v93, v85 op_sel:[1,0,0] op_sel_hi:[1,0,0]
    v_fma_mix_f32 v102, v187, v94, v86 op_sel:[0,0,0] op_sel_hi:[1,0,0]
    v_mfma_f32_16x16x32_bf16 v[212:215], a[148:151], v[32:35], v[212:215]
    v_fma_mix_f32 v103, v187, v95, v87 op_sel:[1,0,0] op_sel_hi:[1,0,0]
    v_cvt_pk_bf16_f32 v56, v96, v97
    v_mfma_f32_16x16x32_bf16 v[216:219], a[152:155], v[32:35], v[216:219]
    v_cvt_pk_bf16_f32 v57, v98, v99
    v_cvt_pk_bf16_f32 v58, v100, v101
    v_cvt_pk_bf16_f32 v59, v102, v103
    v_mfma_f32_16x16x32_bf16 v[248:251], a[152:155], v[36:39], v[248:251]
    v_fma_mix_f32 v104, v188, v88, v80 op_sel:[0,0,0] op_sel_hi:[1,0,0]
    v_fma_mix_f32 v105, v188, v89, v81 op_sel:[1,0,0] op_sel_hi:[1,0,0]
    v_mfma_f32_16x16x32_bf16 a[24:27], a[152:155], v[40:43], a[24:27]
    v_fma_mix_f32 v106, v189, v90, v82 op_sel:[0,0,0] op_sel_hi:[1,0,0]
    v_fma_mix_f32 v107, v189, v91, v83 op_sel:[1,0,0] op_sel_hi:[1,0,0]
    v_mfma_f32_16x16x32_bf16 a[56:59], a[152:155], v[44:47], a[56:59]
    v_fma_mix_f32 v108, v190, v92, v84 op_sel:[0,0,0] op_sel_hi:[1,0,0]
    v_fma_mix_f32 v109, v190, v93, v85 op_sel:[1,0,0] op_sel_hi:[1,0,0]
    v_fma_mix_f32 v110, v191, v94, v86 op_sel:[0,0,0] op_sel_hi:[1,0,0]
    v_mfma_f32_16x16x32_bf16 a[60:63], a[156:159], v[44:47], a[60:63]
    s_add_u32 m0, s32, 65536
    s_mov_b32 s34, 0
    buffer_load_dwordx4 v25, s[12:15], s34 offen offset:3072 nt lds
    v_mfma_f32_16x16x32_bf16 a[28:31], a[156:159], v[40:43], a[28:31]
    v_fma_mix_f32 v111, v191, v95, v87 op_sel:[1,0,0] op_sel_hi:[1,0,0]
    v_cvt_pk_bf16_f32 v60, v104, v105
    v_cvt_pk_bf16_f32 v61, v106, v107
    v_mfma_f32_16x16x32_bf16 v[252:255], a[156:159], v[36:39], v[252:255]
    v_cvt_pk_bf16_f32 v62, v108, v109
    v_cvt_pk_bf16_f32 v63, v110, v111
    v_mfma_f32_16x16x32_bf16 v[220:223], a[156:159], v[32:35], v[220:223]
    s_waitcnt lgkmcnt(0)
    v_mfma_f32_16x16x32_bf16 v[192:195], a[160:163], v[48:51], v[192:195]
    s_waitcnt vmcnt(8)
    s_barrier
    v_mov_b32 v28, 0
    v_mov_b32 v29, 0
    v_mfma_f32_16x16x32_bf16 v[196:199], a[164:167], v[48:51], v[196:199]
    ds_read_b128 a[64:67], v8 offset:0
    v_mov_b32 v30, 0
    v_mfma_f32_16x16x32_bf16 v[200:203], a[168:171], v[48:51], v[200:203]
    ds_read_b128 a[68:71], v9 offset:0
    v_mov_b32 v31, 0
    v_mfma_f32_16x16x32_bf16 v[204:207], a[172:175], v[48:51], v[204:207]
    ds_read_b128 a[72:75], v10 offset:0
    v_lshrrev_b32 v5, 8, v26
    v_mfma_f32_16x16x32_bf16 v[208:211], a[176:179], v[48:51], v[208:211]
    ds_read_b128 a[76:79], v11 offset:0
    v_lshlrev_b32 v5, 24, v5
    v_mfma_f32_16x16x32_bf16 v[212:215], a[180:183], v[48:51], v[212:215]
    ds_read_b128 a[80:83], v8 offset:4096
    v_lshl_add_u32 v2, v26, 3, v5
    v_mfma_f32_16x16x32_bf16 v[216:219], a[184:187], v[48:51], v[216:219]
    ds_read_b128 a[84:87], v9 offset:4096
    v_and_b32 v6, 0x380, v2
    v_mfma_f32_16x16x32_bf16 v[220:223], a[188:191], v[48:51], v[220:223]
    ds_read_b128 a[88:91], v10 offset:4096
    v_min_u32 v6, 764, v6
    v_mfma_f32_16x16x32_bf16 v[224:227], a[160:163], v[52:55], v[224:227]
    ds_read_b128 a[92:95], v11 offset:4096
    v_bfe_u32 v3, v26, 7, 1
    v_mfma_f32_16x16x32_bf16 v[228:231], a[164:167], v[52:55], v[228:231]
    ds_read_b128 a[96:99], v8 offset:8192
    v_mul_u32_u24 v3, 2752, v3
    v_mfma_f32_16x16x32_bf16 v[232:235], a[168:171], v[52:55], v[232:235]
    ds_read_b128 a[100:103], v9 offset:8192
    v_add3_u32 v3, v3, v6, v5
    v_mfma_f32_16x16x32_bf16 v[236:239], a[172:175], v[52:55], v[236:239]
    ds_read_b128 a[104:107], v10 offset:8192
    v_bfe_u32 v4, v26, 6, 2
    v_mfma_f32_16x16x32_bf16 v[240:243], a[176:179], v[52:55], v[240:243]
    ds_read_b128 a[108:111], v11 offset:8192
    v_and_b32 v6, 0x180, v2
    v_mfma_f32_16x16x32_bf16 v[244:247], a[180:183], v[52:55], v[244:247]
    ds_read_b128 a[112:115], v8 offset:12288
    v_lshl_add_u32 v4, v4, 10, v6
    v_mfma_f32_16x16x32_bf16 v[248:251], a[184:187], v[52:55], v[248:251]
    ds_read_b128 a[116:119], v9 offset:12288
    v_add_u32 v4, v4, v5
    v_mfma_f32_16x16x32_bf16 v[252:255], a[188:191], v[52:55], v[252:255]
    ds_read_b128 a[120:123], v10 offset:12288
    v_cvt_pk_bf16_f32 v128, v192, v193
    v_mfma_f32_16x16x32_bf16 a[0:3], a[160:163], v[56:59], a[0:3]
    ds_read_b128 a[124:127], v11 offset:12288
    v_cvt_pk_bf16_f32 v129, v194, v195
    v_mfma_f32_16x16x32_bf16 a[4:7], a[164:167], v[56:59], a[4:7]
    s_lshl_b32 s6, s4, 17
    s_and_b32 s7, s5, 3
    s_lshl_b32 s7, s7, 15
    v_cvt_pk_bf16_f32 v130, v196, v197
    v_cvt_pk_bf16_f32 v131, v198, v199
    v_mfma_f32_16x16x32_bf16 a[8:11], a[168:171], v[56:59], a[8:11]
    s_add_u32 s6, s6, s7
    s_lshl_b32 s7, s45, 13
    s_add_u32 s6, s6, s7
    v_cvt_pk_bf16_f32 v132, v200, v201
    v_cvt_pk_bf16_f32 v133, v202, v203
    v_mfma_f32_16x16x32_bf16 a[12:15], a[172:175], v[56:59], a[12:15]
    s_add_u32 s16, s46, s6
    s_addc_u32 s17, s47, 0
    s_mov_b32 s18, 0x2000
    v_cvt_pk_bf16_f32 v134, v204, v205
    v_cvt_pk_bf16_f32 v135, v206, v207
    v_mfma_f32_16x16x32_bf16 a[16:19], a[176:179], v[56:59], a[16:19]
    s_lshl_b32 s6, s5, 1
    s_bfe_u32 s7, s2, 0x10005
    s_add_u32 s6, s6, s7
    v_cvt_pk_bf16_f32 v136, v208, v209
    v_cvt_pk_bf16_f32 v137, v210, v211
    v_mfma_f32_16x16x32_bf16 a[20:23], a[180:183], v[56:59], a[20:23]
    s_lshl_b32 s6, s6, 2
    s_and_b32 s7, s2, 3
    s_add_u32 s6, s6, s7
    v_cvt_pk_bf16_f32 v138, v212, v213
    v_cvt_pk_bf16_f32 v139, v214, v215
    v_mfma_f32_16x16x32_bf16 a[24:27], a[184:187], v[56:59], a[24:27]
    s_lshl_b32 s6, s6, 2
    s_bfe_u32 s7, s2, 0x20003
    s_add_u32 s6, s6, s7
    v_cvt_pk_bf16_f32 v140, v216, v217
    v_cvt_pk_bf16_f32 v141, v218, v219
    v_mfma_f32_16x16x32_bf16 a[28:31], a[188:191], v[56:59], a[28:31]
    s_lshl_b32 s6, s6, 2
    s_add_u32 s6, s6, s45
    v_cvt_pk_bf16_f32 v142, v220, v221
    v_cvt_pk_bf16_f32 v143, v222, v223
    v_mfma_f32_16x16x32_bf16 a[32:35], a[160:163], v[60:63], a[32:35]
    s_lshl_b32 s6, s6, 11
    s_add_u32 s24, s0, s6
    s_addc_u32 s25, s1, 0
    s_mov_b32 s26, 2048
    v_cvt_pk_bf16_f32 v144, v224, v225
    v_cvt_pk_bf16_f32 v145, v226, v227
    v_mfma_f32_16x16x32_bf16 a[36:39], a[164:167], v[60:63], a[36:39]
    s_lshr_b32 s6, s2, 3
    s_lshl_b32 s6, s6, 2
    s_add_u32 s36, s6, s45
    v_cvt_pk_bf16_f32 v146, v228, v229
    v_cvt_pk_bf16_f32 v147, v230, v231
    v_mfma_f32_16x16x32_bf16 a[40:43], a[168:171], v[60:63], a[40:43]
    s_cmp_lt_u32 s36, 64
    s_cselect_b64 s[20:21], s[56:57], s[58:59]
    v_cvt_pk_bf16_f32 v148, v232, v233
    v_cvt_pk_bf16_f32 v149, v234, v235
    v_mfma_f32_16x16x32_bf16 a[44:47], a[172:175], v[60:63], a[44:47]
    s_and_b32 s6, s36, 63
    s_mul_i32 s6, s6, 22016
    s_and_b32 s7, s2, 3
    v_cvt_pk_bf16_f32 v150, v236, v237
    v_cvt_pk_bf16_f32 v151, v238, v239
    v_mfma_f32_16x16x32_bf16 a[48:51], a[176:179], v[60:63], a[48:51]
    s_mul_i32 s7, s7, 768
    s_add_u32 s6, s6, s7
    s_sub_u32 s7, 1409024, s6
    v_cvt_pk_bf16_f32 v152, v240, v241
    v_cvt_pk_bf16_f32 v153, v242, v243
    v_mfma_f32_16x16x32_bf16 a[52:55], a[180:183], v[60:63], a[52:55]
    s_add_u32 s20, s20, s6
    s_addc_u32 s21, s21, 0
    s_min_u32 s22, s7, 22016
    v_cvt_pk_bf16_f32 v154, v244, v245
    v_cvt_pk_bf16_f32 v155, v246, v247
    v_mfma_f32_16x16x32_bf16 a[56:59], a[184:187], v[60:63], a[56:59]
    s_mul_i32 s6, s36, 11264
    s_and_b32 s7, s2, 1
    s_lshl_b32 s7, s7, 9
    v_cvt_pk_bf16_f32 v156, v248, v249
    v_cvt_pk_bf16_f32 v157, v250, v251
    v_mfma_f32_16x16x32_bf16 a[60:63], a[188:191], v[60:63], a[60:63]
    s_add_u32 s6, s6, s7
    s_min_u32 s6, s6, 1409024
    s_sub_u32 s7, 1409024, s6
    v_cvt_pk_bf16_f32 v158, v252, v253
    v_cvt_pk_bf16_f32 v159, v254, v255
    v_accvgpr_read_b32 v224, a0
    v_accvgpr_read_b32 v225, a1
    s_add_u32 s48, s60, s6
    s_addc_u32 s49, s61, 0
    s_min_u32 s50, s7, 11264
    s_mov_b32 s51, 0x20000
    v_accvgpr_read_b32 v226, a2
    v_accvgpr_read_b32 v227, a3
    v_cvt_pk_bf16_f32 v160, v224, v225
    v_cvt_pk_bf16_f32 v161, v226, v227
    s_waitcnt lgkmcnt(8)
    v_accvgpr_read_b32 v228, a4
    v_accvgpr_read_b32 v229, a5
    v_mfma_f32_16x16x32_bf16 v[64:67], a[64:67], v[128:131], 0
    s_waitcnt lgkmcnt(0)
    v_accvgpr_read_b32 v230, a6
    v_accvgpr_read_b32 v231, a7
    v_mfma_f32_16x16x32_bf16 v[64:67], a[68:71], v[132:135], v[64:67]
    s_add_u32 m0, s32, 32768
    s_mov_b32 s33, 32768
    buffer_load_dwordx4 v20, s[8:11], s33 offen offset:0 nt lds
    v_mfma_f32_16x16x32_bf16 v[64:67], a[72:75], v[136:139], v[64:67]
    s_add_u32 m0, s32, 32768
    s_mov_b32 s33, 32768
    buffer_load_dwordx4 v21, s[8:11], s33 offen offset:1024 nt lds
    v_mfma_f32_16x16x32_bf16 v[64:67], a[76:79], v[140:143], v[64:67]
    s_add_u32 m0, s32, 32768
    s_mov_b32 s33, 32768
    buffer_load_dwordx4 v22, s[8:11], s33 offen offset:2048 nt lds
    v_mfma_f32_16x16x32_bf16 v[80:83], a[92:95], v[140:143], 0
    s_add_u32 m0, s32, 32768
    s_mov_b32 s33, 32768
    buffer_load_dwordx4 v23, s[8:11], s33 offen offset:3072 nt lds
    v_mfma_f32_16x16x32_bf16 v[80:83], a[88:91], v[136:139], v[80:83]
    v_cvt_pk_bf16_f32 v162, v228, v229
    v_cvt_pk_bf16_f32 v163, v230, v231
    v_mfma_f32_16x16x32_bf16 v[80:83], a[84:87], v[132:135], v[80:83]
    v_accvgpr_read_b32 v232, a8
    v_accvgpr_read_b32 v233, a9
    v_mfma_f32_16x16x32_bf16 v[80:83], a[80:83], v[128:131], v[80:83]
    v_accvgpr_read_b32 v234, a10
    v_accvgpr_read_b32 v235, a11
    v_mfma_f32_16x16x32_bf16 v[68:71], a[64:67], v[144:147], 0
    v_cvt_pk_bf16_f32 v164, v232, v233
    v_cvt_pk_bf16_f32 v165, v234, v235
    v_mfma_f32_16x16x32_bf16 v[68:71], a[68:71], v[148:151], v[68:71]
    v_accvgpr_read_b32 v236, a12
    v_accvgpr_read_b32 v237, a13
    v_mfma_f32_16x16x32_bf16 v[68:71], a[72:75], v[152:155], v[68:71]
    v_accvgpr_read_b32 v238, a14
    v_accvgpr_read_b32 v239, a15
    v_mfma_f32_16x16x32_bf16 v[68:71], a[76:79], v[156:159], v[68:71]
    v_cvt_pk_bf16_f32 v166, v236, v237
    v_cvt_pk_bf16_f32 v167, v238, v239
    v_mfma_f32_16x16x32_bf16 v[84:87], a[92:95], v[156:159], 0
    v_accvgpr_read_b32 v224, a16
    v_accvgpr_read_b32 v225, a17
    v_mfma_f32_16x16x32_bf16 v[84:87], a[88:91], v[152:155], v[84:87]
    v_accvgpr_read_b32 v226, a18
    v_accvgpr_read_b32 v227, a19
    v_mfma_f32_16x16x32_bf16 v[84:87], a[84:87], v[148:151], v[84:87]
    v_cvt_pk_bf16_f32 v168, v224, v225
    v_cvt_pk_bf16_f32 v169, v226, v227
    v_mfma_f32_16x16x32_bf16 v[84:87], a[80:83], v[144:147], v[84:87]
    v_accvgpr_read_b32 v228, a20
    v_accvgpr_read_b32 v229, a21
    v_accvgpr_read_b32 v230, a22
    v_accvgpr_read_b32 v231, a23
    v_cvt_pk_bf16_f32 v170, v228, v229
    v_cvt_pk_bf16_f32 v171, v230, v231
    v_accvgpr_read_b32 v232, a24
    v_accvgpr_read_b32 v233, a25
    v_accvgpr_read_b32 v234, a26
    v_accvgpr_read_b32 v235, a27
    v_cvt_pk_bf16_f32 v172, v232, v233
    v_cvt_pk_bf16_f32 v173, v234, v235
    v_accvgpr_read_b32 v236, a28
    v_accvgpr_read_b32 v237, a29
    v_accvgpr_read_b32 v238, a30
    v_accvgpr_read_b32 v239, a31
    v_cvt_pk_bf16_f32 v174, v236, v237
    v_cvt_pk_bf16_f32 v175, v238, v239
    v_max3_f32 v208, v64, v65, v66
    v_max3_f32 v212, v80, v81, v82
    v_mfma_f32_16x16x32_bf16 v[72:75], a[64:67], v[160:163], 0
    v_max3_f32 v208, v208, v67, v83
    v_max_f32 v208, v208, v212
    v_mfma_f32_16x16x32_bf16 v[72:75], a[68:71], v[164:167], v[72:75]
    v_max3_f32 v209, v68, v69, v70
    v_max3_f32 v213, v84, v85, v86
    v_mfma_f32_16x16x32_bf16 v[72:75], a[72:75], v[168:171], v[72:75]
    v_max3_f32 v209, v209, v71, v87
    v_max_f32 v209, v209, v213
    v_mfma_f32_16x16x32_bf16 v[72:75], a[76:79], v[172:175], v[72:75]
    v_mov_b32 v212, v208
    v_mov_b32 v213, v209
    v_mfma_f32_16x16x32_bf16 v[88:91], a[92:95], v[172:175], 0
    v_permlane32_swap_b32 v212, v208
    v_mfma_f32_16x16x32_bf16 v[88:91], a[88:91], v[168:171], v[88:91]
    v_permlane32_swap_b32 v213, v209
    v_mfma_f32_16x16x32_bf16 v[88:91], a[84:87], v[164:167], v[88:91]
    v_max_f32 v208, v208, v212
    v_max_f32 v209, v209, v213
    v_mfma_f32_16x16x32_bf16 v[88:91], a[80:83], v[160:163], v[88:91]
    s_add_u32 m0, s32, 81920
    s_mov_b32 s34, 16384
    buffer_load_dwordx4 v24, s[12:15], s34 offen offset:0 nt lds
    v_mov_b32 v212, v208
    v_mov_b32 v213, v209
    s_add_u32 m0, s32, 81920
    s_mov_b32 s34, 16384
    buffer_load_dwordx4 v25, s[12:15], s34 offen offset:1024 nt lds
    v_permlane16_swap_b32 v212, v208
    s_add_u32 m0, s32, 81920
    s_mov_b32 s34, 16384
    buffer_load_dwordx4 v24, s[12:15], s34 offen offset:2048 nt lds
    v_permlane16_swap_b32 v213, v209
    s_add_u32 m0, s32, 81920
    s_mov_b32 s34, 16384
    buffer_load_dwordx4 v25, s[12:15], s34 offen offset:3072 nt lds
    v_max_f32 v208, v208, v212
    v_max_f32 v209, v209, v213
    v_sub_f32 v192, 0, v208
    v_sub_f32 v193, 0, v208
    v_sub_f32 v194, 0, v208
    v_sub_f32 v195, 0, v208
    v_sub_f32 v196, 0, v209
    v_sub_f32 v197, 0, v209
    v_mfma_f32_16x16x32_bf16 v[96:99], a[96:99], v[128:131], v[192:195]
    v_sub_f32 v198, 0, v209
    v_sub_f32 v199, 0, v209
    v_mfma_f32_16x16x32_bf16 v[96:99], a[100:103], v[132:135], v[96:99]
    v_accvgpr_read_b32 v224, a32
    v_accvgpr_read_b32 v225, a33
    v_mfma_f32_16x16x32_bf16 v[96:99], a[104:107], v[136:139], v[96:99]
    v_accvgpr_read_b32 v226, a34
    v_accvgpr_read_b32 v227, a35
    v_mfma_f32_16x16x32_bf16 v[96:99], a[108:111], v[140:143], v[96:99]
    v_cvt_pk_bf16_f32 v176, v224, v225
    v_cvt_pk_bf16_f32 v177, v226, v227
    v_mfma_f32_16x16x32_bf16 v[112:115], a[124:127], v[140:143], v[192:195]
    v_accvgpr_read_b32 v228, a36
    v_accvgpr_read_b32 v229, a37
    v_mfma_f32_16x16x32_bf16 v[112:115], a[120:123], v[136:139], v[112:115]
    v_accvgpr_read_b32 v230, a38
    v_accvgpr_read_b32 v231, a39
    v_mfma_f32_16x16x32_bf16 v[112:115], a[116:119], v[132:135], v[112:115]
    v_cvt_pk_bf16_f32 v178, v228, v229
    v_cvt_pk_bf16_f32 v179, v230, v231
    v_mfma_f32_16x16x32_bf16 v[112:115], a[112:115], v[128:131], v[112:115]
    v_accvgpr_read_b32 v232, a40
    v_accvgpr_read_b32 v233, a41
    v_mfma_f32_16x16x32_bf16 v[100:103], a[96:99], v[144:147], v[196:199]
    v_accvgpr_read_b32 v234, a42
    v_accvgpr_read_b32 v235, a43
    v_mfma_f32_16x16x32_bf16 v[100:103], a[100:103], v[148:151], v[100:103]
    v_cvt_pk_bf16_f32 v180, v232, v233
    v_cvt_pk_bf16_f32 v181, v234, v235
    v_mfma_f32_16x16x32_bf16 v[100:103], a[104:107], v[152:155], v[100:103]
    v_accvgpr_read_b32 v236, a44
    v_accvgpr_read_b32 v237, a45
    v_mfma_f32_16x16x32_bf16 v[100:103], a[108:111], v[156:159], v[100:103]
    v_accvgpr_read_b32 v238, a46
    v_accvgpr_read_b32 v239, a47
    v_mfma_f32_16x16x32_bf16 v[116:119], a[124:127], v[156:159], v[196:199]
    v_cvt_pk_bf16_f32 v182, v236, v237
    v_cvt_pk_bf16_f32 v183, v238, v239
    v_mfma_f32_16x16x32_bf16 v[116:119], a[120:123], v[152:155], v[116:119]
    v_accvgpr_read_b32 v224, a48
    v_accvgpr_read_b32 v225, a49
    v_mfma_f32_16x16x32_bf16 v[116:119], a[116:119], v[148:151], v[116:119]
    v_accvgpr_read_b32 v226, a50
    v_accvgpr_read_b32 v227, a51
    v_mfma_f32_16x16x32_bf16 v[116:119], a[112:115], v[144:147], v[116:119]
    v_cvt_pk_bf16_f32 v184, v224, v225
    v_cvt_pk_bf16_f32 v185, v226, v227
    v_accvgpr_read_b32 v228, a52
    v_accvgpr_read_b32 v229, a53
    v_accvgpr_read_b32 v230, a54
    v_accvgpr_read_b32 v231, a55
    v_cvt_pk_bf16_f32 v186, v228, v229
    v_cvt_pk_bf16_f32 v187, v230, v231
    v_accvgpr_read_b32 v232, a56
    v_accvgpr_read_b32 v233, a57
    v_accvgpr_read_b32 v234, a58
    v_accvgpr_read_b32 v235, a59
    v_cvt_pk_bf16_f32 v188, v232, v233
    v_cvt_pk_bf16_f32 v189, v234, v235
    v_accvgpr_read_b32 v236, a60
    v_accvgpr_read_b32 v237, a61
    v_accvgpr_read_b32 v238, a62
    v_accvgpr_read_b32 v239, a63
    v_cvt_pk_bf16_f32 v190, v236, v237
    v_cvt_pk_bf16_f32 v191, v238, v239
    v_add_f32 v64, v64, v192
    v_add_f32 v65, v65, v192
    v_mfma_f32_16x16x32_bf16 v[76:79], a[64:67], v[176:179], 0
    v_exp_f32 v64, v64
    v_mfma_f32_16x16x32_bf16 v[76:79], a[68:71], v[180:183], v[76:79]
    v_add_f32 v66, v66, v192
    v_mfma_f32_16x16x32_bf16 v[76:79], a[72:75], v[184:187], v[76:79]
    v_exp_f32 v65, v65
    v_mfma_f32_16x16x32_bf16 v[76:79], a[76:79], v[188:191], v[76:79]
    v_add_f32 v28, v64, v28
    v_add_f32 v67, v67, v192
    v_mfma_f32_16x16x32_bf16 v[92:95], a[92:95], v[188:191], 0
    v_exp_f32 v66, v66
    v_mfma_f32_16x16x32_bf16 v[92:95], a[88:91], v[184:187], v[92:95]
    v_add_f32 v28, v65, v28
    v_cvt_pk_bf16_f32 v32, v64, v65
    v_mfma_f32_16x16x32_bf16 v[92:95], a[84:87], v[180:183], v[92:95]
    v_add_f32 v80, v80, v192
    v_mfma_f32_16x16x32_bf16 v[92:95], a[80:83], v[176:179], v[92:95]
    s_waitcnt vmcnt(8)
    s_barrier
    v_exp_f32 v67, v67
    v_add_f32 v28, v66, v28
    v_add_f32 v81, v81, v192
    ds_read_b128 a[144:147], v8 offset:16384
    v_exp_f32 v80, v80
    v_add_f32 v28, v67, v28
    ds_read_b128 a[148:151], v9 offset:16384
    v_cvt_pk_bf16_f32 v33, v66, v67
    v_add_f32 v82, v82, v192
    v_exp_f32 v81, v81
    ds_read_b128 a[152:155], v10 offset:16384
    v_add_f32 v28, v80, v28
    v_add_f32 v83, v83, v192
    v_exp_f32 v82, v82
    ds_read_b128 a[156:159], v11 offset:16384
    v_add_f32 v28, v81, v28
    v_cvt_pk_bf16_f32 v34, v80, v81
    v_add_f32 v68, v68, v196
    ds_read_b128 a[160:163], v8 offset:20480
    v_exp_f32 v83, v83
    v_add_f32 v28, v82, v28
    ds_read_b128 a[164:167], v9 offset:20480
    v_add_f32 v69, v69, v196
    v_exp_f32 v68, v68
    ds_read_b128 a[168:171], v10 offset:20480
    v_add_f32 v28, v83, v28
    v_cvt_pk_bf16_f32 v35, v82, v83
    v_add_f32 v70, v70, v196
    ds_read_b128 a[172:175], v11 offset:20480
    v_exp_f32 v69, v69
    v_add_f32 v71, v71, v196
    s_add_u32 m0, s32, 49152
    s_mov_b32 s33, 49152
    buffer_load_dwordx4 v20, s[8:11], s33 offen offset:0 nt lds
    v_exp_f32 v70, v70
    s_add_u32 m0, s32, 49152
    s_mov_b32 s33, 49152
    buffer_load_dwordx4 v21, s[8:11], s33 offen offset:1024 nt lds
    v_cvt_pk_bf16_f32 v36, v68, v69
    v_add_f32 v84, v84, v196
    s_add_u32 m0, s32, 49152
    s_mov_b32 s33, 49152
    buffer_load_dwordx4 v22, s[8:11], s33 offen offset:2048 nt lds
    v_exp_f32 v71, v71
    s_add_u32 m0, s32, 49152
    s_mov_b32 s33, 49152
    buffer_load_dwordx4 v23, s[8:11], s33 offen offset:3072 nt lds
    v_add_f32 v85, v85, v196
    v_exp_f32 v84, v84
    s_mov_b32 s35, 8
    v_cvt_pk_bf16_f32 v37, v70, v71
    v_add_f32 v86, v86, v196
    v_exp_f32 v85, v85
    v_add_f32 v87, v87, v196
    v_exp_f32 v86, v86
    v_cvt_pk_bf16_f32 v38, v84, v85
    v_exp_f32 v87, v87
    s_nop 0
    v_cvt_pk_bf16_f32 v39, v86, v87
    v_max3_f32 v210, v72, v73, v74
    v_max3_f32 v214, v88, v89, v90
    v_max3_f32 v210, v210, v75, v91
    v_max_f32 v210, v210, v214
    v_max3_f32 v211, v76, v77, v78
    v_max3_f32 v215, v92, v93, v94
    v_max3_f32 v211, v211, v79, v95
    v_max_f32 v211, v211, v215
    v_mov_b32 v214, v210
    v_mov_b32 v215, v211
    s_nop 0
    v_permlane32_swap_b32 v214, v210
    v_permlane32_swap_b32 v215, v211
    v_max_f32 v210, v210, v214
    v_max_f32 v211, v211, v215
    v_mov_b32 v214, v210
    v_mov_b32 v215, v211
    s_nop 0
    v_permlane16_swap_b32 v214, v210
    v_permlane16_swap_b32 v215, v211
    v_max_f32 v210, v210, v214
    v_max_f32 v211, v211, v215
    v_sub_f32 v200, 0, v210
    v_sub_f32 v201, 0, v210
    v_sub_f32 v202, 0, v210
    v_sub_f32 v203, 0, v210
    v_sub_f32 v204, 0, v211
    v_sub_f32 v205, 0, v211
    v_mfma_f32_16x16x32_bf16 v[104:107], a[96:99], v[160:163], v[200:203]
    v_sub_f32 v206, 0, v211
    v_sub_f32 v207, 0, v211
    v_mfma_f32_16x16x32_bf16 v[104:107], a[100:103], v[164:167], v[104:107]
    v_add_f32 v72, v72, v200
    v_add_f32 v73, v73, v200
    v_mfma_f32_16x16x32_bf16 v[104:107], a[104:107], v[168:171], v[104:107]
    v_exp_f32 v72, v72
    v_mfma_f32_16x16x32_bf16 v[104:107], a[108:111], v[172:175], v[104:107]
    v_add_f32 v74, v74, v200
    v_mfma_f32_16x16x32_bf16 v[120:123], a[124:127], v[172:175], v[200:203]
    v_exp_f32 v73, v73
    v_mfma_f32_16x16x32_bf16 v[120:123], a[120:123], v[168:171], v[120:123]
    v_add_f32 v30, v72, v30
    v_add_f32 v75, v75, v200
    v_mfma_f32_16x16x32_bf16 v[120:123], a[116:119], v[164:167], v[120:123]
    v_exp_f32 v74, v74
    v_mfma_f32_16x16x32_bf16 v[120:123], a[112:115], v[160:163], v[120:123]
    v_add_f32 v30, v73, v30
    v_cvt_pk_bf16_f32 v40, v72, v73
    v_mfma_f32_16x16x32_bf16 v[108:111], a[96:99], v[176:179], v[204:207]
    v_add_f32 v88, v88, v200
    v_mfma_f32_16x16x32_bf16 v[108:111], a[100:103], v[180:183], v[108:111]
    v_exp_f32 v75, v75
    v_mfma_f32_16x16x32_bf16 v[108:111], a[104:107], v[184:187], v[108:111]
    v_add_f32 v30, v74, v30
    v_add_f32 v89, v89, v200
    v_mfma_f32_16x16x32_bf16 v[108:111], a[108:111], v[188:191], v[108:111]
    v_exp_f32 v88, v88
    v_mfma_f32_16x16x32_bf16 v[124:127], a[124:127], v[188:191], v[204:207]
    v_add_f32 v30, v75, v30
    v_cvt_pk_bf16_f32 v41, v74, v75
    v_mfma_f32_16x16x32_bf16 v[124:127], a[120:123], v[184:187], v[124:127]
    v_add_f32 v90, v90, v200
    v_mfma_f32_16x16x32_bf16 v[124:127], a[116:119], v[180:183], v[124:127]
    v_exp_f32 v89, v89
    v_mfma_f32_16x16x32_bf16 v[124:127], a[112:115], v[176:179], v[124:127]
    v_add_f32 v30, v88, v30
    v_add_f32 v91, v91, v200
    v_exp_f32 v90, v90
    v_add_f32 v30, v89, v30
    v_cvt_pk_bf16_f32 v42, v88, v89
    v_add_f32 v76, v76, v204
    v_exp_f32 v91, v91
    v_add_f32 v30, v90, v30
    v_add_f32 v77, v77, v204
    v_exp_f32 v76, v76
    v_add_f32 v30, v91, v30
    v_cvt_pk_bf16_f32 v43, v90, v91
    v_add_f32 v78, v78, v204
    v_exp_f32 v77, v77
    v_add_f32 v79, v79, v204
    v_exp_f32 v78, v78
    v_cvt_pk_bf16_f32 v44, v76, v77
    v_add_f32 v92, v92, v204
    v_exp_f32 v79, v79
    v_add_f32 v93, v93, v204
    v_exp_f32 v92, v92
    v_cvt_pk_bf16_f32 v45, v78, v79
    v_add_f32 v94, v94, v204
    v_exp_f32 v93, v93
    v_add_f32 v95, v95, v204
    v_exp_f32 v94, v94
    v_cvt_pk_bf16_f32 v46, v92, v93
    v_exp_f32 v95, v95
    s_nop 0
    v_cvt_pk_bf16_f32 v47, v94, v95
k1_first:
    s_waitcnt lgkmcnt(0)
    v_mfma_f32_16x16x32_bf16 v[64:67], a[144:147], v[128:131], v[192:195]
    v_exp_f32 v96, v96
    v_mfma_f32_16x16x32_bf16 v[64:67], a[148:151], v[132:135], v[64:67]
    ds_read_b64_tr_b16 a[176:177], v12 offset:0
    ds_read_b64_tr_b16 a[178:179], v12 offset:4096
    v_exp_f32 v97, v97
    v_mfma_f32_16x16x32_bf16 v[64:67], a[152:155], v[136:139], v[64:67]
    v_exp_f32 v98, v98
    v_mfma_f32_16x16x32_bf16 v[64:67], a[156:159], v[140:143], v[64:67]
    s_add_u32 m0, s32, 98304
    s_mov_b32 s34, 32768
    buffer_load_dwordx4 v24, s[12:15], s34 offen offset:0 nt lds
    v_exp_f32 v99, v99
    v_mfma_f32_16x16x32_bf16 v[68:71], a[156:159], v[156:159], v[196:199]
    v_exp_f32 v112, v112
    v_mfma_f32_16x16x32_bf16 v[68:71], a[152:155], v[152:155], v[68:71]
    ds_read_b64_tr_b16 a[208:209], v12 offset:8192
    ds_read_b64_tr_b16 a[210:211], v12 offset:12288
    v_exp_f32 v113, v113
    v_mfma_f32_16x16x32_bf16 v[68:71], a[148:151], v[148:151], v[68:71]
    v_exp_f32 v114, v114
    v_mfma_f32_16x16x32_bf16 v[68:71], a[144:147], v[144:147], v[68:71]
    s_add_u32 m0, s32, 98304
    s_mov_b32 s34, 32768
    buffer_load_dwordx4 v25, s[12:15], s34 offen offset:1024 nt lds
    v_exp_f32 v115, v115
    v_mfma_f32_16x16x32_bf16 v[72:75], a[144:147], v[160:163], v[200:203]
    v_exp_f32 v100, v100
    v_mfma_f32_16x16x32_bf16 v[72:75], a[148:151], v[164:167], v[72:75]
    ds_read_b64_tr_b16 a[180:181], v13 offset:0
    ds_read_b64_tr_b16 a[182:183], v13 offset:4096
    v_exp_f32 v101, v101
    v_mfma_f32_16x16x32_bf16 v[72:75], a[152:155], v[168:171], v[72:75]
    v_exp_f32 v102, v102
    v_mfma_f32_16x16x32_bf16 v[72:75], a[156:159], v[172:175], v[72:75]
    s_add_u32 m0, s32, 98304
    s_mov_b32 s34, 32768
    buffer_load_dwordx4 v24, s[12:15], s34 offen offset:2048 nt lds
    v_exp_f32 v103, v103
    v_mfma_f32_16x16x32_bf16 v[76:79], a[156:159], v[188:191], v[204:207]
    v_exp_f32 v116, v116
    v_mfma_f32_16x16x32_bf16 v[76:79], a[152:155], v[184:187], v[76:79]
    ds_read_b64_tr_b16 a[212:213], v13 offset:8192
    ds_read_b64_tr_b16 a[214:215], v13 offset:12288
    v_exp_f32 v117, v117
    v_add_f32 v28, v96, v28
    v_mfma_f32_16x16x32_bf16 v[76:79], a[148:151], v[180:183], v[76:79]
    v_exp_f32 v118, v118
    v_mfma_f32_16x16x32_bf16 v[76:79], a[144:147], v[176:179], v[76:79]
    s_add_u32 m0, s32, 98304
    s_mov_b32 s34, 32768
    buffer_load_dwordx4 v25, s[12:15], s34 offen offset:3072 nt lds
    s_mov_b32 s6, 0x200000
    buffer_load_dword v5, v2, s[28:31], s6 offen
    v_exp_f32 v119, v119
    v_add_f32 v28, v97, v28
    v_mfma_f32_16x16x32_bf16 v[80:83], a[160:163], v[128:131], v[192:195]
    v_exp_f32 v104, v104
    v_cvt_pk_bf16_f32 v48, v96, v97
    v_mfma_f32_16x16x32_bf16 v[80:83], a[164:167], v[132:135], v[80:83]
    ds_read_b128 a[144:147], v8 offset:24576
    ds_read_b128 a[148:151], v9 offset:24576
    v_exp_f32 v105, v105
    v_add_f32 v28, v98, v28
    v_add_f32 v28, v99, v28
    v_mfma_f32_16x16x32_bf16 v[80:83], a[168:171], v[136:139], v[80:83]
    v_exp_f32 v106, v106
    v_cvt_pk_bf16_f32 v49, v98, v99
    v_mfma_f32_16x16x32_bf16 v[80:83], a[172:175], v[140:143], v[80:83]
    s_add_u32 m0, s32, 0
    s_mov_b32 s33, 65536
    buffer_load_dwordx4 v20, s[8:11], s33 offen offset:0 nt lds
    v_exp_f32 v107, v107
    v_add_f32 v28, v112, v28
    v_add_f32 v28, v113, v28
    v_mfma_f32_16x16x32_bf16 v[84:87], a[172:175], v[156:159], v[196:199]
    v_exp_f32 v120, v120
    v_cvt_pk_bf16_f32 v50, v112, v113
    v_mfma_f32_16x16x32_bf16 v[84:87], a[168:171], v[152:155], v[84:87]
    ds_read_b128 a[152:155], v10 offset:24576
    ds_read_b128 a[156:159], v11 offset:24576
    v_exp_f32 v121, v121
    v_add_f32 v28, v114, v28
    v_add_f32 v28, v115, v28
    v_mfma_f32_16x16x32_bf16 v[84:87], a[164:167], v[148:151], v[84:87]
    v_exp_f32 v122, v122
    v_cvt_pk_bf16_f32 v51, v114, v115
    v_mfma_f32_16x16x32_bf16 v[84:87], a[160:163], v[144:147], v[84:87]
    s_add_u32 m0, s32, 0
    s_mov_b32 s33, 65536
    buffer_load_dwordx4 v21, s[8:11], s33 offen offset:1024 nt lds
    v_exp_f32 v123, v123
    v_cvt_pk_bf16_f32 v52, v100, v101
    v_cvt_pk_bf16_f32 v53, v102, v103
    v_mfma_f32_16x16x32_bf16 v[88:91], a[160:163], v[160:163], v[200:203]
    v_exp_f32 v108, v108
    v_mfma_f32_16x16x32_bf16 v[88:91], a[164:167], v[164:167], v[88:91]
    ds_read_b64_tr_b16 a[184:185], v14 offset:0
    ds_read_b64_tr_b16 a[186:187], v14 offset:4096
    v_exp_f32 v109, v109
    v_cvt_pk_bf16_f32 v54, v116, v117
    v_mfma_f32_16x16x32_bf16 v[88:91], a[168:171], v[168:171], v[88:91]
    v_exp_f32 v110, v110
    v_mfma_f32_16x16x32_bf16 v[88:91], a[172:175], v[172:175], v[88:91]
    s_add_u32 m0, s32, 0
    s_mov_b32 s33, 65536
    buffer_load_dwordx4 v22, s[8:11], s33 offen offset:2048 nt lds
    v_exp_f32 v111, v111
    v_cvt_pk_bf16_f32 v55, v118, v119
    v_mfma_f32_16x16x32_bf16 v[92:95], a[172:175], v[188:191], v[204:207]
    v_exp_f32 v124, v124
    v_mfma_f32_16x16x32_bf16 v[92:95], a[168:171], v[184:187], v[92:95]
    ds_read_b64_tr_b16 a[216:217], v14 offset:8192
    ds_read_b64_tr_b16 a[218:219], v14 offset:12288
    v_exp_f32 v125, v125
    v_add_f32 v30, v104, v30
    v_mfma_f32_16x16x32_bf16 v[92:95], a[164:167], v[180:183], v[92:95]
    s_waitcnt lgkmcnt(4)
    v_exp_f32 v126, v126
    v_mfma_f32_16x16x32_bf16 v[92:95], a[160:163], v[176:179], v[92:95]
    s_add_u32 m0, s32, 0
    s_mov_b32 s33, 65536
    buffer_load_dwordx4 v23, s[8:11], s33 offen offset:3072 nt lds
    v_exp_f32 v127, v127
    v_add_f32 v30, v105, v30
    v_mfma_f32_16x16x32_bf16 v[96:99], a[144:147], v[128:131], v[192:195]
    v_exp_f32 v64, v64
    v_cvt_pk_bf16_f32 v56, v104, v105
    v_mfma_f32_16x16x32_bf16 v[96:99], a[148:151], v[132:135], v[96:99]
    ds_read_b128 a[160:163], v8 offset:28672
    ds_read_b128 a[164:167], v9 offset:28672
    v_mfma_f32_16x16x32_bf16 v[96:99], a[152:155], v[136:139], v[96:99]
    v_exp_f32 v65, v65
    v_add_f32 v30, v106, v30
    v_add_f32 v30, v107, v30
    v_mfma_f32_16x16x32_bf16 v[96:99], a[156:159], v[140:143], v[96:99]
    s_add_u32 m0, s32, 114688
    s_mov_b32 s34, 49152
    buffer_load_dwordx4 v24, s[12:15], s34 offen offset:0 nt lds
    v_mfma_f32_16x16x32_bf16 v[100:103], a[156:159], v[156:159], v[196:199]
    v_exp_f32 v66, v66
    v_cvt_pk_bf16_f32 v57, v106, v107
    v_mfma_f32_16x16x32_bf16 v[100:103], a[152:155], v[152:155], v[100:103]
    ds_read_b128 a[168:171], v10 offset:28672
    ds_read_b128 a[172:175], v11 offset:28672
    v_mfma_f32_16x16x32_bf16 v[100:103], a[148:151], v[148:151], v[100:103]
    v_exp_f32 v67, v67
    v_add_f32 v30, v120, v30
    v_add_f32 v30, v121, v30
    v_mfma_f32_16x16x32_bf16 v[100:103], a[144:147], v[144:147], v[100:103]
    s_add_u32 m0, s32, 114688
    s_mov_b32 s34, 49152
    buffer_load_dwordx4 v25, s[12:15], s34 offen offset:1024 nt lds
    v_cvt_pk_bf16_f32 v58, v120, v121
    v_add_f32 v30, v122, v30
    v_add_f32 v30, v123, v30
    v_cvt_pk_bf16_f32 v59, v122, v123
    v_cvt_pk_bf16_f32 v60, v108, v109
    v_cvt_pk_bf16_f32 v61, v110, v111
    v_cvt_pk_bf16_f32 v62, v124, v125
    v_cvt_pk_bf16_f32 v63, v126, v127
    v_mfma_f32_16x16x32_bf16 v[104:107], a[144:147], v[160:163], v[200:203]
    v_exp_f32 v80, v80
    v_mfma_f32_16x16x32_bf16 v[104:107], a[148:151], v[164:167], v[104:107]
    ds_read_b64_tr_b16 a[188:189], v15 offset:0
    ds_read_b64_tr_b16 a[190:191], v15 offset:4096
    v_mfma_f32_16x16x32_bf16 v[104:107], a[152:155], v[168:171], v[104:107]
    v_exp_f32 v81, v81
    v_mfma_f32_16x16x32_bf16 v[104:107], a[156:159], v[172:175], v[104:107]
    s_add_u32 m0, s32, 114688
    s_mov_b32 s34, 49152
    buffer_load_dwordx4 v24, s[12:15], s34 offen offset:2048 nt lds
    v_mfma_f32_16x16x32_bf16 v[108:111], a[156:159], v[188:191], v[204:207]
    v_exp_f32 v82, v82
    v_mfma_f32_16x16x32_bf16 v[108:111], a[152:155], v[184:187], v[108:111]
    ds_read_b64_tr_b16 a[220:221], v15 offset:8192
    ds_read_b64_tr_b16 a[222:223], v15 offset:12288
    v_mfma_f32_16x16x32_bf16 v[108:111], a[148:151], v[180:183], v[108:111]
    s_waitcnt lgkmcnt(4)
    v_exp_f32 v83, v83
    v_mfma_f32_16x16x32_bf16 v[108:111], a[144:147], v[176:179], v[108:111]
    s_add_u32 m0, s32, 114688
    s_mov_b32 s34, 49152
    buffer_load_dwordx4 v25, s[12:15], s34 offen offset:3072 nt lds
    s_mov_b32 s6, 0x200000
    buffer_load_dword v5, v2, s[28:31], s6 offen
    v_mfma_f32_16x16x32_bf16 v[112:115], a[160:163], v[128:131], v[192:195]
    v_exp_f32 v68, v68
    v_mfma_f32_16x16x32_bf16 v[112:115], a[164:167], v[132:135], v[112:115]
    ds_read_b64_tr_b16 a[192:193], v16 offset:0
    ds_read_b64_tr_b16 a[194:195], v16 offset:4096
    v_mfma_f32_16x16x32_bf16 v[112:115], a[168:171], v[136:139], v[112:115]
    v_exp_f32 v69, v69
    v_mfma_f32_16x16x32_bf16 v[112:115], a[172:175], v[140:143], v[112:115]
    ds_read_b64_tr_b16 a[224:225], v16 offset:8192
    ds_read_b64_tr_b16 a[226:227], v16 offset:12288
    v_mfma_f32_16x16x32_bf16 v[116:119], a[172:175], v[156:159], v[196:199]
    v_exp_f32 v70, v70
    v_mfma_f32_16x16x32_bf16 v[116:119], a[168:171], v[152:155], v[116:119]
    ds_read_b64_tr_b16 a[196:197], v17 offset:0
    ds_read_b64_tr_b16 a[198:199], v17 offset:4096
    v_mfma_f32_16x16x32_bf16 v[116:119], a[164:167], v[148:151], v[116:119]
    v_exp_f32 v71, v71
    v_mfma_f32_16x16x32_bf16 v[116:119], a[160:163], v[144:147], v[116:119]
    ds_read_b64_tr_b16 a[228:229], v17 offset:8192
    ds_read_b64_tr_b16 a[230:231], v17 offset:12288
    v_mfma_f32_16x16x32_bf16 v[120:123], a[160:163], v[160:163], v[200:203]
    v_exp_f32 v84, v84
    v_mfma_f32_16x16x32_bf16 v[120:123], a[164:167], v[164:167], v[120:123]
    ds_read_b64_tr_b16 a[200:201], v18 offset:0
    ds_read_b64_tr_b16 a[202:203], v18 offset:4096
    v_mfma_f32_16x16x32_bf16 v[120:123], a[168:171], v[168:171], v[120:123]
    v_exp_f32 v85, v85
    v_add_f32 v28, v64, v28
    v_mfma_f32_16x16x32_bf16 v[120:123], a[172:175], v[172:175], v[120:123]
    ds_read_b64_tr_b16 a[232:233], v18 offset:8192
    ds_read_b64_tr_b16 a[234:235], v18 offset:12288
    v_mfma_f32_16x16x32_bf16 v[124:127], a[172:175], v[188:191], v[204:207]
    v_exp_f32 v86, v86
    v_mfma_f32_16x16x32_bf16 v[124:127], a[168:171], v[184:187], v[124:127]
    ds_read_b64_tr_b16 a[204:205], v19 offset:0
    ds_read_b64_tr_b16 a[206:207], v19 offset:4096
    v_mfma_f32_16x16x32_bf16 v[124:127], a[164:167], v[180:183], v[124:127]
    v_exp_f32 v87, v87
    v_add_f32 v28, v65, v28
    v_mfma_f32_16x16x32_bf16 v[124:127], a[160:163], v[176:179], v[124:127]
    ds_read_b64_tr_b16 a[236:237], v19 offset:8192
    ds_read_b64_tr_b16 a[238:239], v19 offset:12288
    v_cvt_pk_bf16_f32 v208, v64, v65
    v_add_f32 v28, v66, v28
    v_add_f32 v28, v67, v28
    v_cvt_pk_bf16_f32 v209, v66, v67
    v_add_f32 v28, v80, v28
    v_add_f32 v28, v81, v28
    v_cvt_pk_bf16_f32 v210, v80, v81
    v_add_f32 v28, v82, v28
    v_add_f32 v28, v83, v28
    v_cvt_pk_bf16_f32 v211, v82, v83
    v_cvt_pk_bf16_f32 v212, v68, v69
    v_cvt_pk_bf16_f32 v213, v70, v71
    v_cvt_pk_bf16_f32 v214, v84, v85
    v_cvt_pk_bf16_f32 v215, v86, v87
    s_mov_b32 s33, 81920
    s_mov_b32 s34, 65536
    v_mfma_f32_16x16x32_bf16 a[132:135], a[240:243], v[36:39], 0
    v_exp_f32 v72, v72
    v_mfma_f32_16x16x32_bf16 a[132:135], a[240:243], v[52:55], a[132:135]
    v_add_f32 v30, v72, v30
    v_mfma_f32_16x16x32_bf16 a[140:143], a[240:243], v[60:63], 0
    v_exp_f32 v73, v73
    v_mfma_f32_16x16x32_bf16 a[140:143], a[240:243], v[44:47], a[140:143]
    s_waitcnt vmcnt(18) lgkmcnt(0)
    s_barrier
    v_add_f32 v30, v73, v30
    v_cvt_pk_bf16_f32 v216, v72, v73
    v_mfma_f32_16x16x32_bf16 a[0:3], a[176:179], v[32:35], 0
    v_exp_f32 v74, v74
    v_mfma_f32_16x16x32_bf16 a[0:3], a[208:211], v[48:51], a[0:3]
    ds_read_b128 a[144:147], v8 offset:32768
    v_add_f32 v30, v74, v30
    v_mfma_f32_16x16x32_bf16 a[4:7], a[208:211], v[52:55], 0
    v_exp_f32 v75, v75
    v_mfma_f32_16x16x32_bf16 a[4:7], a[176:179], v[36:39], a[4:7]
    ds_read_b128 a[148:151], v9 offset:32768
    v_add_f32 v30, v75, v30
    v_mfma_f32_16x16x32_bf16 a[8:11], a[176:179], v[40:43], 0
    v_exp_f32 v88, v88
    v_mfma_f32_16x16x32_bf16 a[8:11], a[208:211], v[56:59], a[8:11]
    ds_read_b128 a[152:155], v10 offset:32768
    v_cvt_pk_bf16_f32 v217, v74, v75
    v_mfma_f32_16x16x32_bf16 a[12:15], a[208:211], v[60:63], 0
    v_exp_f32 v89, v89
    v_mfma_f32_16x16x32_bf16 a[12:15], a[176:179], v[44:47], a[12:15]
    ds_read_b128 a[156:159], v11 offset:32768
    v_add_f32 v30, v88, v30
    v_mfma_f32_16x16x32_bf16 a[28:31], a[180:183], v[44:47], 0
    v_exp_f32 v90, v90
    v_mfma_f32_16x16x32_bf16 a[28:31], a[212:215], v[60:63], a[28:31]
    ds_read_b128 a[160:163], v8 offset:36864
    v_add_f32 v30, v89, v30
    v_mfma_f32_16x16x32_bf16 a[24:27], a[212:215], v[56:59], 0
    v_exp_f32 v91, v91
    v_mfma_f32_16x16x32_bf16 a[24:27], a[180:183], v[40:43], a[24:27]
    ds_read_b128 a[164:167], v9 offset:36864
    v_cvt_pk_bf16_f32 v218, v88, v89
    v_mfma_f32_16x16x32_bf16 a[20:23], a[180:183], v[36:39], 0
    v_exp_f32 v76, v76
    v_mfma_f32_16x16x32_bf16 a[20:23], a[212:215], v[52:55], a[20:23]
    s_add_u32 m0, s32, 16384
    s_nop 0
    buffer_load_dwordx4 v20, s[8:11], s33 offen offset:0 nt lds
    v_mfma_f32_16x16x32_bf16 a[16:19], a[212:215], v[48:51], 0
    v_exp_f32 v77, v77
    v_mfma_f32_16x16x32_bf16 a[16:19], a[180:183], v[32:35], a[16:19]
    ds_read_b128 a[168:171], v10 offset:36864
    v_add_f32 v30, v90, v30
    v_mfma_f32_16x16x32_bf16 a[32:35], a[184:187], v[32:35], 0
    v_exp_f32 v78, v78
    v_mfma_f32_16x16x32_bf16 a[32:35], a[216:219], v[48:51], a[32:35]
    ds_read_b128 a[172:175], v11 offset:36864
    v_add_f32 v30, v91, v30
    v_mfma_f32_16x16x32_bf16 a[36:39], a[216:219], v[52:55], 0
    v_exp_f32 v79, v79
    v_mfma_f32_16x16x32_bf16 a[36:39], a[184:187], v[36:39], a[36:39]
    buffer_load_dwordx4 v21, s[8:11], s33 offen offset:1024 nt lds
    v_mfma_f32_16x16x32_bf16 a[40:43], a[184:187], v[40:43], 0
    v_exp_f32 v92, v92
    v_mfma_f32_16x16x32_bf16 a[40:43], a[216:219], v[56:59], a[40:43]
    ds_read_b64_tr_b16 a[176:177], v12 offset:16384
    v_cvt_pk_bf16_f32 v219, v90, v91
    v_mfma_f32_16x16x32_bf16 a[44:47], a[216:219], v[60:63], 0
    v_exp_f32 v93, v93
    v_mfma_f32_16x16x32_bf16 a[44:47], a[184:187], v[44:47], a[44:47]
    ds_read_b64_tr_b16 a[178:179], v12 offset:20480
    v_cvt_pk_bf16_f32 v220, v76, v77
    v_mfma_f32_16x16x32_bf16 a[60:63], a[188:191], v[44:47], 0
    v_exp_f32 v94, v94
    v_mfma_f32_16x16x32_bf16 a[60:63], a[220:223], v[60:63], a[60:63]
    buffer_load_dwordx4 v22, s[8:11], s33 offen offset:2048 nt lds
    v_mfma_f32_16x16x32_bf16 a[56:59], a[220:223], v[56:59], 0
    v_exp_f32 v95, v95
    v_mfma_f32_16x16x32_bf16 a[56:59], a[188:191], v[40:43], a[56:59]
    ds_read_b64_tr_b16 a[208:209], v12 offset:24576
    v_cvt_pk_bf16_f32 v221, v78, v79
    v_mfma_f32_16x16x32_bf16 a[52:55], a[188:191], v[36:39], 0
    v_exp_f32 v96, v96
    v_mfma_f32_16x16x32_bf16 a[52:55], a[220:223], v[52:55], a[52:55]
    ds_read_b64_tr_b16 a[210:211], v12 offset:28672
    v_cvt_pk_bf16_f32 v222, v92, v93
    v_mfma_f32_16x16x32_bf16 a[48:51], a[220:223], v[48:51], 0
    v_exp_f32 v97, v97
    v_mfma_f32_16x16x32_bf16 a[48:51], a[188:191], v[32:35], a[48:51]
    buffer_load_dwordx4 v23, s[8:11], s33 offen offset:3072 nt lds
    v_mfma_f32_16x16x32_bf16 a[64:67], a[192:195], v[32:35], 0
    v_exp_f32 v98, v98
    v_mfma_f32_16x16x32_bf16 a[64:67], a[224:227], v[48:51], a[64:67]
    ds_read_b64_tr_b16 a[180:181], v13 offset:16384
    v_cvt_pk_bf16_f32 v223, v94, v95
    v_mfma_f32_16x16x32_bf16 a[68:71], a[224:227], v[52:55], 0
    v_exp_f32 v99, v99
    v_mfma_f32_16x16x32_bf16 a[68:71], a[192:195], v[36:39], a[68:71]
    ds_read_b64_tr_b16 a[182:183], v13 offset:20480
    v_add_f32 v28, v96, v28
    v_mfma_f32_16x16x32_bf16 a[72:75], a[192:195], v[40:43], 0
    v_exp_f32 v112, v112
    v_mfma_f32_16x16x32_bf16 a[72:75], a[224:227], v[56:59], a[72:75]
    s_add_u32 m0, s32, 65536
    s_add_u32 s33, s33, 16384
    buffer_load_dwordx4 v24, s[12:15], s34 offen offset:0 nt lds
    v_mfma_f32_16x16x32_bf16 a[76:79], a[224:227], v[60:63], 0
    v_exp_f32 v113, v113
    v_mfma_f32_16x16x32_bf16 a[76:79], a[192:195], v[44:47], a[76:79]
    ds_read_b64_tr_b16 a[212:213], v13 offset:24576
    v_add_f32 v28, v97, v28
    v_mfma_f32_16x16x32_bf16 a[92:95], a[196:199], v[44:47], 0
    v_exp_f32 v114, v114
    v_mfma_f32_16x16x32_bf16 a[92:95], a[228:231], v[60:63], a[92:95]
    ds_read_b64_tr_b16 a[214:215], v13 offset:28672
    v_cvt_pk_bf16_f32 v224, v96, v97
    v_mfma_f32_16x16x32_bf16 a[88:91], a[228:231], v[56:59], 0
    v_exp_f32 v115, v115
    v_mfma_f32_16x16x32_bf16 a[88:91], a[196:199], v[40:43], a[88:91]
    buffer_load_dwordx4 v25, s[12:15], s34 offen offset:1024 nt lds
    v_mfma_f32_16x16x32_bf16 a[84:87], a[196:199], v[36:39], 0
    v_exp_f32 v100, v100
    v_mfma_f32_16x16x32_bf16 a[84:87], a[228:231], v[52:55], a[84:87]
    ds_read_b64_tr_b16 a[184:185], v14 offset:16384
    v_add_f32 v28, v98, v28
    v_mfma_f32_16x16x32_bf16 a[80:83], a[228:231], v[48:51], 0
    v_exp_f32 v101, v101
    v_mfma_f32_16x16x32_bf16 a[80:83], a[196:199], v[32:35], a[80:83]
    ds_read_b64_tr_b16 a[186:187], v14 offset:20480
    v_add_f32 v28, v99, v28
    v_mfma_f32_16x16x32_bf16 a[96:99], a[200:203], v[32:35], 0
    v_exp_f32 v102, v102
    v_mfma_f32_16x16x32_bf16 a[96:99], a[232:235], v[48:51], a[96:99]
    buffer_load_dwordx4 v24, s[12:15], s34 offen offset:2048 nt lds
    v_mfma_f32_16x16x32_bf16 a[100:103], a[232:235], v[52:55], 0
    v_exp_f32 v103, v103
    v_mfma_f32_16x16x32_bf16 a[100:103], a[200:203], v[36:39], a[100:103]
    ds_read_b64_tr_b16 a[216:217], v14 offset:24576
    v_cvt_pk_bf16_f32 v225, v98, v99
    v_mfma_f32_16x16x32_bf16 a[104:107], a[200:203], v[40:43], 0
    v_exp_f32 v116, v116
    v_mfma_f32_16x16x32_bf16 a[104:107], a[232:235], v[56:59], a[104:107]
    v_add_f32 v28, v112, v28
    v_add_f32 v28, v113, v28
    v_mfma_f32_16x16x32_bf16 a[108:111], a[232:235], v[60:63], 0
    v_exp_f32 v117, v117
    v_mfma_f32_16x16x32_bf16 a[108:111], a[200:203], v[44:47], a[108:111]
    buffer_load_dwordx4 v25, s[12:15], s34 offen offset:3072 nt lds
    s_add_u32 s34, s34, 16384
    v_mfma_f32_16x16x32_bf16 a[124:127], a[204:207], v[44:47], 0
    v_exp_f32 v118, v118
    v_mfma_f32_16x16x32_bf16 a[124:127], a[236:239], v[60:63], a[124:127]
    v_cvt_pk_bf16_f32 v226, v112, v113
    v_add_f32 v28, v114, v28
    v_mfma_f32_16x16x32_bf16 a[120:123], a[236:239], v[56:59], 0
    v_exp_f32 v119, v119
    v_mfma_f32_16x16x32_bf16 a[120:123], a[204:207], v[40:43], a[120:123]
    v_add_f32 v28, v115, v28
    v_cvt_pk_bf16_f32 v227, v114, v115
    v_mfma_f32_16x16x32_bf16 a[116:119], a[204:207], v[36:39], 0
    v_exp_f32 v104, v104
    v_mfma_f32_16x16x32_bf16 a[116:119], a[236:239], v[52:55], a[116:119]
    v_cvt_pk_bf16_f32 v228, v100, v101
    v_cvt_pk_bf16_f32 v229, v102, v103
    v_mfma_f32_16x16x32_bf16 a[112:115], a[236:239], v[48:51], 0
    v_cvt_pk_bf16_f32 v230, v116, v117
    v_cvt_pk_bf16_f32 v231, v118, v119
    v_mfma_f32_16x16x32_bf16 a[112:115], a[204:207], v[32:35], a[112:115]
    v_add_f32 v30, v104, v30
    s_branch k1_pos2
    .p2align 6
k1_loop:
    v_mfma_f32_16x16x32_bf16 a[132:135], a[240:243], v[36:39], a[132:135]
    v_exp_f32 v72, v72
    v_mfma_f32_16x16x32_bf16 a[132:135], a[240:243], v[52:55], a[132:135]
    v_add_f32 v30, v72, v30
    v_mfma_f32_16x16x32_bf16 a[140:143], a[240:243], v[60:63], a[140:143]
    v_exp_f32 v73, v73
    v_mfma_f32_16x16x32_bf16 a[140:143], a[240:243], v[44:47], a[140:143]
    s_waitcnt vmcnt(19) lgkmcnt(0)
    s_barrier
    v_add_f32 v30, v73, v30
    v_cvt_pk_bf16_f32 v216, v72, v73
    v_mfma_f32_16x16x32_bf16 a[0:3], a[176:179], v[32:35], a[0:3]
    v_exp_f32 v74, v74
    v_mfma_f32_16x16x32_bf16 a[0:3], a[208:211], v[48:51], a[0:3]
    ds_read_b128 a[144:147], v8 offset:0
    v_add_f32 v30, v74, v30
    v_mfma_f32_16x16x32_bf16 a[4:7], a[208:211], v[52:55], a[4:7]
    v_exp_f32 v75, v75
    v_mfma_f32_16x16x32_bf16 a[4:7], a[176:179], v[36:39], a[4:7]
    ds_read_b128 a[148:151], v9 offset:0
    v_add_f32 v30, v75, v30
    v_mfma_f32_16x16x32_bf16 a[8:11], a[176:179], v[40:43], a[8:11]
    v_exp_f32 v88, v88
    v_mfma_f32_16x16x32_bf16 a[8:11], a[208:211], v[56:59], a[8:11]
    ds_read_b128 a[152:155], v10 offset:0
    v_cvt_pk_bf16_f32 v217, v74, v75
    v_mfma_f32_16x16x32_bf16 a[12:15], a[208:211], v[60:63], a[12:15]
    v_exp_f32 v89, v89
    v_mfma_f32_16x16x32_bf16 a[12:15], a[176:179], v[44:47], a[12:15]
    ds_read_b128 a[156:159], v11 offset:0
    v_add_f32 v30, v88, v30
    v_mfma_f32_16x16x32_bf16 a[28:31], a[180:183], v[44:47], a[28:31]
    v_exp_f32 v90, v90
    v_mfma_f32_16x16x32_bf16 a[28:31], a[212:215], v[60:63], a[28:31]
    ds_read_b128 a[160:163], v8 offset:4096
    v_add_f32 v30, v89, v30
    v_mfma_f32_16x16x32_bf16 a[24:27], a[212:215], v[56:59], a[24:27]
    v_exp_f32 v91, v91
    v_mfma_f32_16x16x32_bf16 a[24:27], a[180:183], v[40:43], a[24:27]
    ds_read_b128 a[164:167], v9 offset:4096
    v_cvt_pk_bf16_f32 v218, v88, v89
    v_mfma_f32_16x16x32_bf16 a[20:23], a[180:183], v[36:39], a[20:23]
    v_exp_f32 v76, v76
    v_mfma_f32_16x16x32_bf16 a[20:23], a[212:215], v[52:55], a[20:23]
    s_add_u32 m0, s32, 49152
    s_nop 0
    buffer_load_dwordx4 v20, s[8:11], s33 offen offset:0 nt lds
    v_mfma_f32_16x16x32_bf16 a[16:19], a[212:215], v[48:51], a[16:19]
    v_exp_f32 v77, v77
    v_mfma_f32_16x16x32_bf16 a[16:19], a[180:183], v[32:35], a[16:19]
    ds_read_b128 a[168:171], v10 offset:4096
    v_add_f32 v30, v90, v30
    v_mfma_f32_16x16x32_bf16 a[32:35], a[184:187], v[32:35], a[32:35]
    v_exp_f32 v78, v78
    v_mfma_f32_16x16x32_bf16 a[32:35], a[216:219], v[48:51], a[32:35]
    ds_read_b128 a[172:175], v11 offset:4096
    v_add_f32 v30, v91, v30
    v_mfma_f32_16x16x32_bf16 a[36:39], a[216:219], v[52:55], a[36:39]
    v_exp_f32 v79, v79
    v_mfma_f32_16x16x32_bf16 a[36:39], a[184:187], v[36:39], a[36:39]
    buffer_load_dwordx4 v21, s[8:11], s33 offen offset:1024 nt lds
    v_mfma_f32_16x16x32_bf16 a[40:43], a[184:187], v[40:43], a[40:43]
    v_exp_f32 v92, v92
    v_mfma_f32_16x16x32_bf16 a[40:43], a[216:219], v[56:59], a[40:43]
    ds_read_b64_tr_b16 a[176:177], v12 offset:49152
    v_cvt_pk_bf16_f32 v219, v90, v91
    v_mfma_f32_16x16x32_bf16 a[44:47], a[216:219], v[60:63], a[44:47]
    v_exp_f32 v93, v93
    v_mfma_f32_16x16x32_bf16 a[44:47], a[184:187], v[44:47], a[44:47]
    ds_read_b64_tr_b16 a[178:179], v12 offset:53248
    v_cvt_pk_bf16_f32 v220, v76, v77
    v_mfma_f32_16x16x32_bf16 a[60:63], a[188:191], v[44:47], a[60:63]
    v_exp_f32 v94, v94
    v_mfma_f32_16x16x32_bf16 a[60:63], a[220:223], v[60:63], a[60:63]
    buffer_load_dwordx4 v22, s[8:11], s33 offen offset:2048 nt lds
    v_mfma_f32_16x16x32_bf16 a[56:59], a[220:223], v[56:59], a[56:59]
    v_exp_f32 v95, v95
    v_mfma_f32_16x16x32_bf16 a[56:59], a[188:191], v[40:43], a[56:59]
    ds_read_b64_tr_b16 a[208:209], v12 offset:57344
    v_cvt_pk_bf16_f32 v221, v78, v79
    v_mfma_f32_16x16x32_bf16 a[52:55], a[188:191], v[36:39], a[52:55]
    v_exp_f32 v96, v96
    v_mfma_f32_16x16x32_bf16 a[52:55], a[220:223], v[52:55], a[52:55]
    ds_read_b64_tr_b16 a[210:211], v12 offset:61440
    v_cvt_pk_bf16_f32 v222, v92, v93
    v_mfma_f32_16x16x32_bf16 a[48:51], a[220:223], v[48:51], a[48:51]
    v_exp_f32 v97, v97
    v_mfma_f32_16x16x32_bf16 a[48:51], a[188:191], v[32:35], a[48:51]
    buffer_load_dwordx4 v23, s[8:11], s33 offen offset:3072 nt lds
    v_mfma_f32_16x16x32_bf16 a[64:67], a[192:195], v[32:35], a[64:67]
    v_exp_f32 v98, v98
    v_mfma_f32_16x16x32_bf16 a[64:67], a[224:227], v[48:51], a[64:67]
    ds_read_b64_tr_b16 a[180:181], v13 offset:49152
    v_cvt_pk_bf16_f32 v223, v94, v95
    v_mfma_f32_16x16x32_bf16 a[68:71], a[224:227], v[52:55], a[68:71]
    v_exp_f32 v99, v99
    v_mfma_f32_16x16x32_bf16 a[68:71], a[192:195], v[36:39], a[68:71]
    ds_read_b64_tr_b16 a[182:183], v13 offset:53248
    v_add_f32 v28, v96, v28
    v_mfma_f32_16x16x32_bf16 a[72:75], a[192:195], v[40:43], a[72:75]
    v_exp_f32 v112, v112
    v_mfma_f32_16x16x32_bf16 a[72:75], a[224:227], v[56:59], a[72:75]
    s_add_u32 m0, s32, 98304
    s_add_u32 s33, s33, 16384
    buffer_load_dwordx4 v24, s[12:15], s34 offen offset:0 nt lds
    v_mfma_f32_16x16x32_bf16 a[76:79], a[224:227], v[60:63], a[76:79]
    v_exp_f32 v113, v113
    v_mfma_f32_16x16x32_bf16 a[76:79], a[192:195], v[44:47], a[76:79]
    ds_read_b64_tr_b16 a[212:213], v13 offset:57344
    v_add_f32 v28, v97, v28
    v_mfma_f32_16x16x32_bf16 a[92:95], a[196:199], v[44:47], a[92:95]
    v_exp_f32 v114, v114
    v_mfma_f32_16x16x32_bf16 a[92:95], a[228:231], v[60:63], a[92:95]
    ds_read_b64_tr_b16 a[214:215], v13 offset:61440
    v_cvt_pk_bf16_f32 v224, v96, v97
    v_mfma_f32_16x16x32_bf16 a[88:91], a[228:231], v[56:59], a[88:91]
    v_exp_f32 v115, v115
    v_mfma_f32_16x16x32_bf16 a[88:91], a[196:199], v[40:43], a[88:91]
    buffer_load_dwordx4 v25, s[12:15], s34 offen offset:1024 nt lds
    v_mfma_f32_16x16x32_bf16 a[84:87], a[196:199], v[36:39], a[84:87]
    v_exp_f32 v100, v100
    v_mfma_f32_16x16x32_bf16 a[84:87], a[228:231], v[52:55], a[84:87]
    ds_read_b64_tr_b16 a[184:185], v14 offset:49152
    v_add_f32 v28, v98, v28
    v_mfma_f32_16x16x32_bf16 a[80:83], a[228:231], v[48:51], a[80:83]
    v_exp_f32 v101, v101
    v_mfma_f32_16x16x32_bf16 a[80:83], a[196:199], v[32:35], a[80:83]
    ds_read_b64_tr_b16 a[186:187], v14 offset:53248
    v_add_f32 v28, v99, v28
    v_mfma_f32_16x16x32_bf16 a[96:99], a[200:203], v[32:35], a[96:99]
    v_exp_f32 v102, v102
    v_mfma_f32_16x16x32_bf16 a[96:99], a[232:235], v[48:51], a[96:99]
    buffer_load_dwordx4 v24, s[12:15], s34 offen offset:2048 nt lds
    v_mfma_f32_16x16x32_bf16 a[100:103], a[232:235], v[52:55], a[100:103]
    v_exp_f32 v103, v103
    v_mfma_f32_16x16x32_bf16 a[100:103], a[200:203], v[36:39], a[100:103]
    ds_read_b64_tr_b16 a[216:217], v14 offset:57344
    v_cvt_pk_bf16_f32 v225, v98, v99
    v_mfma_f32_16x16x32_bf16 a[104:107], a[200:203], v[40:43], a[104:107]
    v_exp_f32 v116, v116
    v_mfma_f32_16x16x32_bf16 a[104:107], a[232:235], v[56:59], a[104:107]
    v_add_f32 v28, v112, v28
    v_add_f32 v28, v113, v28
    v_mfma_f32_16x16x32_bf16 a[108:111], a[232:235], v[60:63], a[108:111]
    v_exp_f32 v117, v117
    v_mfma_f32_16x16x32_bf16 a[108:111], a[200:203], v[44:47], a[108:111]
    buffer_load_dwordx4 v25, s[12:15], s34 offen offset:3072 nt lds
    s_add_u32 s34, s34, 16384
    v_mfma_f32_16x16x32_bf16 a[124:127], a[204:207], v[44:47], a[124:127]
    v_exp_f32 v118, v118
    v_mfma_f32_16x16x32_bf16 a[124:127], a[236:239], v[60:63], a[124:127]
    v_cvt_pk_bf16_f32 v226, v112, v113
    v_add_f32 v28, v114, v28
    v_mfma_f32_16x16x32_bf16 a[120:123], a[236:239], v[56:59], a[120:123]
    v_exp_f32 v119, v119
    v_mfma_f32_16x16x32_bf16 a[120:123], a[204:207], v[40:43], a[120:123]
    v_add_f32 v28, v115, v28
    v_cvt_pk_bf16_f32 v227, v114, v115
    v_mfma_f32_16x16x32_bf16 a[116:119], a[204:207], v[36:39], a[116:119]
    v_exp_f32 v104, v104
    v_mfma_f32_16x16x32_bf16 a[116:119], a[236:239], v[52:55], a[116:119]
    v_cvt_pk_bf16_f32 v228, v100, v101
    v_cvt_pk_bf16_f32 v229, v102, v103
    v_mfma_f32_16x16x32_bf16 a[112:115], a[236:239], v[48:51], a[112:115]
    v_cvt_pk_bf16_f32 v230, v116, v117
    v_cvt_pk_bf16_f32 v231, v118, v119
    v_mfma_f32_16x16x32_bf16 a[112:115], a[204:207], v[32:35], a[112:115]
    v_add_f32 v30, v104, v30
    s_waitcnt lgkmcnt(11)
    v_mfma_f32_16x16x32_bf16 v[64:67], a[144:147], v[128:131], v[192:195]
    v_exp_f32 v105, v105
    v_mfma_f32_16x16x32_bf16 v[64:67], a[148:151], v[132:135], v[64:67]
    ds_read_b64_tr_b16 a[218:219], v14 offset:61440
    ds_read_b64_tr_b16 a[188:189], v15 offset:49152
    v_mfma_f32_16x16x32_bf16 v[64:67], a[152:155], v[136:139], v[64:67]
    v_exp_f32 v106, v106
    v_mfma_f32_16x16x32_bf16 v[64:67], a[156:159], v[140:143], v[64:67]
    ds_read_b64_tr_b16 a[190:191], v15 offset:53248
    v_add_f32 v30, v105, v30
    v_mfma_f32_16x16x32_bf16 v[68:71], a[156:159], v[156:159], v[196:199]
    v_exp_f32 v107, v107
    v_mfma_f32_16x16x32_bf16 v[68:71], a[152:155], v[152:155], v[68:71]
    ds_read_b64_tr_b16 a[220:221], v15 offset:57344
    v_cvt_pk_bf16_f32 v232, v104, v105
    v_mfma_f32_16x16x32_bf16 v[68:71], a[148:151], v[148:151], v[68:71]
    v_exp_f32 v120, v120
    v_mfma_f32_16x16x32_bf16 v[68:71], a[144:147], v[144:147], v[68:71]
    ds_read_b64_tr_b16 a[222:223], v15 offset:61440
    v_add_f32 v30, v106, v30
    v_mfma_f32_16x16x32_bf16 v[72:75], a[144:147], v[160:163], v[200:203]
    v_exp_f32 v121, v121
    v_mfma_f32_16x16x32_bf16 v[72:75], a[148:151], v[164:167], v[72:75]
    ds_read_b64_tr_b16 a[192:193], v16 offset:49152
    v_add_f32 v30, v107, v30
    v_mfma_f32_16x16x32_bf16 v[72:75], a[152:155], v[168:171], v[72:75]
    v_exp_f32 v122, v122
    v_mfma_f32_16x16x32_bf16 v[72:75], a[156:159], v[172:175], v[72:75]
    ds_read_b64_tr_b16 a[194:195], v16 offset:53248
    v_cvt_pk_bf16_f32 v233, v106, v107
    v_mfma_f32_16x16x32_bf16 v[76:79], a[156:159], v[188:191], v[204:207]
    v_exp_f32 v123, v123
    v_mfma_f32_16x16x32_bf16 v[76:79], a[152:155], v[184:187], v[76:79]
    ds_read_b64_tr_b16 a[224:225], v16 offset:57344
    v_add_f32 v30, v120, v30
    v_mfma_f32_16x16x32_bf16 v[76:79], a[148:151], v[180:183], v[76:79]
    v_exp_f32 v108, v108
    v_mfma_f32_16x16x32_bf16 v[76:79], a[144:147], v[176:179], v[76:79]
    ds_read_b128 a[144:147], v8 offset:8192
    v_add_f32 v30, v121, v30
    v_mfma_f32_16x16x32_bf16 v[80:83], a[160:163], v[128:131], v[192:195]
    v_exp_f32 v109, v109
    v_mfma_f32_16x16x32_bf16 v[80:83], a[164:167], v[132:135], v[80:83]
    ds_read_b128 a[148:151], v9 offset:8192
    v_cvt_pk_bf16_f32 v234, v120, v121
    v_mfma_f32_16x16x32_bf16 v[80:83], a[168:171], v[136:139], v[80:83]
    v_exp_f32 v110, v110
    v_mfma_f32_16x16x32_bf16 v[80:83], a[172:175], v[140:143], v[80:83]
    ds_read_b128 a[152:155], v10 offset:8192
    v_add_f32 v30, v122, v30
    v_mfma_f32_16x16x32_bf16 v[84:87], a[172:175], v[156:159], v[196:199]
    v_exp_f32 v111, v111
    v_mfma_f32_16x16x32_bf16 v[84:87], a[168:171], v[152:155], v[84:87]
    ds_read_b128 a[156:159], v11 offset:8192
    v_add_f32 v30, v123, v30
    v_mfma_f32_16x16x32_bf16 v[84:87], a[164:167], v[148:151], v[84:87]
    v_exp_f32 v124, v124
    v_mfma_f32_16x16x32_bf16 v[84:87], a[160:163], v[144:147], v[84:87]
    ds_read_b64_tr_b16 a[226:227], v16 offset:61440
    v_cvt_pk_bf16_f32 v235, v122, v123
    v_mfma_f32_16x16x32_bf16 v[88:91], a[160:163], v[160:163], v[200:203]
    v_exp_f32 v125, v125
    v_mfma_f32_16x16x32_bf16 v[88:91], a[164:167], v[164:167], v[88:91]
    ds_read_b64_tr_b16 a[196:197], v17 offset:49152
    v_cvt_pk_bf16_f32 v236, v108, v109
    v_mfma_f32_16x16x32_bf16 v[88:91], a[168:171], v[168:171], v[88:91]
    v_exp_f32 v126, v126
    v_mfma_f32_16x16x32_bf16 v[88:91], a[172:175], v[172:175], v[88:91]
    ds_read_b64_tr_b16 a[198:199], v17 offset:53248
    v_cvt_pk_bf16_f32 v237, v110, v111
    v_mfma_f32_16x16x32_bf16 v[92:95], a[172:175], v[188:191], v[204:207]
    v_exp_f32 v127, v127
    v_mfma_f32_16x16x32_bf16 v[92:95], a[168:171], v[184:187], v[92:95]
    ds_read_b64_tr_b16 a[228:229], v17 offset:57344
    v_cvt_pk_bf16_f32 v238, v124, v125
    v_mfma_f32_16x16x32_bf16 v[92:95], a[164:167], v[180:183], v[92:95]
    s_waitcnt lgkmcnt(4)
    v_exp_f32 v64, v64
    v_mfma_f32_16x16x32_bf16 v[92:95], a[160:163], v[176:179], v[92:95]
    ds_read_b128 a[160:163], v8 offset:12288
    v_cvt_pk_bf16_f32 v239, v126, v127
    v_mfma_f32_16x16x32_bf16 v[96:99], a[144:147], v[128:131], v[192:195]
    v_exp_f32 v65, v65
    v_mfma_f32_16x16x32_bf16 v[96:99], a[148:151], v[132:135], v[96:99]
    ds_read_b128 a[164:167], v9 offset:12288
    v_add_f32 v28, v64, v28
    v_mfma_f32_16x16x32_bf16 v[96:99], a[152:155], v[136:139], v[96:99]
    v_exp_f32 v66, v66
    v_mfma_f32_16x16x32_bf16 v[96:99], a[156:159], v[140:143], v[96:99]
    ds_read_b128 a[168:171], v10 offset:12288
    v_add_f32 v28, v65, v28
    v_mfma_f32_16x16x32_bf16 v[100:103], a[156:159], v[156:159], v[196:199]
    v_exp_f32 v67, v67
    v_mfma_f32_16x16x32_bf16 v[100:103], a[152:155], v[152:155], v[100:103]
    ds_read_b128 a[172:175], v11 offset:12288
    v_cvt_pk_bf16_f32 v32, v64, v65
    v_mfma_f32_16x16x32_bf16 v[100:103], a[148:151], v[148:151], v[100:103]
    s_sub_u32 s6, s35, 2
    s_min_u32 s6, s6, 4
    s_mul_i32 s6, s6, 5504
    v_exp_f32 v80, v80
    v_mfma_f32_16x16x32_bf16 v[100:103], a[144:147], v[144:147], v[100:103]
    ds_read_b64_tr_b16 a[230:231], v17 offset:61440
    v_add_f32 v28, v66, v28
    v_mfma_f32_16x16x32_bf16 v[104:107], a[144:147], v[160:163], v[200:203]
    v_exp_f32 v81, v81
    v_mfma_f32_16x16x32_bf16 v[104:107], a[148:151], v[164:167], v[104:107]
    buffer_load_dword v6, v3, s[20:23], s6 offen
    v_mfma_f32_16x16x32_bf16 v[104:107], a[152:155], v[168:171], v[104:107]
    v_exp_f32 v82, v82
    v_mfma_f32_16x16x32_bf16 v[104:107], a[156:159], v[172:175], v[104:107]
    ds_read_b64_tr_b16 a[200:201], v18 offset:49152
    v_add_f32 v28, v67, v28
    v_mfma_f32_16x16x32_bf16 v[108:111], a[156:159], v[188:191], v[204:207]
    v_exp_f32 v83, v83
    v_mfma_f32_16x16x32_bf16 v[108:111], a[152:155], v[184:187], v[108:111]
    ds_read_b64_tr_b16 a[202:203], v18 offset:53248
    v_cvt_pk_bf16_f32 v33, v66, v67
    v_mfma_f32_16x16x32_bf16 v[108:111], a[148:151], v[180:183], v[108:111]
    s_waitcnt lgkmcnt(3)
    v_exp_f32 v68, v68
    v_mfma_f32_16x16x32_bf16 v[108:111], a[144:147], v[176:179], v[108:111]
    ds_read_b64_tr_b16 a[232:233], v18 offset:57344
    v_add_f32 v28, v80, v28
    v_mfma_f32_16x16x32_bf16 v[112:115], a[160:163], v[128:131], v[192:195]
    v_exp_f32 v69, v69
    v_mfma_f32_16x16x32_bf16 v[112:115], a[164:167], v[132:135], v[112:115]
    ds_read_b64_tr_b16 a[234:235], v18 offset:61440
    v_add_f32 v28, v81, v28
    v_mfma_f32_16x16x32_bf16 v[112:115], a[168:171], v[136:139], v[112:115]
    v_exp_f32 v70, v70
    v_mfma_f32_16x16x32_bf16 v[112:115], a[172:175], v[140:143], v[112:115]
    ds_read_b64_tr_b16 a[204:205], v19 offset:49152
    v_cvt_pk_bf16_f32 v34, v80, v81
    v_mfma_f32_16x16x32_bf16 v[116:119], a[172:175], v[156:159], v[196:199]
    v_exp_f32 v71, v71
    v_mfma_f32_16x16x32_bf16 v[116:119], a[168:171], v[152:155], v[116:119]
    ds_read_b64_tr_b16 a[206:207], v19 offset:53248
    v_add_f32 v28, v82, v28
    v_mfma_f32_16x16x32_bf16 v[116:119], a[164:167], v[148:151], v[116:119]
    v_exp_f32 v84, v84
    v_mfma_f32_16x16x32_bf16 v[116:119], a[160:163], v[144:147], v[116:119]
    ds_read_b64_tr_b16 a[236:237], v19 offset:57344
    v_add_f32 v28, v83, v28
    v_mfma_f32_16x16x32_bf16 v[120:123], a[160:163], v[160:163], v[200:203]
    v_exp_f32 v85, v85
    v_mfma_f32_16x16x32_bf16 v[120:123], a[164:167], v[164:167], v[120:123]
    ds_read_b64_tr_b16 a[238:239], v19 offset:61440
    v_cvt_pk_bf16_f32 v35, v82, v83
    v_mfma_f32_16x16x32_bf16 v[120:123], a[168:171], v[168:171], v[120:123]
    v_exp_f32 v86, v86
    v_mfma_f32_16x16x32_bf16 v[120:123], a[172:175], v[172:175], v[120:123]
    v_cvt_pk_bf16_f32 v36, v68, v69
    v_cvt_pk_bf16_f32 v37, v70, v71
    v_mfma_f32_16x16x32_bf16 v[124:127], a[172:175], v[188:191], v[204:207]
    v_exp_f32 v87, v87
    v_mfma_f32_16x16x32_bf16 v[124:127], a[168:171], v[184:187], v[124:127]
    v_cvt_pk_bf16_f32 v38, v84, v85
    v_cvt_pk_bf16_f32 v39, v86, v87
    v_mfma_f32_16x16x32_bf16 v[124:127], a[164:167], v[180:183], v[124:127]
    v_mfma_f32_16x16x32_bf16 v[124:127], a[160:163], v[176:179], v[124:127]
    v_mfma_f32_16x16x32_bf16 a[132:135], a[240:243], v[212:215], a[132:135]
    v_exp_f32 v72, v72
    v_mfma_f32_16x16x32_bf16 a[132:135], a[240:243], v[228:231], a[132:135]
    v_add_f32 v30, v72, v30
    v_mfma_f32_16x16x32_bf16 a[140:143], a[240:243], v[236:239], a[140:143]
    v_exp_f32 v73, v73
    v_mfma_f32_16x16x32_bf16 a[140:143], a[240:243], v[220:223], a[140:143]
    s_waitcnt vmcnt(19) lgkmcnt(0)
    s_barrier
    v_add_f32 v30, v73, v30
    v_cvt_pk_bf16_f32 v40, v72, v73
    v_mfma_f32_16x16x32_bf16 a[0:3], a[176:179], v[208:211], a[0:3]
    v_exp_f32 v74, v74
    v_mfma_f32_16x16x32_bf16 a[0:3], a[208:211], v[224:227], a[0:3]
    ds_read_b128 a[144:147], v8 offset:16384
    v_add_f32 v30, v74, v30
    v_mfma_f32_16x16x32_bf16 a[4:7], a[208:211], v[228:231], a[4:7]
    v_exp_f32 v75, v75
    v_mfma_f32_16x16x32_bf16 a[4:7], a[176:179], v[212:215], a[4:7]
    ds_read_b128 a[148:151], v9 offset:16384
    v_add_f32 v30, v75, v30
    v_mfma_f32_16x16x32_bf16 a[8:11], a[176:179], v[216:219], a[8:11]
    v_exp_f32 v88, v88
    v_mfma_f32_16x16x32_bf16 a[8:11], a[208:211], v[232:235], a[8:11]
    ds_read_b128 a[152:155], v10 offset:16384
    v_cvt_pk_bf16_f32 v41, v74, v75
    v_mfma_f32_16x16x32_bf16 a[12:15], a[208:211], v[236:239], a[12:15]
    v_exp_f32 v89, v89
    v_mfma_f32_16x16x32_bf16 a[12:15], a[176:179], v[220:223], a[12:15]
    ds_read_b128 a[156:159], v11 offset:16384
    v_add_f32 v30, v88, v30
    v_mfma_f32_16x16x32_bf16 a[28:31], a[180:183], v[220:223], a[28:31]
    v_exp_f32 v90, v90
    v_mfma_f32_16x16x32_bf16 a[28:31], a[212:215], v[236:239], a[28:31]
    ds_read_b128 a[160:163], v8 offset:20480
    v_add_f32 v30, v89, v30
    v_mfma_f32_16x16x32_bf16 a[24:27], a[212:215], v[232:235], a[24:27]
    v_exp_f32 v91, v91
    v_mfma_f32_16x16x32_bf16 a[24:27], a[180:183], v[216:219], a[24:27]
    ds_read_b128 a[164:167], v9 offset:20480
    v_cvt_pk_bf16_f32 v42, v88, v89
    v_mfma_f32_16x16x32_bf16 a[20:23], a[180:183], v[212:215], a[20:23]
    v_exp_f32 v76, v76
    v_mfma_f32_16x16x32_bf16 a[20:23], a[212:215], v[228:231], a[20:23]
    s_add_u32 m0, s32, 0
    s_nop 0
    buffer_load_dwordx4 v20, s[8:11], s33 offen offset:0 nt lds
    v_mfma_f32_16x16x32_bf16 a[16:19], a[212:215], v[224:227], a[16:19]
    v_exp_f32 v77, v77
    v_mfma_f32_16x16x32_bf16 a[16:19], a[180:183], v[208:211], a[16:19]
    ds_read_b128 a[168:171], v10 offset:20480
    v_add_f32 v30, v90, v30
    v_mfma_f32_16x16x32_bf16 a[32:35], a[184:187], v[208:211], a[32:35]
    v_exp_f32 v78, v78
    v_mfma_f32_16x16x32_bf16 a[32:35], a[216:219], v[224:227], a[32:35]
    ds_read_b128 a[172:175], v11 offset:20480
    v_add_f32 v30, v91, v30
    v_mfma_f32_16x16x32_bf16 a[36:39], a[216:219], v[228:231], a[36:39]
    v_exp_f32 v79, v79
    v_mfma_f32_16x16x32_bf16 a[36:39], a[184:187], v[212:215], a[36:39]
    buffer_load_dwordx4 v21, s[8:11], s33 offen offset:1024 nt lds
    v_mfma_f32_16x16x32_bf16 a[40:43], a[184:187], v[216:219], a[40:43]
    v_exp_f32 v92, v92
    v_mfma_f32_16x16x32_bf16 a[40:43], a[216:219], v[232:235], a[40:43]
    ds_read_b64_tr_b16 a[176:177], v12 offset:0
    v_cvt_pk_bf16_f32 v43, v90, v91
    v_mfma_f32_16x16x32_bf16 a[44:47], a[216:219], v[236:239], a[44:47]
    v_exp_f32 v93, v93
    v_mfma_f32_16x16x32_bf16 a[44:47], a[184:187], v[220:223], a[44:47]
    ds_read_b64_tr_b16 a[178:179], v12 offset:4096
    v_cvt_pk_bf16_f32 v44, v76, v77
    v_mfma_f32_16x16x32_bf16 a[60:63], a[188:191], v[220:223], a[60:63]
    v_exp_f32 v94, v94
    v_mfma_f32_16x16x32_bf16 a[60:63], a[220:223], v[236:239], a[60:63]
    buffer_load_dwordx4 v22, s[8:11], s33 offen offset:2048 nt lds
    v_mfma_f32_16x16x32_bf16 a[56:59], a[220:223], v[232:235], a[56:59]
    v_exp_f32 v95, v95
    v_mfma_f32_16x16x32_bf16 a[56:59], a[188:191], v[216:219], a[56:59]
    ds_read_b64_tr_b16 a[208:209], v12 offset:8192
    v_cvt_pk_bf16_f32 v45, v78, v79
    v_mfma_f32_16x16x32_bf16 a[52:55], a[188:191], v[212:215], a[52:55]
    v_exp_f32 v96, v96
    v_mfma_f32_16x16x32_bf16 a[52:55], a[220:223], v[228:231], a[52:55]
    ds_read_b64_tr_b16 a[210:211], v12 offset:12288
    v_cvt_pk_bf16_f32 v46, v92, v93
    v_mfma_f32_16x16x32_bf16 a[48:51], a[220:223], v[224:227], a[48:51]
    v_exp_f32 v97, v97
    v_mfma_f32_16x16x32_bf16 a[48:51], a[188:191], v[208:211], a[48:51]
    buffer_load_dwordx4 v23, s[8:11], s33 offen offset:3072 nt lds
    v_mfma_f32_16x16x32_bf16 a[64:67], a[192:195], v[208:211], a[64:67]
    v_exp_f32 v98, v98
    v_mfma_f32_16x16x32_bf16 a[64:67], a[224:227], v[224:227], a[64:67]
    ds_read_b64_tr_b16 a[180:181], v13 offset:0
    v_cvt_pk_bf16_f32 v47, v94, v95
    v_mfma_f32_16x16x32_bf16 a[68:71], a[224:227], v[228:231], a[68:71]
    v_exp_f32 v99, v99
    v_mfma_f32_16x16x32_bf16 a[68:71], a[192:195], v[212:215], a[68:71]
    ds_read_b64_tr_b16 a[182:183], v13 offset:4096
    v_add_f32 v28, v96, v28
    v_mfma_f32_16x16x32_bf16 a[72:75], a[192:195], v[216:219], a[72:75]
    v_exp_f32 v112, v112
    v_mfma_f32_16x16x32_bf16 a[72:75], a[224:227], v[232:235], a[72:75]
    s_add_u32 m0, s32, 114688
    s_add_u32 s33, s33, 16384
    buffer_load_dwordx4 v24, s[12:15], s34 offen offset:0 nt lds
    v_mfma_f32_16x16x32_bf16 a[76:79], a[224:227], v[236:239], a[76:79]
    v_exp_f32 v113, v113
    v_mfma_f32_16x16x32_bf16 a[76:79], a[192:195], v[220:223], a[76:79]
    ds_read_b64_tr_b16 a[212:213], v13 offset:8192
    v_add_f32 v28, v97, v28
    v_mfma_f32_16x16x32_bf16 a[92:95], a[196:199], v[220:223], a[92:95]
    v_exp_f32 v114, v114
    v_mfma_f32_16x16x32_bf16 a[92:95], a[228:231], v[236:239], a[92:95]
    ds_read_b64_tr_b16 a[214:215], v13 offset:12288
    v_cvt_pk_bf16_f32 v48, v96, v97
    v_mfma_f32_16x16x32_bf16 a[88:91], a[228:231], v[232:235], a[88:91]
    v_exp_f32 v115, v115
    v_mfma_f32_16x16x32_bf16 a[88:91], a[196:199], v[216:219], a[88:91]
    buffer_load_dwordx4 v25, s[12:15], s34 offen offset:1024 nt lds
    v_mfma_f32_16x16x32_bf16 a[84:87], a[196:199], v[212:215], a[84:87]
    v_exp_f32 v100, v100
    v_mfma_f32_16x16x32_bf16 a[84:87], a[228:231], v[228:231], a[84:87]
    ds_read_b64_tr_b16 a[184:185], v14 offset:0
    v_add_f32 v28, v98, v28
    v_mfma_f32_16x16x32_bf16 a[80:83], a[228:231], v[224:227], a[80:83]
    v_exp_f32 v101, v101
    v_mfma_f32_16x16x32_bf16 a[80:83], a[196:199], v[208:211], a[80:83]
    ds_read_b64_tr_b16 a[186:187], v14 offset:4096
    v_add_f32 v28, v99, v28
    v_mfma_f32_16x16x32_bf16 a[96:99], a[200:203], v[208:211], a[96:99]
    v_exp_f32 v102, v102
    v_mfma_f32_16x16x32_bf16 a[96:99], a[232:235], v[224:227], a[96:99]
    buffer_load_dwordx4 v24, s[12:15], s34 offen offset:2048 nt lds
    v_mfma_f32_16x16x32_bf16 a[100:103], a[232:235], v[228:231], a[100:103]
    v_exp_f32 v103, v103
    v_mfma_f32_16x16x32_bf16 a[100:103], a[200:203], v[212:215], a[100:103]
    ds_read_b64_tr_b16 a[216:217], v14 offset:8192
    v_cvt_pk_bf16_f32 v49, v98, v99
    v_mfma_f32_16x16x32_bf16 a[104:107], a[200:203], v[216:219], a[104:107]
    v_exp_f32 v116, v116
    v_mfma_f32_16x16x32_bf16 a[104:107], a[232:235], v[232:235], a[104:107]
    v_add_f32 v28, v112, v28
    v_add_f32 v28, v113, v28
    v_mfma_f32_16x16x32_bf16 a[108:111], a[232:235], v[236:239], a[108:111]
    v_exp_f32 v117, v117
    v_mfma_f32_16x16x32_bf16 a[108:111], a[200:203], v[220:223], a[108:111]
    buffer_load_dwordx4 v25, s[12:15], s34 offen offset:3072 nt lds
    s_add_u32 s34, s34, 16384
    v_mfma_f32_16x16x32_bf16 a[124:127], a[204:207], v[220:223], a[124:127]
    v_exp_f32 v118, v118
    v_mfma_f32_16x16x32_bf16 a[124:127], a[236:239], v[236:239], a[124:127]
    v_cvt_pk_bf16_f32 v50, v112, v113
    v_add_f32 v28, v114, v28
    v_mfma_f32_16x16x32_bf16 a[120:123], a[236:239], v[232:235], a[120:123]
    v_exp_f32 v119, v119
    v_mfma_f32_16x16x32_bf16 a[120:123], a[204:207], v[216:219], a[120:123]
    v_add_f32 v28, v115, v28
    v_cvt_pk_bf16_f32 v51, v114, v115
    v_mfma_f32_16x16x32_bf16 a[116:119], a[204:207], v[212:215], a[116:119]
    v_exp_f32 v104, v104
    v_mfma_f32_16x16x32_bf16 a[116:119], a[236:239], v[228:231], a[116:119]
    v_cvt_pk_bf16_f32 v52, v100, v101
    v_cvt_pk_bf16_f32 v53, v102, v103
    v_mfma_f32_16x16x32_bf16 a[112:115], a[236:239], v[224:227], a[112:115]
    v_cvt_pk_bf16_f32 v54, v116, v117
    v_cvt_pk_bf16_f32 v55, v118, v119
    v_mfma_f32_16x16x32_bf16 a[112:115], a[204:207], v[208:211], a[112:115]
    v_add_f32 v30, v104, v30
    s_waitcnt lgkmcnt(11)
    v_mfma_f32_16x16x32_bf16 v[64:67], a[144:147], v[128:131], v[192:195]
    v_exp_f32 v105, v105
    v_mfma_f32_16x16x32_bf16 v[64:67], a[148:151], v[132:135], v[64:67]
    ds_read_b64_tr_b16 a[218:219], v14 offset:12288
    ds_read_b64_tr_b16 a[188:189], v15 offset:0
    v_mfma_f32_16x16x32_bf16 v[64:67], a[152:155], v[136:139], v[64:67]
    v_exp_f32 v106, v106
    v_mfma_f32_16x16x32_bf16 v[64:67], a[156:159], v[140:143], v[64:67]
    ds_read_b64_tr_b16 a[190:191], v15 offset:4096
    v_add_f32 v30, v105, v30
    v_mfma_f32_16x16x32_bf16 v[68:71], a[156:159], v[156:159], v[196:199]
    v_exp_f32 v107, v107
    v_mfma_f32_16x16x32_bf16 v[68:71], a[152:155], v[152:155], v[68:71]
    ds_read_b64_tr_b16 a[220:221], v15 offset:8192
    v_cvt_pk_bf16_f32 v56, v104, v105
    v_mfma_f32_16x16x32_bf16 v[68:71], a[148:151], v[148:151], v[68:71]
    v_exp_f32 v120, v120
    v_mfma_f32_16x16x32_bf16 v[68:71], a[144:147], v[144:147], v[68:71]
    ds_read_b64_tr_b16 a[222:223], v15 offset:12288
    v_add_f32 v30, v106, v30
    v_mfma_f32_16x16x32_bf16 v[72:75], a[144:147], v[160:163], v[200:203]
    v_exp_f32 v121, v121
    v_mfma_f32_16x16x32_bf16 v[72:75], a[148:151], v[164:167], v[72:75]
    ds_read_b64_tr_b16 a[192:193], v16 offset:0
    v_add_f32 v30, v107, v30
    v_mfma_f32_16x16x32_bf16 v[72:75], a[152:155], v[168:171], v[72:75]
    v_exp_f32 v122, v122
    v_mfma_f32_16x16x32_bf16 v[72:75], a[156:159], v[172:175], v[72:75]
    ds_read_b64_tr_b16 a[194:195], v16 offset:4096
    v_cvt_pk_bf16_f32 v57, v106, v107
    v_mfma_f32_16x16x32_bf16 v[76:79], a[156:159], v[188:191], v[204:207]
    v_exp_f32 v123, v123
    v_mfma_f32_16x16x32_bf16 v[76:79], a[152:155], v[184:187], v[76:79]
    ds_read_b64_tr_b16 a[224:225], v16 offset:8192
    v_add_f32 v30, v120, v30
    v_mfma_f32_16x16x32_bf16 v[76:79], a[148:151], v[180:183], v[76:79]
    v_exp_f32 v108, v108
    v_mfma_f32_16x16x32_bf16 v[76:79], a[144:147], v[176:179], v[76:79]
    ds_read_b128 a[144:147], v8 offset:24576
    v_add_f32 v30, v121, v30
    v_mfma_f32_16x16x32_bf16 v[80:83], a[160:163], v[128:131], v[192:195]
    v_exp_f32 v109, v109
    v_mfma_f32_16x16x32_bf16 v[80:83], a[164:167], v[132:135], v[80:83]
    ds_read_b128 a[148:151], v9 offset:24576
    v_cvt_pk_bf16_f32 v58, v120, v121
    v_mfma_f32_16x16x32_bf16 v[80:83], a[168:171], v[136:139], v[80:83]
    v_exp_f32 v110, v110
    v_mfma_f32_16x16x32_bf16 v[80:83], a[172:175], v[140:143], v[80:83]
    ds_read_b128 a[152:155], v10 offset:24576
    v_add_f32 v30, v122, v30
    v_mfma_f32_16x16x32_bf16 v[84:87], a[172:175], v[156:159], v[196:199]
    v_exp_f32 v111, v111
    v_mfma_f32_16x16x32_bf16 v[84:87], a[168:171], v[152:155], v[84:87]
    ds_read_b128 a[156:159], v11 offset:24576
    v_add_f32 v30, v123, v30
    v_mfma_f32_16x16x32_bf16 v[84:87], a[164:167], v[148:151], v[84:87]
    v_exp_f32 v124, v124
    v_mfma_f32_16x16x32_bf16 v[84:87], a[160:163], v[144:147], v[84:87]
    ds_read_b64_tr_b16 a[226:227], v16 offset:12288
    v_cvt_pk_bf16_f32 v59, v122, v123
    v_mfma_f32_16x16x32_bf16 v[88:91], a[160:163], v[160:163], v[200:203]
    v_exp_f32 v125, v125
    v_mfma_f32_16x16x32_bf16 v[88:91], a[164:167], v[164:167], v[88:91]
    ds_read_b64_tr_b16 a[196:197], v17 offset:0
    v_cvt_pk_bf16_f32 v60, v108, v109
    v_mfma_f32_16x16x32_bf16 v[88:91], a[168:171], v[168:171], v[88:91]
    v_exp_f32 v126, v126
    v_mfma_f32_16x16x32_bf16 v[88:91], a[172:175], v[172:175], v[88:91]
    ds_read_b64_tr_b16 a[198:199], v17 offset:4096
    v_cvt_pk_bf16_f32 v61, v110, v111
    v_mfma_f32_16x16x32_bf16 v[92:95], a[172:175], v[188:191], v[204:207]
    v_exp_f32 v127, v127
    v_mfma_f32_16x16x32_bf16 v[92:95], a[168:171], v[184:187], v[92:95]
    ds_read_b64_tr_b16 a[228:229], v17 offset:8192
    v_cvt_pk_bf16_f32 v62, v124, v125
    v_mfma_f32_16x16x32_bf16 v[92:95], a[164:167], v[180:183], v[92:95]
    s_waitcnt lgkmcnt(4)
    v_exp_f32 v64, v64
    v_mfma_f32_16x16x32_bf16 v[92:95], a[160:163], v[176:179], v[92:95]
    ds_read_b128 a[160:163], v8 offset:28672
    v_cvt_pk_bf16_f32 v63, v126, v127
    v_mfma_f32_16x16x32_bf16 v[96:99], a[144:147], v[128:131], v[192:195]
    v_exp_f32 v65, v65
    v_mfma_f32_16x16x32_bf16 v[96:99], a[148:151], v[132:135], v[96:99]
    ds_read_b128 a[164:167], v9 offset:28672
    v_add_f32 v28, v64, v28
    v_mfma_f32_16x16x32_bf16 v[96:99], a[152:155], v[136:139], v[96:99]
    v_exp_f32 v66, v66
    v_mfma_f32_16x16x32_bf16 v[96:99], a[156:159], v[140:143], v[96:99]
    ds_read_b128 a[168:171], v10 offset:28672
    v_add_f32 v28, v65, v28
    v_mfma_f32_16x16x32_bf16 v[100:103], a[156:159], v[156:159], v[196:199]
    v_exp_f32 v67, v67
    v_mfma_f32_16x16x32_bf16 v[100:103], a[152:155], v[152:155], v[100:103]
    ds_read_b128 a[172:175], v11 offset:28672
    v_cvt_pk_bf16_f32 v208, v64, v65
    v_mfma_f32_16x16x32_bf16 v[100:103], a[148:151], v[148:151], v[100:103]
    s_sub_u32 s6, s35, 3
    s_min_u32 s6, s6, 4
    s_lshl_b32 s6, s6, 11
    v_exp_f32 v80, v80
    v_mfma_f32_16x16x32_bf16 v[100:103], a[144:147], v[144:147], v[100:103]
    ds_read_b64_tr_b16 a[230:231], v17 offset:12288
    v_add_f32 v28, v66, v28
    v_mfma_f32_16x16x32_bf16 v[104:107], a[144:147], v[160:163], v[200:203]
    v_exp_f32 v81, v81
    v_mfma_f32_16x16x32_bf16 v[104:107], a[148:151], v[164:167], v[104:107]
    buffer_load_dword v5, v2, s[24:27], s6 offen offset:0
    v_mfma_f32_16x16x32_bf16 v[104:107], a[152:155], v[168:171], v[104:107]
    v_exp_f32 v82, v82
    v_mfma_f32_16x16x32_bf16 v[104:107], a[156:159], v[172:175], v[104:107]
    ds_read_b64_tr_b16 a[200:201], v18 offset:0
    v_add_f32 v28, v67, v28
    v_mfma_f32_16x16x32_bf16 v[108:111], a[156:159], v[188:191], v[204:207]
    v_exp_f32 v83, v83
    v_mfma_f32_16x16x32_bf16 v[108:111], a[152:155], v[184:187], v[108:111]
    ds_read_b64_tr_b16 a[202:203], v18 offset:4096
    v_cvt_pk_bf16_f32 v209, v66, v67
    v_mfma_f32_16x16x32_bf16 v[108:111], a[148:151], v[180:183], v[108:111]
    s_waitcnt lgkmcnt(3)
    v_exp_f32 v68, v68
    v_mfma_f32_16x16x32_bf16 v[108:111], a[144:147], v[176:179], v[108:111]
    ds_read_b64_tr_b16 a[232:233], v18 offset:8192
    v_add_f32 v28, v80, v28
    v_mfma_f32_16x16x32_bf16 v[112:115], a[160:163], v[128:131], v[192:195]
    v_exp_f32 v69, v69
    v_mfma_f32_16x16x32_bf16 v[112:115], a[164:167], v[132:135], v[112:115]
    ds_read_b64_tr_b16 a[234:235], v18 offset:12288
    v_add_f32 v28, v81, v28
    v_mfma_f32_16x16x32_bf16 v[112:115], a[168:171], v[136:139], v[112:115]
    v_exp_f32 v70, v70
    v_mfma_f32_16x16x32_bf16 v[112:115], a[172:175], v[140:143], v[112:115]
    ds_read_b64_tr_b16 a[204:205], v19 offset:0
    v_cvt_pk_bf16_f32 v210, v80, v81
    v_mfma_f32_16x16x32_bf16 v[116:119], a[172:175], v[156:159], v[196:199]
    v_exp_f32 v71, v71
    v_mfma_f32_16x16x32_bf16 v[116:119], a[168:171], v[152:155], v[116:119]
    ds_read_b64_tr_b16 a[206:207], v19 offset:4096
    v_add_f32 v28, v82, v28
    v_mfma_f32_16x16x32_bf16 v[116:119], a[164:167], v[148:151], v[116:119]
    v_exp_f32 v84, v84
    v_mfma_f32_16x16x32_bf16 v[116:119], a[160:163], v[144:147], v[116:119]
    ds_read_b64_tr_b16 a[236:237], v19 offset:8192
    v_add_f32 v28, v83, v28
    v_mfma_f32_16x16x32_bf16 v[120:123], a[160:163], v[160:163], v[200:203]
    v_exp_f32 v85, v85
    v_mfma_f32_16x16x32_bf16 v[120:123], a[164:167], v[164:167], v[120:123]
    ds_read_b64_tr_b16 a[238:239], v19 offset:12288
    v_cvt_pk_bf16_f32 v211, v82, v83
    v_mfma_f32_16x16x32_bf16 v[120:123], a[168:171], v[168:171], v[120:123]
    v_exp_f32 v86, v86
    v_mfma_f32_16x16x32_bf16 v[120:123], a[172:175], v[172:175], v[120:123]
    v_cvt_pk_bf16_f32 v212, v68, v69
    v_cvt_pk_bf16_f32 v213, v70, v71
    v_mfma_f32_16x16x32_bf16 v[124:127], a[172:175], v[188:191], v[204:207]
    v_exp_f32 v87, v87
    v_mfma_f32_16x16x32_bf16 v[124:127], a[168:171], v[184:187], v[124:127]
    v_cvt_pk_bf16_f32 v214, v84, v85
    v_cvt_pk_bf16_f32 v215, v86, v87
    v_mfma_f32_16x16x32_bf16 v[124:127], a[164:167], v[180:183], v[124:127]
    v_mfma_f32_16x16x32_bf16 v[124:127], a[160:163], v[176:179], v[124:127]
    v_mfma_f32_16x16x32_bf16 a[132:135], a[240:243], v[36:39], a[132:135]
    v_exp_f32 v72, v72
    v_mfma_f32_16x16x32_bf16 a[132:135], a[240:243], v[52:55], a[132:135]
    v_add_f32 v30, v72, v30
    v_mfma_f32_16x16x32_bf16 a[140:143], a[240:243], v[60:63], a[140:143]
    v_exp_f32 v73, v73
    v_mfma_f32_16x16x32_bf16 a[140:143], a[240:243], v[44:47], a[140:143]
    s_waitcnt vmcnt(19) lgkmcnt(0)
    s_barrier
    v_add_f32 v30, v73, v30
    v_cvt_pk_bf16_f32 v216, v72, v73
    v_mfma_f32_16x16x32_bf16 a[0:3], a[176:179], v[32:35], a[0:3]
    v_exp_f32 v74, v74
    v_mfma_f32_16x16x32_bf16 a[0:3], a[208:211], v[48:51], a[0:3]
    ds_read_b128 a[144:147], v8 offset:32768
    v_add_f32 v30, v74, v30
    v_mfma_f32_16x16x32_bf16 a[4:7], a[208:211], v[52:55], a[4:7]
    v_exp_f32 v75, v75
    v_mfma_f32_16x16x32_bf16 a[4:7], a[176:179], v[36:39], a[4:7]
    ds_read_b128 a[148:151], v9 offset:32768
    v_add_f32 v30, v75, v30
    v_mfma_f32_16x16x32_bf16 a[8:11], a[176:179], v[40:43], a[8:11]
    v_exp_f32 v88, v88
    v_mfma_f32_16x16x32_bf16 a[8:11], a[208:211], v[56:59], a[8:11]
    ds_read_b128 a[152:155], v10 offset:32768
    v_cvt_pk_bf16_f32 v217, v74, v75
    v_mfma_f32_16x16x32_bf16 a[12:15], a[208:211], v[60:63], a[12:15]
    v_exp_f32 v89, v89
    v_mfma_f32_16x16x32_bf16 a[12:15], a[176:179], v[44:47], a[12:15]
    ds_read_b128 a[156:159], v11 offset:32768
    v_add_f32 v30, v88, v30
    v_mfma_f32_16x16x32_bf16 a[28:31], a[180:183], v[44:47], a[28:31]
    v_exp_f32 v90, v90
    v_mfma_f32_16x16x32_bf16 a[28:31], a[212:215], v[60:63], a[28:31]
    ds_read_b128 a[160:163], v8 offset:36864
    v_add_f32 v30, v89, v30
    v_mfma_f32_16x16x32_bf16 a[24:27], a[212:215], v[56:59], a[24:27]
    v_exp_f32 v91, v91
    v_mfma_f32_16x16x32_bf16 a[24:27], a[180:183], v[40:43], a[24:27]
    ds_read_b128 a[164:167], v9 offset:36864
    v_cvt_pk_bf16_f32 v218, v88, v89
    v_mfma_f32_16x16x32_bf16 a[20:23], a[180:183], v[36:39], a[20:23]
    v_exp_f32 v76, v76
    v_mfma_f32_16x16x32_bf16 a[20:23], a[212:215], v[52:55], a[20:23]
    s_add_u32 m0, s32, 16384
    s_nop 0
    buffer_load_dwordx4 v20, s[8:11], s33 offen offset:0 nt lds
    v_mfma_f32_16x16x32_bf16 a[16:19], a[212:215], v[48:51], a[16:19]
    v_exp_f32 v77, v77
    v_mfma_f32_16x16x32_bf16 a[16:19], a[180:183], v[32:35], a[16:19]
    ds_read_b128 a[168:171], v10 offset:36864
    v_add_f32 v30, v90, v30
    v_mfma_f32_16x16x32_bf16 a[32:35], a[184:187], v[32:35], a[32:35]
    v_exp_f32 v78, v78
    v_mfma_f32_16x16x32_bf16 a[32:35], a[216:219], v[48:51], a[32:35]
    ds_read_b128 a[172:175], v11 offset:36864
    v_add_f32 v30, v91, v30
    v_mfma_f32_16x16x32_bf16 a[36:39], a[216:219], v[52:55], a[36:39]
    v_exp_f32 v79, v79
    v_mfma_f32_16x16x32_bf16 a[36:39], a[184:187], v[36:39], a[36:39]
    buffer_load_dwordx4 v21, s[8:11], s33 offen offset:1024 nt lds
    v_mfma_f32_16x16x32_bf16 a[40:43], a[184:187], v[40:43], a[40:43]
    v_exp_f32 v92, v92
    v_mfma_f32_16x16x32_bf16 a[40:43], a[216:219], v[56:59], a[40:43]
    ds_read_b64_tr_b16 a[176:177], v12 offset:16384
    v_cvt_pk_bf16_f32 v219, v90, v91
    v_mfma_f32_16x16x32_bf16 a[44:47], a[216:219], v[60:63], a[44:47]
    v_exp_f32 v93, v93
    v_mfma_f32_16x16x32_bf16 a[44:47], a[184:187], v[44:47], a[44:47]
    ds_read_b64_tr_b16 a[178:179], v12 offset:20480
    v_cvt_pk_bf16_f32 v220, v76, v77
    v_mfma_f32_16x16x32_bf16 a[60:63], a[188:191], v[44:47], a[60:63]
    v_exp_f32 v94, v94
    v_mfma_f32_16x16x32_bf16 a[60:63], a[220:223], v[60:63], a[60:63]
    buffer_load_dwordx4 v22, s[8:11], s33 offen offset:2048 nt lds
    v_mfma_f32_16x16x32_bf16 a[56:59], a[220:223], v[56:59], a[56:59]
    v_exp_f32 v95, v95
    v_mfma_f32_16x16x32_bf16 a[56:59], a[188:191], v[40:43], a[56:59]
    ds_read_b64_tr_b16 a[208:209], v12 offset:24576
    v_cvt_pk_bf16_f32 v221, v78, v79
    v_mfma_f32_16x16x32_bf16 a[52:55], a[188:191], v[36:39], a[52:55]
    v_exp_f32 v96, v96
    v_mfma_f32_16x16x32_bf16 a[52:55], a[220:223], v[52:55], a[52:55]
    ds_read_b64_tr_b16 a[210:211], v12 offset:28672
    v_cvt_pk_bf16_f32 v222, v92, v93
    v_mfma_f32_16x16x32_bf16 a[48:51], a[220:223], v[48:51], a[48:51]
    v_exp_f32 v97, v97
    v_mfma_f32_16x16x32_bf16 a[48:51], a[188:191], v[32:35], a[48:51]
    buffer_load_dwordx4 v23, s[8:11], s33 offen offset:3072 nt lds
    v_mfma_f32_16x16x32_bf16 a[64:67], a[192:195], v[32:35], a[64:67]
    v_exp_f32 v98, v98
    v_mfma_f32_16x16x32_bf16 a[64:67], a[224:227], v[48:51], a[64:67]
    ds_read_b64_tr_b16 a[180:181], v13 offset:16384
    v_cvt_pk_bf16_f32 v223, v94, v95
    v_mfma_f32_16x16x32_bf16 a[68:71], a[224:227], v[52:55], a[68:71]
    v_exp_f32 v99, v99
    v_mfma_f32_16x16x32_bf16 a[68:71], a[192:195], v[36:39], a[68:71]
    ds_read_b64_tr_b16 a[182:183], v13 offset:20480
    v_add_f32 v28, v96, v28
    v_mfma_f32_16x16x32_bf16 a[72:75], a[192:195], v[40:43], a[72:75]
    v_exp_f32 v112, v112
    v_mfma_f32_16x16x32_bf16 a[72:75], a[224:227], v[56:59], a[72:75]
    s_add_u32 m0, s32, 65536
    s_add_u32 s33, s33, 16384
    buffer_load_dwordx4 v24, s[12:15], s34 offen offset:0 nt lds
    v_mfma_f32_16x16x32_bf16 a[76:79], a[224:227], v[60:63], a[76:79]
    v_exp_f32 v113, v113
    v_mfma_f32_16x16x32_bf16 a[76:79], a[192:195], v[44:47], a[76:79]
    ds_read_b64_tr_b16 a[212:213], v13 offset:24576
    v_add_f32 v28, v97, v28
    v_mfma_f32_16x16x32_bf16 a[92:95], a[196:199], v[44:47], a[92:95]
    v_exp_f32 v114, v114
    v_mfma_f32_16x16x32_bf16 a[92:95], a[228:231], v[60:63], a[92:95]
    ds_read_b64_tr_b16 a[214:215], v13 offset:28672
    v_cvt_pk_bf16_f32 v224, v96, v97
    v_mfma_f32_16x16x32_bf16 a[88:91], a[228:231], v[56:59], a[88:91]
    v_exp_f32 v115, v115
    v_mfma_f32_16x16x32_bf16 a[88:91], a[196:199], v[40:43], a[88:91]
    buffer_load_dwordx4 v25, s[12:15], s34 offen offset:1024 nt lds
    v_mfma_f32_16x16x32_bf16 a[84:87], a[196:199], v[36:39], a[84:87]
    v_exp_f32 v100, v100
    v_mfma_f32_16x16x32_bf16 a[84:87], a[228:231], v[52:55], a[84:87]
    ds_read_b64_tr_b16 a[184:185], v14 offset:16384
    v_add_f32 v28, v98, v28
    v_mfma_f32_16x16x32_bf16 a[80:83], a[228:231], v[48:51], a[80:83]
    v_exp_f32 v101, v101
    v_mfma_f32_16x16x32_bf16 a[80:83], a[196:199], v[32:35], a[80:83]
    ds_read_b64_tr_b16 a[186:187], v14 offset:20480
    v_add_f32 v28, v99, v28
    v_mfma_f32_16x16x32_bf16 a[96:99], a[200:203], v[32:35], a[96:99]
    v_exp_f32 v102, v102
    v_mfma_f32_16x16x32_bf16 a[96:99], a[232:235], v[48:51], a[96:99]
    buffer_load_dwordx4 v24, s[12:15], s34 offen offset:2048 nt lds
    v_mfma_f32_16x16x32_bf16 a[100:103], a[232:235], v[52:55], a[100:103]
    v_exp_f32 v103, v103
    v_mfma_f32_16x16x32_bf16 a[100:103], a[200:203], v[36:39], a[100:103]
    ds_read_b64_tr_b16 a[216:217], v14 offset:24576
    v_cvt_pk_bf16_f32 v225, v98, v99
    v_mfma_f32_16x16x32_bf16 a[104:107], a[200:203], v[40:43], a[104:107]
    v_exp_f32 v116, v116
    v_mfma_f32_16x16x32_bf16 a[104:107], a[232:235], v[56:59], a[104:107]
    v_add_f32 v28, v112, v28
    v_add_f32 v28, v113, v28
    v_mfma_f32_16x16x32_bf16 a[108:111], a[232:235], v[60:63], a[108:111]
    v_exp_f32 v117, v117
    v_mfma_f32_16x16x32_bf16 a[108:111], a[200:203], v[44:47], a[108:111]
    buffer_load_dwordx4 v25, s[12:15], s34 offen offset:3072 nt lds
    s_add_u32 s34, s34, 16384
    v_mfma_f32_16x16x32_bf16 a[124:127], a[204:207], v[44:47], a[124:127]
    v_exp_f32 v118, v118
    v_mfma_f32_16x16x32_bf16 a[124:127], a[236:239], v[60:63], a[124:127]
    v_cvt_pk_bf16_f32 v226, v112, v113
    v_add_f32 v28, v114, v28
    v_mfma_f32_16x16x32_bf16 a[120:123], a[236:239], v[56:59], a[120:123]
    v_exp_f32 v119, v119
    v_mfma_f32_16x16x32_bf16 a[120:123], a[204:207], v[40:43], a[120:123]
    v_add_f32 v28, v115, v28
    v_cvt_pk_bf16_f32 v227, v114, v115
    v_mfma_f32_16x16x32_bf16 a[116:119], a[204:207], v[36:39], a[116:119]
    v_exp_f32 v104, v104
    v_mfma_f32_16x16x32_bf16 a[116:119], a[236:239], v[52:55], a[116:119]
    v_cvt_pk_bf16_f32 v228, v100, v101
    v_cvt_pk_bf16_f32 v229, v102, v103
    v_mfma_f32_16x16x32_bf16 a[112:115], a[236:239], v[48:51], a[112:115]
    v_cvt_pk_bf16_f32 v230, v116, v117
    v_cvt_pk_bf16_f32 v231, v118, v119
    v_mfma_f32_16x16x32_bf16 a[112:115], a[204:207], v[32:35], a[112:115]
    v_add_f32 v30, v104, v30
k1_pos2:
    s_waitcnt lgkmcnt(11)
    v_mfma_f32_16x16x32_bf16 v[64:67], a[144:147], v[128:131], v[192:195]
    v_exp_f32 v105, v105
    v_mfma_f32_16x16x32_bf16 v[64:67], a[148:151], v[132:135], v[64:67]
    ds_read_b64_tr_b16 a[218:219], v14 offset:28672
    ds_read_b64_tr_b16 a[188:189], v15 offset:16384
    v_mfma_f32_16x16x32_bf16 v[64:67], a[152:155], v[136:139], v[64:67]
    v_exp_f32 v106, v106
    v_mfma_f32_16x16x32_bf16 v[64:67], a[156:159], v[140:143], v[64:67]
    ds_read_b64_tr_b16 a[190:191], v15 offset:20480
    v_add_f32 v30, v105, v30
    v_mfma_f32_16x16x32_bf16 v[68:71], a[156:159], v[156:159], v[196:199]
    v_exp_f32 v107, v107
    v_mfma_f32_16x16x32_bf16 v[68:71], a[152:155], v[152:155], v[68:71]
    ds_read_b64_tr_b16 a[220:221], v15 offset:24576
    v_cvt_pk_bf16_f32 v232, v104, v105
    v_mfma_f32_16x16x32_bf16 v[68:71], a[148:151], v[148:151], v[68:71]
    v_exp_f32 v120, v120
    v_mfma_f32_16x16x32_bf16 v[68:71], a[144:147], v[144:147], v[68:71]
    ds_read_b64_tr_b16 a[222:223], v15 offset:28672
    v_add_f32 v30, v106, v30
    v_mfma_f32_16x16x32_bf16 v[72:75], a[144:147], v[160:163], v[200:203]
    v_exp_f32 v121, v121
    v_mfma_f32_16x16x32_bf16 v[72:75], a[148:151], v[164:167], v[72:75]
    ds_read_b64_tr_b16 a[192:193], v16 offset:16384
    v_add_f32 v30, v107, v30
    v_mfma_f32_16x16x32_bf16 v[72:75], a[152:155], v[168:171], v[72:75]
    v_exp_f32 v122, v122
    v_mfma_f32_16x16x32_bf16 v[72:75], a[156:159], v[172:175], v[72:75]
    ds_read_b64_tr_b16 a[194:195], v16 offset:20480
    v_cvt_pk_bf16_f32 v233, v106, v107
    v_mfma_f32_16x16x32_bf16 v[76:79], a[156:159], v[188:191], v[204:207]
    v_exp_f32 v123, v123
    v_mfma_f32_16x16x32_bf16 v[76:79], a[152:155], v[184:187], v[76:79]
    ds_read_b64_tr_b16 a[224:225], v16 offset:24576
    v_add_f32 v30, v120, v30
    v_mfma_f32_16x16x32_bf16 v[76:79], a[148:151], v[180:183], v[76:79]
    v_exp_f32 v108, v108
    v_mfma_f32_16x16x32_bf16 v[76:79], a[144:147], v[176:179], v[76:79]
    ds_read_b128 a[144:147], v8 offset:40960
    v_add_f32 v30, v121, v30
    v_mfma_f32_16x16x32_bf16 v[80:83], a[160:163], v[128:131], v[192:195]
    v_exp_f32 v109, v109
    v_mfma_f32_16x16x32_bf16 v[80:83], a[164:167], v[132:135], v[80:83]
    ds_read_b128 a[148:151], v9 offset:40960
    v_cvt_pk_bf16_f32 v234, v120, v121
    v_mfma_f32_16x16x32_bf16 v[80:83], a[168:171], v[136:139], v[80:83]
    v_exp_f32 v110, v110
    v_mfma_f32_16x16x32_bf16 v[80:83], a[172:175], v[140:143], v[80:83]
    ds_read_b128 a[152:155], v10 offset:40960
    v_add_f32 v30, v122, v30
    v_mfma_f32_16x16x32_bf16 v[84:87], a[172:175], v[156:159], v[196:199]
    v_exp_f32 v111, v111
    v_mfma_f32_16x16x32_bf16 v[84:87], a[168:171], v[152:155], v[84:87]
    ds_read_b128 a[156:159], v11 offset:40960
    v_add_f32 v30, v123, v30
    v_mfma_f32_16x16x32_bf16 v[84:87], a[164:167], v[148:151], v[84:87]
    v_exp_f32 v124, v124
    v_mfma_f32_16x16x32_bf16 v[84:87], a[160:163], v[144:147], v[84:87]
    ds_read_b64_tr_b16 a[226:227], v16 offset:28672
    v_cvt_pk_bf16_f32 v235, v122, v123
    v_mfma_f32_16x16x32_bf16 v[88:91], a[160:163], v[160:163], v[200:203]
    v_exp_f32 v125, v125
    v_mfma_f32_16x16x32_bf16 v[88:91], a[164:167], v[164:167], v[88:91]
    ds_read_b64_tr_b16 a[196:197], v17 offset:16384
    v_cvt_pk_bf16_f32 v236, v108, v109
    v_mfma_f32_16x16x32_bf16 v[88:91], a[168:171], v[168:171], v[88:91]
    v_exp_f32 v126, v126
    v_mfma_f32_16x16x32_bf16 v[88:91], a[172:175], v[172:175], v[88:91]
    ds_read_b64_tr_b16 a[198:199], v17 offset:20480
    v_cvt_pk_bf16_f32 v237, v110, v111
    v_mfma_f32_16x16x32_bf16 v[92:95], a[172:175], v[188:191], v[204:207]
    v_exp_f32 v127, v127
    v_mfma_f32_16x16x32_bf16 v[92:95], a[168:171], v[184:187], v[92:95]
    ds_read_b64_tr_b16 a[228:229], v17 offset:24576
    v_cvt_pk_bf16_f32 v238, v124, v125
    v_mfma_f32_16x16x32_bf16 v[92:95], a[164:167], v[180:183], v[92:95]
    s_waitcnt lgkmcnt(4)
    v_exp_f32 v64, v64
    v_mfma_f32_16x16x32_bf16 v[92:95], a[160:163], v[176:179], v[92:95]
    ds_read_b128 a[160:163], v8 offset:45056
    v_cvt_pk_bf16_f32 v239, v126, v127
    v_mfma_f32_16x16x32_bf16 v[96:99], a[144:147], v[128:131], v[192:195]
    v_exp_f32 v65, v65
    v_mfma_f32_16x16x32_bf16 v[96:99], a[148:151], v[132:135], v[96:99]
    ds_read_b128 a[164:167], v9 offset:45056
    v_add_f32 v28, v64, v28
    v_mfma_f32_16x16x32_bf16 v[96:99], a[152:155], v[136:139], v[96:99]
    v_exp_f32 v66, v66
    v_mfma_f32_16x16x32_bf16 v[96:99], a[156:159], v[140:143], v[96:99]
    ds_read_b128 a[168:171], v10 offset:45056
    v_add_f32 v28, v65, v28
    v_mfma_f32_16x16x32_bf16 v[100:103], a[156:159], v[156:159], v[196:199]
    v_exp_f32 v67, v67
    v_mfma_f32_16x16x32_bf16 v[100:103], a[152:155], v[152:155], v[100:103]
    ds_read_b128 a[172:175], v11 offset:45056
    v_cvt_pk_bf16_f32 v32, v64, v65
    v_mfma_f32_16x16x32_bf16 v[100:103], a[148:151], v[148:151], v[100:103]
    s_sub_u32 s6, s35, 2
    s_min_u32 s6, s6, 4
    s_lshl_b32 s6, s6, 11
    v_exp_f32 v80, v80
    v_mfma_f32_16x16x32_bf16 v[100:103], a[144:147], v[144:147], v[100:103]
    ds_read_b64_tr_b16 a[230:231], v17 offset:28672
    v_add_f32 v28, v66, v28
    v_mfma_f32_16x16x32_bf16 v[104:107], a[144:147], v[160:163], v[200:203]
    v_exp_f32 v81, v81
    v_mfma_f32_16x16x32_bf16 v[104:107], a[148:151], v[164:167], v[104:107]
    buffer_load_dword v5, v2, s[16:19], s6 offen offset:0
    v_mfma_f32_16x16x32_bf16 v[104:107], a[152:155], v[168:171], v[104:107]
    v_exp_f32 v82, v82
    v_mfma_f32_16x16x32_bf16 v[104:107], a[156:159], v[172:175], v[104:107]
    ds_read_b64_tr_b16 a[200:201], v18 offset:16384
    v_add_f32 v28, v67, v28
    v_mfma_f32_16x16x32_bf16 v[108:111], a[156:159], v[188:191], v[204:207]
    v_exp_f32 v83, v83
    v_mfma_f32_16x16x32_bf16 v[108:111], a[152:155], v[184:187], v[108:111]
    ds_read_b64_tr_b16 a[202:203], v18 offset:20480
    v_cvt_pk_bf16_f32 v33, v66, v67
    v_mfma_f32_16x16x32_bf16 v[108:111], a[148:151], v[180:183], v[108:111]
    s_waitcnt lgkmcnt(3)
    v_exp_f32 v68, v68
    v_mfma_f32_16x16x32_bf16 v[108:111], a[144:147], v[176:179], v[108:111]
    ds_read_b64_tr_b16 a[232:233], v18 offset:24576
    v_add_f32 v28, v80, v28
    v_mfma_f32_16x16x32_bf16 v[112:115], a[160:163], v[128:131], v[192:195]
    v_exp_f32 v69, v69
    v_mfma_f32_16x16x32_bf16 v[112:115], a[164:167], v[132:135], v[112:115]
    ds_read_b64_tr_b16 a[234:235], v18 offset:28672
    v_add_f32 v28, v81, v28
    v_mfma_f32_16x16x32_bf16 v[112:115], a[168:171], v[136:139], v[112:115]
    v_exp_f32 v70, v70
    v_mfma_f32_16x16x32_bf16 v[112:115], a[172:175], v[140:143], v[112:115]
    ds_read_b64_tr_b16 a[204:205], v19 offset:16384
    v_cvt_pk_bf16_f32 v34, v80, v81
    v_mfma_f32_16x16x32_bf16 v[116:119], a[172:175], v[156:159], v[196:199]
    v_exp_f32 v71, v71
    v_mfma_f32_16x16x32_bf16 v[116:119], a[168:171], v[152:155], v[116:119]
    ds_read_b64_tr_b16 a[206:207], v19 offset:20480
    v_add_f32 v28, v82, v28
    v_mfma_f32_16x16x32_bf16 v[116:119], a[164:167], v[148:151], v[116:119]
    v_exp_f32 v84, v84
    v_mfma_f32_16x16x32_bf16 v[116:119], a[160:163], v[144:147], v[116:119]
    ds_read_b64_tr_b16 a[236:237], v19 offset:24576
    v_add_f32 v28, v83, v28
    v_mfma_f32_16x16x32_bf16 v[120:123], a[160:163], v[160:163], v[200:203]
    v_exp_f32 v85, v85
    v_mfma_f32_16x16x32_bf16 v[120:123], a[164:167], v[164:167], v[120:123]
    ds_read_b64_tr_b16 a[238:239], v19 offset:28672
    v_cvt_pk_bf16_f32 v35, v82, v83
    v_mfma_f32_16x16x32_bf16 v[120:123], a[168:171], v[168:171], v[120:123]
    v_exp_f32 v86, v86
    v_mfma_f32_16x16x32_bf16 v[120:123], a[172:175], v[172:175], v[120:123]
    v_cvt_pk_bf16_f32 v36, v68, v69
    v_cvt_pk_bf16_f32 v37, v70, v71
    v_mfma_f32_16x16x32_bf16 v[124:127], a[172:175], v[188:191], v[204:207]
    v_exp_f32 v87, v87
    v_mfma_f32_16x16x32_bf16 v[124:127], a[168:171], v[184:187], v[124:127]
    v_cvt_pk_bf16_f32 v38, v84, v85
    v_cvt_pk_bf16_f32 v39, v86, v87
    v_mfma_f32_16x16x32_bf16 v[124:127], a[164:167], v[180:183], v[124:127]
    v_mfma_f32_16x16x32_bf16 v[124:127], a[160:163], v[176:179], v[124:127]
    v_mfma_f32_16x16x32_bf16 a[132:135], a[240:243], v[212:215], a[132:135]
    v_exp_f32 v72, v72
    v_mfma_f32_16x16x32_bf16 a[132:135], a[240:243], v[228:231], a[132:135]
    v_add_f32 v30, v72, v30
    v_mfma_f32_16x16x32_bf16 a[140:143], a[240:243], v[236:239], a[140:143]
    v_exp_f32 v73, v73
    v_mfma_f32_16x16x32_bf16 a[140:143], a[240:243], v[220:223], a[140:143]
    s_waitcnt vmcnt(19) lgkmcnt(0)
    s_barrier
    v_add_f32 v30, v73, v30
    v_cvt_pk_bf16_f32 v40, v72, v73
    v_mfma_f32_16x16x32_bf16 a[0:3], a[176:179], v[208:211], a[0:3]
    v_exp_f32 v74, v74
    v_mfma_f32_16x16x32_bf16 a[0:3], a[208:211], v[224:227], a[0:3]
    ds_read_b128 a[144:147], v8 offset:49152
    v_add_f32 v30, v74, v30
    v_mfma_f32_16x16x32_bf16 a[4:7], a[208:211], v[228:231], a[4:7]
    v_exp_f32 v75, v75
    v_mfma_f32_16x16x32_bf16 a[4:7], a[176:179], v[212:215], a[4:7]
    ds_read_b128 a[148:151], v9 offset:49152
    v_add_f32 v30, v75, v30
    v_mfma_f32_16x16x32_bf16 a[8:11], a[176:179], v[216:219], a[8:11]
    v_exp_f32 v88, v88
    v_mfma_f32_16x16x32_bf16 a[8:11], a[208:211], v[232:235], a[8:11]
    ds_read_b128 a[152:155], v10 offset:49152
    v_cvt_pk_bf16_f32 v41, v74, v75
    v_mfma_f32_16x16x32_bf16 a[12:15], a[208:211], v[236:239], a[12:15]
    v_exp_f32 v89, v89
    v_mfma_f32_16x16x32_bf16 a[12:15], a[176:179], v[220:223], a[12:15]
    ds_read_b128 a[156:159], v11 offset:49152
    v_add_f32 v30, v88, v30
    v_mfma_f32_16x16x32_bf16 a[28:31], a[180:183], v[220:223], a[28:31]
    v_exp_f32 v90, v90
    v_mfma_f32_16x16x32_bf16 a[28:31], a[212:215], v[236:239], a[28:31]
    ds_read_b128 a[160:163], v8 offset:53248
    v_add_f32 v30, v89, v30
    v_mfma_f32_16x16x32_bf16 a[24:27], a[212:215], v[232:235], a[24:27]
    v_exp_f32 v91, v91
    v_mfma_f32_16x16x32_bf16 a[24:27], a[180:183], v[216:219], a[24:27]
    ds_read_b128 a[164:167], v9 offset:53248
    v_cvt_pk_bf16_f32 v42, v88, v89
    v_mfma_f32_16x16x32_bf16 a[20:23], a[180:183], v[212:215], a[20:23]
    v_exp_f32 v76, v76
    v_mfma_f32_16x16x32_bf16 a[20:23], a[212:215], v[228:231], a[20:23]
    s_add_u32 m0, s32, 32768
    s_nop 0
    buffer_load_dwordx4 v20, s[8:11], s33 offen offset:0 nt lds
    v_mfma_f32_16x16x32_bf16 a[16:19], a[212:215], v[224:227], a[16:19]
    v_exp_f32 v77, v77
    v_mfma_f32_16x16x32_bf16 a[16:19], a[180:183], v[208:211], a[16:19]
    ds_read_b128 a[168:171], v10 offset:53248
    v_add_f32 v30, v90, v30
    v_mfma_f32_16x16x32_bf16 a[32:35], a[184:187], v[208:211], a[32:35]
    v_exp_f32 v78, v78
    v_mfma_f32_16x16x32_bf16 a[32:35], a[216:219], v[224:227], a[32:35]
    ds_read_b128 a[172:175], v11 offset:53248
    v_add_f32 v30, v91, v30
    v_mfma_f32_16x16x32_bf16 a[36:39], a[216:219], v[228:231], a[36:39]
    v_exp_f32 v79, v79
    v_mfma_f32_16x16x32_bf16 a[36:39], a[184:187], v[212:215], a[36:39]
    buffer_load_dwordx4 v21, s[8:11], s33 offen offset:1024 nt lds
    v_mfma_f32_16x16x32_bf16 a[40:43], a[184:187], v[216:219], a[40:43]
    v_exp_f32 v92, v92
    v_mfma_f32_16x16x32_bf16 a[40:43], a[216:219], v[232:235], a[40:43]
    ds_read_b64_tr_b16 a[176:177], v12 offset:32768
    v_cvt_pk_bf16_f32 v43, v90, v91
    v_mfma_f32_16x16x32_bf16 a[44:47], a[216:219], v[236:239], a[44:47]
    v_exp_f32 v93, v93
    v_mfma_f32_16x16x32_bf16 a[44:47], a[184:187], v[220:223], a[44:47]
    ds_read_b64_tr_b16 a[178:179], v12 offset:36864
    v_cvt_pk_bf16_f32 v44, v76, v77
    v_mfma_f32_16x16x32_bf16 a[60:63], a[188:191], v[220:223], a[60:63]
    v_exp_f32 v94, v94
    v_mfma_f32_16x16x32_bf16 a[60:63], a[220:223], v[236:239], a[60:63]
    buffer_load_dwordx4 v22, s[8:11], s33 offen offset:2048 nt lds
    v_mfma_f32_16x16x32_bf16 a[56:59], a[220:223], v[232:235], a[56:59]
    v_exp_f32 v95, v95
    v_mfma_f32_16x16x32_bf16 a[56:59], a[188:191], v[216:219], a[56:59]
    ds_read_b64_tr_b16 a[208:209], v12 offset:40960
    v_cvt_pk_bf16_f32 v45, v78, v79
    v_mfma_f32_16x16x32_bf16 a[52:55], a[188:191], v[212:215], a[52:55]
    v_exp_f32 v96, v96
    v_mfma_f32_16x16x32_bf16 a[52:55], a[220:223], v[228:231], a[52:55]
    ds_read_b64_tr_b16 a[210:211], v12 offset:45056
    v_cvt_pk_bf16_f32 v46, v92, v93
    v_mfma_f32_16x16x32_bf16 a[48:51], a[220:223], v[224:227], a[48:51]
    v_exp_f32 v97, v97
    v_mfma_f32_16x16x32_bf16 a[48:51], a[188:191], v[208:211], a[48:51]
    buffer_load_dwordx4 v23, s[8:11], s33 offen offset:3072 nt lds
    v_mfma_f32_16x16x32_bf16 a[64:67], a[192:195], v[208:211], a[64:67]
    v_exp_f32 v98, v98
    v_mfma_f32_16x16x32_bf16 a[64:67], a[224:227], v[224:227], a[64:67]
    ds_read_b64_tr_b16 a[180:181], v13 offset:32768
    v_cvt_pk_bf16_f32 v47, v94, v95
    v_mfma_f32_16x16x32_bf16 a[68:71], a[224:227], v[228:231], a[68:71]
    v_exp_f32 v99, v99
    v_mfma_f32_16x16x32_bf16 a[68:71], a[192:195], v[212:215], a[68:71]
    ds_read_b64_tr_b16 a[182:183], v13 offset:36864
    v_add_f32 v28, v96, v28
    v_mfma_f32_16x16x32_bf16 a[72:75], a[192:195], v[216:219], a[72:75]
    v_exp_f32 v112, v112
    v_mfma_f32_16x16x32_bf16 a[72:75], a[224:227], v[232:235], a[72:75]
    s_add_u32 m0, s32, 81920
    s_add_u32 s33, s33, 16384
    buffer_load_dwordx4 v24, s[12:15], s34 offen offset:0 nt lds
    v_mfma_f32_16x16x32_bf16 a[76:79], a[224:227], v[236:239], a[76:79]
    v_exp_f32 v113, v113
    v_mfma_f32_16x16x32_bf16 a[76:79], a[192:195], v[220:223], a[76:79]
    ds_read_b64_tr_b16 a[212:213], v13 offset:40960
    v_add_f32 v28, v97, v28
    v_mfma_f32_16x16x32_bf16 a[92:95], a[196:199], v[220:223], a[92:95]
    v_exp_f32 v114, v114
    v_mfma_f32_16x16x32_bf16 a[92:95], a[228:231], v[236:239], a[92:95]
    ds_read_b64_tr_b16 a[214:215], v13 offset:45056
    v_cvt_pk_bf16_f32 v48, v96, v97
    v_mfma_f32_16x16x32_bf16 a[88:91], a[228:231], v[232:235], a[88:91]
    v_exp_f32 v115, v115
    v_mfma_f32_16x16x32_bf16 a[88:91], a[196:199], v[216:219], a[88:91]
    buffer_load_dwordx4 v25, s[12:15], s34 offen offset:1024 nt lds
    v_mfma_f32_16x16x32_bf16 a[84:87], a[196:199], v[212:215], a[84:87]
    v_exp_f32 v100, v100
    v_mfma_f32_16x16x32_bf16 a[84:87], a[228:231], v[228:231], a[84:87]
    ds_read_b64_tr_b16 a[184:185], v14 offset:32768
    v_add_f32 v28, v98, v28
    v_mfma_f32_16x16x32_bf16 a[80:83], a[228:231], v[224:227], a[80:83]
    v_exp_f32 v101, v101
    v_mfma_f32_16x16x32_bf16 a[80:83], a[196:199], v[208:211], a[80:83]
    ds_read_b64_tr_b16 a[186:187], v14 offset:36864
    v_add_f32 v28, v99, v28
    v_mfma_f32_16x16x32_bf16 a[96:99], a[200:203], v[208:211], a[96:99]
    v_exp_f32 v102, v102
    v_mfma_f32_16x16x32_bf16 a[96:99], a[232:235], v[224:227], a[96:99]
    buffer_load_dwordx4 v24, s[12:15], s34 offen offset:2048 nt lds
    v_mfma_f32_16x16x32_bf16 a[100:103], a[232:235], v[228:231], a[100:103]
    v_exp_f32 v103, v103
    v_mfma_f32_16x16x32_bf16 a[100:103], a[200:203], v[212:215], a[100:103]
    ds_read_b64_tr_b16 a[216:217], v14 offset:40960
    v_cvt_pk_bf16_f32 v49, v98, v99
    v_mfma_f32_16x16x32_bf16 a[104:107], a[200:203], v[216:219], a[104:107]
    v_exp_f32 v116, v116
    v_mfma_f32_16x16x32_bf16 a[104:107], a[232:235], v[232:235], a[104:107]
    v_add_f32 v28, v112, v28
    v_add_f32 v28, v113, v28
    v_mfma_f32_16x16x32_bf16 a[108:111], a[232:235], v[236:239], a[108:111]
    v_exp_f32 v117, v117
    v_mfma_f32_16x16x32_bf16 a[108:111], a[200:203], v[220:223], a[108:111]
    buffer_load_dwordx4 v25, s[12:15], s34 offen offset:3072 nt lds
    s_add_u32 s34, s34, 16384
    v_mfma_f32_16x16x32_bf16 a[124:127], a[204:207], v[220:223], a[124:127]
    v_exp_f32 v118, v118
    v_mfma_f32_16x16x32_bf16 a[124:127], a[236:239], v[236:239], a[124:127]
    v_cvt_pk_bf16_f32 v50, v112, v113
    v_add_f32 v28, v114, v28
    v_mfma_f32_16x16x32_bf16 a[120:123], a[236:239], v[232:235], a[120:123]
    v_exp_f32 v119, v119
    v_mfma_f32_16x16x32_bf16 a[120:123], a[204:207], v[216:219], a[120:123]
    v_add_f32 v28, v115, v28
    v_cvt_pk_bf16_f32 v51, v114, v115
    v_mfma_f32_16x16x32_bf16 a[116:119], a[204:207], v[212:215], a[116:119]
    v_exp_f32 v104, v104
    v_mfma_f32_16x16x32_bf16 a[116:119], a[236:239], v[228:231], a[116:119]
    v_cvt_pk_bf16_f32 v52, v100, v101
    v_cvt_pk_bf16_f32 v53, v102, v103
    v_mfma_f32_16x16x32_bf16 a[112:115], a[236:239], v[224:227], a[112:115]
    v_cvt_pk_bf16_f32 v54, v116, v117
    v_cvt_pk_bf16_f32 v55, v118, v119
    v_mfma_f32_16x16x32_bf16 a[112:115], a[204:207], v[208:211], a[112:115]
    v_add_f32 v30, v104, v30
    s_waitcnt lgkmcnt(11)
    v_mfma_f32_16x16x32_bf16 v[64:67], a[144:147], v[128:131], v[192:195]
    v_exp_f32 v105, v105
    v_mfma_f32_16x16x32_bf16 v[64:67], a[148:151], v[132:135], v[64:67]
    ds_read_b64_tr_b16 a[218:219], v14 offset:45056
    ds_read_b64_tr_b16 a[188:189], v15 offset:32768
    v_mfma_f32_16x16x32_bf16 v[64:67], a[152:155], v[136:139], v[64:67]
    v_exp_f32 v106, v106
    v_mfma_f32_16x16x32_bf16 v[64:67], a[156:159], v[140:143], v[64:67]
    ds_read_b64_tr_b16 a[190:191], v15 offset:36864
    v_add_f32 v30, v105, v30
    v_mfma_f32_16x16x32_bf16 v[68:71], a[156:159], v[156:159], v[196:199]
    v_exp_f32 v107, v107
    v_mfma_f32_16x16x32_bf16 v[68:71], a[152:155], v[152:155], v[68:71]
    ds_read_b64_tr_b16 a[220:221], v15 offset:40960
    v_cvt_pk_bf16_f32 v56, v104, v105
    v_mfma_f32_16x16x32_bf16 v[68:71], a[148:151], v[148:151], v[68:71]
    v_exp_f32 v120, v120
    v_mfma_f32_16x16x32_bf16 v[68:71], a[144:147], v[144:147], v[68:71]
    ds_read_b64_tr_b16 a[222:223], v15 offset:45056
    v_add_f32 v30, v106, v30
    v_mfma_f32_16x16x32_bf16 v[72:75], a[144:147], v[160:163], v[200:203]
    v_exp_f32 v121, v121
    v_mfma_f32_16x16x32_bf16 v[72:75], a[148:151], v[164:167], v[72:75]
    ds_read_b64_tr_b16 a[192:193], v16 offset:32768
    v_add_f32 v30, v107, v30
    v_mfma_f32_16x16x32_bf16 v[72:75], a[152:155], v[168:171], v[72:75]
    v_exp_f32 v122, v122
    v_mfma_f32_16x16x32_bf16 v[72:75], a[156:159], v[172:175], v[72:75]
    ds_read_b64_tr_b16 a[194:195], v16 offset:36864
    v_cvt_pk_bf16_f32 v57, v106, v107
    v_mfma_f32_16x16x32_bf16 v[76:79], a[156:159], v[188:191], v[204:207]
    v_exp_f32 v123, v123
    v_mfma_f32_16x16x32_bf16 v[76:79], a[152:155], v[184:187], v[76:79]
    ds_read_b64_tr_b16 a[224:225], v16 offset:40960
    v_add_f32 v30, v120, v30
    v_mfma_f32_16x16x32_bf16 v[76:79], a[148:151], v[180:183], v[76:79]
    v_exp_f32 v108, v108
    v_mfma_f32_16x16x32_bf16 v[76:79], a[144:147], v[176:179], v[76:79]
    ds_read_b128 a[144:147], v8 offset:57344
    v_add_f32 v30, v121, v30
    v_mfma_f32_16x16x32_bf16 v[80:83], a[160:163], v[128:131], v[192:195]
    v_exp_f32 v109, v109
    v_mfma_f32_16x16x32_bf16 v[80:83], a[164:167], v[132:135], v[80:83]
    ds_read_b128 a[148:151], v9 offset:57344
    v_cvt_pk_bf16_f32 v58, v120, v121
    v_mfma_f32_16x16x32_bf16 v[80:83], a[168:171], v[136:139], v[80:83]
    v_exp_f32 v110, v110
    v_mfma_f32_16x16x32_bf16 v[80:83], a[172:175], v[140:143], v[80:83]
    ds_read_b128 a[152:155], v10 offset:57344
    v_add_f32 v30, v122, v30
    v_mfma_f32_16x16x32_bf16 v[84:87], a[172:175], v[156:159], v[196:199]
    v_exp_f32 v111, v111
    v_mfma_f32_16x16x32_bf16 v[84:87], a[168:171], v[152:155], v[84:87]
    ds_read_b128 a[156:159], v11 offset:57344
    v_add_f32 v30, v123, v30
    v_mfma_f32_16x16x32_bf16 v[84:87], a[164:167], v[148:151], v[84:87]
    v_exp_f32 v124, v124
    v_mfma_f32_16x16x32_bf16 v[84:87], a[160:163], v[144:147], v[84:87]
    ds_read_b64_tr_b16 a[226:227], v16 offset:45056
    v_cvt_pk_bf16_f32 v59, v122, v123
    v_mfma_f32_16x16x32_bf16 v[88:91], a[160:163], v[160:163], v[200:203]
    v_exp_f32 v125, v125
    v_mfma_f32_16x16x32_bf16 v[88:91], a[164:167], v[164:167], v[88:91]
    ds_read_b64_tr_b16 a[196:197], v17 offset:32768
    v_cvt_pk_bf16_f32 v60, v108, v109
    v_mfma_f32_16x16x32_bf16 v[88:91], a[168:171], v[168:171], v[88:91]
    v_exp_f32 v126, v126
    v_mfma_f32_16x16x32_bf16 v[88:91], a[172:175], v[172:175], v[88:91]
    ds_read_b64_tr_b16 a[198:199], v17 offset:36864
    v_cvt_pk_bf16_f32 v61, v110, v111
    v_mfma_f32_16x16x32_bf16 v[92:95], a[172:175], v[188:191], v[204:207]
    v_exp_f32 v127, v127
    v_mfma_f32_16x16x32_bf16 v[92:95], a[168:171], v[184:187], v[92:95]
    ds_read_b64_tr_b16 a[228:229], v17 offset:40960
    v_cvt_pk_bf16_f32 v62, v124, v125
    v_mfma_f32_16x16x32_bf16 v[92:95], a[164:167], v[180:183], v[92:95]
    s_waitcnt lgkmcnt(4)
    v_exp_f32 v64, v64
    v_mfma_f32_16x16x32_bf16 v[92:95], a[160:163], v[176:179], v[92:95]
    ds_read_b128 a[160:163], v8 offset:61440
    v_cvt_pk_bf16_f32 v63, v126, v127
    v_mfma_f32_16x16x32_bf16 v[96:99], a[144:147], v[128:131], v[192:195]
    v_exp_f32 v65, v65
    v_mfma_f32_16x16x32_bf16 v[96:99], a[148:151], v[132:135], v[96:99]
    ds_read_b128 a[164:167], v9 offset:61440
    v_add_f32 v28, v64, v28
    v_mfma_f32_16x16x32_bf16 v[96:99], a[152:155], v[136:139], v[96:99]
    v_exp_f32 v66, v66
    v_mfma_f32_16x16x32_bf16 v[96:99], a[156:159], v[140:143], v[96:99]
    ds_read_b128 a[168:171], v10 offset:61440
    v_add_f32 v28, v65, v28
    v_mfma_f32_16x16x32_bf16 v[100:103], a[156:159], v[156:159], v[196:199]
    v_exp_f32 v67, v67
    v_mfma_f32_16x16x32_bf16 v[100:103], a[152:155], v[152:155], v[100:103]
    ds_read_b128 a[172:175], v11 offset:61440
    v_cvt_pk_bf16_f32 v208, v64, v65
    v_mfma_f32_16x16x32_bf16 v[100:103], a[148:151], v[148:151], v[100:103]
    s_sub_u32 s6, s35, 2
    s_min_u32 s6, s6, 3
    s_lshl_b32 s6, s6, 12
    v_exp_f32 v80, v80
    v_mfma_f32_16x16x32_bf16 v[100:103], a[144:147], v[144:147], v[100:103]
    ds_read_b64_tr_b16 a[230:231], v17 offset:45056
    v_add_f32 v28, v66, v28
    v_mfma_f32_16x16x32_bf16 v[104:107], a[144:147], v[160:163], v[200:203]
    v_exp_f32 v81, v81
    v_mfma_f32_16x16x32_bf16 v[104:107], a[148:151], v[164:167], v[104:107]
    buffer_load_dword v6, v4, s[48:51], s6 offen
    v_mfma_f32_16x16x32_bf16 v[104:107], a[152:155], v[168:171], v[104:107]
    v_exp_f32 v82, v82
    v_mfma_f32_16x16x32_bf16 v[104:107], a[156:159], v[172:175], v[104:107]
    ds_read_b64_tr_b16 a[200:201], v18 offset:32768
    v_add_f32 v28, v67, v28
    v_mfma_f32_16x16x32_bf16 v[108:111], a[156:159], v[188:191], v[204:207]
    v_exp_f32 v83, v83
    v_mfma_f32_16x16x32_bf16 v[108:111], a[152:155], v[184:187], v[108:111]
    ds_read_b64_tr_b16 a[202:203], v18 offset:36864
    v_cvt_pk_bf16_f32 v209, v66, v67
    v_mfma_f32_16x16x32_bf16 v[108:111], a[148:151], v[180:183], v[108:111]
    s_waitcnt lgkmcnt(3)
    v_exp_f32 v68, v68
    v_mfma_f32_16x16x32_bf16 v[108:111], a[144:147], v[176:179], v[108:111]
    ds_read_b64_tr_b16 a[232:233], v18 offset:40960
    v_add_f32 v28, v80, v28
    v_mfma_f32_16x16x32_bf16 v[112:115], a[160:163], v[128:131], v[192:195]
    v_exp_f32 v69, v69
    v_mfma_f32_16x16x32_bf16 v[112:115], a[164:167], v[132:135], v[112:115]
    ds_read_b64_tr_b16 a[234:235], v18 offset:45056
    v_add_f32 v28, v81, v28
    v_mfma_f32_16x16x32_bf16 v[112:115], a[168:171], v[136:139], v[112:115]
    v_exp_f32 v70, v70
    v_mfma_f32_16x16x32_bf16 v[112:115], a[172:175], v[140:143], v[112:115]
    ds_read_b64_tr_b16 a[204:205], v19 offset:32768
    v_cvt_pk_bf16_f32 v210, v80, v81
    v_mfma_f32_16x16x32_bf16 v[116:119], a[172:175], v[156:159], v[196:199]
    v_exp_f32 v71, v71
    v_mfma_f32_16x16x32_bf16 v[116:119], a[168:171], v[152:155], v[116:119]
    ds_read_b64_tr_b16 a[206:207], v19 offset:36864
    v_add_f32 v28, v82, v28
    v_mfma_f32_16x16x32_bf16 v[116:119], a[164:167], v[148:151], v[116:119]
    v_exp_f32 v84, v84
    v_mfma_f32_16x16x32_bf16 v[116:119], a[160:163], v[144:147], v[116:119]
    ds_read_b64_tr_b16 a[236:237], v19 offset:40960
    v_add_f32 v28, v83, v28
    v_mfma_f32_16x16x32_bf16 v[120:123], a[160:163], v[160:163], v[200:203]
    v_exp_f32 v85, v85
    v_mfma_f32_16x16x32_bf16 v[120:123], a[164:167], v[164:167], v[120:123]
    ds_read_b64_tr_b16 a[238:239], v19 offset:45056
    v_cvt_pk_bf16_f32 v211, v82, v83
    v_mfma_f32_16x16x32_bf16 v[120:123], a[168:171], v[168:171], v[120:123]
    v_exp_f32 v86, v86
    v_mfma_f32_16x16x32_bf16 v[120:123], a[172:175], v[172:175], v[120:123]
    v_cvt_pk_bf16_f32 v212, v68, v69
    v_cvt_pk_bf16_f32 v213, v70, v71
    v_mfma_f32_16x16x32_bf16 v[124:127], a[172:175], v[188:191], v[204:207]
    v_exp_f32 v87, v87
    v_mfma_f32_16x16x32_bf16 v[124:127], a[168:171], v[184:187], v[124:127]
    v_cvt_pk_bf16_f32 v214, v84, v85
    v_cvt_pk_bf16_f32 v215, v86, v87
    v_mfma_f32_16x16x32_bf16 v[124:127], a[164:167], v[180:183], v[124:127]
    v_mfma_f32_16x16x32_bf16 v[124:127], a[160:163], v[176:179], v[124:127]
    s_sub_u32 s35, s35, 1
    s_cmp_lg_u32 s35, 0
    s_cbranch_scc1 k1_loop
    s_cmp_ge_u32 s2, 16
    s_cbranch_scc1 k1_nocode
    s_lshr_b32 s6, s2, 3
    s_lshl_b32 s6, s6, 2
    s_add_u32 s6, s6, s45
    s_getpc_b64 s[24:25]
k1_attn_kernel_pc_1:
    s_add_u32 s24, s24, k1_nocode-k1_attn_kernel_pc_1
    s_addc_u32 s25, s25, 0
    v_and_b32 v240, 63, v0
    v_lshlrev_b32 v240, 7, v240
    s_lshl_b32 s26, s6, 13
    v_add_u32 v240, s26, v240
    v_min_u32 v240, code_end_marker-k1_nocode-4, v240
    v_mov_b32 v241, s25
    v_add_co_u32 v240, vcc, s24, v240
    s_nop 1
    v_addc_co_u32 v241, vcc, 0, v241, vcc
    global_load_dword v242, v[240:241], off
k1_nocode:
    v_lshrrev_b32 v2, 8, v26
    v_lshl_add_u32 v2, v1, 2, v2
    v_and_b32 v3, 7, v2
    v_lshlrev_b32 v3, 5, v3
    v_and_b32 v4, 0xf0, v26
    v_xor_b32 v3, v3, v4
    v_lshl_add_u32 v7, v2, 10, v3
    s_and_b32 s6, s2, 3
    s_lshl_b32 s6, s6, 17
    s_bfe_u32 s7, s2, 0x20003
    s_lshl_b32 s7, s7, 8
    s_add_u32 s6, s6, s7
    s_add_u32 s24, s46, s6
    s_addc_u32 s25, s47, 0
    s_sub_u32 s26, 4194304, s6
    s_mov_b32 s27, 0x20000
    s_lshl_b32 s97, s101, 4
    s_bfe_u32 s96, s2, 0x30003
    s_lshl_b32 s96, s96, 19
    v_mfma_f32_16x16x32_bf16 a[132:135], a[240:243], v[36:39], a[132:135]
    s_waitcnt vmcnt(0) lgkmcnt(0)
    s_barrier
    v_exp_f32 v72, v72
    v_exp_f32 v73, v73
    v_add_f32 v30, v72, v30
    v_mfma_f32_16x16x32_bf16 a[132:135], a[240:243], v[52:55], a[132:135]
    ds_read_b64_tr_b16 a[144:145], v12 offset:49152
    v_exp_f32 v74, v74
    v_add_f32 v30, v73, v30
    v_cvt_pk_bf16_f32 v216, v72, v73
    v_mfma_f32_16x16x32_bf16 a[140:143], a[240:243], v[60:63], a[140:143]
    ds_read_b64_tr_b16 a[146:147], v12 offset:53248
    v_exp_f32 v75, v75
    v_add_f32 v30, v74, v30
    v_mfma_f32_16x16x32_bf16 a[140:143], a[240:243], v[44:47], a[140:143]
    ds_read_b64_tr_b16 a[160:161], v12 offset:57344
    v_exp_f32 v88, v88
    v_add_f32 v30, v75, v30
    v_cvt_pk_bf16_f32 v217, v74, v75
    v_mfma_f32_16x16x32_bf16 a[0:3], a[176:179], v[32:35], a[0:3]
    ds_read_b64_tr_b16 a[162:163], v12 offset:61440
    v_exp_f32 v89, v89
    v_add_f32 v30, v88, v30
    v_mfma_f32_16x16x32_bf16 a[0:3], a[208:211], v[48:51], a[0:3]
    ds_read_b64_tr_b16 a[148:149], v13 offset:49152
    v_exp_f32 v90, v90
    v_add_f32 v30, v89, v30
    v_cvt_pk_bf16_f32 v218, v88, v89
    v_mfma_f32_16x16x32_bf16 a[4:7], a[208:211], v[52:55], a[4:7]
    ds_read_b64_tr_b16 a[150:151], v13 offset:53248
    v_exp_f32 v91, v91
    v_add_f32 v30, v90, v30
    v_mfma_f32_16x16x32_bf16 a[4:7], a[176:179], v[36:39], a[4:7]
    ds_read_b64_tr_b16 a[164:165], v13 offset:57344
    v_exp_f32 v76, v76
    v_add_f32 v30, v91, v30
    v_cvt_pk_bf16_f32 v219, v90, v91
    v_mfma_f32_16x16x32_bf16 a[8:11], a[176:179], v[40:43], a[8:11]
    ds_read_b64_tr_b16 a[166:167], v13 offset:61440
    v_exp_f32 v77, v77
    v_exp_f32 v78, v78
    v_mfma_f32_16x16x32_bf16 a[8:11], a[208:211], v[56:59], a[8:11]
    s_add_u32 m0, s62, 0
    s_xor_b32 s40, s96, 0
    buffer_load_dwordx4 v7, s[24:27], s40 offen lds
    v_cvt_pk_bf16_f32 v220, v76, v77
    v_exp_f32 v79, v79
    v_mfma_f32_16x16x32_bf16 a[12:15], a[208:211], v[60:63], a[12:15]
    s_add_u32 m0, s62, 4096
    s_xor_b32 s41, s96, 16384
    buffer_load_dwordx4 v7, s[24:27], s41 offen lds
    v_exp_f32 v92, v92
    v_cvt_pk_bf16_f32 v221, v78, v79
    v_mfma_f32_16x16x32_bf16 a[12:15], a[176:179], v[44:47], a[12:15]
    s_add_u32 m0, s62, 8192
    s_xor_b32 s40, s96, 32768
    buffer_load_dwordx4 v7, s[24:27], s40 offen lds
    v_exp_f32 v93, v93
    v_mfma_f32_16x16x32_bf16 a[28:31], a[180:183], v[44:47], a[28:31]
    s_add_u32 m0, s62, 12288
    s_xor_b32 s41, s96, 49152
    buffer_load_dwordx4 v7, s[24:27], s41 offen lds
    v_exp_f32 v94, v94
    v_cvt_pk_bf16_f32 v222, v92, v93
    v_mfma_f32_16x16x32_bf16 a[28:31], a[212:215], v[60:63], a[28:31]
    ds_read_b64_tr_b16 a[152:153], v14 offset:49152
    v_exp_f32 v95, v95
    v_exp_f32 v96, v96
    v_mfma_f32_16x16x32_bf16 a[24:27], a[212:215], v[56:59], a[24:27]
    ds_read_b64_tr_b16 a[154:155], v14 offset:53248
    v_cvt_pk_bf16_f32 v223, v94, v95
    v_exp_f32 v97, v97
    v_add_f32 v28, v96, v28
    v_mfma_f32_16x16x32_bf16 a[24:27], a[180:183], v[40:43], a[24:27]
    ds_read_b64_tr_b16 a[168:169], v14 offset:57344
    v_exp_f32 v98, v98
    v_add_f32 v28, v97, v28
    v_cvt_pk_bf16_f32 v224, v96, v97
    v_mfma_f32_16x16x32_bf16 a[20:23], a[180:183], v[36:39], a[20:23]
    ds_read_b64_tr_b16 a[170:171], v14 offset:61440
    v_exp_f32 v99, v99
    v_add_f32 v28, v98, v28
    v_mfma_f32_16x16x32_bf16 a[20:23], a[212:215], v[52:55], a[20:23]
    ds_read_b64_tr_b16 a[156:157], v15 offset:49152
    v_exp_f32 v112, v112
    v_add_f32 v28, v99, v28
    v_cvt_pk_bf16_f32 v225, v98, v99
    v_mfma_f32_16x16x32_bf16 a[16:19], a[212:215], v[48:51], a[16:19]
    ds_read_b64_tr_b16 a[158:159], v15 offset:53248
    v_exp_f32 v113, v113
    v_add_f32 v28, v112, v28
    v_mfma_f32_16x16x32_bf16 a[16:19], a[180:183], v[32:35], a[16:19]
    ds_read_b64_tr_b16 a[172:173], v15 offset:57344
    v_exp_f32 v114, v114
    v_add_f32 v28, v113, v28
    v_cvt_pk_bf16_f32 v226, v112, v113
    v_exp_f32 v115, v115
    ds_read_b64_tr_b16 a[174:175], v15 offset:61440
    v_add_f32 v28, v114, v28
    v_exp_f32 v100, v100
    v_add_f32 v28, v115, v28
    v_cvt_pk_bf16_f32 v227, v114, v115
    v_exp_f32 v101, v101
    s_lshl_b32 s36, s101, 3
    s_xor_b32 s36, s36, 0
    v_exp_f32 v102, v102
    v_cvt_pk_bf16_f32 v228, v100, v101
    v_exp_f32 v103, v103
    v_exp_f32 v116, v116
    s_lshl_b32 s37, s101, 3
    s_xor_b32 s37, s37, 131072
    v_cvt_pk_bf16_f32 v229, v102, v103
    v_exp_f32 v117, v117
    v_exp_f32 v118, v118
    v_cvt_pk_bf16_f32 v230, v116, v117
    v_exp_f32 v119, v119
    s_lshl_b32 s38, s101, 3
    s_xor_b32 s38, s38, 1048576
    v_exp_f32 v104, v104
    v_cvt_pk_bf16_f32 v231, v118, v119
    v_exp_f32 v105, v105
    v_add_f32 v30, v104, v30
    v_exp_f32 v106, v106
    s_lshl_b32 s39, s101, 3
    s_xor_b32 s39, s39, 1179648
    v_add_f32 v30, v105, v30
    v_cvt_pk_bf16_f32 v232, v104, v105
    v_exp_f32 v107, v107
    v_add_f32 v30, v106, v30
    v_exp_f32 v120, v120
    s_waitcnt lgkmcnt(8)
    v_add_f32 v30, v107, v30
    v_cvt_pk_bf16_f32 v233, v106, v107
    v_exp_f32 v121, v121
    v_add_f32 v30, v120, v30
    v_mfma_f32_16x16x32_bf16 a[0:3], a[144:147], v[208:211], a[0:3]
    ds_read_b64_tr_b16 a[176:177], v16 offset:49152
    v_exp_f32 v122, v122
    v_add_f32 v30, v121, v30
    v_cvt_pk_bf16_f32 v234, v120, v121
    v_mfma_f32_16x16x32_bf16 a[0:3], a[160:163], v[224:227], a[0:3]
    ds_read_b64_tr_b16 a[178:179], v16 offset:53248
    v_exp_f32 v123, v123
    v_add_f32 v30, v122, v30
    v_mfma_f32_16x16x32_bf16 a[16:19], a[164:167], v[224:227], a[16:19]
    ds_read_b64_tr_b16 a[208:209], v16 offset:57344
    v_exp_f32 v108, v108
    v_add_f32 v30, v123, v30
    v_cvt_pk_bf16_f32 v235, v122, v123
    v_mfma_f32_16x16x32_bf16 a[16:19], a[148:151], v[208:211], a[16:19]
    ds_read_b64_tr_b16 a[210:211], v16 offset:61440
    v_exp_f32 v109, v109
    v_exp_f32 v110, v110
    v_mfma_f32_16x16x32_bf16 a[132:135], a[240:243], v[212:215], a[132:135]
    ds_read_b64_tr_b16 a[180:181], v17 offset:49152
    v_cvt_pk_bf16_f32 v236, v108, v109
    v_exp_f32 v111, v111
    v_mfma_f32_16x16x32_bf16 a[132:135], a[240:243], v[228:231], a[132:135]
    ds_read_b64_tr_b16 a[182:183], v17 offset:53248
    v_exp_f32 v124, v124
    v_cvt_pk_bf16_f32 v237, v110, v111
    v_mfma_f32_16x16x32_bf16 a[4:7], a[144:147], v[212:215], a[4:7]
    ds_read_b64_tr_b16 a[212:213], v17 offset:57344
    v_exp_f32 v125, v125
    v_exp_f32 v126, v126
    v_mfma_f32_16x16x32_bf16 a[4:7], a[160:163], v[228:231], a[4:7]
    ds_read_b64_tr_b16 a[214:215], v17 offset:61440
    v_cvt_pk_bf16_f32 v238, v124, v125
    v_exp_f32 v127, v127
    v_mfma_f32_16x16x32_bf16 a[20:23], a[164:167], v[228:231], a[20:23]
    s_waitcnt lgkmcnt(8)
    v_cvt_pk_bf16_f32 v239, v126, v127
    v_mov_b32 v244, v28
    v_mov_b32 v246, v30
    v_mfma_f32_16x16x32_bf16 a[20:23], a[148:151], v[212:215], a[20:23]
    s_add_u32 m0, s62, 16384
    s_xor_b32 s40, s96, 65536
    buffer_load_dwordx4 v7, s[24:27], s40 offen lds
    v_permlane32_swap_b32 v244, v28
    v_mfma_f32_16x16x32_bf16 a[8:11], a[144:147], v[216:219], a[8:11]
    s_add_u32 m0, s62, 20480
    s_xor_b32 s41, s96, 81920
    buffer_load_dwordx4 v7, s[24:27], s41 offen lds
    v_permlane32_swap_b32 v246, v30
    v_add_f32 v28, v28, v244
    v_mfma_f32_16x16x32_bf16 a[8:11], a[160:163], v[232:235], a[8:11]
    s_add_u32 m0, s62, 24576
    s_xor_b32 s40, s96, 98304
    buffer_load_dwordx4 v7, s[24:27], s40 offen lds
    v_add_f32 v30, v30, v246
    v_mov_b32 v244, v28
    v_mov_b32 v246, v30
    v_mfma_f32_16x16x32_bf16 a[24:27], a[164:167], v[232:235], a[24:27]
    s_add_u32 m0, s62, 28672
    s_xor_b32 s41, s96, 114688
    buffer_load_dwordx4 v7, s[24:27], s41 offen lds
    v_permlane16_swap_b32 v244, v28
    v_mfma_f32_16x16x32_bf16 a[24:27], a[148:151], v[216:219], a[24:27]
    s_add_u32 m0, s62, 32768
    s_xor_b32 s40, s97, 2097152
    buffer_load_dwordx4 v7, s[24:27], s40 offen lds
    v_permlane16_swap_b32 v246, v30
    v_add_f32 v28, v28, v244
    v_mfma_f32_16x16x32_bf16 a[140:143], a[240:243], v[220:223], a[140:143]
    s_add_u32 m0, s62, 36864
    s_xor_b32 s41, s97, 2113536
    buffer_load_dwordx4 v7, s[24:27], s41 offen lds
    v_add_f32 v30, v30, v246
    v_mfma_f32_16x16x32_bf16 a[140:143], a[240:243], v[236:239], a[140:143]
    s_add_u32 m0, s62, 40960
    s_xor_b32 s40, s97, 2129920
    buffer_load_dwordx4 v7, s[24:27], s40 offen lds
    v_mfma_f32_16x16x32_bf16 a[12:15], a[144:147], v[220:223], a[12:15]
    s_add_u32 m0, s62, 45056
    s_xor_b32 s41, s97, 2146304
    buffer_load_dwordx4 v7, s[24:27], s41 offen lds
    v_mfma_f32_16x16x32_bf16 a[12:15], a[160:163], v[236:239], a[12:15]
    s_add_u32 m0, s62, 49152
    s_xor_b32 s40, s97, 2162688
    buffer_load_dwordx4 v7, s[24:27], s40 offen lds
    v_accvgpr_read_b32 v29, a132
    v_accvgpr_read_b32 v31, a140
    v_mfma_f32_16x16x32_bf16 a[28:31], a[164:167], v[236:239], a[28:31]
    s_waitcnt lgkmcnt(0)
    v_rcp_f32 v240, v28
    v_rcp_f32 v242, v29
    v_mfma_f32_16x16x32_bf16 a[28:31], a[148:151], v[220:223], a[28:31]
    v_rcp_f32 v244, v30
    v_rcp_f32 v246, v31
    v_accvgpr_read_b32 v64, a0
    v_mfma_f32_16x16x32_bf16 a[32:35], a[184:187], v[32:35], a[32:35]
    v_accvgpr_read_b32 v65, a1
    v_accvgpr_read_b32 v66, a2
    v_accvgpr_read_b32 v67, a3
    v_mfma_f32_16x16x32_bf16 a[32:35], a[216:219], v[48:51], a[32:35]
    v_accvgpr_read_b32 v68, a16
    v_accvgpr_read_b32 v69, a17
    v_accvgpr_read_b32 v70, a18
    v_accvgpr_read_b32 v71, a19
    v_mul_f32 v64, v64, v240
    v_mfma_f32_16x16x32_bf16 a[32:35], a[152:155], v[208:211], a[32:35]
    v_mul_f32 v65, v65, v240
    v_mul_f32 v66, v66, v240
    v_mul_f32 v67, v67, v240
    v_mul_f32 v68, v68, v240
    v_mul_f32 v69, v69, v240
    v_mfma_f32_16x16x32_bf16 a[32:35], a[168:171], v[224:227], a[32:35]
    v_mul_f32 v70, v70, v240
    v_mul_f32 v71, v71, v240
    v_cvt_pk_bf16_f32 v96, v64, v65
    v_cvt_pk_bf16_f32 v97, v66, v67
    v_cvt_pk_bf16_f32 v98, v68, v69
    v_mfma_f32_16x16x32_bf16 a[36:39], a[168:171], v[228:231], a[36:39]
    v_cvt_pk_bf16_f32 v99, v70, v71
    buffer_store_dwordx4 v[96:99], v26, s[28:31], s36 offen offset:0 sc1
    v_accvgpr_read_b32 v72, a4
    v_accvgpr_read_b32 v73, a5
    v_mfma_f32_16x16x32_bf16 a[36:39], a[152:155], v[212:215], a[36:39]
    v_accvgpr_read_b32 v74, a6
    v_accvgpr_read_b32 v75, a7
    v_accvgpr_read_b32 v76, a20
    v_accvgpr_read_b32 v77, a21
    v_accvgpr_read_b32 v78, a22
    v_mfma_f32_16x16x32_bf16 a[36:39], a[216:219], v[52:55], a[36:39]
    v_accvgpr_read_b32 v79, a23
    v_mul_f32 v72, v72, v242
    v_mul_f32 v73, v73, v242
    v_mul_f32 v74, v74, v242
    v_mul_f32 v75, v75, v242
    v_mfma_f32_16x16x32_bf16 a[36:39], a[184:187], v[36:39], a[36:39]
    v_mul_f32 v76, v76, v242
    v_mul_f32 v77, v77, v242
    v_mul_f32 v78, v78, v242
    v_mul_f32 v79, v79, v242
    v_cvt_pk_bf16_f32 v100, v72, v73
    v_mfma_f32_16x16x32_bf16 a[40:43], a[184:187], v[40:43], a[40:43]
    v_cvt_pk_bf16_f32 v101, v74, v75
    v_cvt_pk_bf16_f32 v102, v76, v77
    v_cvt_pk_bf16_f32 v103, v78, v79
    buffer_store_dwordx4 v[100:103], v26, s[28:31], s37 offen offset:0 sc1
    v_mfma_f32_16x16x32_bf16 a[40:43], a[216:219], v[56:59], a[40:43]
    v_add_f32 v248, v28, v29
    v_add_f32 v249, v30, v31
    v_mfma_f32_16x16x32_bf16 a[40:43], a[152:155], v[216:219], a[40:43]
    v_add_f32 v248, v248, v249
    s_mov_b32 s7, 0x5f800000
    v_cmp_nle_f32 vcc, v248, s7
    v_mfma_f32_16x16x32_bf16 a[40:43], a[168:171], v[232:235], a[40:43]
    s_lshl_b32 s7, s45, 2
    s_add_u32 s7, s7, 151552
    v_mov_b32 v250, s7
    v_mov_b32 v251, 151552
    v_mfma_f32_16x16x32_bf16 a[44:47], a[168:171], v[236:239], a[44:47]
    s_cmp_lg_u64 vcc, 0
    s_cselect_b32 s7, 1, 0
    v_mov_b32 v249, s7
    ds_write_b32 v250, v249
    v_mfma_f32_16x16x32_bf16 a[44:47], a[152:155], v[220:223], a[44:47]
    v_accvgpr_read_b32 v64, a8
    v_accvgpr_read_b32 v65, a9
    v_mfma_f32_16x16x32_bf16 a[44:47], a[216:219], v[60:63], a[44:47]
    v_accvgpr_read_b32 v66, a10
    v_accvgpr_read_b32 v67, a11
    v_mfma_f32_16x16x32_bf16 a[44:47], a[184:187], v[44:47], a[44:47]
    ds_read_b64_tr_b16 a[184:185], v18 offset:49152
    v_accvgpr_read_b32 v68, a24
    v_mfma_f32_16x16x32_bf16 a[60:63], a[188:191], v[44:47], a[60:63]
    ds_read_b64_tr_b16 a[186:187], v18 offset:53248
    v_accvgpr_read_b32 v69, a25
    v_mfma_f32_16x16x32_bf16 a[60:63], a[220:223], v[60:63], a[60:63]
    ds_read_b64_tr_b16 a[216:217], v18 offset:57344
    v_accvgpr_read_b32 v70, a26
    v_mfma_f32_16x16x32_bf16 a[60:63], a[156:159], v[220:223], a[60:63]
    ds_read_b64_tr_b16 a[218:219], v18 offset:61440
    v_accvgpr_read_b32 v71, a27
    v_mfma_f32_16x16x32_bf16 a[60:63], a[172:175], v[236:239], a[60:63]
    v_mul_f32 v64, v64, v244
    v_mul_f32 v65, v65, v244
    v_mfma_f32_16x16x32_bf16 a[56:59], a[172:175], v[232:235], a[56:59]
    v_mul_f32 v66, v66, v244
    v_mul_f32 v67, v67, v244
    v_mfma_f32_16x16x32_bf16 a[56:59], a[156:159], v[216:219], a[56:59]
    v_mul_f32 v68, v68, v244
    v_mul_f32 v69, v69, v244
    v_mfma_f32_16x16x32_bf16 a[56:59], a[220:223], v[56:59], a[56:59]
    v_mul_f32 v70, v70, v244
    v_mul_f32 v71, v71, v244
    v_mfma_f32_16x16x32_bf16 a[56:59], a[188:191], v[40:43], a[56:59]
    v_cvt_pk_bf16_f32 v88, v64, v65
    v_cvt_pk_bf16_f32 v89, v66, v67
    v_mfma_f32_16x16x32_bf16 a[52:55], a[188:191], v[36:39], a[52:55]
    v_cvt_pk_bf16_f32 v90, v68, v69
    v_cvt_pk_bf16_f32 v91, v70, v71
    v_mfma_f32_16x16x32_bf16 a[52:55], a[220:223], v[52:55], a[52:55]
    buffer_store_dwordx4 v[88:91], v26, s[28:31], s38 offen offset:0 sc1
    v_mfma_f32_16x16x32_bf16 a[52:55], a[156:159], v[212:215], a[52:55]
    v_accvgpr_read_b32 v72, a12
    v_accvgpr_read_b32 v73, a13
    v_mfma_f32_16x16x32_bf16 a[52:55], a[172:175], v[228:231], a[52:55]
    v_accvgpr_read_b32 v74, a14
    v_accvgpr_read_b32 v75, a15
    v_mfma_f32_16x16x32_bf16 a[48:51], a[172:175], v[224:227], a[48:51]
    v_accvgpr_read_b32 v76, a28
    v_accvgpr_read_b32 v77, a29
    v_mfma_f32_16x16x32_bf16 a[48:51], a[156:159], v[208:211], a[48:51]
    v_accvgpr_read_b32 v78, a30
    v_accvgpr_read_b32 v79, a31
    v_mfma_f32_16x16x32_bf16 a[48:51], a[220:223], v[48:51], a[48:51]
    v_mul_f32 v72, v72, v246
    v_mul_f32 v73, v73, v246
    v_mfma_f32_16x16x32_bf16 a[48:51], a[188:191], v[32:35], a[48:51]
    ds_read_b64_tr_b16 a[188:189], v19 offset:49152
    v_mul_f32 v74, v74, v246
    v_mfma_f32_16x16x32_bf16 a[64:67], a[192:195], v[32:35], a[64:67]
    ds_read_b64_tr_b16 a[190:191], v19 offset:53248
    v_mul_f32 v75, v75, v246
    v_mfma_f32_16x16x32_bf16 a[64:67], a[224:227], v[48:51], a[64:67]
    ds_read_b64_tr_b16 a[220:221], v19 offset:57344
    v_mul_f32 v76, v76, v246
    v_mfma_f32_16x16x32_bf16 a[64:67], a[176:179], v[208:211], a[64:67]
    ds_read_b64_tr_b16 a[222:223], v19 offset:61440
    v_mul_f32 v77, v77, v246
    v_mfma_f32_16x16x32_bf16 a[64:67], a[208:211], v[224:227], a[64:67]
    s_add_u32 m0, s62, 53248
    s_xor_b32 s41, s97, 2179072
    buffer_load_dwordx4 v7, s[24:27], s41 offen lds
    v_mfma_f32_16x16x32_bf16 a[68:71], a[208:211], v[228:231], a[68:71]
    s_add_u32 m0, s62, 57344
    s_xor_b32 s40, s97, 2195456
    buffer_load_dwordx4 v7, s[24:27], s40 offen lds
    v_mfma_f32_16x16x32_bf16 a[68:71], a[176:179], v[212:215], a[68:71]
    s_add_u32 m0, s62, 61440
    s_xor_b32 s41, s97, 2211840
    buffer_load_dwordx4 v7, s[24:27], s41 offen lds
    v_mfma_f32_16x16x32_bf16 a[68:71], a[224:227], v[52:55], a[68:71]
    s_add_u32 m0, s62, 65536
    s_xor_b32 s40, s97, 2621440
    buffer_load_dwordx4 v7, s[24:27], s40 offen lds
    v_mfma_f32_16x16x32_bf16 a[68:71], a[192:195], v[36:39], a[68:71]
    s_add_u32 m0, s62, 69632
    s_xor_b32 s41, s97, 2637824
    buffer_load_dwordx4 v7, s[24:27], s41 offen lds
    v_mfma_f32_16x16x32_bf16 a[72:75], a[192:195], v[40:43], a[72:75]
    s_add_u32 m0, s62, 73728
    s_xor_b32 s40, s97, 2654208
    buffer_load_dwordx4 v7, s[24:27], s40 offen lds
    v_mfma_f32_16x16x32_bf16 a[72:75], a[224:227], v[56:59], a[72:75]
    s_add_u32 m0, s62, 77824
    s_xor_b32 s41, s97, 2670592
    buffer_load_dwordx4 v7, s[24:27], s41 offen lds
    v_mfma_f32_16x16x32_bf16 a[72:75], a[176:179], v[216:219], a[72:75]
    s_add_u32 m0, s62, 81920
    s_xor_b32 s40, s97, 2686976
    buffer_load_dwordx4 v7, s[24:27], s40 offen lds
    v_mfma_f32_16x16x32_bf16 a[72:75], a[208:211], v[232:235], a[72:75]
    s_add_u32 m0, s62, 86016
    s_xor_b32 s41, s97, 2703360
    buffer_load_dwordx4 v7, s[24:27], s41 offen lds
    v_mfma_f32_16x16x32_bf16 a[76:79], a[208:211], v[236:239], a[76:79]
    v_mul_f32 v78, v78, v246
    v_mul_f32 v79, v79, v246
    v_mfma_f32_16x16x32_bf16 a[76:79], a[176:179], v[220:223], a[76:79]
    v_cvt_pk_bf16_f32 v92, v72, v73
    v_cvt_pk_bf16_f32 v93, v74, v75
    v_mfma_f32_16x16x32_bf16 a[76:79], a[224:227], v[60:63], a[76:79]
    v_cvt_pk_bf16_f32 v94, v76, v77
    v_cvt_pk_bf16_f32 v95, v78, v79
    v_mfma_f32_16x16x32_bf16 a[76:79], a[192:195], v[44:47], a[76:79]
    s_waitcnt lgkmcnt(0)
    buffer_store_dwordx4 v[92:95], v26, s[28:31], s39 offen offset:0 sc1
    v_mfma_f32_16x16x32_bf16 a[92:95], a[196:199], v[44:47], a[92:95]
    v_accvgpr_read_b32 v64, a32
    v_accvgpr_read_b32 v65, a33
    v_mfma_f32_16x16x32_bf16 a[92:95], a[228:231], v[60:63], a[92:95]
    v_accvgpr_read_b32 v66, a34
    v_accvgpr_read_b32 v67, a35
    v_mfma_f32_16x16x32_bf16 a[92:95], a[180:183], v[220:223], a[92:95]
    v_accvgpr_read_b32 v68, a48
    v_accvgpr_read_b32 v69, a49
    v_mfma_f32_16x16x32_bf16 a[92:95], a[212:215], v[236:239], a[92:95]
    v_accvgpr_read_b32 v70, a50
    v_accvgpr_read_b32 v71, a51
    v_mfma_f32_16x16x32_bf16 a[88:91], a[212:215], v[232:235], a[88:91]
    v_mul_f32 v64, v64, v240
    v_mul_f32 v65, v65, v240
    v_mfma_f32_16x16x32_bf16 a[88:91], a[180:183], v[216:219], a[88:91]
    v_mul_f32 v66, v66, v240
    v_mul_f32 v67, v67, v240
    v_mfma_f32_16x16x32_bf16 a[88:91], a[228:231], v[56:59], a[88:91]
    v_mul_f32 v68, v68, v240
    v_mul_f32 v69, v69, v240
    v_mfma_f32_16x16x32_bf16 a[88:91], a[196:199], v[40:43], a[88:91]
    v_mul_f32 v70, v70, v240
    v_mul_f32 v71, v71, v240
    v_mfma_f32_16x16x32_bf16 a[84:87], a[196:199], v[36:39], a[84:87]
    v_cvt_pk_bf16_f32 v104, v64, v65
    v_cvt_pk_bf16_f32 v105, v66, v67
    v_mfma_f32_16x16x32_bf16 a[84:87], a[228:231], v[52:55], a[84:87]
    v_cvt_pk_bf16_f32 v106, v68, v69
    v_cvt_pk_bf16_f32 v107, v70, v71
    v_mfma_f32_16x16x32_bf16 a[84:87], a[180:183], v[212:215], a[84:87]
    buffer_store_dwordx4 v[104:107], v26, s[28:31], s36 offen offset:1024 sc1
    v_mfma_f32_16x16x32_bf16 a[84:87], a[212:215], v[228:231], a[84:87]
    v_accvgpr_read_b32 v72, a36
    v_accvgpr_read_b32 v73, a37
    v_mfma_f32_16x16x32_bf16 a[80:83], a[212:215], v[224:227], a[80:83]
    v_accvgpr_read_b32 v74, a38
    v_accvgpr_read_b32 v75, a39
    v_mfma_f32_16x16x32_bf16 a[80:83], a[180:183], v[208:211], a[80:83]
    v_accvgpr_read_b32 v76, a52
    v_accvgpr_read_b32 v77, a53
    v_mfma_f32_16x16x32_bf16 a[80:83], a[228:231], v[48:51], a[80:83]
    v_accvgpr_read_b32 v78, a54
    v_accvgpr_read_b32 v79, a55
    v_mfma_f32_16x16x32_bf16 a[80:83], a[196:199], v[32:35], a[80:83]
    v_mul_f32 v72, v72, v242
    v_mul_f32 v73, v73, v242
    v_mfma_f32_16x16x32_bf16 a[96:99], a[200:203], v[32:35], a[96:99]
    v_mul_f32 v74, v74, v242
    v_mul_f32 v75, v75, v242
    v_mfma_f32_16x16x32_bf16 a[96:99], a[232:235], v[48:51], a[96:99]
    v_mul_f32 v76, v76, v242
    v_mul_f32 v77, v77, v242
    v_mfma_f32_16x16x32_bf16 a[96:99], a[184:187], v[208:211], a[96:99]
    v_mul_f32 v78, v78, v242
    v_mul_f32 v79, v79, v242
    v_mfma_f32_16x16x32_bf16 a[96:99], a[216:219], v[224:227], a[96:99]
    v_cvt_pk_bf16_f32 v108, v72, v73
    v_cvt_pk_bf16_f32 v109, v74, v75
    v_mfma_f32_16x16x32_bf16 a[100:103], a[216:219], v[228:231], a[100:103]
    v_cvt_pk_bf16_f32 v110, v76, v77
    v_cvt_pk_bf16_f32 v111, v78, v79
    v_mfma_f32_16x16x32_bf16 a[100:103], a[184:187], v[212:215], a[100:103]
    buffer_store_dwordx4 v[108:111], v26, s[28:31], s37 offen offset:1024 sc1
    v_mfma_f32_16x16x32_bf16 a[100:103], a[232:235], v[52:55], a[100:103]
    v_accvgpr_read_b32 v64, a40
    v_accvgpr_read_b32 v65, a41
    v_mfma_f32_16x16x32_bf16 a[100:103], a[200:203], v[36:39], a[100:103]
    v_accvgpr_read_b32 v66, a42
    v_accvgpr_read_b32 v67, a43
    v_mfma_f32_16x16x32_bf16 a[104:107], a[200:203], v[40:43], a[104:107]
    v_accvgpr_read_b32 v68, a56
    v_accvgpr_read_b32 v69, a57
    v_mfma_f32_16x16x32_bf16 a[104:107], a[232:235], v[56:59], a[104:107]
    v_accvgpr_read_b32 v70, a58
    v_accvgpr_read_b32 v71, a59
    v_mfma_f32_16x16x32_bf16 a[104:107], a[184:187], v[216:219], a[104:107]
    v_mul_f32 v64, v64, v244
    v_mul_f32 v65, v65, v244
    v_mfma_f32_16x16x32_bf16 a[104:107], a[216:219], v[232:235], a[104:107]
    v_mul_f32 v66, v66, v244
    v_mul_f32 v67, v67, v244
    v_mfma_f32_16x16x32_bf16 a[108:111], a[216:219], v[236:239], a[108:111]
    v_mul_f32 v68, v68, v244
    v_mul_f32 v69, v69, v244
    v_mfma_f32_16x16x32_bf16 a[108:111], a[184:187], v[220:223], a[108:111]
    v_mul_f32 v70, v70, v244
    v_mul_f32 v71, v71, v244
    v_mfma_f32_16x16x32_bf16 a[108:111], a[232:235], v[60:63], a[108:111]
    v_cvt_pk_bf16_f32 v80, v64, v65
    v_cvt_pk_bf16_f32 v81, v66, v67
    v_mfma_f32_16x16x32_bf16 a[108:111], a[200:203], v[44:47], a[108:111]
    v_cvt_pk_bf16_f32 v82, v68, v69
    v_cvt_pk_bf16_f32 v83, v70, v71
    v_mfma_f32_16x16x32_bf16 a[124:127], a[204:207], v[44:47], a[124:127]
    buffer_store_dwordx4 v[80:83], v26, s[28:31], s38 offen offset:1024 sc1
    v_mfma_f32_16x16x32_bf16 a[124:127], a[236:239], v[60:63], a[124:127]
    v_accvgpr_read_b32 v72, a44
    v_accvgpr_read_b32 v73, a45
    v_mfma_f32_16x16x32_bf16 a[124:127], a[188:191], v[220:223], a[124:127]
    v_accvgpr_read_b32 v74, a46
    v_accvgpr_read_b32 v75, a47
    v_mfma_f32_16x16x32_bf16 a[124:127], a[220:223], v[236:239], a[124:127]
    v_accvgpr_read_b32 v76, a60
    v_accvgpr_read_b32 v77, a61
    v_mfma_f32_16x16x32_bf16 a[120:123], a[220:223], v[232:235], a[120:123]
    v_accvgpr_read_b32 v78, a62
    v_accvgpr_read_b32 v79, a63
    v_mfma_f32_16x16x32_bf16 a[120:123], a[188:191], v[216:219], a[120:123]
    v_mul_f32 v72, v72, v246
    v_mul_f32 v73, v73, v246
    v_mfma_f32_16x16x32_bf16 a[120:123], a[236:239], v[56:59], a[120:123]
    v_mul_f32 v74, v74, v246
    v_mul_f32 v75, v75, v246
    v_mfma_f32_16x16x32_bf16 a[120:123], a[204:207], v[40:43], a[120:123]
    v_mul_f32 v76, v76, v246
    v_mul_f32 v77, v77, v246
    v_mfma_f32_16x16x32_bf16 a[116:119], a[204:207], v[36:39], a[116:119]
    v_mul_f32 v78, v78, v246
    v_mul_f32 v79, v79, v246
    v_mfma_f32_16x16x32_bf16 a[116:119], a[236:239], v[52:55], a[116:119]
    v_cvt_pk_bf16_f32 v84, v72, v73
    v_cvt_pk_bf16_f32 v85, v74, v75
    v_mfma_f32_16x16x32_bf16 a[116:119], a[188:191], v[212:215], a[116:119]
    v_cvt_pk_bf16_f32 v86, v76, v77
    v_cvt_pk_bf16_f32 v87, v78, v79
    v_mfma_f32_16x16x32_bf16 a[116:119], a[220:223], v[228:231], a[116:119]
    buffer_store_dwordx4 v[84:87], v26, s[28:31], s39 offen offset:1024 sc1
    v_mfma_f32_16x16x32_bf16 a[112:115], a[220:223], v[224:227], a[112:115]
    v_accvgpr_read_b32 v64, a64
    v_accvgpr_read_b32 v65, a65
    v_mfma_f32_16x16x32_bf16 a[112:115], a[188:191], v[208:211], a[112:115]
    v_accvgpr_read_b32 v66, a66
    v_accvgpr_read_b32 v67, a67
    v_mfma_f32_16x16x32_bf16 a[112:115], a[236:239], v[48:51], a[112:115]
    v_accvgpr_read_b32 v68, a80
    v_accvgpr_read_b32 v69, a81
    v_mfma_f32_16x16x32_bf16 a[112:115], a[204:207], v[32:35], a[112:115]
    v_accvgpr_read_b32 v70, a82
    v_accvgpr_read_b32 v71, a83
    v_mul_f32 v64, v64, v240
    v_mul_f32 v65, v65, v240
    v_mul_f32 v66, v66, v240
    v_mul_f32 v67, v67, v240
    v_mul_f32 v68, v68, v240
    v_mul_f32 v69, v69, v240
    v_mul_f32 v70, v70, v240
    v_mul_f32 v71, v71, v240
    v_cvt_pk_bf16_f32 v112, v64, v65
    v_cvt_pk_bf16_f32 v113, v66, v67
    v_cvt_pk_bf16_f32 v114, v68, v69
    v_cvt_pk_bf16_f32 v115, v70, v71
    buffer_store_dwordx4 v[112:115], v26, s[28:31], s36 offen offset:2048 sc1
    v_accvgpr_read_b32 v72, a68
    v_accvgpr_read_b32 v73, a69
    v_accvgpr_read_b32 v74, a70
    v_accvgpr_read_b32 v75, a71
    v_accvgpr_read_b32 v76, a84
    v_accvgpr_read_b32 v77, a85
    v_accvgpr_read_b32 v78, a86
    v_accvgpr_read_b32 v79, a87
    v_mul_f32 v72, v72, v242
    v_mul_f32 v73, v73, v242
    v_mul_f32 v74, v74, v242
    v_mul_f32 v75, v75, v242
    v_mul_f32 v76, v76, v242
    v_mul_f32 v77, v77, v242
    v_mul_f32 v78, v78, v242
    v_mul_f32 v79, v79, v242
    v_cvt_pk_bf16_f32 v116, v72, v73
    v_cvt_pk_bf16_f32 v117, v74, v75
    v_cvt_pk_bf16_f32 v118, v76, v77
    v_cvt_pk_bf16_f32 v119, v78, v79
    buffer_store_dwordx4 v[116:119], v26, s[28:31], s37 offen offset:2048 sc1
    v_accvgpr_read_b32 v64, a72
    v_accvgpr_read_b32 v65, a73
    v_accvgpr_read_b32 v66, a74
    v_accvgpr_read_b32 v67, a75
    v_accvgpr_read_b32 v68, a88
    v_accvgpr_read_b32 v69, a89
    v_accvgpr_read_b32 v70, a90
    v_accvgpr_read_b32 v71, a91
    v_pk_mul_f32 v[64:65], v[64:65], v[244:245] op_sel_hi:[1,0]
    v_pk_mul_f32 v[66:67], v[66:67], v[244:245] op_sel_hi:[1,0]
    v_pk_mul_f32 v[68:69], v[68:69], v[244:245] op_sel_hi:[1,0]
    v_pk_mul_f32 v[70:71], v[70:71], v[244:245] op_sel_hi:[1,0]
    v_cvt_pk_bf16_f32 v88, v64, v65
    v_cvt_pk_bf16_f32 v89, v66, v67
    v_cvt_pk_bf16_f32 v90, v68, v69
    v_cvt_pk_bf16_f32 v91, v70, v71
    buffer_store_dwordx4 v[88:91], v26, s[28:31], s38 offen offset:2048 sc1
    v_accvgpr_read_b32 v72, a76
    v_accvgpr_read_b32 v73, a77
    v_accvgpr_read_b32 v74, a78
    v_accvgpr_read_b32 v75, a79
    v_accvgpr_read_b32 v76, a92
    v_accvgpr_read_b32 v77, a93
    v_accvgpr_read_b32 v78, a94
    v_accvgpr_read_b32 v79, a95
    v_pk_mul_f32 v[72:73], v[72:73], v[246:247] op_sel_hi:[1,0]
    v_pk_mul_f32 v[74:75], v[74:75], v[246:247] op_sel_hi:[1,0]
    v_pk_mul_f32 v[76:77], v[76:77], v[246:247] op_sel_hi:[1,0]
    v_pk_mul_f32 v[78:79], v[78:79], v[246:247] op_sel_hi:[1,0]
    v_cvt_pk_bf16_f32 v92, v72, v73
    v_cvt_pk_bf16_f32 v93, v74, v75
    v_cvt_pk_bf16_f32 v94, v76, v77
    v_cvt_pk_bf16_f32 v95, v78, v79
    buffer_store_dwordx4 v[92:95], v26, s[28:31], s39 offen offset:2048 sc1
    v_accvgpr_read_b32 v64, a96
    v_accvgpr_read_b32 v65, a97
    v_accvgpr_read_b32 v66, a98
    v_accvgpr_read_b32 v67, a99
    v_accvgpr_read_b32 v68, a112
    v_accvgpr_read_b32 v69, a113
    v_accvgpr_read_b32 v70, a114
    v_accvgpr_read_b32 v71, a115
    v_pk_mul_f32 v[64:65], v[64:65], v[240:241] op_sel_hi:[1,0]
    v_pk_mul_f32 v[66:67], v[66:67], v[240:241] op_sel_hi:[1,0]
    v_pk_mul_f32 v[68:69], v[68:69], v[240:241] op_sel_hi:[1,0]
    v_pk_mul_f32 v[70:71], v[70:71], v[240:241] op_sel_hi:[1,0]
    v_cvt_pk_bf16_f32 v120, v64, v65
    v_cvt_pk_bf16_f32 v121, v66, v67
    v_cvt_pk_bf16_f32 v122, v68, v69
    v_cvt_pk_bf16_f32 v123, v70, v71
    buffer_store_dwordx4 v[120:123], v26, s[28:31], s36 offen offset:3072 sc1
    v_accvgpr_read_b32 v72, a100
    v_accvgpr_read_b32 v73, a101
    v_accvgpr_read_b32 v74, a102
    v_accvgpr_read_b32 v75, a103
    v_accvgpr_read_b32 v76, a116
    v_accvgpr_read_b32 v77, a117
    v_accvgpr_read_b32 v78, a118
    v_accvgpr_read_b32 v79, a119
    v_pk_mul_f32 v[72:73], v[72:73], v[242:243] op_sel_hi:[1,0]
    v_pk_mul_f32 v[74:75], v[74:75], v[242:243] op_sel_hi:[1,0]
    v_pk_mul_f32 v[76:77], v[76:77], v[242:243] op_sel_hi:[1,0]
    v_pk_mul_f32 v[78:79], v[78:79], v[242:243] op_sel_hi:[1,0]
    v_cvt_pk_bf16_f32 v124, v72, v73
    v_cvt_pk_bf16_f32 v125, v74, v75
    v_cvt_pk_bf16_f32 v126, v76, v77
    v_cvt_pk_bf16_f32 v127, v78, v79
    buffer_store_dwordx4 v[124:127], v26, s[28:31], s37 offen offset:3072 sc1
    v_accvgpr_read_b32 v64, a104
    v_accvgpr_read_b32 v65, a105
    v_accvgpr_read_b32 v66, a106
    v_accvgpr_read_b32 v67, a107
    v_accvgpr_read_b32 v68, a120
    v_accvgpr_read_b32 v69, a121
    v_accvgpr_read_b32 v70, a122
    v_accvgpr_read_b32 v71, a123
    v_pk_mul_f32 v[64:65], v[64:65], v[244:245] op_sel_hi:[1,0]
    v_pk_mul_f32 v[66:67], v[66:67], v[244:245] op_sel_hi:[1,0]
    v_pk_mul_f32 v[68:69], v[68:69], v[244:245] op_sel_hi:[1,0]
    v_pk_mul_f32 v[70:71], v[70:71], v[244:245] op_sel_hi:[1,0]
    v_cvt_pk_bf16_f32 v80, v64, v65
    v_cvt_pk_bf16_f32 v81, v66, v67
    v_cvt_pk_bf16_f32 v82, v68, v69
    v_cvt_pk_bf16_f32 v83, v70, v71
    buffer_store_dwordx4 v[80:83], v26, s[28:31], s38 offen offset:3072 sc1
    v_accvgpr_read_b32 v72, a108
    v_accvgpr_read_b32 v73, a109
    v_accvgpr_read_b32 v74, a110
    v_accvgpr_read_b32 v75, a111
    v_accvgpr_read_b32 v76, a124
    v_accvgpr_read_b32 v77, a125
    v_accvgpr_read_b32 v78, a126
    v_accvgpr_read_b32 v79, a127
    v_pk_mul_f32 v[72:73], v[72:73], v[246:247] op_sel_hi:[1,0]
    v_pk_mul_f32 v[74:75], v[74:75], v[246:247] op_sel_hi:[1,0]
    v_pk_mul_f32 v[76:77], v[76:77], v[246:247] op_sel_hi:[1,0]
    v_pk_mul_f32 v[78:79], v[78:79], v[246:247] op_sel_hi:[1,0]
    v_cvt_pk_bf16_f32 v84, v72, v73
    v_cvt_pk_bf16_f32 v85, v74, v75
    v_cvt_pk_bf16_f32 v86, v76, v77
    v_cvt_pk_bf16_f32 v87, v78, v79
    buffer_store_dwordx4 v[84:87], v26, s[28:31], s39 offen offset:3072 sc1
    s_lshl_b32 s6, s5, 1
    s_bfe_u32 s7, s2, 0x10005
    s_add_u32 s6, s6, s7
    s_lshl_b32 s6, s6, 1
    s_and_b32 s7, s45, 1
    s_add_u32 s6, s6, s7
    s_lshr_b32 s52, s45, 1
    s_lshl_b32 s35, s6, 1
    s_add_u32 s35, s35, s52
    s_lshl_b32 s6, s6, 19
    s_and_b32 s7, s2, 3
    s_lshl_b32 s7, s7, 12
    s_add_u32 s6, s6, s7
    s_lshl_b32 s53, s52, 11
    s_add_u32 s6, s6, s53
    s_add_u32 s6, s6, 0x800000
    s_add_u32 s20, s54, s6
    s_addc_u32 s21, s55, 0
    s_mov_b32 s22, 524288
    s_lshl_b32 s52, s52, 18
    s_lshr_b32 s100, s101, 1
    s_or_b32 s100, s100, s52
    s_lshr_b32 s53, s96, 5
    s_or_b32 s52, s52, s53
    s_xor_b32 s53, s52, 0x40000
    s_lshl_b32 s6, s35, 15
    s_lshl_b32 s7, s7, 9
    s_add_u32 s6, s6, s7
    s_bfe_u32 s7, s2, 0x20003
    s_lshl_b32 s7, s7, 12
    s_add_u32 s6, s6, s7
    s_add_u32 s6, s6, 0x1800000
    s_add_u32 s16, s54, s6
    s_addc_u32 s17, s55, 0
    s_mov_b32 s18, 20480
    s_waitcnt vmcnt(30)
    s_waitcnt lgkmcnt(0)
    s_barrier
    ds_read_b128 v[252:255], v251
    s_waitcnt lgkmcnt(0)
    v_or_b32 v252, v252, v253
    v_or3_b32 v252, v252, v254, v255
    s_nop 0
    v_readfirstlane_b32 s6, v252
    s_andn2_b32 s6, s6, s44
    s_cmp_lg_u32 s6, 0
    s_cbranch_scc1 k1_fallback
    s_add_u32 s8, s54, 0x640000
    s_addc_u32 s9, s55, 0
    s_mov_b32 s10, 0x120000
    s_mov_b32 s11, 0x20000
    s_and_b32 s6, s2, 7
    s_lshl_b32 s6, s6, 2
    s_lshr_b32 s7, s2, 6
    s_add_u32 s6, s6, s7
    s_lshl_b32 s63, s6, 10
    s_bfe_u32 s7, s2, 0x30003
    v_lshlrev_b32 v2, 3, v26
    s_lshl_b32 s6, s7, 2
    v_add_u32 v2, s6, v2
    v_mov_b32 v3, 0x5ac3e19b
    v_bfe_u32 v27, v26, 4, 3
    v_lshlrev_b32 v27, 2, v27
    s_lshl_b32 s6, s7, 7
    v_add_u32 v27, s6, v27
    v_add_u32 v64, 4294901760, v12
    v_add_u32 v65, 4294901760, v13
    v_add_u32 v66, 4294901760, v14
    v_add_u32 v67, 4294901760, v15
    v_add_u32 v68, 4294901760, v16
    v_add_u32 v69, 4294901760, v17
    v_add_u32 v70, 4294901760, v18
    v_add_u32 v71, 4294901760, v19
    ds_read_b64_tr_b16 a[192:193], v64 offset:16384
    ds_read_b64_tr_b16 a[194:195], v64 offset:20480
    ds_read_b64_tr_b16 a[224:225], v64 offset:24576
    ds_read_b64_tr_b16 a[226:227], v64 offset:28672
    ds_read_b64_tr_b16 a[196:197], v65 offset:16384
    ds_read_b64_tr_b16 a[198:199], v65 offset:20480
    ds_read_b64_tr_b16 a[228:229], v65 offset:24576
    ds_read_b64_tr_b16 a[230:231], v65 offset:28672
    ds_read_b64_tr_b16 a[200:201], v66 offset:16384
    ds_read_b64_tr_b16 a[202:203], v66 offset:20480
    ds_read_b64_tr_b16 a[232:233], v66 offset:24576
    ds_read_b64_tr_b16 a[234:235], v66 offset:28672
    ds_read_b64_tr_b16 a[204:205], v67 offset:16384
    ds_read_b64_tr_b16 a[206:207], v67 offset:20480
    ds_read_b64_tr_b16 a[236:237], v67 offset:24576
    ds_read_b64_tr_b16 a[238:239], v67 offset:28672
    ds_read_b64_tr_b16 a[208:209], v68 offset:16384
    ds_read_b64_tr_b16 a[210:211], v68 offset:20480
    ds_read_b64_tr_b16 a[240:241], v68 offset:24576
    ds_read_b64_tr_b16 a[242:243], v68 offset:28672
    ds_read_b64_tr_b16 a[212:213], v69 offset:16384
    ds_read_b64_tr_b16 a[214:215], v69 offset:20480
    ds_read_b64_tr_b16 a[244:245], v69 offset:24576
    ds_read_b64_tr_b16 a[246:247], v69 offset:28672
    ds_read_b64_tr_b16 a[216:217], v70 offset:16384
    ds_read_b64_tr_b16 a[218:219], v70 offset:20480
    ds_read_b64_tr_b16 a[248:249], v70 offset:24576
    ds_read_b64_tr_b16 a[250:251], v70 offset:28672
    ds_read_b64_tr_b16 a[220:221], v71 offset:16384
    ds_read_b64_tr_b16 a[222:223], v71 offset:20480
    ds_read_b64_tr_b16 a[252:253], v71 offset:24576
    ds_read_b64_tr_b16 a[254:255], v71 offset:28672
    v_accvgpr_write_b32 a0, v96
    v_accvgpr_write_b32 a1, v97
    v_accvgpr_write_b32 a2, v98
    v_accvgpr_write_b32 a3, v99
    v_accvgpr_write_b32 a4, v100
    v_accvgpr_write_b32 a5, v101
    v_accvgpr_write_b32 a6, v102
    v_accvgpr_write_b32 a7, v103
    v_accvgpr_write_b32 a8, v104
    v_accvgpr_write_b32 a9, v105
    v_accvgpr_write_b32 a10, v106
    v_accvgpr_write_b32 a11, v107
    v_accvgpr_write_b32 a12, v108
    v_accvgpr_write_b32 a13, v109
    v_accvgpr_write_b32 a14, v110
    v_accvgpr_write_b32 a15, v111
    v_accvgpr_write_b32 a16, v112
    v_accvgpr_write_b32 a17, v113
    v_accvgpr_write_b32 a18, v114
    v_accvgpr_write_b32 a19, v115
    v_accvgpr_write_b32 a20, v116
    v_accvgpr_write_b32 a21, v117
    v_accvgpr_write_b32 a22, v118
    v_accvgpr_write_b32 a23, v119
    v_accvgpr_write_b32 a24, v120
    v_accvgpr_write_b32 a25, v121
    v_accvgpr_write_b32 a26, v122
    v_accvgpr_write_b32 a27, v123
    v_accvgpr_write_b32 a28, v124
    v_accvgpr_write_b32 a29, v125
    v_accvgpr_write_b32 a30, v126
    v_accvgpr_write_b32 a31, v127
    ds_read_b64_tr_b16 v[192:193], v64 offset:0
    ds_read_b64_tr_b16 v[194:195], v64 offset:4096
    ds_read_b64_tr_b16 v[224:225], v64 offset:8192
    ds_read_b64_tr_b16 v[226:227], v64 offset:12288
    ds_read_b64_tr_b16 v[196:197], v65 offset:0
    ds_read_b64_tr_b16 v[198:199], v65 offset:4096
    ds_read_b64_tr_b16 v[228:229], v65 offset:8192
    ds_read_b64_tr_b16 v[230:231], v65 offset:12288
    ds_read_b64_tr_b16 v[200:201], v66 offset:0
    ds_read_b64_tr_b16 v[202:203], v66 offset:4096
    ds_read_b64_tr_b16 v[232:233], v66 offset:8192
    ds_read_b64_tr_b16 v[234:235], v66 offset:12288
    ds_read_b64_tr_b16 v[204:205], v67 offset:0
    ds_read_b64_tr_b16 v[206:207], v67 offset:4096
    ds_read_b64_tr_b16 v[236:237], v67 offset:8192
    ds_read_b64_tr_b16 v[238:239], v67 offset:12288
    ds_read_b64_tr_b16 v[208:209], v68 offset:0
    ds_read_b64_tr_b16 v[210:211], v68 offset:4096
    ds_read_b64_tr_b16 v[240:241], v68 offset:8192
    ds_read_b64_tr_b16 v[242:243], v68 offset:12288
    ds_read_b64_tr_b16 v[212:213], v69 offset:0
    ds_read_b64_tr_b16 v[214:215], v69 offset:4096
    ds_read_b64_tr_b16 v[244:245], v69 offset:8192
    ds_read_b64_tr_b16 v[246:247], v69 offset:12288
    ds_read_b64_tr_b16 v[216:217], v70 offset:0
    ds_read_b64_tr_b16 v[218:219], v70 offset:4096
    ds_read_b64_tr_b16 v[248:249], v70 offset:8192
    ds_read_b64_tr_b16 v[250:251], v70 offset:12288
    ds_read_b64_tr_b16 v[220:221], v71 offset:0
    ds_read_b64_tr_b16 v[222:223], v71 offset:4096
    ds_read_b64_tr_b16 v[252:253], v71 offset:8192
    ds_read_b64_tr_b16 v[254:255], v71 offset:12288
    v_lshrrev_b32 v4, 1, v1
    v_lshlrev_b32 v4, 14, v4
    v_add_u32 v40, v4, v12
    v_add_u32 v32, 4294901760, v40
    v_add_u32 v41, v4, v13
    v_add_u32 v33, 4294901760, v41
    v_add_u32 v42, v4, v14
    v_add_u32 v34, 4294901760, v42
    v_add_u32 v43, v4, v15
    v_add_u32 v35, 4294901760, v43
    v_add_u32 v44, v4, v16
    v_add_u32 v36, 4294901760, v44
    v_add_u32 v45, v4, v17
    v_add_u32 v37, 4294901760, v45
    v_add_u32 v46, v4, v18
    v_add_u32 v38, 4294901760, v46
    v_add_u32 v47, v4, v19
    v_add_u32 v39, 4294901760, v47
    v_lshl_add_u32 v8, v1, 14, v26
    v_xor_b32 v9, 0x8000, v8
    s_lshl_b32 s33, s5, 1
    s_bfe_u32 s6, s2, 0x10005
    s_add_u32 s33, s33, s6
    s_and_b32 s34, s2, 3
    s_lshl_b32 s34, s34, 2
    s_bfe_u32 s6, s2, 0x20003
    s_add_u32 s34, s34, s6
    v_lshlrev_b32 v31, 4, v0
    s_mul_i32 s35, s45, 3072
    s_mul_i32 s6, s34, 192
    s_min_u32 s6, s6, 2688
    s_cmp_lt_u32 s45, 2
    s_cselect_b64 s[12:13], s[56:57], s[58:59]
    s_add_u32 s12, s12, s6
    s_addc_u32 s13, s13, 0
    s_sub_u32 s14, 1409024, s6
    s_cmp_eq_u32 s34, 15
    s_cselect_b32 s14, 0, s14
    s_and_b32 s6, s34, 7
    s_lshl_b32 s6, s6, 7
    s_lshl_b32 s40, s45, 15
    s_add_u32 s6, s6, s40
    s_add_u32 s48, s60, s6
    s_addc_u32 s49, s61, 0
    s_sub_u32 s50, 1409024, s6
    s_mov_b32 s51, 0x20000
    v_lshrrev_b32 v5, 4, v26
    v_and_b32 v6, 1, v1
    v_lshlrev_b32 v6, 4, v6
    v_add_u32 v56, 0, v5
    v_mul_u32_u24 v57, 0x5556, v56
    v_lshrrev_b32 v57, 18, v57
    v_mul_u32_u24 v58, 12, v57
    v_sub_u32 v58, v56, v58
    v_lshrrev_b32 v59, 1, v57
    v_and_b32 v59, 2, v59
    v_xor_b32 v58, v58, v59
    v_add_u32 v57, v57, v6
    v_mul_u32_u24 v57, 2752, v57
    v_lshl_add_u32 v20, v58, 4, v57
    v_add_u32 v56, 64, v5
    v_mul_u32_u24 v57, 0x5556, v56
    v_lshrrev_b32 v57, 18, v57
    v_mul_u32_u24 v58, 12, v57
    v_sub_u32 v58, v56, v58
    v_lshrrev_b32 v59, 1, v57
    v_and_b32 v59, 2, v59
    v_xor_b32 v58, v58, v59
    v_add_u32 v57, v57, v6
    v_mul_u32_u24 v57, 2752, v57
    v_lshl_add_u32 v21, v58, 4, v57
    v_subrev_u32 v21, 1024, v21
    v_add_u32 v56, 128, v5
    v_mul_u32_u24 v57, 0x5556, v56
    v_lshrrev_b32 v57, 18, v57
    v_mul_u32_u24 v58, 12, v57
    v_sub_u32 v58, v56, v58
    v_lshrrev_b32 v59, 1, v57
    v_and_b32 v59, 2, v59
    v_xor_b32 v58, v58, v59
    v_add_u32 v57, v57, v6
    v_mul_u32_u24 v57, 2752, v57
    v_lshl_add_u32 v22, v58, 4, v57
    v_subrev_u32 v22, 2048, v22
    v_lshrrev_b32 v56, 3, v5
    v_and_b32 v57, 7, v5
    v_and_b32 v58, 6, v56
    v_xor_b32 v57, v57, v58
    v_lshlrev_b32 v56, 10, v56
    v_lshl_add_u32 v23, v57, 4, v56
    v_and_b32 v56, 7, v0
    v_bfe_u32 v57, v0, 3, 2
    v_lshrrev_b32 v58, 5, v0
    v_lshlrev_b32 v24, 10, v58
    v_lshl_add_u32 v24, v57, 8, v24
    v_lshl_add_u32 v24, v56, 4, v24
    v_lshlrev_b32 v25, 10, v56
    v_lshl_add_u32 v25, v58, 6, v25
    v_lshl_add_u32 v25, v57, 3, v25
    v_lshlrev_b32 v28, 7, v58
    v_lshl_add_u32 v28, v57, 4, v28
    v_add_u32 v28, 155648, v28
    v_lshlrev_b32 v29, 4, v56
    v_add_u32 v29, 151616, v29
    v_lshl_add_u32 v30, v1, 2, v29
    s_lshl_b32 s6, s33, 4
    s_add_u32 s6, s6, s34
    s_lshl_b32 s6, s6, 13
    s_add_u32 s28, s0, s6
    s_addc_u32 s29, s1, 0
    s_mov_b32 s30, 8192
    s_add_u32 s56, s54, 0x4000
    s_addc_u32 s57, s55, 0
    s_mov_b32 s58, 0xc000
    s_mov_b32 s59, 0x20000
    s_waitcnt vmcnt(0) lgkmcnt(0)
    s_barrier
    s_cmp_eq_u32 s45, 1
    s_cbranch_scc0 k1_nf1
    s_mov_b64 exec, 255
    buffer_store_dword v3, v2, s[8:11], s63 offen offset:0 sc1
    s_mov_b64 exec, -1
k1_nf1:
    v_mfma_f32_16x16x32_bf16 v[64:67], a[192:195], a[16:19], 0
    s_add_u32 m0, s62, 90112
    s_xor_b32 s40, s97, 2719744
    buffer_load_dwordx4 v7, s[24:27], s40 offen lds
    v_mfma_f32_16x16x32_bf16 v[64:67], a[224:227], a[24:27], v[64:67]
    s_add_u32 m0, s62, 94208
    s_xor_b32 s41, s97, 2736128
    buffer_load_dwordx4 v7, s[24:27], s41 offen lds
    v_mfma_f32_16x16x32_bf16 v[96:99], a[224:227], a[28:31], 0
    v_mfma_f32_16x16x32_bf16 v[96:99], a[192:195], a[20:23], v[96:99]
    s_add_u32 m0, s62, 98304
    s_xor_b32 s40, s97, 3145728
    buffer_load_dwordx4 v7, s[24:27], s40 offen lds
    v_mfma_f32_16x16x32_bf16 v[100:103], a[196:199], a[20:23], 0
    v_mfma_f32_16x16x32_bf16 v[100:103], a[228:231], a[28:31], v[100:103]
    s_add_u32 m0, s62, 102400
    s_xor_b32 s41, s97, 3162112
    buffer_load_dwordx4 v7, s[24:27], s41 offen lds
    v_mfma_f32_16x16x32_bf16 v[68:71], a[228:231], a[24:27], 0
    s_add_u32 m0, s62, 106496
    s_xor_b32 s40, s97, 3178496
    buffer_load_dwordx4 v7, s[24:27], s40 offen lds
    v_mfma_f32_16x16x32_bf16 v[68:71], a[196:199], a[16:19], v[68:71]
    v_mfma_f32_16x16x32_bf16 v[72:75], a[200:203], a[16:19], 0
    s_add_u32 m0, s62, 110592
    s_xor_b32 s41, s97, 3194880
    buffer_load_dwordx4 v7, s[24:27], s41 offen lds
    v_mfma_f32_16x16x32_bf16 v[72:75], a[232:235], a[24:27], v[72:75]
    v_mfma_f32_16x16x32_bf16 v[104:107], a[232:235], a[28:31], 0
    s_add_u32 m0, s62, 114688
    s_xor_b32 s40, s97, 3211264
    buffer_load_dwordx4 v7, s[24:27], s40 offen lds
    v_mfma_f32_16x16x32_bf16 v[104:107], a[200:203], a[20:23], v[104:107]
    s_add_u32 m0, s62, 118784
    s_xor_b32 s41, s97, 3227648
    buffer_load_dwordx4 v7, s[24:27], s41 offen lds
    v_mfma_f32_16x16x32_bf16 v[108:111], a[204:207], a[20:23], 0
    v_mfma_f32_16x16x32_bf16 v[108:111], a[236:239], a[28:31], v[108:111]
    s_add_u32 m0, s62, 122880
    s_xor_b32 s40, s97, 3244032
    buffer_load_dwordx4 v7, s[24:27], s40 offen lds
    v_mfma_f32_16x16x32_bf16 v[76:79], a[236:239], a[24:27], 0
    v_mfma_f32_16x16x32_bf16 v[76:79], a[204:207], a[16:19], v[76:79]
    s_add_u32 m0, s62, 126976
    s_xor_b32 s41, s97, 3260416
    buffer_load_dwordx4 v7, s[24:27], s41 offen lds
    v_mfma_f32_16x16x32_bf16 v[80:83], a[208:211], a[16:19], 0
    s_add_u32 m0, s62, 0
    s_xor_b32 s40, s97, 3670016
    buffer_load_dwordx4 v7, s[24:27], s40 offen lds
    v_mfma_f32_16x16x32_bf16 v[80:83], a[240:243], a[24:27], v[80:83]
    v_mfma_f32_16x16x32_bf16 v[112:115], a[240:243], a[28:31], 0
    s_add_u32 m0, s62, 4096
    s_xor_b32 s41, s97, 3686400
    buffer_load_dwordx4 v7, s[24:27], s41 offen lds
    v_mfma_f32_16x16x32_bf16 v[112:115], a[208:211], a[20:23], v[112:115]
    v_mfma_f32_16x16x32_bf16 v[116:119], a[212:215], a[20:23], 0
    s_add_u32 m0, s62, 8192
    s_xor_b32 s40, s97, 3702784
    buffer_load_dwordx4 v7, s[24:27], s40 offen lds
    v_mfma_f32_16x16x32_bf16 v[116:119], a[244:247], a[28:31], v[116:119]
    s_add_u32 m0, s62, 12288
    s_xor_b32 s41, s97, 3719168
    buffer_load_dwordx4 v7, s[24:27], s41 offen lds
    v_mfma_f32_16x16x32_bf16 v[84:87], a[244:247], a[24:27], 0
    v_mfma_f32_16x16x32_bf16 v[84:87], a[212:215], a[16:19], v[84:87]
    s_add_u32 m0, s62, 16384
    s_xor_b32 s40, s97, 3735552
    buffer_load_dwordx4 v7, s[24:27], s40 offen lds
    v_mfma_f32_16x16x32_bf16 v[88:91], a[216:219], a[16:19], 0
    v_mfma_f32_16x16x32_bf16 v[88:91], a[248:251], a[24:27], v[88:91]
    s_add_u32 m0, s62, 20480
    s_xor_b32 s41, s97, 3751936
    buffer_load_dwordx4 v7, s[24:27], s41 offen lds
    v_mfma_f32_16x16x32_bf16 v[120:123], a[248:251], a[28:31], 0
    s_add_u32 m0, s62, 24576
    s_xor_b32 s40, s97, 3768320
    buffer_load_dwordx4 v7, s[24:27], s40 offen lds
    v_mfma_f32_16x16x32_bf16 v[120:123], a[216:219], a[20:23], v[120:123]
    v_mfma_f32_16x16x32_bf16 v[124:127], a[220:223], a[20:23], 0
    s_add_u32 m0, s62, 28672
    s_xor_b32 s41, s97, 3784704
    buffer_load_dwordx4 v7, s[24:27], s41 offen lds
    v_mfma_f32_16x16x32_bf16 v[124:127], a[252:255], a[28:31], v[124:127]
    v_mfma_f32_16x16x32_bf16 v[92:95], a[252:255], a[24:27], 0
    v_mfma_f32_16x16x32_bf16 v[92:95], a[220:223], a[16:19], v[92:95]
    ds_read_b64_tr_b16 a[192:193], v32 offset:32768
    ds_read_b64_tr_b16 a[194:195], v32 offset:36864
    v_mfma_f32_16x16x32_bf16 v[64:67], v[192:195], a[0:3], v[64:67]
    ds_read_b64_tr_b16 a[224:225], v32 offset:40960
    ds_read_b64_tr_b16 a[226:227], v32 offset:45056
    v_mfma_f32_16x16x32_bf16 v[64:67], v[224:227], a[8:11], v[64:67]
    ds_read_b64_tr_b16 a[196:197], v33 offset:32768
    ds_read_b64_tr_b16 a[198:199], v33 offset:36864
    v_mfma_f32_16x16x32_bf16 v[96:99], v[224:227], a[12:15], v[96:99]
    ds_read_b64_tr_b16 a[228:229], v33 offset:40960
    ds_read_b64_tr_b16 a[230:231], v33 offset:45056
    v_mfma_f32_16x16x32_bf16 v[96:99], v[192:195], a[4:7], v[96:99]
    ds_read_b64_tr_b16 a[200:201], v34 offset:32768
    ds_read_b64_tr_b16 a[202:203], v34 offset:36864
    v_mfma_f32_16x16x32_bf16 v[100:103], v[196:199], a[4:7], v[100:103]
    ds_read_b64_tr_b16 a[232:233], v34 offset:40960
    ds_read_b64_tr_b16 a[234:235], v34 offset:45056
    v_mfma_f32_16x16x32_bf16 v[100:103], v[228:231], a[12:15], v[100:103]
    ds_read_b64_tr_b16 a[204:205], v35 offset:32768
    ds_read_b64_tr_b16 a[206:207], v35 offset:36864
    v_mfma_f32_16x16x32_bf16 v[68:71], v[228:231], a[8:11], v[68:71]
    ds_read_b64_tr_b16 a[236:237], v35 offset:40960
    ds_read_b64_tr_b16 a[238:239], v35 offset:45056
    v_mfma_f32_16x16x32_bf16 v[68:71], v[196:199], a[0:3], v[68:71]
    ds_read_b64_tr_b16 a[208:209], v36 offset:32768
    ds_read_b64_tr_b16 a[210:211], v36 offset:36864
    v_mfma_f32_16x16x32_bf16 v[72:75], v[200:203], a[0:3], v[72:75]
    ds_read_b64_tr_b16 a[240:241], v36 offset:40960
    ds_read_b64_tr_b16 a[242:243], v36 offset:45056
    v_mfma_f32_16x16x32_bf16 v[72:75], v[232:235], a[8:11], v[72:75]
    ds_read_b64_tr_b16 a[212:213], v37 offset:32768
    ds_read_b64_tr_b16 a[214:215], v37 offset:36864
    v_mfma_f32_16x16x32_bf16 v[104:107], v[232:235], a[12:15], v[104:107]
    ds_read_b64_tr_b16 a[244:245], v37 offset:40960
    ds_read_b64_tr_b16 a[246:247], v37 offset:45056
    v_mfma_f32_16x16x32_bf16 v[104:107], v[200:203], a[4:7], v[104:107]
    ds_read_b64_tr_b16 a[216:217], v38 offset:32768
    ds_read_b64_tr_b16 a[218:219], v38 offset:36864
    v_mfma_f32_16x16x32_bf16 v[108:111], v[204:207], a[4:7], v[108:111]
    ds_read_b64_tr_b16 a[248:249], v38 offset:40960
    ds_read_b64_tr_b16 a[250:251], v38 offset:45056
    v_mfma_f32_16x16x32_bf16 v[108:111], v[236:239], a[12:15], v[108:111]
    ds_read_b64_tr_b16 a[220:221], v39 offset:32768
    ds_read_b64_tr_b16 a[222:223], v39 offset:36864
    v_mfma_f32_16x16x32_bf16 v[76:79], v[236:239], a[8:11], v[76:79]
    ds_read_b64_tr_b16 a[252:253], v39 offset:40960
    ds_read_b64_tr_b16 a[254:255], v39 offset:45056
    v_mfma_f32_16x16x32_bf16 v[76:79], v[204:207], a[0:3], v[76:79]
    v_mfma_f32_16x16x32_bf16 v[80:83], v[208:211], a[0:3], v[80:83]
    v_mfma_f32_16x16x32_bf16 v[80:83], v[240:243], a[8:11], v[80:83]
    v_mfma_f32_16x16x32_bf16 v[112:115], v[240:243], a[12:15], v[112:115]
    v_mfma_f32_16x16x32_bf16 v[112:115], v[208:211], a[4:7], v[112:115]
    v_mfma_f32_16x16x32_bf16 v[116:119], v[212:215], a[4:7], v[116:119]
    v_mfma_f32_16x16x32_bf16 v[116:119], v[244:247], a[12:15], v[116:119]
    v_mfma_f32_16x16x32_bf16 v[84:87], v[244:247], a[8:11], v[84:87]
    buffer_load_dword v3, v27, s[8:11], s63 offen sc1
    v_mfma_f32_16x16x32_bf16 v[84:87], v[212:215], a[0:3], v[84:87]
    v_mfma_f32_16x16x32_bf16 v[88:91], v[216:219], a[0:3], v[88:91]
    v_mfma_f32_16x16x32_bf16 v[88:91], v[248:251], a[8:11], v[88:91]
    v_mfma_f32_16x16x32_bf16 v[120:123], v[248:251], a[12:15], v[120:123]
    v_mfma_f32_16x16x32_bf16 v[120:123], v[216:219], a[4:7], v[120:123]
    v_mfma_f32_16x16x32_bf16 v[124:127], v[220:223], a[4:7], v[124:127]
    v_mfma_f32_16x16x32_bf16 v[124:127], v[252:255], a[12:15], v[124:127]
    v_mfma_f32_16x16x32_bf16 v[92:95], v[252:255], a[8:11], v[92:95]
    v_mfma_f32_16x16x32_bf16 v[92:95], v[220:223], a[0:3], v[92:95]
    s_waitcnt vmcnt(0)
    v_cmp_ne_u32 vcc, 0x5ac3e19b, v3
    s_cbranch_vccnz k1_spin1
k1_spin1_ret:
    s_xor_b32 s36, s100, 65536
    buffer_load_dwordx4 a[32:35], v26, s[20:23], s36 offen offset:0 sc1
    s_xor_b32 s36, s100, 65536
    buffer_load_dwordx4 a[48:51], v26, s[20:23], s36 offen offset:1024 sc1
    s_xor_b32 s37, s100, 196608
    buffer_load_dwordx4 a[36:39], v26, s[20:23], s37 offen offset:0 sc1
    s_xor_b32 s37, s100, 196608
    buffer_load_dwordx4 a[52:55], v26, s[20:23], s37 offen offset:1024 sc1
    s_xor_b32 s36, s100, 327680
    buffer_load_dwordx4 a[40:43], v26, s[20:23], s36 offen offset:0 sc1
    s_xor_b32 s36, s100, 327680
    buffer_load_dwordx4 a[56:59], v26, s[20:23], s36 offen offset:1024 sc1
    s_xor_b32 s37, s100, 458752
    buffer_load_dwordx4 a[44:47], v26, s[20:23], s37 offen offset:0 sc1
    s_xor_b32 s37, s100, 458752
    buffer_load_dwordx4 a[60:63], v26, s[20:23], s37 offen offset:1024 sc1
    s_waitcnt vmcnt(6) lgkmcnt(0)
    v_mfma_f32_16x16x32_bf16 v[64:67], a[192:195], a[32:35], v[64:67]
    s_barrier
    v_mfma_f32_16x16x32_bf16 v[64:67], a[224:227], a[48:51], v[64:67]
    s_waitcnt vmcnt(4)
    ds_read_b64_tr_b16 v[192:193], v40 offset:0
    v_mfma_f32_16x16x32_bf16 v[96:99], a[224:227], a[52:55], v[96:99]
    v_mfma_f32_16x16x32_bf16 v[96:99], a[192:195], a[36:39], v[96:99]
    s_waitcnt vmcnt(2)
    s_xor_b32 s36, s100, 81920
    buffer_load_dwordx4 a[64:67], v26, s[20:23], s36 offen offset:0 sc1
    v_mfma_f32_16x16x32_bf16 v[128:131], a[192:195], a[40:43], 0
    ds_read_b64_tr_b16 v[194:195], v40 offset:4096
    v_mfma_f32_16x16x32_bf16 v[128:131], a[224:227], a[56:59], v[128:131]
    s_waitcnt vmcnt(1)
    v_mfma_f32_16x16x32_bf16 v[160:163], a[224:227], a[60:63], 0
    ds_read_b64_tr_b16 v[224:225], v40 offset:8192
    v_mfma_f32_16x16x32_bf16 v[160:163], a[192:195], a[44:47], v[160:163]
    s_xor_b32 s36, s100, 81920
    buffer_load_dwordx4 a[80:83], v26, s[20:23], s36 offen offset:1024 sc1
    v_mfma_f32_16x16x32_bf16 v[164:167], a[196:199], a[44:47], 0
    v_mfma_f32_16x16x32_bf16 v[164:167], a[228:231], a[60:63], v[164:167]
    ds_read_b64_tr_b16 v[226:227], v40 offset:12288
    v_mfma_f32_16x16x32_bf16 v[132:135], a[228:231], a[56:59], 0
    v_mfma_f32_16x16x32_bf16 v[132:135], a[196:199], a[40:43], v[132:135]
    ds_read_b64_tr_b16 v[196:197], v41 offset:0
    v_mfma_f32_16x16x32_bf16 v[100:103], a[196:199], a[36:39], v[100:103]
    s_xor_b32 s37, s100, 212992
    buffer_load_dwordx4 a[68:71], v26, s[20:23], s37 offen offset:0 sc1
    v_mfma_f32_16x16x32_bf16 v[100:103], a[228:231], a[52:55], v[100:103]
    v_mfma_f32_16x16x32_bf16 v[68:71], a[228:231], a[48:51], v[68:71]
    ds_read_b64_tr_b16 v[198:199], v41 offset:4096
    v_mfma_f32_16x16x32_bf16 v[68:71], a[196:199], a[32:35], v[68:71]
    v_mfma_f32_16x16x32_bf16 v[72:75], a[200:203], a[32:35], v[72:75]
    s_xor_b32 s37, s100, 212992
    buffer_load_dwordx4 a[84:87], v26, s[20:23], s37 offen offset:1024 sc1
    v_mfma_f32_16x16x32_bf16 v[72:75], a[232:235], a[48:51], v[72:75]
    ds_read_b64_tr_b16 v[228:229], v41 offset:8192
    v_mfma_f32_16x16x32_bf16 v[104:107], a[232:235], a[52:55], v[104:107]
    v_mfma_f32_16x16x32_bf16 v[104:107], a[200:203], a[36:39], v[104:107]
    ds_read_b64_tr_b16 v[230:231], v41 offset:12288
    v_mfma_f32_16x16x32_bf16 v[136:139], a[200:203], a[40:43], 0
    v_mfma_f32_16x16x32_bf16 v[136:139], a[232:235], a[56:59], v[136:139]
    s_xor_b32 s36, s100, 344064
    buffer_load_dwordx4 a[72:75], v26, s[20:23], s36 offen offset:0 sc1
    v_mfma_f32_16x16x32_bf16 v[168:171], a[232:235], a[60:63], 0
    ds_read_b64_tr_b16 v[200:201], v42 offset:0
    v_mfma_f32_16x16x32_bf16 v[168:171], a[200:203], a[44:47], v[168:171]
    v_mfma_f32_16x16x32_bf16 v[172:175], a[204:207], a[44:47], 0
    ds_read_b64_tr_b16 v[202:203], v42 offset:4096
    v_mfma_f32_16x16x32_bf16 v[172:175], a[236:239], a[60:63], v[172:175]
    s_xor_b32 s36, s100, 344064
    buffer_load_dwordx4 a[88:91], v26, s[20:23], s36 offen offset:1024 sc1
    v_mfma_f32_16x16x32_bf16 v[140:143], a[236:239], a[56:59], 0
    v_mfma_f32_16x16x32_bf16 v[140:143], a[204:207], a[40:43], v[140:143]
    ds_read_b64_tr_b16 v[232:233], v42 offset:8192
    v_mfma_f32_16x16x32_bf16 v[108:111], a[204:207], a[36:39], v[108:111]
    v_mfma_f32_16x16x32_bf16 v[108:111], a[236:239], a[52:55], v[108:111]
    ds_read_b64_tr_b16 v[234:235], v42 offset:12288
    v_mfma_f32_16x16x32_bf16 v[76:79], a[236:239], a[48:51], v[76:79]
    s_xor_b32 s37, s100, 475136
    buffer_load_dwordx4 a[76:79], v26, s[20:23], s37 offen offset:0 sc1
    v_mfma_f32_16x16x32_bf16 v[76:79], a[204:207], a[32:35], v[76:79]
    ds_read_b64_tr_b16 v[204:205], v43 offset:0
    v_mfma_f32_16x16x32_bf16 v[80:83], a[208:211], a[32:35], v[80:83]
    ds_read_b64_tr_b16 v[206:207], v43 offset:4096
    v_mfma_f32_16x16x32_bf16 v[80:83], a[240:243], a[48:51], v[80:83]
    ds_read_b64_tr_b16 v[236:237], v43 offset:8192
    v_mfma_f32_16x16x32_bf16 v[112:115], a[240:243], a[52:55], v[112:115]
    s_xor_b32 s37, s100, 475136
    buffer_load_dwordx4 a[92:95], v26, s[20:23], s37 offen offset:1024 sc1
    v_mfma_f32_16x16x32_bf16 v[112:115], a[208:211], a[36:39], v[112:115]
    ds_read_b64_tr_b16 v[238:239], v43 offset:12288
    v_mfma_f32_16x16x32_bf16 v[144:147], a[208:211], a[40:43], 0
    ds_read_b64_tr_b16 v[208:209], v44 offset:0
    v_mfma_f32_16x16x32_bf16 v[144:147], a[240:243], a[56:59], v[144:147]
    ds_read_b64_tr_b16 v[210:211], v44 offset:4096
    v_mfma_f32_16x16x32_bf16 v[176:179], a[240:243], a[60:63], 0
    ds_read_b64_tr_b16 v[240:241], v44 offset:8192
    v_mfma_f32_16x16x32_bf16 v[176:179], a[208:211], a[44:47], v[176:179]
    s_xor_b32 s36, s100, 98304
    buffer_load_dwordx4 a[96:99], v26, s[20:23], s36 offen offset:0 sc1
    v_mfma_f32_16x16x32_bf16 v[180:183], a[212:215], a[44:47], 0
    ds_read_b64_tr_b16 v[242:243], v44 offset:12288
    v_mfma_f32_16x16x32_bf16 v[180:183], a[244:247], a[60:63], v[180:183]
    ds_read_b64_tr_b16 v[212:213], v45 offset:0
    v_mfma_f32_16x16x32_bf16 v[148:151], a[244:247], a[56:59], 0
    ds_read_b64_tr_b16 v[214:215], v45 offset:4096
    v_mfma_f32_16x16x32_bf16 v[148:151], a[212:215], a[40:43], v[148:151]
    s_xor_b32 s36, s100, 98304
    buffer_load_dwordx4 a[112:115], v26, s[20:23], s36 offen offset:1024 sc1
    v_mfma_f32_16x16x32_bf16 v[116:119], a[212:215], a[36:39], v[116:119]
    ds_read_b64_tr_b16 v[244:245], v45 offset:8192
    v_mfma_f32_16x16x32_bf16 v[116:119], a[244:247], a[52:55], v[116:119]
    ds_read_b64_tr_b16 v[246:247], v45 offset:12288
    v_mfma_f32_16x16x32_bf16 v[84:87], a[244:247], a[48:51], v[84:87]
    ds_read_b64_tr_b16 v[216:217], v46 offset:0
    v_mfma_f32_16x16x32_bf16 v[84:87], a[212:215], a[32:35], v[84:87]
    ds_read_b64_tr_b16 v[218:219], v46 offset:4096
    v_mfma_f32_16x16x32_bf16 v[88:91], a[216:219], a[32:35], v[88:91]
    s_xor_b32 s37, s100, 229376
    buffer_load_dwordx4 a[100:103], v26, s[20:23], s37 offen offset:0 sc1
    v_mfma_f32_16x16x32_bf16 v[88:91], a[248:251], a[48:51], v[88:91]
    ds_read_b64_tr_b16 v[248:249], v46 offset:8192
    v_mfma_f32_16x16x32_bf16 v[120:123], a[248:251], a[52:55], v[120:123]
    ds_read_b64_tr_b16 v[250:251], v46 offset:12288
    v_mfma_f32_16x16x32_bf16 v[120:123], a[216:219], a[36:39], v[120:123]
    ds_read_b64_tr_b16 v[220:221], v47 offset:0
    v_mfma_f32_16x16x32_bf16 v[152:155], a[216:219], a[40:43], 0
    s_xor_b32 s37, s100, 229376
    buffer_load_dwordx4 a[116:119], v26, s[20:23], s37 offen offset:1024 sc1
    v_mfma_f32_16x16x32_bf16 v[152:155], a[248:251], a[56:59], v[152:155]
    ds_read_b64_tr_b16 v[222:223], v47 offset:4096
    v_mfma_f32_16x16x32_bf16 v[184:187], a[248:251], a[60:63], 0
    ds_read_b64_tr_b16 v[252:253], v47 offset:8192
    v_mfma_f32_16x16x32_bf16 v[184:187], a[216:219], a[44:47], v[184:187]
    ds_read_b64_tr_b16 v[254:255], v47 offset:12288
    v_mfma_f32_16x16x32_bf16 v[188:191], a[220:223], a[44:47], 0
    v_mfma_f32_16x16x32_bf16 v[188:191], a[252:255], a[60:63], v[188:191]
    s_xor_b32 s36, s100, 360448
    buffer_load_dwordx4 a[104:107], v26, s[20:23], s36 offen offset:0 sc1
    v_mfma_f32_16x16x32_bf16 v[156:159], a[252:255], a[56:59], 0
    v_mfma_f32_16x16x32_bf16 v[156:159], a[220:223], a[40:43], v[156:159]
    v_mfma_f32_16x16x32_bf16 v[124:127], a[220:223], a[36:39], v[124:127]
    v_mfma_f32_16x16x32_bf16 v[124:127], a[252:255], a[52:55], v[124:127]
    s_xor_b32 s36, s100, 360448
    buffer_load_dwordx4 a[120:123], v26, s[20:23], s36 offen offset:1024 sc1
    v_mfma_f32_16x16x32_bf16 v[92:95], a[252:255], a[48:51], v[92:95]
    v_mfma_f32_16x16x32_bf16 v[92:95], a[220:223], a[32:35], v[92:95]
    s_waitcnt vmcnt(6) lgkmcnt(0)
    v_mfma_f32_16x16x32_bf16 v[64:67], v[192:195], a[64:67], v[64:67]
    s_barrier
    v_mfma_f32_16x16x32_bf16 v[64:67], v[224:227], a[80:83], v[64:67]
    ds_read_b64_tr_b16 a[192:193], v40 offset:32768
    v_mfma_f32_16x16x32_bf16 v[96:99], v[224:227], a[84:87], v[96:99]
    v_mfma_f32_16x16x32_bf16 v[96:99], v[192:195], a[68:71], v[96:99]
    s_xor_b32 s37, s100, 491520
    buffer_load_dwordx4 a[108:111], v26, s[20:23], s37 offen offset:0 sc1
    v_mfma_f32_16x16x32_bf16 v[128:131], v[192:195], a[72:75], v[128:131]
    ds_read_b64_tr_b16 a[194:195], v40 offset:36864
    v_mfma_f32_16x16x32_bf16 v[128:131], v[224:227], a[88:91], v[128:131]
    v_mfma_f32_16x16x32_bf16 v[160:163], v[224:227], a[92:95], v[160:163]
    ds_read_b64_tr_b16 a[224:225], v40 offset:40960
    v_mfma_f32_16x16x32_bf16 v[160:163], v[192:195], a[76:79], v[160:163]
    s_xor_b32 s37, s100, 491520
    buffer_load_dwordx4 a[124:127], v26, s[20:23], s37 offen offset:1024 sc1
    v_mfma_f32_16x16x32_bf16 v[164:167], v[196:199], a[76:79], v[164:167]
    v_mfma_f32_16x16x32_bf16 v[164:167], v[228:231], a[92:95], v[164:167]
    ds_read_b64_tr_b16 a[226:227], v40 offset:45056
    v_mfma_f32_16x16x32_bf16 v[132:135], v[228:231], a[88:91], v[132:135]
    v_mfma_f32_16x16x32_bf16 v[132:135], v[196:199], a[72:75], v[132:135]
    ds_read_b64_tr_b16 a[196:197], v41 offset:32768
    v_mfma_f32_16x16x32_bf16 v[100:103], v[196:199], a[68:71], v[100:103]
    s_add_u32 m0, s62, 32768
    s_xor_b32 s40, s96, 524288
    buffer_load_dwordx4 v7, s[24:27], s40 offen lds
    v_mfma_f32_16x16x32_bf16 v[100:103], v[228:231], a[84:87], v[100:103]
    v_mfma_f32_16x16x32_bf16 v[68:71], v[228:231], a[80:83], v[68:71]
    ds_read_b64_tr_b16 a[198:199], v41 offset:36864
    v_mfma_f32_16x16x32_bf16 v[68:71], v[196:199], a[64:67], v[68:71]
    v_mfma_f32_16x16x32_bf16 v[72:75], v[200:203], a[64:67], v[72:75]
    s_add_u32 m0, s62, 36864
    s_xor_b32 s41, s96, 540672
    buffer_load_dwordx4 v7, s[24:27], s41 offen lds
    v_mfma_f32_16x16x32_bf16 v[72:75], v[232:235], a[80:83], v[72:75]
    ds_read_b64_tr_b16 a[228:229], v41 offset:40960
    v_mfma_f32_16x16x32_bf16 v[104:107], v[232:235], a[84:87], v[104:107]
    v_mfma_f32_16x16x32_bf16 v[104:107], v[200:203], a[68:71], v[104:107]
    ds_read_b64_tr_b16 a[230:231], v41 offset:45056
    v_mfma_f32_16x16x32_bf16 v[136:139], v[200:203], a[72:75], v[136:139]
    v_mfma_f32_16x16x32_bf16 v[136:139], v[232:235], a[88:91], v[136:139]
    s_add_u32 m0, s62, 40960
    s_xor_b32 s40, s96, 557056
    buffer_load_dwordx4 v7, s[24:27], s40 offen lds
    v_mfma_f32_16x16x32_bf16 v[168:171], v[232:235], a[92:95], v[168:171]
    ds_read_b64_tr_b16 a[200:201], v42 offset:32768
    v_mfma_f32_16x16x32_bf16 v[168:171], v[200:203], a[76:79], v[168:171]
    v_mfma_f32_16x16x32_bf16 v[172:175], v[204:207], a[76:79], v[172:175]
    ds_read_b64_tr_b16 a[202:203], v42 offset:36864
    v_mfma_f32_16x16x32_bf16 v[172:175], v[236:239], a[92:95], v[172:175]
    s_add_u32 m0, s62, 45056
    s_xor_b32 s41, s96, 573440
    buffer_load_dwordx4 v7, s[24:27], s41 offen lds
    v_mfma_f32_16x16x32_bf16 v[140:143], v[236:239], a[88:91], v[140:143]
    v_mfma_f32_16x16x32_bf16 v[140:143], v[204:207], a[72:75], v[140:143]
    ds_read_b64_tr_b16 a[232:233], v42 offset:40960
    v_mfma_f32_16x16x32_bf16 v[108:111], v[204:207], a[68:71], v[108:111]
    v_mfma_f32_16x16x32_bf16 v[108:111], v[236:239], a[84:87], v[108:111]
    ds_read_b64_tr_b16 a[234:235], v42 offset:45056
    v_mfma_f32_16x16x32_bf16 v[76:79], v[236:239], a[80:83], v[76:79]
    s_add_u32 m0, s62, 49152
    s_xor_b32 s40, s96, 589824
    buffer_load_dwordx4 v7, s[24:27], s40 offen lds
    v_mfma_f32_16x16x32_bf16 v[76:79], v[204:207], a[64:67], v[76:79]
    ds_read_b64_tr_b16 a[204:205], v43 offset:32768
    v_mfma_f32_16x16x32_bf16 v[80:83], v[208:211], a[64:67], v[80:83]
    ds_read_b64_tr_b16 a[206:207], v43 offset:36864
    v_mfma_f32_16x16x32_bf16 v[80:83], v[240:243], a[80:83], v[80:83]
    ds_read_b64_tr_b16 a[236:237], v43 offset:40960
    v_mfma_f32_16x16x32_bf16 v[112:115], v[240:243], a[84:87], v[112:115]
    s_add_u32 m0, s62, 53248
    s_xor_b32 s41, s96, 606208
    buffer_load_dwordx4 v7, s[24:27], s41 offen lds
    v_mfma_f32_16x16x32_bf16 v[112:115], v[208:211], a[68:71], v[112:115]
    ds_read_b64_tr_b16 a[238:239], v43 offset:45056
    v_mfma_f32_16x16x32_bf16 v[144:147], v[208:211], a[72:75], v[144:147]
    ds_read_b64_tr_b16 a[208:209], v44 offset:32768
    v_mfma_f32_16x16x32_bf16 v[144:147], v[240:243], a[88:91], v[144:147]
    ds_read_b64_tr_b16 a[210:211], v44 offset:36864
    v_mfma_f32_16x16x32_bf16 v[176:179], v[240:243], a[92:95], v[176:179]
    ds_read_b64_tr_b16 a[240:241], v44 offset:40960
    v_mfma_f32_16x16x32_bf16 v[176:179], v[208:211], a[76:79], v[176:179]
    s_add_u32 m0, s62, 57344
    s_xor_b32 s40, s96, 622592
    buffer_load_dwordx4 v7, s[24:27], s40 offen lds
    v_mfma_f32_16x16x32_bf16 v[180:183], v[212:215], a[76:79], v[180:183]
    ds_read_b64_tr_b16 a[242:243], v44 offset:45056
    v_mfma_f32_16x16x32_bf16 v[180:183], v[244:247], a[92:95], v[180:183]
    ds_read_b64_tr_b16 a[212:213], v45 offset:32768
    v_mfma_f32_16x16x32_bf16 v[148:151], v[244:247], a[88:91], v[148:151]
    ds_read_b64_tr_b16 a[214:215], v45 offset:36864
    v_mfma_f32_16x16x32_bf16 v[148:151], v[212:215], a[72:75], v[148:151]
    s_add_u32 m0, s62, 61440
    s_xor_b32 s41, s96, 638976
    buffer_load_dwordx4 v7, s[24:27], s41 offen lds
    v_mfma_f32_16x16x32_bf16 v[116:119], v[212:215], a[68:71], v[116:119]
    ds_read_b64_tr_b16 a[244:245], v45 offset:40960
    v_mfma_f32_16x16x32_bf16 v[116:119], v[244:247], a[84:87], v[116:119]
    ds_read_b64_tr_b16 a[246:247], v45 offset:45056
    v_mfma_f32_16x16x32_bf16 v[84:87], v[244:247], a[80:83], v[84:87]
    ds_read_b64_tr_b16 a[216:217], v46 offset:32768
    v_mfma_f32_16x16x32_bf16 v[84:87], v[212:215], a[64:67], v[84:87]
    ds_read_b64_tr_b16 a[218:219], v46 offset:36864
    v_mfma_f32_16x16x32_bf16 v[88:91], v[216:219], a[64:67], v[88:91]
    s_xor_b32 s36, s100, 114688
    buffer_load_dwordx4 a[128:131], v26, s[20:23], s36 offen offset:0 sc1
    v_mfma_f32_16x16x32_bf16 v[88:91], v[248:251], a[80:83], v[88:91]
    ds_read_b64_tr_b16 a[248:249], v46 offset:40960
    v_mfma_f32_16x16x32_bf16 v[120:123], v[248:251], a[84:87], v[120:123]
    ds_read_b64_tr_b16 a[250:251], v46 offset:45056
    v_mfma_f32_16x16x32_bf16 v[120:123], v[216:219], a[68:71], v[120:123]
    ds_read_b64_tr_b16 a[220:221], v47 offset:32768
    v_mfma_f32_16x16x32_bf16 v[152:155], v[216:219], a[72:75], v[152:155]
    s_xor_b32 s36, s100, 114688
    buffer_load_dwordx4 a[144:147], v26, s[20:23], s36 offen offset:1024 sc1
    v_mfma_f32_16x16x32_bf16 v[152:155], v[248:251], a[88:91], v[152:155]
    ds_read_b64_tr_b16 a[222:223], v47 offset:36864
    v_mfma_f32_16x16x32_bf16 v[184:187], v[248:251], a[92:95], v[184:187]
    ds_read_b64_tr_b16 a[252:253], v47 offset:40960
    v_mfma_f32_16x16x32_bf16 v[184:187], v[216:219], a[76:79], v[184:187]
    ds_read_b64_tr_b16 a[254:255], v47 offset:45056
    v_mfma_f32_16x16x32_bf16 v[188:191], v[220:223], a[76:79], v[188:191]
    v_mfma_f32_16x16x32_bf16 v[188:191], v[252:255], a[92:95], v[188:191]
    s_xor_b32 s37, s100, 245760
    buffer_load_dwordx4 a[132:135], v26, s[20:23], s37 offen offset:0 sc1
    v_mfma_f32_16x16x32_bf16 v[156:159], v[252:255], a[88:91], v[156:159]
    v_mfma_f32_16x16x32_bf16 v[156:159], v[220:223], a[72:75], v[156:159]
    v_mfma_f32_16x16x32_bf16 v[124:127], v[220:223], a[68:71], v[124:127]
    v_mfma_f32_16x16x32_bf16 v[124:127], v[252:255], a[84:87], v[124:127]
    s_xor_b32 s37, s100, 245760
    buffer_load_dwordx4 a[148:151], v26, s[20:23], s37 offen offset:1024 sc1
    v_mfma_f32_16x16x32_bf16 v[92:95], v[252:255], a[80:83], v[92:95]
    v_mfma_f32_16x16x32_bf16 v[92:95], v[220:223], a[64:67], v[92:95]
    s_waitcnt vmcnt(12) lgkmcnt(0)
    v_mfma_f32_16x16x32_bf16 v[64:67], a[192:195], a[96:99], v[64:67]
    s_barrier
    v_mfma_f32_16x16x32_bf16 v[64:67], a[224:227], a[112:115], v[64:67]
    ds_read_b64_tr_b16 v[192:193], v32 offset:0
    v_mfma_f32_16x16x32_bf16 v[96:99], a[224:227], a[116:119], v[96:99]
    v_mfma_f32_16x16x32_bf16 v[96:99], a[192:195], a[100:103], v[96:99]
    s_xor_b32 s36, s100, 376832
    buffer_load_dwordx4 a[136:139], v26, s[20:23], s36 offen offset:0 sc1
    v_mfma_f32_16x16x32_bf16 v[128:131], a[192:195], a[104:107], v[128:131]
    ds_read_b64_tr_b16 v[194:195], v32 offset:4096
    v_mfma_f32_16x16x32_bf16 v[128:131], a[224:227], a[120:123], v[128:131]
    v_mfma_f32_16x16x32_bf16 v[160:163], a[224:227], a[124:127], v[160:163]
    ds_read_b64_tr_b16 v[224:225], v32 offset:8192
    v_mfma_f32_16x16x32_bf16 v[160:163], a[192:195], a[108:111], v[160:163]
    s_xor_b32 s36, s100, 376832
    buffer_load_dwordx4 a[152:155], v26, s[20:23], s36 offen offset:1024 sc1
    v_mfma_f32_16x16x32_bf16 v[164:167], a[196:199], a[108:111], v[164:167]
    v_mfma_f32_16x16x32_bf16 v[164:167], a[228:231], a[124:127], v[164:167]
    ds_read_b64_tr_b16 v[226:227], v32 offset:12288
    v_mfma_f32_16x16x32_bf16 v[132:135], a[228:231], a[120:123], v[132:135]
    v_mfma_f32_16x16x32_bf16 v[132:135], a[196:199], a[104:107], v[132:135]
    ds_read_b64_tr_b16 v[196:197], v33 offset:0
    v_mfma_f32_16x16x32_bf16 v[100:103], a[196:199], a[100:103], v[100:103]
    s_xor_b32 s37, s100, 507904
    buffer_load_dwordx4 a[140:143], v26, s[20:23], s37 offen offset:0 sc1
    v_mfma_f32_16x16x32_bf16 v[100:103], a[228:231], a[116:119], v[100:103]
    v_mfma_f32_16x16x32_bf16 v[68:71], a[228:231], a[112:115], v[68:71]
    ds_read_b64_tr_b16 v[198:199], v33 offset:4096
    v_mfma_f32_16x16x32_bf16 v[68:71], a[196:199], a[96:99], v[68:71]
    v_mfma_f32_16x16x32_bf16 v[72:75], a[200:203], a[96:99], v[72:75]
    s_xor_b32 s37, s100, 507904
    buffer_load_dwordx4 a[156:159], v26, s[20:23], s37 offen offset:1024 sc1
    v_mfma_f32_16x16x32_bf16 v[72:75], a[232:235], a[112:115], v[72:75]
    ds_read_b64_tr_b16 v[228:229], v33 offset:8192
    v_mfma_f32_16x16x32_bf16 v[104:107], a[232:235], a[116:119], v[104:107]
    v_mfma_f32_16x16x32_bf16 v[104:107], a[200:203], a[100:103], v[104:107]
    ds_read_b64_tr_b16 v[230:231], v33 offset:12288
    v_mfma_f32_16x16x32_bf16 v[136:139], a[200:203], a[104:107], v[136:139]
    v_mfma_f32_16x16x32_bf16 v[136:139], a[232:235], a[120:123], v[136:139]
    s_add_u32 m0, s62, 65536
    s_xor_b32 s40, s96, 1048576
    buffer_load_dwordx4 v7, s[24:27], s40 offen lds
    v_mfma_f32_16x16x32_bf16 v[168:171], a[232:235], a[124:127], v[168:171]
    ds_read_b64_tr_b16 v[200:201], v34 offset:0
    v_mfma_f32_16x16x32_bf16 v[168:171], a[200:203], a[108:111], v[168:171]
    v_mfma_f32_16x16x32_bf16 v[172:175], a[204:207], a[108:111], v[172:175]
    ds_read_b64_tr_b16 v[202:203], v34 offset:4096
    v_mfma_f32_16x16x32_bf16 v[172:175], a[236:239], a[124:127], v[172:175]
    s_add_u32 m0, s62, 69632
    s_xor_b32 s41, s96, 1064960
    buffer_load_dwordx4 v7, s[24:27], s41 offen lds
    v_mfma_f32_16x16x32_bf16 v[140:143], a[236:239], a[120:123], v[140:143]
    v_mfma_f32_16x16x32_bf16 v[140:143], a[204:207], a[104:107], v[140:143]
    ds_read_b64_tr_b16 v[232:233], v34 offset:8192
    v_mfma_f32_16x16x32_bf16 v[108:111], a[204:207], a[100:103], v[108:111]
    v_mfma_f32_16x16x32_bf16 v[108:111], a[236:239], a[116:119], v[108:111]
    ds_read_b64_tr_b16 v[234:235], v34 offset:12288
    v_mfma_f32_16x16x32_bf16 v[76:79], a[236:239], a[112:115], v[76:79]
    s_add_u32 m0, s62, 73728
    s_xor_b32 s40, s96, 1081344
    buffer_load_dwordx4 v7, s[24:27], s40 offen lds
    v_mfma_f32_16x16x32_bf16 v[76:79], a[204:207], a[96:99], v[76:79]
    ds_read_b64_tr_b16 v[204:205], v35 offset:0
    v_mfma_f32_16x16x32_bf16 v[80:83], a[208:211], a[96:99], v[80:83]
    ds_read_b64_tr_b16 v[206:207], v35 offset:4096
    v_mfma_f32_16x16x32_bf16 v[80:83], a[240:243], a[112:115], v[80:83]
    ds_read_b64_tr_b16 v[236:237], v35 offset:8192
    v_mfma_f32_16x16x32_bf16 v[112:115], a[240:243], a[116:119], v[112:115]
    s_add_u32 m0, s62, 77824
    s_xor_b32 s41, s96, 1097728
    buffer_load_dwordx4 v7, s[24:27], s41 offen lds
    v_mfma_f32_16x16x32_bf16 v[112:115], a[208:211], a[100:103], v[112:115]
    ds_read_b64_tr_b16 v[238:239], v35 offset:12288
    v_mfma_f32_16x16x32_bf16 v[144:147], a[208:211], a[104:107], v[144:147]
    ds_read_b64_tr_b16 v[208:209], v36 offset:0
    v_mfma_f32_16x16x32_bf16 v[144:147], a[240:243], a[120:123], v[144:147]
    ds_read_b64_tr_b16 v[210:211], v36 offset:4096
    v_mfma_f32_16x16x32_bf16 v[176:179], a[240:243], a[124:127], v[176:179]
    ds_read_b64_tr_b16 v[240:241], v36 offset:8192
    v_mfma_f32_16x16x32_bf16 v[176:179], a[208:211], a[108:111], v[176:179]
    s_add_u32 m0, s62, 81920
    s_xor_b32 s40, s96, 1114112
    buffer_load_dwordx4 v7, s[24:27], s40 offen lds
    v_mfma_f32_16x16x32_bf16 v[180:183], a[212:215], a[108:111], v[180:183]
    ds_read_b64_tr_b16 v[242:243], v36 offset:12288
    v_mfma_f32_16x16x32_bf16 v[180:183], a[244:247], a[124:127], v[180:183]
    ds_read_b64_tr_b16 v[212:213], v37 offset:0
    v_mfma_f32_16x16x32_bf16 v[148:151], a[244:247], a[120:123], v[148:151]
    ds_read_b64_tr_b16 v[214:215], v37 offset:4096
    v_mfma_f32_16x16x32_bf16 v[148:151], a[212:215], a[104:107], v[148:151]
    s_add_u32 m0, s62, 86016
    s_xor_b32 s41, s96, 1130496
    buffer_load_dwordx4 v7, s[24:27], s41 offen lds
    v_mfma_f32_16x16x32_bf16 v[116:119], a[212:215], a[100:103], v[116:119]
    ds_read_b64_tr_b16 v[244:245], v37 offset:8192
    v_mfma_f32_16x16x32_bf16 v[116:119], a[244:247], a[116:119], v[116:119]
    ds_read_b64_tr_b16 v[246:247], v37 offset:12288
    v_mfma_f32_16x16x32_bf16 v[84:87], a[244:247], a[112:115], v[84:87]
    ds_read_b64_tr_b16 v[216:217], v38 offset:0
    v_mfma_f32_16x16x32_bf16 v[84:87], a[212:215], a[96:99], v[84:87]
    ds_read_b64_tr_b16 v[218:219], v38 offset:4096
    v_mfma_f32_16x16x32_bf16 v[88:91], a[216:219], a[96:99], v[88:91]
    s_add_u32 m0, s62, 90112
    s_xor_b32 s40, s96, 1146880
    buffer_load_dwordx4 v7, s[24:27], s40 offen lds
    v_mfma_f32_16x16x32_bf16 v[88:91], a[248:251], a[112:115], v[88:91]
    ds_read_b64_tr_b16 v[248:249], v38 offset:8192
    v_mfma_f32_16x16x32_bf16 v[120:123], a[248:251], a[116:119], v[120:123]
    ds_read_b64_tr_b16 v[250:251], v38 offset:12288
    v_mfma_f32_16x16x32_bf16 v[120:123], a[216:219], a[100:103], v[120:123]
    ds_read_b64_tr_b16 v[220:221], v39 offset:0
    v_mfma_f32_16x16x32_bf16 v[152:155], a[216:219], a[104:107], v[152:155]
    s_add_u32 m0, s62, 94208
    s_xor_b32 s41, s96, 1163264
    buffer_load_dwordx4 v7, s[24:27], s41 offen lds
    v_mfma_f32_16x16x32_bf16 v[152:155], a[248:251], a[120:123], v[152:155]
    ds_read_b64_tr_b16 v[222:223], v39 offset:4096
    v_mfma_f32_16x16x32_bf16 v[184:187], a[248:251], a[124:127], v[184:187]
    ds_read_b64_tr_b16 v[252:253], v39 offset:8192
    v_mfma_f32_16x16x32_bf16 v[184:187], a[216:219], a[108:111], v[184:187]
    ds_read_b64_tr_b16 v[254:255], v39 offset:12288
    v_mfma_f32_16x16x32_bf16 v[188:191], a[220:223], a[108:111], v[188:191]
    v_mfma_f32_16x16x32_bf16 v[188:191], a[252:255], a[124:127], v[188:191]
    s_xor_b32 s36, s52, 16384
    buffer_load_dwordx4 a[160:163], v26, s[20:23], s36 offen offset:0 sc1
    v_mfma_f32_16x16x32_bf16 v[156:159], a[252:255], a[120:123], v[156:159]
    v_mfma_f32_16x16x32_bf16 v[156:159], a[220:223], a[104:107], v[156:159]
    v_mfma_f32_16x16x32_bf16 v[124:127], a[220:223], a[100:103], v[124:127]
    v_mfma_f32_16x16x32_bf16 v[124:127], a[252:255], a[116:119], v[124:127]
    s_xor_b32 s36, s52, 16384
    buffer_load_dwordx4 a[176:179], v26, s[20:23], s36 offen offset:1024 sc1
    v_mfma_f32_16x16x32_bf16 v[92:95], a[252:255], a[112:115], v[92:95]
    v_mfma_f32_16x16x32_bf16 v[92:95], a[220:223], a[96:99], v[92:95]
    s_waitcnt vmcnt(10) lgkmcnt(0)
    v_mfma_f32_16x16x32_bf16 v[64:67], v[192:195], a[128:131], v[64:67]
    s_barrier
    v_mfma_f32_16x16x32_bf16 v[64:67], v[224:227], a[144:147], v[64:67]
    ds_read_b64_tr_b16 a[192:193], v32 offset:32768
    v_mfma_f32_16x16x32_bf16 v[96:99], v[224:227], a[148:151], v[96:99]
    v_mfma_f32_16x16x32_bf16 v[96:99], v[192:195], a[132:135], v[96:99]
    s_xor_b32 s37, s52, 147456
    buffer_load_dwordx4 a[164:167], v26, s[20:23], s37 offen offset:0 sc1
    v_mfma_f32_16x16x32_bf16 v[128:131], v[192:195], a[136:139], v[128:131]
    ds_read_b64_tr_b16 a[194:195], v32 offset:36864
    v_mfma_f32_16x16x32_bf16 v[128:131], v[224:227], a[152:155], v[128:131]
    v_mfma_f32_16x16x32_bf16 v[160:163], v[224:227], a[156:159], v[160:163]
    ds_read_b64_tr_b16 a[224:225], v32 offset:40960
    v_mfma_f32_16x16x32_bf16 v[160:163], v[192:195], a[140:143], v[160:163]
    s_xor_b32 s37, s52, 147456
    buffer_load_dwordx4 a[180:183], v26, s[20:23], s37 offen offset:1024 sc1
    v_mfma_f32_16x16x32_bf16 v[164:167], v[196:199], a[140:143], v[164:167]
    v_mfma_f32_16x16x32_bf16 v[164:167], v[228:231], a[156:159], v[164:167]
    ds_read_b64_tr_b16 a[226:227], v32 offset:45056
    v_mfma_f32_16x16x32_bf16 v[132:135], v[228:231], a[152:155], v[132:135]
    v_mfma_f32_16x16x32_bf16 v[132:135], v[196:199], a[136:139], v[132:135]
    ds_read_b64_tr_b16 a[196:197], v33 offset:32768
    v_mfma_f32_16x16x32_bf16 v[100:103], v[196:199], a[132:135], v[100:103]
    s_xor_b32 s36, s52, 278528
    buffer_load_dwordx4 a[168:171], v26, s[20:23], s36 offen offset:0 sc1
    v_mfma_f32_16x16x32_bf16 v[100:103], v[228:231], a[148:151], v[100:103]
    v_mfma_f32_16x16x32_bf16 v[68:71], v[228:231], a[144:147], v[68:71]
    ds_read_b64_tr_b16 a[198:199], v33 offset:36864
    v_mfma_f32_16x16x32_bf16 v[68:71], v[196:199], a[128:131], v[68:71]
    v_mfma_f32_16x16x32_bf16 v[72:75], v[200:203], a[128:131], v[72:75]
    s_xor_b32 s36, s52, 278528
    buffer_load_dwordx4 a[184:187], v26, s[20:23], s36 offen offset:1024 sc1
    v_mfma_f32_16x16x32_bf16 v[72:75], v[232:235], a[144:147], v[72:75]
    ds_read_b64_tr_b16 a[228:229], v33 offset:40960
    v_mfma_f32_16x16x32_bf16 v[104:107], v[232:235], a[148:151], v[104:107]
    v_mfma_f32_16x16x32_bf16 v[104:107], v[200:203], a[132:135], v[104:107]
    ds_read_b64_tr_b16 a[230:231], v33 offset:45056
    v_mfma_f32_16x16x32_bf16 v[136:139], v[200:203], a[136:139], v[136:139]
    v_mfma_f32_16x16x32_bf16 v[136:139], v[232:235], a[152:155], v[136:139]
    s_xor_b32 s37, s52, 409600
    buffer_load_dwordx4 a[172:175], v26, s[20:23], s37 offen offset:0 sc1
    v_mfma_f32_16x16x32_bf16 v[168:171], v[232:235], a[156:159], v[168:171]
    ds_read_b64_tr_b16 a[200:201], v34 offset:32768
    v_mfma_f32_16x16x32_bf16 v[168:171], v[200:203], a[140:143], v[168:171]
    v_mfma_f32_16x16x32_bf16 v[172:175], v[204:207], a[140:143], v[172:175]
    ds_read_b64_tr_b16 a[202:203], v34 offset:36864
    v_mfma_f32_16x16x32_bf16 v[172:175], v[236:239], a[156:159], v[172:175]
    s_xor_b32 s37, s52, 409600
    buffer_load_dwordx4 a[188:191], v26, s[20:23], s37 offen offset:1024 sc1
    v_mfma_f32_16x16x32_bf16 v[140:143], v[236:239], a[152:155], v[140:143]
    v_mfma_f32_16x16x32_bf16 v[140:143], v[204:207], a[136:139], v[140:143]
    ds_read_b64_tr_b16 a[232:233], v34 offset:40960
    v_mfma_f32_16x16x32_bf16 v[108:111], v[204:207], a[132:135], v[108:111]
    v_mfma_f32_16x16x32_bf16 v[108:111], v[236:239], a[148:151], v[108:111]
    ds_read_b64_tr_b16 a[234:235], v34 offset:45056
    v_mfma_f32_16x16x32_bf16 v[76:79], v[236:239], a[144:147], v[76:79]
    s_add_u32 m0, s62, 98304
    s_xor_b32 s40, s96, 1572864
    buffer_load_dwordx4 v7, s[24:27], s40 offen lds
    v_mfma_f32_16x16x32_bf16 v[76:79], v[204:207], a[128:131], v[76:79]
    ds_read_b64_tr_b16 a[204:205], v35 offset:32768
    v_mfma_f32_16x16x32_bf16 v[80:83], v[208:211], a[128:131], v[80:83]
    ds_read_b64_tr_b16 a[206:207], v35 offset:36864
    v_mfma_f32_16x16x32_bf16 v[80:83], v[240:243], a[144:147], v[80:83]
    ds_read_b64_tr_b16 a[236:237], v35 offset:40960
    v_mfma_f32_16x16x32_bf16 v[112:115], v[240:243], a[148:151], v[112:115]
    s_add_u32 m0, s62, 102400
    s_xor_b32 s41, s96, 1589248
    buffer_load_dwordx4 v7, s[24:27], s41 offen lds
    v_mfma_f32_16x16x32_bf16 v[112:115], v[208:211], a[132:135], v[112:115]
    ds_read_b64_tr_b16 a[238:239], v35 offset:45056
    v_mfma_f32_16x16x32_bf16 v[144:147], v[208:211], a[136:139], v[144:147]
    ds_read_b64_tr_b16 a[208:209], v36 offset:32768
    v_mfma_f32_16x16x32_bf16 v[144:147], v[240:243], a[152:155], v[144:147]
    ds_read_b64_tr_b16 a[210:211], v36 offset:36864
    v_mfma_f32_16x16x32_bf16 v[176:179], v[240:243], a[156:159], v[176:179]
    ds_read_b64_tr_b16 a[240:241], v36 offset:40960
    v_mfma_f32_16x16x32_bf16 v[176:179], v[208:211], a[140:143], v[176:179]
    s_add_u32 m0, s62, 106496
    s_xor_b32 s40, s96, 1605632
    buffer_load_dwordx4 v7, s[24:27], s40 offen lds
    v_mfma_f32_16x16x32_bf16 v[180:183], v[212:215], a[140:143], v[180:183]
    ds_read_b64_tr_b16 a[242:243], v36 offset:45056
    v_mfma_f32_16x16x32_bf16 v[180:183], v[244:247], a[156:159], v[180:183]
    ds_read_b64_tr_b16 a[212:213], v37 offset:32768
    v_mfma_f32_16x16x32_bf16 v[148:151], v[244:247], a[152:155], v[148:151]
    ds_read_b64_tr_b16 a[214:215], v37 offset:36864
    v_mfma_f32_16x16x32_bf16 v[148:151], v[212:215], a[136:139], v[148:151]
    s_add_u32 m0, s62, 110592
    s_xor_b32 s41, s96, 1622016
    buffer_load_dwordx4 v7, s[24:27], s41 offen lds
    v_mfma_f32_16x16x32_bf16 v[116:119], v[212:215], a[132:135], v[116:119]
    ds_read_b64_tr_b16 a[244:245], v37 offset:40960
    v_mfma_f32_16x16x32_bf16 v[116:119], v[244:247], a[148:151], v[116:119]
    ds_read_b64_tr_b16 a[246:247], v37 offset:45056
    v_mfma_f32_16x16x32_bf16 v[84:87], v[244:247], a[144:147], v[84:87]
    ds_read_b64_tr_b16 a[216:217], v38 offset:32768
    v_mfma_f32_16x16x32_bf16 v[84:87], v[212:215], a[128:131], v[84:87]
    ds_read_b64_tr_b16 a[218:219], v38 offset:36864
    v_mfma_f32_16x16x32_bf16 v[88:91], v[216:219], a[128:131], v[88:91]
    s_add_u32 m0, s62, 114688
    s_xor_b32 s40, s96, 1638400
    buffer_load_dwordx4 v7, s[24:27], s40 offen lds
    v_mfma_f32_16x16x32_bf16 v[88:91], v[248:251], a[144:147], v[88:91]
    ds_read_b64_tr_b16 a[248:249], v38 offset:40960
    v_mfma_f32_16x16x32_bf16 v[120:123], v[248:251], a[148:151], v[120:123]
    ds_read_b64_tr_b16 a[250:251], v38 offset:45056
    v_mfma_f32_16x16x32_bf16 v[120:123], v[216:219], a[132:135], v[120:123]
    ds_read_b64_tr_b16 a[220:221], v39 offset:32768
    v_mfma_f32_16x16x32_bf16 v[152:155], v[216:219], a[136:139], v[152:155]
    s_add_u32 m0, s62, 118784
    s_xor_b32 s41, s96, 1654784
    buffer_load_dwordx4 v7, s[24:27], s41 offen lds
    v_mfma_f32_16x16x32_bf16 v[152:155], v[248:251], a[152:155], v[152:155]
    ds_read_b64_tr_b16 a[222:223], v39 offset:36864
    v_mfma_f32_16x16x32_bf16 v[184:187], v[248:251], a[156:159], v[184:187]
    ds_read_b64_tr_b16 a[252:253], v39 offset:40960
    v_mfma_f32_16x16x32_bf16 v[184:187], v[216:219], a[140:143], v[184:187]
    ds_read_b64_tr_b16 a[254:255], v39 offset:45056
    v_mfma_f32_16x16x32_bf16 v[188:191], v[220:223], a[140:143], v[188:191]
    v_mfma_f32_16x16x32_bf16 v[188:191], v[252:255], a[156:159], v[188:191]
    s_add_u32 m0, s62, 122880
    s_xor_b32 s40, s96, 1671168
    buffer_load_dwordx4 v7, s[24:27], s40 offen lds
    v_mfma_f32_16x16x32_bf16 v[156:159], v[252:255], a[152:155], v[156:159]
    v_mfma_f32_16x16x32_bf16 v[156:159], v[220:223], a[136:139], v[156:159]
    v_mfma_f32_16x16x32_bf16 v[124:127], v[220:223], a[132:135], v[124:127]
    v_mfma_f32_16x16x32_bf16 v[124:127], v[252:255], a[148:151], v[124:127]
    s_add_u32 m0, s62, 126976
    s_xor_b32 s41, s96, 1687552
    buffer_load_dwordx4 v7, s[24:27], s41 offen lds
    v_mfma_f32_16x16x32_bf16 v[92:95], v[252:255], a[144:147], v[92:95]
    v_mfma_f32_16x16x32_bf16 v[92:95], v[220:223], a[128:131], v[92:95]
    s_waitcnt vmcnt(8) lgkmcnt(0)
    v_mfma_f32_16x16x32_bf16 v[64:67], a[192:195], a[160:163], v[64:67]
    s_barrier
    v_mfma_f32_16x16x32_bf16 v[64:67], a[224:227], a[176:179], v[64:67]
    ds_read_b64_tr_b16 v[192:193], v40 offset:0
    v_mfma_f32_16x16x32_bf16 v[96:99], a[224:227], a[180:183], v[96:99]
    v_mfma_f32_16x16x32_bf16 v[96:99], a[192:195], a[164:167], v[96:99]
    s_xor_b32 s36, s52, 32768
    buffer_load_dwordx4 a[0:3], v26, s[20:23], s36 offen offset:0 sc1
    v_mfma_f32_16x16x32_bf16 v[128:131], a[192:195], a[168:171], v[128:131]
    ds_read_b64_tr_b16 v[194:195], v40 offset:4096
    v_mfma_f32_16x16x32_bf16 v[128:131], a[224:227], a[184:187], v[128:131]
    v_mfma_f32_16x16x32_bf16 v[160:163], a[224:227], a[188:191], v[160:163]
    ds_read_b64_tr_b16 v[224:225], v40 offset:8192
    v_mfma_f32_16x16x32_bf16 v[160:163], a[192:195], a[172:175], v[160:163]
    s_xor_b32 s36, s52, 32768
    buffer_load_dwordx4 a[16:19], v26, s[20:23], s36 offen offset:1024 sc1
    v_mfma_f32_16x16x32_bf16 v[164:167], a[196:199], a[172:175], v[164:167]
    v_mfma_f32_16x16x32_bf16 v[164:167], a[228:231], a[188:191], v[164:167]
    ds_read_b64_tr_b16 v[226:227], v40 offset:12288
    v_mfma_f32_16x16x32_bf16 v[132:135], a[228:231], a[184:187], v[132:135]
    v_mfma_f32_16x16x32_bf16 v[132:135], a[196:199], a[168:171], v[132:135]
    ds_read_b64_tr_b16 v[196:197], v41 offset:0
    v_mfma_f32_16x16x32_bf16 v[100:103], a[196:199], a[164:167], v[100:103]
    s_xor_b32 s37, s52, 163840
    buffer_load_dwordx4 a[4:7], v26, s[20:23], s37 offen offset:0 sc1
    v_mfma_f32_16x16x32_bf16 v[100:103], a[228:231], a[180:183], v[100:103]
    v_mfma_f32_16x16x32_bf16 v[68:71], a[228:231], a[176:179], v[68:71]
    ds_read_b64_tr_b16 v[198:199], v41 offset:4096
    v_mfma_f32_16x16x32_bf16 v[68:71], a[196:199], a[160:163], v[68:71]
    v_mfma_f32_16x16x32_bf16 v[72:75], a[200:203], a[160:163], v[72:75]
    s_xor_b32 s37, s52, 163840
    buffer_load_dwordx4 a[20:23], v26, s[20:23], s37 offen offset:1024 sc1
    v_mfma_f32_16x16x32_bf16 v[72:75], a[232:235], a[176:179], v[72:75]
    ds_read_b64_tr_b16 v[228:229], v41 offset:8192
    v_mfma_f32_16x16x32_bf16 v[104:107], a[232:235], a[180:183], v[104:107]
    v_mfma_f32_16x16x32_bf16 v[104:107], a[200:203], a[164:167], v[104:107]
    ds_read_b64_tr_b16 v[230:231], v41 offset:12288
    v_mfma_f32_16x16x32_bf16 v[136:139], a[200:203], a[168:171], v[136:139]
    v_mfma_f32_16x16x32_bf16 v[136:139], a[232:235], a[184:187], v[136:139]
    s_xor_b32 s36, s52, 294912
    buffer_load_dwordx4 a[8:11], v26, s[20:23], s36 offen offset:0 sc1
    v_mfma_f32_16x16x32_bf16 v[168:171], a[232:235], a[188:191], v[168:171]
    ds_read_b64_tr_b16 v[200:201], v42 offset:0
    v_mfma_f32_16x16x32_bf16 v[168:171], a[200:203], a[172:175], v[168:171]
    v_mfma_f32_16x16x32_bf16 v[172:175], a[204:207], a[172:175], v[172:175]
    ds_read_b64_tr_b16 v[202:203], v42 offset:4096
    v_mfma_f32_16x16x32_bf16 v[172:175], a[236:239], a[188:191], v[172:175]
    s_xor_b32 s36, s52, 294912
    buffer_load_dwordx4 a[24:27], v26, s[20:23], s36 offen offset:1024 sc1
    v_mfma_f32_16x16x32_bf16 v[140:143], a[236:239], a[184:187], v[140:143]
    v_mfma_f32_16x16x32_bf16 v[140:143], a[204:207], a[168:171], v[140:143]
    ds_read_b64_tr_b16 v[232:233], v42 offset:8192
    v_mfma_f32_16x16x32_bf16 v[108:111], a[204:207], a[164:167], v[108:111]
    v_mfma_f32_16x16x32_bf16 v[108:111], a[236:239], a[180:183], v[108:111]
    ds_read_b64_tr_b16 v[234:235], v42 offset:12288
    v_mfma_f32_16x16x32_bf16 v[76:79], a[236:239], a[176:179], v[76:79]
    s_xor_b32 s37, s52, 425984
    buffer_load_dwordx4 a[12:15], v26, s[20:23], s37 offen offset:0 sc1
    v_mfma_f32_16x16x32_bf16 v[76:79], a[204:207], a[160:163], v[76:79]
    ds_read_b64_tr_b16 v[204:205], v43 offset:0
    v_mfma_f32_16x16x32_bf16 v[80:83], a[208:211], a[160:163], v[80:83]
    ds_read_b64_tr_b16 v[206:207], v43 offset:4096
    v_mfma_f32_16x16x32_bf16 v[80:83], a[240:243], a[176:179], v[80:83]
    ds_read_b64_tr_b16 v[236:237], v43 offset:8192
    v_mfma_f32_16x16x32_bf16 v[112:115], a[240:243], a[180:183], v[112:115]
    s_xor_b32 s37, s52, 425984
    buffer_load_dwordx4 a[28:31], v26, s[20:23], s37 offen offset:1024 sc1
    v_mfma_f32_16x16x32_bf16 v[112:115], a[208:211], a[164:167], v[112:115]
    ds_read_b64_tr_b16 v[238:239], v43 offset:12288
    v_mfma_f32_16x16x32_bf16 v[144:147], a[208:211], a[168:171], v[144:147]
    ds_read_b64_tr_b16 v[208:209], v44 offset:0
    v_mfma_f32_16x16x32_bf16 v[144:147], a[240:243], a[184:187], v[144:147]
    ds_read_b64_tr_b16 v[210:211], v44 offset:4096
    v_mfma_f32_16x16x32_bf16 v[176:179], a[240:243], a[188:191], v[176:179]
    ds_read_b64_tr_b16 v[240:241], v44 offset:8192
    v_mfma_f32_16x16x32_bf16 v[176:179], a[208:211], a[172:175], v[176:179]
    s_xor_b32 s36, s52, 49152
    buffer_load_dwordx4 a[32:35], v26, s[20:23], s36 offen offset:0 sc1
    v_mfma_f32_16x16x32_bf16 v[180:183], a[212:215], a[172:175], v[180:183]
    ds_read_b64_tr_b16 v[242:243], v44 offset:12288
    v_mfma_f32_16x16x32_bf16 v[180:183], a[244:247], a[188:191], v[180:183]
    ds_read_b64_tr_b16 v[212:213], v45 offset:0
    v_mfma_f32_16x16x32_bf16 v[148:151], a[244:247], a[184:187], v[148:151]
    ds_read_b64_tr_b16 v[214:215], v45 offset:4096
    v_mfma_f32_16x16x32_bf16 v[148:151], a[212:215], a[168:171], v[148:151]
    s_xor_b32 s36, s52, 49152
    buffer_load_dwordx4 a[48:51], v26, s[20:23], s36 offen offset:1024 sc1
    v_mfma_f32_16x16x32_bf16 v[116:119], a[212:215], a[164:167], v[116:119]
    ds_read_b64_tr_b16 v[244:245], v45 offset:8192
    v_mfma_f32_16x16x32_bf16 v[116:119], a[244:247], a[180:183], v[116:119]
    ds_read_b64_tr_b16 v[246:247], v45 offset:12288
    v_mfma_f32_16x16x32_bf16 v[84:87], a[244:247], a[176:179], v[84:87]
    ds_read_b64_tr_b16 v[216:217], v46 offset:0
    v_mfma_f32_16x16x32_bf16 v[84:87], a[212:215], a[160:163], v[84:87]
    ds_read_b64_tr_b16 v[218:219], v46 offset:4096
    v_mfma_f32_16x16x32_bf16 v[88:91], a[216:219], a[160:163], v[88:91]
    s_xor_b32 s37, s52, 180224
    buffer_load_dwordx4 a[36:39], v26, s[20:23], s37 offen offset:0 sc1
    v_mfma_f32_16x16x32_bf16 v[88:91], a[248:251], a[176:179], v[88:91]
    ds_read_b64_tr_b16 v[248:249], v46 offset:8192
    v_mfma_f32_16x16x32_bf16 v[120:123], a[248:251], a[180:183], v[120:123]
    ds_read_b64_tr_b16 v[250:251], v46 offset:12288
    v_mfma_f32_16x16x32_bf16 v[120:123], a[216:219], a[164:167], v[120:123]
    ds_read_b64_tr_b16 v[220:221], v47 offset:0
    v_mfma_f32_16x16x32_bf16 v[152:155], a[216:219], a[168:171], v[152:155]
    s_xor_b32 s37, s52, 180224
    buffer_load_dwordx4 a[52:55], v26, s[20:23], s37 offen offset:1024 sc1
    v_mfma_f32_16x16x32_bf16 v[152:155], a[248:251], a[184:187], v[152:155]
    ds_read_b64_tr_b16 v[222:223], v47 offset:4096
    v_mfma_f32_16x16x32_bf16 v[184:187], a[248:251], a[188:191], v[184:187]
    ds_read_b64_tr_b16 v[252:253], v47 offset:8192
    v_mfma_f32_16x16x32_bf16 v[184:187], a[216:219], a[172:175], v[184:187]
    ds_read_b64_tr_b16 v[254:255], v47 offset:12288
    v_mfma_f32_16x16x32_bf16 v[188:191], a[220:223], a[172:175], v[188:191]
    v_mfma_f32_16x16x32_bf16 v[188:191], a[252:255], a[188:191], v[188:191]
    s_xor_b32 s36, s52, 311296
    buffer_load_dwordx4 a[40:43], v26, s[20:23], s36 offen offset:0 sc1
    v_mfma_f32_16x16x32_bf16 v[156:159], a[252:255], a[184:187], v[156:159]
    v_mfma_f32_16x16x32_bf16 v[156:159], a[220:223], a[168:171], v[156:159]
    v_mfma_f32_16x16x32_bf16 v[124:127], a[220:223], a[164:167], v[124:127]
    v_mfma_f32_16x16x32_bf16 v[124:127], a[252:255], a[180:183], v[124:127]
    s_xor_b32 s36, s52, 311296
    buffer_load_dwordx4 a[56:59], v26, s[20:23], s36 offen offset:1024 sc1
    v_mfma_f32_16x16x32_bf16 v[92:95], a[252:255], a[176:179], v[92:95]
    v_mfma_f32_16x16x32_bf16 v[92:95], a[220:223], a[160:163], v[92:95]
    s_waitcnt vmcnt(6) lgkmcnt(0)
    v_mfma_f32_16x16x32_bf16 v[64:67], v[192:195], a[0:3], v[64:67]
    s_barrier
    v_mfma_f32_16x16x32_bf16 v[64:67], v[224:227], a[16:19], v[64:67]
    ds_read_b64_tr_b16 a[192:193], v40 offset:32768
    v_mfma_f32_16x16x32_bf16 v[96:99], v[224:227], a[20:23], v[96:99]
    v_mfma_f32_16x16x32_bf16 v[96:99], v[192:195], a[4:7], v[96:99]
    s_xor_b32 s37, s52, 442368
    buffer_load_dwordx4 a[44:47], v26, s[20:23], s37 offen offset:0 sc1
    v_mfma_f32_16x16x32_bf16 v[128:131], v[192:195], a[8:11], v[128:131]
    ds_read_b64_tr_b16 a[194:195], v40 offset:36864
    v_mfma_f32_16x16x32_bf16 v[128:131], v[224:227], a[24:27], v[128:131]
    v_mfma_f32_16x16x32_bf16 v[160:163], v[224:227], a[28:31], v[160:163]
    ds_read_b64_tr_b16 a[224:225], v40 offset:40960
    v_mfma_f32_16x16x32_bf16 v[160:163], v[192:195], a[12:15], v[160:163]
    s_xor_b32 s37, s52, 442368
    buffer_load_dwordx4 a[60:63], v26, s[20:23], s37 offen offset:1024 sc1
    v_mfma_f32_16x16x32_bf16 v[164:167], v[196:199], a[12:15], v[164:167]
    v_mfma_f32_16x16x32_bf16 v[164:167], v[228:231], a[28:31], v[164:167]
    ds_read_b64_tr_b16 a[226:227], v40 offset:45056
    v_mfma_f32_16x16x32_bf16 v[132:135], v[228:231], a[24:27], v[132:135]
    v_mfma_f32_16x16x32_bf16 v[132:135], v[196:199], a[8:11], v[132:135]
    ds_read_b64_tr_b16 a[196:197], v41 offset:32768
    v_mfma_f32_16x16x32_bf16 v[100:103], v[196:199], a[4:7], v[100:103]
    s_mov_b32 s38, 4096
    buffer_load_dwordx4 a[64:67], v31, s[56:59], s38 offen sc1
    v_mfma_f32_16x16x32_bf16 v[100:103], v[228:231], a[20:23], v[100:103]
    v_mfma_f32_16x16x32_bf16 v[68:71], v[228:231], a[16:19], v[68:71]
    ds_read_b64_tr_b16 a[198:199], v41 offset:36864
    v_mfma_f32_16x16x32_bf16 v[68:71], v[196:199], a[0:3], v[68:71]
    v_mfma_f32_16x16x32_bf16 v[72:75], v[200:203], a[0:3], v[72:75]
    s_mov_b32 s38, 16384
    buffer_load_dwordx4 a[68:71], v31, s[56:59], s38 offen sc1
    v_mfma_f32_16x16x32_bf16 v[72:75], v[232:235], a[16:19], v[72:75]
    ds_read_b64_tr_b16 a[228:229], v41 offset:40960
    v_mfma_f32_16x16x32_bf16 v[104:107], v[232:235], a[20:23], v[104:107]
    v_mfma_f32_16x16x32_bf16 v[104:107], v[200:203], a[4:7], v[104:107]
    ds_read_b64_tr_b16 a[230:231], v41 offset:45056
    v_mfma_f32_16x16x32_bf16 v[136:139], v[200:203], a[8:11], v[136:139]
    v_mfma_f32_16x16x32_bf16 v[136:139], v[232:235], a[24:27], v[136:139]
    s_mov_b32 s38, 28672
    buffer_load_dwordx4 a[72:75], v31, s[56:59], s38 offen sc1
    v_mfma_f32_16x16x32_bf16 v[168:171], v[232:235], a[28:31], v[168:171]
    ds_read_b64_tr_b16 a[200:201], v42 offset:32768
    v_mfma_f32_16x16x32_bf16 v[168:171], v[200:203], a[12:15], v[168:171]
    v_mfma_f32_16x16x32_bf16 v[172:175], v[204:207], a[12:15], v[172:175]
    ds_read_b64_tr_b16 a[202:203], v42 offset:36864
    v_mfma_f32_16x16x32_bf16 v[172:175], v[236:239], a[28:31], v[172:175]
    s_mov_b32 s38, 40960
    buffer_load_dwordx4 a[76:79], v31, s[56:59], s38 offen sc1
    v_mfma_f32_16x16x32_bf16 v[140:143], v[236:239], a[24:27], v[140:143]
    v_mfma_f32_16x16x32_bf16 v[140:143], v[204:207], a[8:11], v[140:143]
    ds_read_b64_tr_b16 a[232:233], v42 offset:40960
    v_mfma_f32_16x16x32_bf16 v[108:111], v[204:207], a[4:7], v[108:111]
    v_mfma_f32_16x16x32_bf16 v[108:111], v[236:239], a[20:23], v[108:111]
    ds_read_b64_tr_b16 a[234:235], v42 offset:45056
    v_mfma_f32_16x16x32_bf16 v[76:79], v[236:239], a[16:19], v[76:79]
    s_mov_b32 s38, 8192
    buffer_load_dwordx4 a[80:83], v31, s[56:59], s38 offen sc1
    v_mfma_f32_16x16x32_bf16 v[76:79], v[204:207], a[0:3], v[76:79]
    ds_read_b64_tr_b16 a[204:205], v43 offset:32768
    v_mfma_f32_16x16x32_bf16 v[80:83], v[208:211], a[0:3], v[80:83]
    ds_read_b64_tr_b16 a[206:207], v43 offset:36864
    v_mfma_f32_16x16x32_bf16 v[80:83], v[240:243], a[16:19], v[80:83]
    ds_read_b64_tr_b16 a[236:237], v43 offset:40960
    v_mfma_f32_16x16x32_bf16 v[112:115], v[240:243], a[20:23], v[112:115]
    s_mov_b32 s38, 20480
    buffer_load_dwordx4 a[84:87], v31, s[56:59], s38 offen sc1
    v_mfma_f32_16x16x32_bf16 v[112:115], v[208:211], a[4:7], v[112:115]
    ds_read_b64_tr_b16 a[238:239], v43 offset:45056
    v_mfma_f32_16x16x32_bf16 v[144:147], v[208:211], a[8:11], v[144:147]
    ds_read_b64_tr_b16 a[208:209], v44 offset:32768
    v_mfma_f32_16x16x32_bf16 v[144:147], v[240:243], a[24:27], v[144:147]
    ds_read_b64_tr_b16 a[210:211], v44 offset:36864
    v_mfma_f32_16x16x32_bf16 v[176:179], v[240:243], a[28:31], v[176:179]
    ds_read_b64_tr_b16 a[240:241], v44 offset:40960
    v_mfma_f32_16x16x32_bf16 v[176:179], v[208:211], a[12:15], v[176:179]
    s_mov_b32 s38, 32768
    buffer_load_dwordx4 a[88:91], v31, s[56:59], s38 offen sc1
    v_mfma_f32_16x16x32_bf16 v[180:183], v[212:215], a[12:15], v[180:183]
    ds_read_b64_tr_b16 a[242:243], v44 offset:45056
    v_mfma_f32_16x16x32_bf16 v[180:183], v[244:247], a[28:31], v[180:183]
    ds_read_b64_tr_b16 a[212:213], v45 offset:32768
    v_mfma_f32_16x16x32_bf16 v[148:151], v[244:247], a[24:27], v[148:151]
    ds_read_b64_tr_b16 a[214:215], v45 offset:36864
    v_mfma_f32_16x16x32_bf16 v[148:151], v[212:215], a[8:11], v[148:151]
    s_mov_b32 s38, 45056
    buffer_load_dwordx4 a[92:95], v31, s[56:59], s38 offen sc1
    v_mfma_f32_16x16x32_bf16 v[116:119], v[212:215], a[4:7], v[116:119]
    ds_read_b64_tr_b16 a[244:245], v45 offset:40960
    v_mfma_f32_16x16x32_bf16 v[116:119], v[244:247], a[20:23], v[116:119]
    ds_read_b64_tr_b16 a[246:247], v45 offset:45056
    v_mfma_f32_16x16x32_bf16 v[84:87], v[244:247], a[16:19], v[84:87]
    ds_read_b64_tr_b16 a[216:217], v46 offset:32768
    v_mfma_f32_16x16x32_bf16 v[84:87], v[212:215], a[0:3], v[84:87]
    ds_read_b64_tr_b16 a[218:219], v46 offset:36864
    v_mfma_f32_16x16x32_bf16 v[88:91], v[216:219], a[0:3], v[88:91]
    buffer_load_dwordx2 v[48:49], v25, s[28:31], 0 offen offset:0
    v_mfma_f32_16x16x32_bf16 v[88:91], v[248:251], a[16:19], v[88:91]
    ds_read_b64_tr_b16 a[248:249], v46 offset:40960
    v_mfma_f32_16x16x32_bf16 v[120:123], v[248:251], a[20:23], v[120:123]
    ds_read_b64_tr_b16 a[250:251], v46 offset:45056
    v_mfma_f32_16x16x32_bf16 v[120:123], v[216:219], a[4:7], v[120:123]
    ds_read_b64_tr_b16 a[220:221], v47 offset:32768
    v_mfma_f32_16x16x32_bf16 v[152:155], v[216:219], a[8:11], v[152:155]
    buffer_load_dwordx2 v[50:51], v25, s[28:31], 0 offen offset:32
    v_mfma_f32_16x16x32_bf16 v[152:155], v[248:251], a[24:27], v[152:155]
    ds_read_b64_tr_b16 a[222:223], v47 offset:36864
    v_mfma_f32_16x16x32_bf16 v[184:187], v[248:251], a[28:31], v[184:187]
    ds_read_b64_tr_b16 a[252:253], v47 offset:40960
    v_mfma_f32_16x16x32_bf16 v[184:187], v[216:219], a[12:15], v[184:187]
    ds_read_b64_tr_b16 a[254:255], v47 offset:45056
    v_mfma_f32_16x16x32_bf16 v[188:191], v[220:223], a[12:15], v[188:191]
    v_mfma_f32_16x16x32_bf16 v[188:191], v[252:255], a[28:31], v[188:191]
    buffer_load_dwordx2 v[52:53], v25, s[28:31], 0 offen offset:512
    v_mfma_f32_16x16x32_bf16 v[156:159], v[252:255], a[24:27], v[156:159]
    v_mfma_f32_16x16x32_bf16 v[156:159], v[220:223], a[8:11], v[156:159]
    v_mfma_f32_16x16x32_bf16 v[124:127], v[220:223], a[4:7], v[124:127]
    v_mfma_f32_16x16x32_bf16 v[124:127], v[252:255], a[20:23], v[124:127]
    buffer_load_dwordx2 v[54:55], v25, s[28:31], 0 offen offset:544
    v_mfma_f32_16x16x32_bf16 v[92:95], v[252:255], a[16:19], v[92:95]
    v_mfma_f32_16x16x32_bf16 v[92:95], v[220:223], a[0:3], v[92:95]
    s_waitcnt vmcnt(12) lgkmcnt(0)
    v_mfma_f32_16x16x32_bf16 v[128:131], a[192:195], a[40:43], v[128:131]
    s_mov_b32 s36, 0
    s_mov_b32 s37, 16384
    v_mfma_f32_16x16x32_bf16 v[128:131], a[224:227], a[56:59], v[128:131]
    v_mfma_f32_16x16x32_bf16 v[132:135], a[228:231], a[56:59], v[132:135]
    v_mfma_f32_16x16x32_bf16 v[132:135], a[196:199], a[40:43], v[132:135]
    v_mfma_f32_16x16x32_bf16 v[136:139], a[200:203], a[40:43], v[136:139]
    v_mfma_f32_16x16x32_bf16 v[136:139], a[232:235], a[56:59], v[136:139]
    v_mfma_f32_16x16x32_bf16 v[140:143], a[236:239], a[56:59], v[140:143]
    v_mfma_f32_16x16x32_bf16 v[140:143], a[204:207], a[40:43], v[140:143]
    v_mfma_f32_16x16x32_bf16 v[144:147], a[208:211], a[40:43], v[144:147]
    v_mfma_f32_16x16x32_bf16 v[144:147], a[240:243], a[56:59], v[144:147]
    ds_write_b128 v8, v[128:131] offset:0
    v_mfma_f32_16x16x32_bf16 v[148:151], a[244:247], a[56:59], v[148:151]
    v_mfma_f32_16x16x32_bf16 v[148:151], a[212:215], a[40:43], v[148:151]
    v_mfma_f32_16x16x32_bf16 v[152:155], a[216:219], a[40:43], v[152:155]
    ds_write_b128 v8, v[132:135] offset:1024
    v_mfma_f32_16x16x32_bf16 v[152:155], a[248:251], a[56:59], v[152:155]
    v_mfma_f32_16x16x32_bf16 v[156:159], a[252:255], a[56:59], v[156:159]
    v_mfma_f32_16x16x32_bf16 v[156:159], a[220:223], a[40:43], v[156:159]
    ds_write_b128 v8, v[136:139] offset:2048
    v_mfma_f32_16x16x32_bf16 v[188:191], a[220:223], a[44:47], v[188:191]
    v_mfma_f32_16x16x32_bf16 v[188:191], a[252:255], a[60:63], v[188:191]
    v_mfma_f32_16x16x32_bf16 v[184:187], a[248:251], a[60:63], v[184:187]
    ds_write_b128 v8, v[140:143] offset:3072
    v_mfma_f32_16x16x32_bf16 v[184:187], a[216:219], a[44:47], v[184:187]
    v_mfma_f32_16x16x32_bf16 v[180:183], a[212:215], a[44:47], v[180:183]
    v_mfma_f32_16x16x32_bf16 v[180:183], a[244:247], a[60:63], v[180:183]
    ds_write_b128 v8, v[144:147] offset:4096
    v_mfma_f32_16x16x32_bf16 v[176:179], a[240:243], a[60:63], v[176:179]
    v_mfma_f32_16x16x32_bf16 v[176:179], a[208:211], a[44:47], v[176:179]
    v_mfma_f32_16x16x32_bf16 v[172:175], a[204:207], a[44:47], v[172:175]
    ds_write_b128 v8, v[148:151] offset:5120
    v_mfma_f32_16x16x32_bf16 v[172:175], a[236:239], a[60:63], v[172:175]
    v_mfma_f32_16x16x32_bf16 v[168:171], a[232:235], a[60:63], v[168:171]
    v_mfma_f32_16x16x32_bf16 v[168:171], a[200:203], a[44:47], v[168:171]
    ds_write_b128 v8, v[152:155] offset:6144
    v_mfma_f32_16x16x32_bf16 v[164:167], a[196:199], a[44:47], v[164:167]
    v_mfma_f32_16x16x32_bf16 v[164:167], a[228:231], a[60:63], v[164:167]
    v_mfma_f32_16x16x32_bf16 v[160:163], a[224:227], a[60:63], v[160:163]
    ds_write_b128 v8, v[156:159] offset:7168
    v_mfma_f32_16x16x32_bf16 v[160:163], a[192:195], a[44:47], v[160:163]
    v_mfma_f32_16x16x32_bf16 v[64:67], a[192:195], a[32:35], v[64:67]
    v_mfma_f32_16x16x32_bf16 v[64:67], a[224:227], a[48:51], v[64:67]
    ds_write_b128 v8, v[188:191] offset:15360
    v_mfma_f32_16x16x32_bf16 v[68:71], a[228:231], a[48:51], v[68:71]
    v_mfma_f32_16x16x32_bf16 v[68:71], a[196:199], a[32:35], v[68:71]
    v_mfma_f32_16x16x32_bf16 v[72:75], a[200:203], a[32:35], v[72:75]
    ds_write_b128 v8, v[184:187] offset:14336
    v_mfma_f32_16x16x32_bf16 v[72:75], a[232:235], a[48:51], v[72:75]
    v_mfma_f32_16x16x32_bf16 v[76:79], a[236:239], a[48:51], v[76:79]
    v_mfma_f32_16x16x32_bf16 v[76:79], a[204:207], a[32:35], v[76:79]
    ds_write_b128 v8, v[180:183] offset:13312
    v_mfma_f32_16x16x32_bf16 v[80:83], a[208:211], a[32:35], v[80:83]
    v_mfma_f32_16x16x32_bf16 v[80:83], a[240:243], a[48:51], v[80:83]
    v_mfma_f32_16x16x32_bf16 v[84:87], a[244:247], a[48:51], v[84:87]
    ds_write_b128 v8, v[176:179] offset:12288
    v_mfma_f32_16x16x32_bf16 v[84:87], a[212:215], a[32:35], v[84:87]
    v_mfma_f32_16x16x32_bf16 v[88:91], a[216:219], a[32:35], v[88:91]
    v_mfma_f32_16x16x32_bf16 v[88:91], a[248:251], a[48:51], v[88:91]
    ds_write_b128 v8, v[172:175] offset:11264
    v_mfma_f32_16x16x32_bf16 v[92:95], a[252:255], a[48:51], v[92:95]
    v_mfma_f32_16x16x32_bf16 v[92:95], a[220:223], a[32:35], v[92:95]
    v_mfma_f32_16x16x32_bf16 v[124:127], a[220:223], a[36:39], v[124:127]
    ds_write_b128 v8, v[168:171] offset:10240
    v_mfma_f32_16x16x32_bf16 v[124:127], a[252:255], a[52:55], v[124:127]
    v_mfma_f32_16x16x32_bf16 v[120:123], a[248:251], a[52:55], v[120:123]
    v_mfma_f32_16x16x32_bf16 v[120:123], a[216:219], a[36:39], v[120:123]
    ds_write_b128 v8, v[164:167] offset:9216
    v_mfma_f32_16x16x32_bf16 v[116:119], a[212:215], a[36:39], v[116:119]
    v_mfma_f32_16x16x32_bf16 v[116:119], a[244:247], a[52:55], v[116:119]
    v_mfma_f32_16x16x32_bf16 v[112:115], a[240:243], a[52:55], v[112:115]
    ds_write_b128 v8, v[160:163] offset:8192
    v_mfma_f32_16x16x32_bf16 v[112:115], a[208:211], a[36:39], v[112:115]
    v_mfma_f32_16x16x32_bf16 v[108:111], a[204:207], a[36:39], v[108:111]
    v_mfma_f32_16x16x32_bf16 v[108:111], a[236:239], a[52:55], v[108:111]
    v_mfma_f32_16x16x32_bf16 v[104:107], a[232:235], a[52:55], v[104:107]
    v_mfma_f32_16x16x32_bf16 v[104:107], a[200:203], a[36:39], v[104:107]
    v_mfma_f32_16x16x32_bf16 v[100:103], a[196:199], a[36:39], v[100:103]
    v_mfma_f32_16x16x32_bf16 v[100:103], a[228:231], a[52:55], v[100:103]
    v_mfma_f32_16x16x32_bf16 v[96:99], a[224:227], a[52:55], v[96:99]
    v_mfma_f32_16x16x32_bf16 v[96:99], a[192:195], a[36:39], v[96:99]
    s_waitcnt lgkmcnt(0)
    s_barrier
    ds_read_b128 v[128:131], v9 offset:0
    ds_read_b128 v[132:135], v9 offset:1024
    ds_read_b128 v[136:139], v9 offset:2048
    ds_read_b128 v[140:143], v9 offset:3072
    ds_read_b128 v[144:147], v9 offset:4096
    ds_read_b128 v[148:151], v9 offset:5120
    ds_read_b128 v[152:155], v9 offset:6144
    ds_read_b128 v[156:159], v9 offset:7168
    ds_read_b128 v[160:163], v9 offset:8192
    ds_read_b128 v[164:167], v9 offset:9216
    ds_read_b128 v[168:171], v9 offset:10240
    ds_read_b128 v[172:175], v9 offset:11264
    ds_read_b128 v[176:179], v9 offset:12288
    ds_read_b128 v[180:183], v9 offset:13312
    ds_read_b128 v[184:187], v9 offset:14336
    ds_read_b128 v[188:191], v9 offset:15360
    s_waitcnt lgkmcnt(14)
    v_pk_add_f32 v[64:65], v[64:65], v[128:129]
    v_pk_add_f32 v[66:67], v[66:67], v[130:131]
    v_pk_add_f32 v[68:69], v[68:69], v[132:133]
    v_pk_add_f32 v[70:71], v[70:71], v[134:135]
    v_cvt_pk_bf16_f32 v192, v64, v65
    v_cvt_pk_bf16_f32 v193, v66, v67
    v_cvt_pk_bf16_f32 v194, v68, v69
    v_cvt_pk_bf16_f32 v195, v70, v71
    buffer_store_dwordx4 v[192:195], v26, s[16:19], s36 offen offset:0 sc1
    s_waitcnt lgkmcnt(12)
    v_pk_add_f32 v[72:73], v[72:73], v[136:137]
    v_pk_add_f32 v[74:75], v[74:75], v[138:139]
    v_pk_add_f32 v[76:77], v[76:77], v[140:141]
    v_pk_add_f32 v[78:79], v[78:79], v[142:143]
    v_cvt_pk_bf16_f32 v196, v72, v73
    v_cvt_pk_bf16_f32 v197, v74, v75
    v_cvt_pk_bf16_f32 v198, v76, v77
    v_cvt_pk_bf16_f32 v199, v78, v79
    buffer_store_dwordx4 v[196:199], v26, s[16:19], s36 offen offset:1024 sc1
    s_waitcnt lgkmcnt(10)
    v_pk_add_f32 v[80:81], v[80:81], v[144:145]
    v_pk_add_f32 v[82:83], v[82:83], v[146:147]
    v_pk_add_f32 v[84:85], v[84:85], v[148:149]
    v_pk_add_f32 v[86:87], v[86:87], v[150:151]
    v_cvt_pk_bf16_f32 v200, v80, v81
    v_cvt_pk_bf16_f32 v201, v82, v83
    v_cvt_pk_bf16_f32 v202, v84, v85
    v_cvt_pk_bf16_f32 v203, v86, v87
    buffer_store_dwordx4 v[200:203], v26, s[16:19], s36 offen offset:2048 sc1
    s_waitcnt lgkmcnt(8)
    v_pk_add_f32 v[88:89], v[88:89], v[152:153]
    v_pk_add_f32 v[90:91], v[90:91], v[154:155]
    v_pk_add_f32 v[92:93], v[92:93], v[156:157]
    v_pk_add_f32 v[94:95], v[94:95], v[158:159]
    v_cvt_pk_bf16_f32 v204, v88, v89
    v_cvt_pk_bf16_f32 v205, v90, v91
    v_cvt_pk_bf16_f32 v206, v92, v93
    v_cvt_pk_bf16_f32 v207, v94, v95
    buffer_store_dwordx4 v[204:207], v26, s[16:19], s36 offen offset:3072 sc1
    s_waitcnt lgkmcnt(6)
    v_pk_add_f32 v[96:97], v[96:97], v[160:161]
    v_pk_add_f32 v[98:99], v[98:99], v[162:163]
    v_pk_add_f32 v[100:101], v[100:101], v[164:165]
    v_pk_add_f32 v[102:103], v[102:103], v[166:167]
    v_cvt_pk_bf16_f32 v208, v96, v97
    v_cvt_pk_bf16_f32 v209, v98, v99
    v_cvt_pk_bf16_f32 v210, v100, v101
    v_cvt_pk_bf16_f32 v211, v102, v103
    buffer_store_dwordx4 v[208:211], v26, s[16:19], s37 offen offset:0 sc1
    s_waitcnt lgkmcnt(4)
    v_pk_add_f32 v[104:105], v[104:105], v[168:169]
    v_pk_add_f32 v[106:107], v[106:107], v[170:171]
    v_pk_add_f32 v[108:109], v[108:109], v[172:173]
    v_pk_add_f32 v[110:111], v[110:111], v[174:175]
    v_cvt_pk_bf16_f32 v212, v104, v105
    v_cvt_pk_bf16_f32 v213, v106, v107
    v_cvt_pk_bf16_f32 v214, v108, v109
    v_cvt_pk_bf16_f32 v215, v110, v111
    buffer_store_dwordx4 v[212:215], v26, s[16:19], s37 offen offset:1024 sc1
    s_waitcnt lgkmcnt(2)
    v_pk_add_f32 v[112:113], v[112:113], v[176:177]
    v_pk_add_f32 v[114:115], v[114:115], v[178:179]
    v_pk_add_f32 v[116:117], v[116:117], v[180:181]
    v_pk_add_f32 v[118:119], v[118:119], v[182:183]
    v_cvt_pk_bf16_f32 v216, v112, v113
    v_cvt_pk_bf16_f32 v217, v114, v115
    v_cvt_pk_bf16_f32 v218, v116, v117
    v_cvt_pk_bf16_f32 v219, v118, v119
    buffer_store_dwordx4 v[216:219], v26, s[16:19], s37 offen offset:2048 sc1
    s_waitcnt lgkmcnt(0)
    v_pk_add_f32 v[120:121], v[120:121], v[184:185]
    v_pk_add_f32 v[122:123], v[122:123], v[186:187]
    v_pk_add_f32 v[124:125], v[124:125], v[188:189]
    v_pk_add_f32 v[126:127], v[126:127], v[190:191]
    v_cvt_pk_bf16_f32 v220, v120, v121
    v_cvt_pk_bf16_f32 v221, v122, v123
    v_cvt_pk_bf16_f32 v222, v124, v125
    v_cvt_pk_bf16_f32 v223, v126, v127
    buffer_store_dwordx4 v[220:223], v26, s[16:19], s37 offen offset:3072 sc1
    s_add_u32 s20, s54, 0x1800000
    s_addc_u32 s21, s55, 0
    s_mov_b32 s22, 0x800000
    s_mov_b32 s23, 0x20000
    s_add_u32 s24, s54, 0x210000
    s_addc_u32 s25, s55, 0
    s_mov_b32 s26, 0x200000
    s_mov_b32 s27, 0x20000
    s_lshl_b32 s6, s33, 4
    s_add_u32 s6, s6, s34
    s_lshr_b32 s7, s6, 1
    s_lshl_b32 s7, s7, 14
    s_and_b32 s6, s6, 1
    s_lshl_b32 s6, s6, 7
    s_add_u32 s44, s7, s6
    s_waitcnt vmcnt(12)
    v_accvgpr_read_b32 v64, a64
    v_accvgpr_read_b32 v65, a65
    v_accvgpr_read_b32 v66, a66
    v_accvgpr_read_b32 v67, a67
    v_accvgpr_read_b32 v68, a68
    v_accvgpr_read_b32 v69, a69
    v_accvgpr_read_b32 v70, a70
    v_accvgpr_read_b32 v71, a71
    v_accvgpr_read_b32 v72, a72
    v_accvgpr_read_b32 v73, a73
    v_accvgpr_read_b32 v74, a74
    v_accvgpr_read_b32 v75, a75
    v_accvgpr_read_b32 v76, a76
    v_accvgpr_read_b32 v77, a77
    v_accvgpr_read_b32 v78, a78
    v_accvgpr_read_b32 v79, a79
    v_accvgpr_read_b32 v80, a80
    v_accvgpr_read_b32 v81, a81
    v_accvgpr_read_b32 v82, a82
    v_accvgpr_read_b32 v83, a83
    v_accvgpr_read_b32 v84, a84
    v_accvgpr_read_b32 v85, a85
    v_accvgpr_read_b32 v86, a86
    v_accvgpr_read_b32 v87, a87
    v_accvgpr_read_b32 v88, a88
    v_accvgpr_read_b32 v89, a89
    v_accvgpr_read_b32 v90, a90
    v_accvgpr_read_b32 v91, a91
    v_accvgpr_read_b32 v92, a92
    v_accvgpr_read_b32 v93, a93
    v_accvgpr_read_b32 v94, a94
    v_accvgpr_read_b32 v95, a95
    s_mov_b32 s6, 0
    s_cmp_lt_u32 s45, 2
    s_cselect_b32 s40, 1.0, 0
    v_add_u32 v31, 155648, v31
    v_pk_add_f32 v[64:65], v[64:65], v[68:69]
    v_pk_add_f32 v[72:73], v[72:73], v[76:77]
    v_pk_add_f32 v[66:67], v[66:67], v[70:71]
    v_pk_add_f32 v[74:75], v[74:75], v[78:79]
    v_pk_add_f32 v[64:65], v[64:65], v[72:73]
    v_pk_add_f32 v[66:67], v[66:67], v[74:75]
    v_cvt_pk_bf16_f32 v68, v64, v65
    v_cvt_pk_bf16_f32 v69, v66, v67
    v_lshlrev_b32 v64, 16, v68
    v_and_b32 v65, 0xffff0000, v68
    v_lshlrev_b32 v66, 16, v69
    v_and_b32 v67, 0xffff0000, v69
    v_add_f32 v64, s6, v64
    v_add_f32 v65, s6, v65
    v_add_f32 v66, s6, v66
    v_add_f32 v67, s6, v67
    v_cvt_pk_bf16_f32 v68, v64, v65
    v_cvt_pk_bf16_f32 v69, v66, v67
    v_lshlrev_b32 v64, 16, v68
    v_and_b32 v65, 0xffff0000, v68
    v_lshlrev_b32 v66, 16, v69
    v_and_b32 v67, 0xffff0000, v69
    v_pk_add_f32 v[80:81], v[80:81], v[84:85]
    v_pk_add_f32 v[88:89], v[88:89], v[92:93]
    v_pk_add_f32 v[82:83], v[82:83], v[86:87]
    v_pk_add_f32 v[90:91], v[90:91], v[94:95]
    v_pk_add_f32 v[80:81], v[80:81], v[88:89]
    v_pk_add_f32 v[82:83], v[82:83], v[90:91]
    v_cvt_pk_bf16_f32 v84, v80, v81
    v_cvt_pk_bf16_f32 v85, v82, v83
    v_lshlrev_b32 v80, 16, v84
    v_and_b32 v81, 0xffff0000, v84
    v_lshlrev_b32 v82, 16, v85
    v_and_b32 v83, 0xffff0000, v85
    v_add_f32 v80, s40, v80
    v_add_f32 v81, s40, v81
    v_add_f32 v82, s40, v82
    v_add_f32 v83, s40, v83
    v_cvt_pk_bf16_f32 v84, v80, v81
    v_cvt_pk_bf16_f32 v85, v82, v83
    v_lshlrev_b32 v80, 16, v84
    v_and_b32 v81, 0xffff0000, v84
    v_lshlrev_b32 v82, 16, v85
    v_and_b32 v83, 0xffff0000, v85
    ds_write_b128 v31, v[64:67]
    ds_write_b128 v31, v[80:83] offset:4096
    s_waitcnt lgkmcnt(0)
    s_lshl_b32 s63, s33, 11
    s_add_u32 s63, s63, 32768
    v_lshlrev_b32 v2, 3, v26
    s_lshl_b32 s6, s34, 2
    v_add_u32 v2, s6, v2
    v_mov_b32 v3, 0x5ac3e19b
    v_bfe_u32 v4, v26, 4, 4
    v_lshlrev_b32 v4, 2, v4
    s_lshl_b32 s6, s34, 7
    v_add_u32 v4, s6, v4
    s_waitcnt vmcnt(0)
    s_barrier
    s_cmp_eq_u32 s45, 1
    s_cbranch_scc0 k1_h1_a
    s_mov_b64 exec, 0xffff
    buffer_store_dword v3, v2, s[8:11], s63 offen sc1
    s_mov_b64 exec, -1
k1_h1_a:
    s_add_u32 m0, s35, 98304
    s_mov_b32 s42, 0
    buffer_load_dwordx4 v20, s[12:15], s42 offen offset:0 lds
    s_add_u32 m0, s35, 98304
    s_mov_b32 s42, 0
    buffer_load_dwordx4 v21, s[12:15], s42 offen offset:1024 lds
    s_add_u32 m0, s35, 98304
    s_mov_b32 s42, 0
    buffer_load_dwordx4 v22, s[12:15], s42 offen offset:2048 lds
    s_add_u32 m0, s35, 110592
    s_mov_b32 s42, 88064
    buffer_load_dwordx4 v20, s[12:15], s42 offen offset:0 lds
    s_add_u32 m0, s35, 110592
    s_mov_b32 s42, 88064
    buffer_load_dwordx4 v21, s[12:15], s42 offen offset:1024 lds
    s_add_u32 m0, s35, 110592
    s_mov_b32 s42, 88064
    buffer_load_dwordx4 v22, s[12:15], s42 offen offset:2048 lds
    s_add_u32 m0, s35, 122880
    s_mov_b32 s42, 176128
    buffer_load_dwordx4 v20, s[12:15], s42 offen offset:0 lds
    s_add_u32 m0, s35, 122880
    s_mov_b32 s42, 176128
    buffer_load_dwordx4 v21, s[12:15], s42 offen offset:1024 lds
    s_add_u32 m0, s35, 122880
    s_mov_b32 s42, 176128
    buffer_load_dwordx4 v22, s[12:15], s42 offen offset:2048 lds
    s_mov_b32 s7, 0
    s_mov_b32 s46, 0
k1_pg:
    buffer_load_dword v3, v4, s[8:11], s63 offen sc1
    s_waitcnt vmcnt(0)
    v_cmp_eq_u32 vcc, 0x5ac3e19b, v3
    s_add_u32 s7, s7, 1
    s_cmp_ge_u32 s7, 0x10000
    s_cselect_b32 s47, -1, vcc_lo
    s_andn2_b32 s47, s47, s46
    s_bfe_u32 s6, s47, 262144
    s_cmp_eq_u32 s6, 15
    s_cbranch_scc0 k1_pg0
    s_or_b32 s46, s46, 0xf
    s_add_u32 s6, s44, 0
    buffer_load_dwordx4 v[64:67], v24, s[20:23], s6 offen sc1
    s_add_u32 s6, s44, 8192
    buffer_load_dwordx4 v[68:71], v24, s[20:23], s6 offen sc1
k1_pg0:
    s_bfe_u32 s6, s47, 262148
    s_cmp_eq_u32 s6, 15
    s_cbranch_scc0 k1_pg1
    s_or_b32 s46, s46, 0xf0
    s_add_u32 s6, s44, 2097152
    buffer_load_dwordx4 v[72:75], v24, s[20:23], s6 offen sc1
    s_add_u32 s6, s44, 2105344
    buffer_load_dwordx4 v[76:79], v24, s[20:23], s6 offen sc1
k1_pg1:
    s_bfe_u32 s6, s47, 262152
    s_cmp_eq_u32 s6, 15
    s_cbranch_scc0 k1_pg2
    s_or_b32 s46, s46, 0xf00
    s_add_u32 s6, s44, 4194304
    buffer_load_dwordx4 v[80:83], v24, s[20:23], s6 offen sc1
    s_add_u32 s6, s44, 4202496
    buffer_load_dwordx4 v[84:87], v24, s[20:23], s6 offen sc1
k1_pg2:
    s_bfe_u32 s6, s47, 262156
    s_cmp_eq_u32 s6, 15
    s_cbranch_scc0 k1_pg3
    s_or_b32 s46, s46, 0xf000
    s_add_u32 s6, s44, 6291456
    buffer_load_dwordx4 v[88:91], v24, s[20:23], s6 offen sc1
    s_add_u32 s6, s44, 6299648
    buffer_load_dwordx4 v[92:95], v24, s[20:23], s6 offen sc1
k1_pg3:
    s_cmp_lg_u32 s46, 65535
    s_cbranch_scc1 k1_pg
    s_add_u32 s16, s54, 0x410000
    s_addc_u32 s17, s55, 0
    s_mov_b32 s18, 0x200000
    s_mov_b32 s19, 0x20000
    s_add_u32 s40, s44, 8192
    ds_read_b128 v[96:99], v28 offset:0
    ds_read_b128 v[100:103], v28 offset:64
    ds_read_b128 v[104:107], v28 offset:1024
    ds_read_b128 v[108:111], v28 offset:1088
    ds_read_b128 v[112:115], v28 offset:2048
    ds_read_b128 v[116:119], v28 offset:2112
    ds_read_b128 v[120:123], v28 offset:3072
    ds_read_b128 v[124:127], v28 offset:3136
    ds_read_b128 v[128:131], v28 offset:4096
    ds_read_b128 v[132:135], v28 offset:4160
    ds_read_b128 v[136:139], v28 offset:5120
    ds_read_b128 v[140:143], v28 offset:5184
    s_add_u32 m0, s35, 135168
    s_mov_b32 s42, 264192
    buffer_load_dwordx4 v20, s[12:15], s42 offen offset:0 lds
    s_add_u32 m0, s35, 135168
    s_mov_b32 s42, 264192
    buffer_load_dwordx4 v21, s[12:15], s42 offen offset:1024 lds
    s_add_u32 m0, s35, 135168
    s_mov_b32 s42, 264192
    buffer_load_dwordx4 v22, s[12:15], s42 offen offset:2048 lds
    s_add_u32 m0, s35, 0
    s_mov_b32 s42, 352256
    buffer_load_dwordx4 v20, s[12:15], s42 offen offset:0 lds
    s_add_u32 m0, s35, 0
    s_mov_b32 s42, 352256
    buffer_load_dwordx4 v21, s[12:15], s42 offen offset:1024 lds
    s_add_u32 m0, s35, 0
    s_mov_b32 s42, 352256
    buffer_load_dwordx4 v22, s[12:15], s42 offen offset:2048 lds
    s_add_u32 m0, s35, 12288
    s_mov_b32 s42, 440320
    buffer_load_dwordx4 v20, s[12:15], s42 offen offset:0 lds
    s_add_u32 m0, s35, 12288
    s_mov_b32 s42, 440320
    buffer_load_dwordx4 v21, s[12:15], s42 offen offset:1024 lds
    s_add_u32 m0, s35, 12288
    s_mov_b32 s42, 440320
    buffer_load_dwordx4 v22, s[12:15], s42 offen offset:2048 lds
    s_add_u32 m0, s35, 24576
    s_mov_b32 s42, 528384
    buffer_load_dwordx4 v20, s[12:15], s42 offen offset:0 lds
    s_add_u32 m0, s35, 24576
    s_mov_b32 s42, 528384
    buffer_load_dwordx4 v21, s[12:15], s42 offen offset:1024 lds
    s_add_u32 m0, s35, 24576
    s_mov_b32 s42, 528384
    buffer_load_dwordx4 v22, s[12:15], s42 offen offset:2048 lds
    v_lshlrev_b32 v168, 16, v48
    v_and_b32 v169, 0xffff0000, v48
    v_lshlrev_b32 v170, 16, v49
    v_and_b32 v171, 0xffff0000, v49
    v_lshlrev_b32 v172, 16, v50
    v_and_b32 v173, 0xffff0000, v50
    v_lshlrev_b32 v174, 16, v51
    v_and_b32 v175, 0xffff0000, v51
    v_lshlrev_b32 v176, 16, v52
    v_and_b32 v177, 0xffff0000, v52
    v_lshlrev_b32 v178, 16, v53
    v_and_b32 v179, 0xffff0000, v53
    v_lshlrev_b32 v180, 16, v54
    v_and_b32 v181, 0xffff0000, v54
    v_lshlrev_b32 v182, 16, v55
    v_and_b32 v183, 0xffff0000, v55
    s_waitcnt vmcnt(12)
    v_lshlrev_b32 v144, 16, v64
    v_and_b32 v145, 0xffff0000, v64
    v_lshlrev_b32 v146, 16, v65
    v_and_b32 v147, 0xffff0000, v65
    v_lshlrev_b32 v148, 16, v66
    v_and_b32 v149, 0xffff0000, v66
    v_lshlrev_b32 v150, 16, v67
    v_and_b32 v151, 0xffff0000, v67
    v_lshlrev_b32 v152, 16, v68
    v_and_b32 v153, 0xffff0000, v68
    v_lshlrev_b32 v154, 16, v69
    v_and_b32 v155, 0xffff0000, v69
    v_lshlrev_b32 v156, 16, v70
    v_and_b32 v157, 0xffff0000, v70
    v_lshlrev_b32 v158, 16, v71
    v_and_b32 v159, 0xffff0000, v71
    v_lshlrev_b32 v160, 16, v72
    v_and_b32 v161, 0xffff0000, v72
    v_pk_add_f32 v[144:145], v[144:145], v[160:161]
    v_lshlrev_b32 v162, 16, v73
    v_and_b32 v163, 0xffff0000, v73
    v_pk_add_f32 v[146:147], v[146:147], v[162:163]
    v_lshlrev_b32 v164, 16, v74
    v_and_b32 v165, 0xffff0000, v74
    v_pk_add_f32 v[148:149], v[148:149], v[164:165]
    v_lshlrev_b32 v166, 16, v75
    v_and_b32 v167, 0xffff0000, v75
    v_pk_add_f32 v[150:151], v[150:151], v[166:167]
    v_lshlrev_b32 v160, 16, v76
    v_and_b32 v161, 0xffff0000, v76
    v_pk_add_f32 v[152:153], v[152:153], v[160:161]
    v_lshlrev_b32 v162, 16, v77
    v_and_b32 v163, 0xffff0000, v77
    v_pk_add_f32 v[154:155], v[154:155], v[162:163]
    v_lshlrev_b32 v164, 16, v78
    v_and_b32 v165, 0xffff0000, v78
    v_pk_add_f32 v[156:157], v[156:157], v[164:165]
    v_lshlrev_b32 v166, 16, v79
    v_and_b32 v167, 0xffff0000, v79
    v_pk_add_f32 v[158:159], v[158:159], v[166:167]
    v_lshlrev_b32 v160, 16, v80
    v_and_b32 v161, 0xffff0000, v80
    v_pk_add_f32 v[144:145], v[144:145], v[160:161]
    v_lshlrev_b32 v162, 16, v81
    v_and_b32 v163, 0xffff0000, v81
    v_pk_add_f32 v[146:147], v[146:147], v[162:163]
    v_lshlrev_b32 v164, 16, v82
    v_and_b32 v165, 0xffff0000, v82
    v_pk_add_f32 v[148:149], v[148:149], v[164:165]
    v_lshlrev_b32 v166, 16, v83
    v_and_b32 v167, 0xffff0000, v83
    v_pk_add_f32 v[150:151], v[150:151], v[166:167]
    v_lshlrev_b32 v160, 16, v84
    v_and_b32 v161, 0xffff0000, v84
    v_pk_add_f32 v[152:153], v[152:153], v[160:161]
    v_lshlrev_b32 v162, 16, v85
    v_and_b32 v163, 0xffff0000, v85
    v_pk_add_f32 v[154:155], v[154:155], v[162:163]
    v_lshlrev_b32 v164, 16, v86
    v_and_b32 v165, 0xffff0000, v86
    v_pk_add_f32 v[156:157], v[156:157], v[164:165]
    v_lshlrev_b32 v166, 16, v87
    v_and_b32 v167, 0xffff0000, v87
    v_pk_add_f32 v[158:159], v[158:159], v[166:167]
    v_lshlrev_b32 v160, 16, v88
    v_and_b32 v161, 0xffff0000, v88
    v_pk_add_f32 v[144:145], v[144:145], v[160:161]
    v_lshlrev_b32 v162, 16, v89
    v_and_b32 v163, 0xffff0000, v89
    v_pk_add_f32 v[146:147], v[146:147], v[162:163]
    v_lshlrev_b32 v164, 16, v90
    v_and_b32 v165, 0xffff0000, v90
    v_pk_add_f32 v[148:149], v[148:149], v[164:165]
    v_lshlrev_b32 v166, 16, v91
    v_and_b32 v167, 0xffff0000, v91
    v_pk_add_f32 v[150:151], v[150:151], v[166:167]
    v_lshlrev_b32 v160, 16, v92
    v_and_b32 v161, 0xffff0000, v92
    v_pk_add_f32 v[152:153], v[152:153], v[160:161]
    v_lshlrev_b32 v162, 16, v93
    v_and_b32 v163, 0xffff0000, v93
    v_pk_add_f32 v[154:155], v[154:155], v[162:163]
    v_lshlrev_b32 v164, 16, v94
    v_and_b32 v165, 0xffff0000, v94
    v_pk_add_f32 v[156:157], v[156:157], v[164:165]
    v_lshlrev_b32 v166, 16, v95
    v_and_b32 v167, 0xffff0000, v95
    v_pk_add_f32 v[158:159], v[158:159], v[166:167]
    s_waitcnt lgkmcnt(0)
    v_pk_fma_f32 v[144:145], v[144:145], v[96:97], v[168:169]
    v_pk_fma_f32 v[146:147], v[146:147], v[98:99], v[170:171]
    v_pk_fma_f32 v[148:149], v[148:149], v[100:101], v[172:173]
    v_pk_fma_f32 v[150:151], v[150:151], v[102:103], v[174:175]
    v_pk_fma_f32 v[152:153], v[152:153], v[104:105], v[176:177]
    v_pk_fma_f32 v[154:155], v[154:155], v[106:107], v[178:179]
    v_pk_fma_f32 v[156:157], v[156:157], v[108:109], v[180:181]
    v_pk_fma_f32 v[158:159], v[158:159], v[110:111], v[182:183]
    v_cvt_pk_bf16_f32 v48, v144, v145
    v_cvt_pk_bf16_f32 v49, v146, v147
    v_cvt_pk_bf16_f32 v50, v148, v149
    v_cvt_pk_bf16_f32 v51, v150, v151
    v_cvt_pk_bf16_f32 v52, v152, v153
    v_cvt_pk_bf16_f32 v53, v154, v155
    v_cvt_pk_bf16_f32 v54, v156, v157
    v_cvt_pk_bf16_f32 v55, v158, v159
    v_lshlrev_b32 v144, 16, v48
    v_and_b32 v145, 0xffff0000, v48
    v_lshlrev_b32 v146, 16, v49
    v_and_b32 v147, 0xffff0000, v49
    v_lshlrev_b32 v148, 16, v50
    v_and_b32 v149, 0xffff0000, v50
    v_lshlrev_b32 v150, 16, v51
    v_and_b32 v151, 0xffff0000, v51
    v_lshlrev_b32 v152, 16, v52
    v_and_b32 v153, 0xffff0000, v52
    v_lshlrev_b32 v154, 16, v53
    v_and_b32 v155, 0xffff0000, v53
    v_lshlrev_b32 v156, 16, v54
    v_and_b32 v157, 0xffff0000, v54
    v_lshlrev_b32 v158, 16, v55
    v_and_b32 v159, 0xffff0000, v55
    v_pk_add_f32 v[160:161], v[144:145], v[152:153]
    v_pk_add_f32 v[162:163], v[146:147], v[154:155]
    v_pk_add_f32 v[164:165], v[148:149], v[156:157]
    v_pk_add_f32 v[166:167], v[150:151], v[158:159]
    v_pk_add_f32 v[160:161], v[160:161], v[164:165]
    v_pk_add_f32 v[162:163], v[162:163], v[166:167]
    v_pk_add_f32 v[160:161], v[160:161], v[162:163]
    v_add_f32 v160, v160, v161
    buffer_store_dwordx4 v[48:51], v24, s[16:19], s44 offen sc1
    buffer_store_dwordx4 v[52:55], v24, s[16:19], s40 offen sc1
    s_nop 1
    v_add_f32 v160, v160, v160 row_ror:8
    v_mov_b32 v161, v160
    s_nop 1
    v_permlane16_swap_b32 v161, v160
    s_nop 1
    v_add_f32 v160, v160, v161
    v_mov_b32 v161, v160
    s_nop 1
    v_permlane32_swap_b32 v161, v160
    s_nop 1
    v_add_f32 v160, v160, v161
    v_mul_f32 v14, 0xbc000000, v160
    v_pk_add_f32 v[144:145], v[144:145], v[14:15] op_sel_hi:[1,0]
    v_pk_add_f32 v[146:147], v[146:147], v[14:15] op_sel_hi:[1,0]
    v_pk_add_f32 v[148:149], v[148:149], v[14:15] op_sel_hi:[1,0]
    v_pk_add_f32 v[150:151], v[150:151], v[14:15] op_sel_hi:[1,0]
    v_pk_add_f32 v[152:153], v[152:153], v[14:15] op_sel_hi:[1,0]
    v_pk_add_f32 v[154:155], v[154:155], v[14:15] op_sel_hi:[1,0]
    v_pk_add_f32 v[156:157], v[156:157], v[14:15] op_sel_hi:[1,0]
    v_pk_add_f32 v[158:159], v[158:159], v[14:15] op_sel_hi:[1,0]
    v_pk_mul_f32 v[160:161], v[144:145], v[144:145]
    v_pk_mul_f32 v[162:163], v[146:147], v[146:147]
    v_pk_fma_f32 v[160:161], v[148:149], v[148:149], v[160:161]
    v_pk_fma_f32 v[162:163], v[150:151], v[150:151], v[162:163]
    v_pk_fma_f32 v[160:161], v[152:153], v[152:153], v[160:161]
    v_pk_fma_f32 v[162:163], v[154:155], v[154:155], v[162:163]
    v_pk_fma_f32 v[160:161], v[156:157], v[156:157], v[160:161]
    v_pk_fma_f32 v[162:163], v[158:159], v[158:159], v[162:163]
    v_pk_add_f32 v[160:161], v[160:161], v[162:163]
    v_add_f32 v160, v160, v161
    s_nop 1
    v_add_f32 v160, v160, v160 row_ror:8
    v_mov_b32 v161, v160
    s_nop 1
    v_permlane16_swap_b32 v161, v160
    s_nop 1
    v_add_f32 v160, v160, v161
    v_mov_b32 v161, v160
    s_nop 1
    v_permlane32_swap_b32 v161, v160
    s_nop 1
    v_add_f32 v160, v160, v161
    ds_write_b32 v30, v14
    ds_write_b32 v30, v160 offset:128
    v_pk_mul_f32 v[144:145], v[144:145], v[128:129]
    v_pk_mul_f32 v[146:147], v[146:147], v[130:131]
    v_pk_mul_f32 v[148:149], v[148:149], v[132:133]
    v_pk_mul_f32 v[150:151], v[150:151], v[134:135]
    v_pk_mul_f32 v[152:153], v[152:153], v[136:137]
    v_pk_mul_f32 v[154:155], v[154:155], v[138:139]
    v_pk_mul_f32 v[156:157], v[156:157], v[140:141]
    v_pk_mul_f32 v[158:159], v[158:159], v[142:143]
    s_waitcnt lgkmcnt(0)
    s_barrier
    ds_read_b128 v[160:163], v29
    ds_read_b128 v[164:167], v29 offset:128
    s_waitcnt lgkmcnt(1)
    v_pk_add_f32 v[12:13], v[160:161], v[162:163]
    v_add_f32 v12, v12, v13
    v_mul_f32 v12, 0xbe800000, v12
    v_pk_add_f32 v[160:161], v[160:161], v[12:13] op_sel_hi:[1,0]
    v_pk_add_f32 v[162:163], v[162:163], v[12:13] op_sel_hi:[1,0]
    v_add_f32 v14, v14, v12
    v_pk_mul_f32 v[160:161], v[160:161], v[160:161]
    v_pk_fma_f32 v[160:161], v[162:163], v[162:163], v[160:161]
    s_waitcnt lgkmcnt(0)
    v_pk_add_f32 v[164:165], v[164:165], v[166:167]
    v_add_f32 v160, v160, v161
    v_add_f32 v164, v164, v165
    v_mov_b32 v12, 0x3727c5ac
    v_fmac_f32 v12, 0x3e800000, v160
    v_fmac_f32 v12, 0x3b000000, v164
    v_rsq_f32 v12, v12
    s_nop 0
    v_mul_f32 v14, v14, v12
    v_sub_f32 v14, 0, v14
    v_pk_fma_f32 v[112:113], v[128:129], v[14:15], v[112:113] op_sel_hi:[1,0,1]
    v_pk_fma_f32 v[114:115], v[130:131], v[14:15], v[114:115] op_sel_hi:[1,0,1]
    v_pk_fma_f32 v[116:117], v[132:133], v[14:15], v[116:117] op_sel_hi:[1,0,1]
    v_pk_fma_f32 v[118:119], v[134:135], v[14:15], v[118:119] op_sel_hi:[1,0,1]
    v_pk_fma_f32 v[144:145], v[144:145], v[12:13], v[112:113] op_sel_hi:[1,0,1]
    v_pk_fma_f32 v[146:147], v[146:147], v[12:13], v[114:115] op_sel_hi:[1,0,1]
    v_pk_fma_f32 v[148:149], v[148:149], v[12:13], v[116:117] op_sel_hi:[1,0,1]
    v_pk_fma_f32 v[150:151], v[150:151], v[12:13], v[118:119] op_sel_hi:[1,0,1]
    v_cvt_pk_bf16_f32 v64, v144, v145
    v_cvt_pk_bf16_f32 v65, v146, v147
    v_cvt_pk_bf16_f32 v66, v148, v149
    v_cvt_pk_bf16_f32 v67, v150, v151
    buffer_store_dwordx4 v[64:67], v24, s[24:27], s44 offen sc1
    v_pk_fma_f32 v[120:121], v[136:137], v[14:15], v[120:121] op_sel_hi:[1,0,1]
    v_pk_fma_f32 v[122:123], v[138:139], v[14:15], v[122:123] op_sel_hi:[1,0,1]
    v_pk_fma_f32 v[124:125], v[140:141], v[14:15], v[124:125] op_sel_hi:[1,0,1]
    v_pk_fma_f32 v[126:127], v[142:143], v[14:15], v[126:127] op_sel_hi:[1,0,1]
    v_pk_fma_f32 v[152:153], v[152:153], v[12:13], v[120:121] op_sel_hi:[1,0,1]
    v_pk_fma_f32 v[154:155], v[154:155], v[12:13], v[122:123] op_sel_hi:[1,0,1]
    v_pk_fma_f32 v[156:157], v[156:157], v[12:13], v[124:125] op_sel_hi:[1,0,1]
    v_pk_fma_f32 v[158:159], v[158:159], v[12:13], v[126:127] op_sel_hi:[1,0,1]
    v_cvt_pk_bf16_f32 v68, v152, v153
    v_cvt_pk_bf16_f32 v69, v154, v155
    v_cvt_pk_bf16_f32 v70, v156, v157
    v_cvt_pk_bf16_f32 v71, v158, v159
    buffer_store_dwordx4 v[68:71], v24, s[24:27], s40 offen sc1
    v_lshrrev_b32 v56, 8, v26
    v_bfe_u32 v57, v26, 6, 2
    v_bfe_u32 v58, v26, 4, 2
    v_lshl_add_u32 v59, v56, 2, v57
    v_mul_u32_u24 v60, 192, v59
    v_lshl_add_u32 v60, v58, 3, v60
    v_and_b32 v61, 1, v56
    v_xor_b32 v62, 0, v61
    v_lshl_add_u32 v8, v62, 5, v60
    v_add_u32 v10, 61440, v8
    v_add_u32 v12, 122880, v8
    v_xor_b32 v62, 1, v61
    v_lshl_add_u32 v9, v62, 5, v60
    v_add_u32 v11, 61440, v9
    v_add_u32 v13, 122880, v9
    s_lshl_b32 s6, s33, 2
    s_add_u32 s6, s6, s45
    s_lshl_b32 s44, s6, 15
    s_mul_i32 s6, s6, 88064
    s_mul_i32 s7, s34, 3072
    s_add_u32 s6, s6, s7
    s_add_u32 s6, s6, 0x2800000
    s_add_u32 s20, s54, s6
    s_addc_u32 s21, s55, 0
    s_mov_b32 s22, 47104
    s_mov_b32 s28, s20
    s_mov_b32 s29, s21
    s_cmp_eq_u32 s34, 14
    s_cselect_b32 s30, 0, s22
    s_lshl_b32 s63, s33, 11
    s_add_u32 s63, s63, 65536
    v_lshlrev_b32 v2, 3, v26
    s_lshl_b32 s6, s34, 2
    v_add_u32 v2, s6, v2
    v_mov_b32 v3, 0x5ac3e19b
    v_bfe_u32 v4, v26, 4, 4
    v_lshlrev_b32 v4, 2, v4
    s_lshl_b32 s6, s34, 7
    v_add_u32 v4, s6, v4
    s_waitcnt vmcnt(0)
    s_barrier
    s_cmp_eq_u32 s45, 1
    s_cbranch_scc0 k1_h2_a
    s_mov_b64 exec, 0xffff
    buffer_store_dword v3, v2, s[8:11], s63 offen sc1
    s_mov_b64 exec, -1
k1_h2_a:
    s_add_u32 m0, s35, 36864
    s_mov_b32 s42, 616448
    buffer_load_dwordx4 v20, s[12:15], s42 offen offset:0 lds
    s_add_u32 m0, s35, 36864
    s_mov_b32 s42, 616448
    buffer_load_dwordx4 v21, s[12:15], s42 offen offset:1024 lds
    s_add_u32 m0, s35, 36864
    s_mov_b32 s42, 616448
    buffer_load_dwordx4 v22, s[12:15], s42 offen offset:2048 lds
    s_add_u32 m0, s35, 49152
    s_mov_b32 s42, 704512
    buffer_load_dwordx4 v20, s[12:15], s42 offen offset:0 lds
    s_add_u32 m0, s35, 49152
    s_mov_b32 s42, 704512
    buffer_load_dwordx4 v21, s[12:15], s42 offen offset:1024 lds
    s_add_u32 m0, s35, 49152
    s_mov_b32 s42, 704512
    buffer_load_dwordx4 v22, s[12:15], s42 offen offset:2048 lds
    s_add_u32 m0, s35, 61440
    s_mov_b32 s42, 792576
    buffer_load_dwordx4 v20, s[12:15], s42 offen offset:0 lds
    s_add_u32 m0, s35, 61440
    s_mov_b32 s42, 792576
    buffer_load_dwordx4 v21, s[12:15], s42 offen offset:1024 lds
    s_add_u32 m0, s35, 61440
    s_mov_b32 s42, 792576
    buffer_load_dwordx4 v22, s[12:15], s42 offen offset:2048 lds
    s_add_u32 m0, s35, 73728
    s_mov_b32 s42, 880640
    buffer_load_dwordx4 v20, s[12:15], s42 offen offset:0 lds
    s_add_u32 m0, s35, 73728
    s_mov_b32 s42, 880640
    buffer_load_dwordx4 v21, s[12:15], s42 offen offset:1024 lds
    s_add_u32 m0, s35, 73728
    s_mov_b32 s42, 880640
    buffer_load_dwordx4 v22, s[12:15], s42 offen offset:2048 lds
    s_add_u32 m0, s35, 86016
    s_mov_b32 s42, 968704
    buffer_load_dwordx4 v20, s[12:15], s42 offen offset:0 lds
    s_add_u32 m0, s35, 86016
    s_mov_b32 s42, 968704
    buffer_load_dwordx4 v21, s[12:15], s42 offen offset:1024 lds
    s_add_u32 m0, s35, 86016
    s_mov_b32 s42, 968704
    buffer_load_dwordx4 v22, s[12:15], s42 offen offset:2048 lds
    ds_read_b64_tr_b16 v[160:161], v10 offset:36864
    ds_read_b64_tr_b16 v[162:163], v10 offset:39936
    ds_read_b64_tr_b16 v[208:209], v10 offset:49152
    ds_read_b64_tr_b16 v[210:211], v10 offset:52224
    ds_read_b64_tr_b16 v[164:165], v10 offset:43008
    ds_read_b64_tr_b16 v[166:167], v10 offset:46080
    ds_read_b64_tr_b16 v[212:213], v10 offset:55296
    ds_read_b64_tr_b16 v[214:215], v10 offset:58368
    ds_read_b64_tr_b16 v[168:169], v11 offset:36864
    ds_read_b64_tr_b16 v[170:171], v11 offset:39936
    ds_read_b64_tr_b16 v[216:217], v11 offset:49152
    ds_read_b64_tr_b16 v[218:219], v11 offset:52224
    ds_read_b64_tr_b16 v[172:173], v11 offset:43008
    ds_read_b64_tr_b16 v[174:175], v11 offset:46080
    ds_read_b64_tr_b16 v[220:221], v11 offset:55296
    ds_read_b64_tr_b16 v[222:223], v11 offset:58368
    ds_read_b64_tr_b16 v[176:177], v10 offset:36928
    ds_read_b64_tr_b16 v[178:179], v10 offset:40000
    ds_read_b64_tr_b16 v[224:225], v10 offset:49216
    ds_read_b64_tr_b16 v[226:227], v10 offset:52288
    ds_read_b64_tr_b16 v[180:181], v10 offset:43072
    ds_read_b64_tr_b16 v[182:183], v10 offset:46144
    ds_read_b64_tr_b16 v[228:229], v10 offset:55360
    ds_read_b64_tr_b16 v[230:231], v10 offset:58432
    ds_read_b64_tr_b16 v[184:185], v11 offset:36928
    ds_read_b64_tr_b16 v[186:187], v11 offset:40000
    ds_read_b64_tr_b16 v[232:233], v11 offset:49216
    ds_read_b64_tr_b16 v[234:235], v11 offset:52288
    ds_read_b64_tr_b16 v[188:189], v11 offset:43072
    ds_read_b64_tr_b16 v[190:191], v11 offset:46144
    ds_read_b64_tr_b16 v[236:237], v11 offset:55360
    ds_read_b64_tr_b16 v[238:239], v11 offset:58432
    ds_read_b64_tr_b16 v[192:193], v10 offset:36992
    ds_read_b64_tr_b16 v[194:195], v10 offset:40064
    ds_read_b64_tr_b16 v[240:241], v10 offset:49280
    ds_read_b64_tr_b16 v[242:243], v10 offset:52352
    ds_read_b64_tr_b16 v[196:197], v10 offset:43136
    ds_read_b64_tr_b16 v[198:199], v10 offset:46208
    ds_read_b64_tr_b16 v[244:245], v10 offset:55424
    ds_read_b64_tr_b16 v[246:247], v10 offset:58496
    ds_read_b64_tr_b16 v[200:201], v11 offset:36992
    ds_read_b64_tr_b16 v[202:203], v11 offset:40064
    ds_read_b64_tr_b16 v[248:249], v11 offset:49280
    ds_read_b64_tr_b16 v[250:251], v11 offset:52352
    ds_read_b64_tr_b16 v[204:205], v11 offset:43136
    ds_read_b64_tr_b16 v[206:207], v11 offset:46208
    ds_read_b64_tr_b16 v[252:253], v11 offset:55424
    ds_read_b64_tr_b16 v[254:255], v11 offset:58496
    s_cmp_eq_u32 s45, 0
    s_cbranch_scc0 k1_h2_c
    s_mov_b32 s7, 0
k1_h2_b:
    buffer_load_dword v3, v4, s[8:11], s63 offen sc1
    s_waitcnt vmcnt(0)
    v_cmp_ne_u32 vcc, 0x5ac3e19b, v3
    s_cbranch_vccz k1_h2_d
    s_add_u32 s7, s7, 1
    s_cmp_lt_u32 s7, 0x10000
    s_cbranch_scc1 k1_h2_b
k1_h2_c:
    s_waitcnt vmcnt(0)
k1_h2_d:
    s_barrier
    s_cmp_eq_u32 s34, 15
    s_cbranch_scc1 k1_c15
    s_add_u32 s36, s44, 0
    buffer_load_dwordx4 a[0:3], v26, s[24:27], s36 offen offset:0 sc1
    s_add_u32 s37, s44, 16384
    buffer_load_dwordx4 a[4:7], v26, s[24:27], s37 offen offset:0 sc1
    s_add_u32 s36, s44, 0
    buffer_load_dwordx4 a[8:11], v26, s[24:27], s36 offen offset:1024 sc1
    s_add_u32 s37, s44, 16384
    buffer_load_dwordx4 a[12:15], v26, s[24:27], s37 offen offset:1024 sc1
    s_add_u32 s36, s44, 0
    buffer_load_dwordx4 a[16:19], v26, s[24:27], s36 offen offset:2048 sc1
    s_add_u32 s37, s44, 16384
    buffer_load_dwordx4 a[20:23], v26, s[24:27], s37 offen offset:2048 sc1
    s_add_u32 s36, s44, 0
    buffer_load_dwordx4 a[24:27], v26, s[24:27], s36 offen offset:3072 sc1
    s_add_u32 s37, s44, 16384
    buffer_load_dwordx4 a[28:31], v26, s[24:27], s37 offen offset:3072 sc1
    s_waitcnt vmcnt(4) lgkmcnt(15)
    v_mfma_f32_16x16x32_bf16 v[64:67], v[160:163], a[0:3], 0
    v_mfma_f32_16x16x32_bf16 v[64:67], v[208:211], a[8:11], v[64:67]
    ds_read_b64_tr_b16 a[128:129], v12 offset:0
    ds_read_b64_tr_b16 a[130:131], v12 offset:3072
    v_mfma_f32_16x16x32_bf16 v[68:71], v[208:211], a[12:15], 0
    ds_read_b64_tr_b16 a[176:177], v12 offset:12288
    v_mfma_f32_16x16x32_bf16 v[68:71], v[160:163], a[4:7], v[68:71]
    s_add_u32 s36, s44, 4096
    buffer_load_dwordx4 a[32:35], v26, s[24:27], s36 offen offset:0 sc1
    v_mfma_f32_16x16x32_bf16 v[76:79], v[164:167], a[4:7], 0
    ds_read_b64_tr_b16 a[178:179], v12 offset:15360
    ds_read_b64_tr_b16 a[132:133], v12 offset:6144
    v_mfma_f32_16x16x32_bf16 v[76:79], v[212:215], a[12:15], v[76:79]
    ds_read_b64_tr_b16 a[134:135], v12 offset:9216
    v_mfma_f32_16x16x32_bf16 v[72:75], v[212:215], a[8:11], 0
    ds_read_b64_tr_b16 a[180:181], v12 offset:18432
    ds_read_b64_tr_b16 a[182:183], v12 offset:21504
    v_mfma_f32_16x16x32_bf16 v[72:75], v[164:167], a[0:3], v[72:75]
    ds_read_b64_tr_b16 a[136:137], v13 offset:0
    v_mfma_f32_16x16x32_bf16 v[80:83], v[168:171], a[0:3], 0
    s_add_u32 s37, s44, 20480
    buffer_load_dwordx4 a[36:39], v26, s[24:27], s37 offen offset:0 sc1
    v_mfma_f32_16x16x32_bf16 v[80:83], v[216:219], a[8:11], v[80:83]
    ds_read_b64_tr_b16 a[138:139], v13 offset:3072
    ds_read_b64_tr_b16 a[184:185], v13 offset:12288
    v_mfma_f32_16x16x32_bf16 v[84:87], v[216:219], a[12:15], 0
    ds_read_b64_tr_b16 a[186:187], v13 offset:15360
    v_mfma_f32_16x16x32_bf16 v[84:87], v[168:171], a[4:7], v[84:87]
    ds_read_b64_tr_b16 a[140:141], v13 offset:6144
    ds_read_b64_tr_b16 a[142:143], v13 offset:9216
    v_mfma_f32_16x16x32_bf16 v[92:95], v[172:175], a[4:7], 0
    s_add_u32 s36, s44, 4096
    buffer_load_dwordx4 a[40:43], v26, s[24:27], s36 offen offset:1024 sc1
    v_mfma_f32_16x16x32_bf16 v[92:95], v[220:223], a[12:15], v[92:95]
    ds_read_b64_tr_b16 a[188:189], v13 offset:18432
    v_mfma_f32_16x16x32_bf16 v[88:91], v[220:223], a[8:11], 0
    ds_read_b64_tr_b16 a[190:191], v13 offset:21504
    ds_read_b64_tr_b16 a[144:145], v12 offset:64
    v_mfma_f32_16x16x32_bf16 v[88:91], v[172:175], a[0:3], v[88:91]
    ds_read_b64_tr_b16 a[146:147], v12 offset:3136
    v_mfma_f32_16x16x32_bf16 v[96:99], v[176:179], a[0:3], 0
    ds_read_b64_tr_b16 a[192:193], v12 offset:12352
    ds_read_b64_tr_b16 a[194:195], v12 offset:15424
    v_mfma_f32_16x16x32_bf16 v[96:99], v[224:227], a[8:11], v[96:99]
    s_add_u32 s37, s44, 20480
    buffer_load_dwordx4 a[44:47], v26, s[24:27], s37 offen offset:1024 sc1
    v_mfma_f32_16x16x32_bf16 v[100:103], v[224:227], a[12:15], 0
    ds_read_b64_tr_b16 a[148:149], v12 offset:6208
    v_mfma_f32_16x16x32_bf16 v[100:103], v[176:179], a[4:7], v[100:103]
    ds_read_b64_tr_b16 a[150:151], v12 offset:9280
    ds_read_b64_tr_b16 a[196:197], v12 offset:18496
    v_mfma_f32_16x16x32_bf16 v[108:111], v[180:183], a[4:7], 0
    ds_read_b64_tr_b16 a[198:199], v12 offset:21568
    v_mfma_f32_16x16x32_bf16 v[108:111], v[228:231], a[12:15], v[108:111]
    ds_read_b64_tr_b16 a[152:153], v13 offset:64
    ds_read_b64_tr_b16 a[154:155], v13 offset:3136
    v_mfma_f32_16x16x32_bf16 v[104:107], v[228:231], a[8:11], 0
    s_add_u32 s36, s44, 4096
    buffer_load_dwordx4 a[48:51], v26, s[24:27], s36 offen offset:2048 sc1
    v_mfma_f32_16x16x32_bf16 v[104:107], v[180:183], a[0:3], v[104:107]
    ds_read_b64_tr_b16 a[200:201], v13 offset:12352
    v_mfma_f32_16x16x32_bf16 v[112:115], v[184:187], a[0:3], 0
    ds_read_b64_tr_b16 a[202:203], v13 offset:15424
    ds_read_b64_tr_b16 a[156:157], v13 offset:6208
    v_mfma_f32_16x16x32_bf16 v[112:115], v[232:235], a[8:11], v[112:115]
    ds_read_b64_tr_b16 a[158:159], v13 offset:9280
    v_mfma_f32_16x16x32_bf16 v[116:119], v[232:235], a[12:15], 0
    s_waitcnt lgkmcnt(15)
    s_add_u32 s37, s44, 20480
    buffer_load_dwordx4 a[52:55], v26, s[24:27], s37 offen offset:2048 sc1
    v_mfma_f32_16x16x32_bf16 v[116:119], v[184:187], a[4:7], v[116:119]
    ds_read_b64_tr_b16 a[204:205], v13 offset:18496
    ds_read_b64_tr_b16 a[206:207], v13 offset:21568
    v_mfma_f32_16x16x32_bf16 v[124:127], v[188:191], a[4:7], 0
    ds_read_b64_tr_b16 a[160:161], v12 offset:128
    v_mfma_f32_16x16x32_bf16 v[124:127], v[236:239], a[12:15], v[124:127]
    ds_read_b64_tr_b16 a[162:163], v12 offset:3200
    ds_read_b64_tr_b16 a[208:209], v12 offset:12416
    v_mfma_f32_16x16x32_bf16 v[120:123], v[236:239], a[8:11], 0
    ds_read_b64_tr_b16 a[210:211], v12 offset:15488
    v_mfma_f32_16x16x32_bf16 v[120:123], v[188:191], a[0:3], v[120:123]
    s_add_u32 s36, s44, 4096
    buffer_load_dwordx4 a[56:59], v26, s[24:27], s36 offen offset:3072 sc1
    v_mfma_f32_16x16x32_bf16 v[128:131], v[192:195], a[0:3], 0
    ds_read_b64_tr_b16 a[164:165], v12 offset:6272
    v_mfma_f32_16x16x32_bf16 v[128:131], v[240:243], a[8:11], v[128:131]
    ds_read_b64_tr_b16 a[166:167], v12 offset:9344
    v_mfma_f32_16x16x32_bf16 v[132:135], v[240:243], a[12:15], 0
    ds_read_b64_tr_b16 a[212:213], v12 offset:18560
    v_mfma_f32_16x16x32_bf16 v[132:135], v[192:195], a[4:7], v[132:135]
    ds_read_b64_tr_b16 a[214:215], v12 offset:21632
    v_mfma_f32_16x16x32_bf16 v[140:143], v[196:199], a[4:7], 0
    s_add_u32 s37, s44, 20480
    buffer_load_dwordx4 a[60:63], v26, s[24:27], s37 offen offset:3072 sc1
    v_mfma_f32_16x16x32_bf16 v[140:143], v[244:247], a[12:15], v[140:143]
    ds_read_b64_tr_b16 a[168:169], v13 offset:128
    v_mfma_f32_16x16x32_bf16 v[136:139], v[244:247], a[8:11], 0
    ds_read_b64_tr_b16 a[170:171], v13 offset:3200
    v_mfma_f32_16x16x32_bf16 v[136:139], v[196:199], a[0:3], v[136:139]
    ds_read_b64_tr_b16 a[216:217], v13 offset:12416
    v_mfma_f32_16x16x32_bf16 v[144:147], v[200:203], a[0:3], 0
    s_add_u32 s36, s44, 8192
    buffer_load_dwordx4 a[64:67], v26, s[24:27], s36 offen offset:0 sc1
    v_mfma_f32_16x16x32_bf16 v[144:147], v[248:251], a[8:11], v[144:147]
    ds_read_b64_tr_b16 a[218:219], v13 offset:15488
    v_mfma_f32_16x16x32_bf16 v[148:151], v[248:251], a[12:15], 0
    ds_read_b64_tr_b16 a[172:173], v13 offset:6272
    v_mfma_f32_16x16x32_bf16 v[148:151], v[200:203], a[4:7], v[148:151]
    ds_read_b64_tr_b16 a[174:175], v13 offset:9344
    v_mfma_f32_16x16x32_bf16 v[156:159], v[204:207], a[4:7], 0
    ds_read_b64_tr_b16 a[220:221], v13 offset:18560
    v_mfma_f32_16x16x32_bf16 v[156:159], v[252:255], a[12:15], v[156:159]
    s_add_u32 s37, s44, 24576
    buffer_load_dwordx4 a[68:71], v26, s[24:27], s37 offen offset:0 sc1
    v_mfma_f32_16x16x32_bf16 v[152:155], v[252:255], a[8:11], 0
    ds_read_b64_tr_b16 a[222:223], v13 offset:21632
    v_mfma_f32_16x16x32_bf16 v[152:155], v[204:207], a[0:3], v[152:155]
    s_waitcnt vmcnt(10) lgkmcnt(15)
    v_mfma_f32_16x16x32_bf16 v[64:67], a[128:131], a[16:19], v[64:67]
    s_barrier
    v_mfma_f32_16x16x32_bf16 v[64:67], a[176:179], a[24:27], v[64:67]
    ds_read_b64_tr_b16 v[160:161], v8 offset:0
    ds_read_b64_tr_b16 v[162:163], v8 offset:3072
    v_mfma_f32_16x16x32_bf16 v[68:71], a[176:179], a[28:31], v[68:71]
    ds_read_b64_tr_b16 v[208:209], v8 offset:12288
    v_mfma_f32_16x16x32_bf16 v[68:71], a[128:131], a[20:23], v[68:71]
    s_add_u32 m0, s35, 98304
    s_mov_b32 s42, 1056768
    buffer_load_dwordx4 v20, s[12:15], s42 offen offset:0 lds
    v_mfma_f32_16x16x32_bf16 v[76:79], a[132:135], a[20:23], v[76:79]
    ds_read_b64_tr_b16 v[210:211], v8 offset:15360
    ds_read_b64_tr_b16 v[164:165], v8 offset:6144
    v_mfma_f32_16x16x32_bf16 v[76:79], a[180:183], a[28:31], v[76:79]
    ds_read_b64_tr_b16 v[166:167], v8 offset:9216
    v_mfma_f32_16x16x32_bf16 v[72:75], a[180:183], a[24:27], v[72:75]
    ds_read_b64_tr_b16 v[212:213], v8 offset:18432
    ds_read_b64_tr_b16 v[214:215], v8 offset:21504
    v_mfma_f32_16x16x32_bf16 v[72:75], a[132:135], a[16:19], v[72:75]
    ds_read_b64_tr_b16 v[168:169], v9 offset:0
    v_mfma_f32_16x16x32_bf16 v[80:83], a[136:139], a[16:19], v[80:83]
    s_add_u32 m0, s35, 98304
    s_mov_b32 s42, 1056768
    buffer_load_dwordx4 v21, s[12:15], s42 offen offset:1024 lds
    v_mfma_f32_16x16x32_bf16 v[80:83], a[184:187], a[24:27], v[80:83]
    ds_read_b64_tr_b16 v[170:171], v9 offset:3072
    ds_read_b64_tr_b16 v[216:217], v9 offset:12288
    v_mfma_f32_16x16x32_bf16 v[84:87], a[184:187], a[28:31], v[84:87]
    ds_read_b64_tr_b16 v[218:219], v9 offset:15360
    v_mfma_f32_16x16x32_bf16 v[84:87], a[136:139], a[20:23], v[84:87]
    ds_read_b64_tr_b16 v[172:173], v9 offset:6144
    ds_read_b64_tr_b16 v[174:175], v9 offset:9216
    v_mfma_f32_16x16x32_bf16 v[92:95], a[140:143], a[20:23], v[92:95]
    s_add_u32 m0, s35, 98304
    s_mov_b32 s42, 1056768
    buffer_load_dwordx4 v22, s[12:15], s42 offen offset:2048 lds
    v_mfma_f32_16x16x32_bf16 v[92:95], a[188:191], a[28:31], v[92:95]
    ds_read_b64_tr_b16 v[220:221], v9 offset:18432
    v_mfma_f32_16x16x32_bf16 v[88:91], a[188:191], a[24:27], v[88:91]
    ds_read_b64_tr_b16 v[222:223], v9 offset:21504
    ds_read_b64_tr_b16 v[176:177], v8 offset:64
    v_mfma_f32_16x16x32_bf16 v[88:91], a[140:143], a[16:19], v[88:91]
    ds_read_b64_tr_b16 v[178:179], v8 offset:3136
    v_mfma_f32_16x16x32_bf16 v[96:99], a[144:147], a[16:19], v[96:99]
    ds_read_b64_tr_b16 v[224:225], v8 offset:12352
    ds_read_b64_tr_b16 v[226:227], v8 offset:15424
    v_mfma_f32_16x16x32_bf16 v[96:99], a[192:195], a[24:27], v[96:99]
    s_add_u32 m0, s35, 110592
    s_mov_b32 s42, 1144832
    buffer_load_dwordx4 v20, s[12:15], s42 offen offset:0 lds
    v_mfma_f32_16x16x32_bf16 v[100:103], a[192:195], a[28:31], v[100:103]
    ds_read_b64_tr_b16 v[180:181], v8 offset:6208
    v_mfma_f32_16x16x32_bf16 v[100:103], a[144:147], a[20:23], v[100:103]
    ds_read_b64_tr_b16 v[182:183], v8 offset:9280
    ds_read_b64_tr_b16 v[228:229], v8 offset:18496
    v_mfma_f32_16x16x32_bf16 v[108:111], a[148:151], a[20:23], v[108:111]
    ds_read_b64_tr_b16 v[230:231], v8 offset:21568
    v_mfma_f32_16x16x32_bf16 v[108:111], a[196:199], a[28:31], v[108:111]
    ds_read_b64_tr_b16 v[184:185], v9 offset:64
    ds_read_b64_tr_b16 v[186:187], v9 offset:3136
    v_mfma_f32_16x16x32_bf16 v[104:107], a[196:199], a[24:27], v[104:107]
    s_add_u32 m0, s35, 110592
    s_mov_b32 s42, 1144832
    buffer_load_dwordx4 v21, s[12:15], s42 offen offset:1024 lds
    v_mfma_f32_16x16x32_bf16 v[104:107], a[148:151], a[16:19], v[104:107]
    ds_read_b64_tr_b16 v[232:233], v9 offset:12352
    v_mfma_f32_16x16x32_bf16 v[112:115], a[152:155], a[16:19], v[112:115]
    ds_read_b64_tr_b16 v[234:235], v9 offset:15424
    ds_read_b64_tr_b16 v[188:189], v9 offset:6208
    v_mfma_f32_16x16x32_bf16 v[112:115], a[200:203], a[24:27], v[112:115]
    ds_read_b64_tr_b16 v[190:191], v9 offset:9280
    v_mfma_f32_16x16x32_bf16 v[116:119], a[200:203], a[28:31], v[116:119]
    s_waitcnt lgkmcnt(15)
    s_add_u32 m0, s35, 110592
    s_mov_b32 s42, 1144832
    buffer_load_dwordx4 v22, s[12:15], s42 offen offset:2048 lds
    v_mfma_f32_16x16x32_bf16 v[116:119], a[152:155], a[20:23], v[116:119]
    ds_read_b64_tr_b16 v[236:237], v9 offset:18496
    ds_read_b64_tr_b16 v[238:239], v9 offset:21568
    v_mfma_f32_16x16x32_bf16 v[124:127], a[156:159], a[20:23], v[124:127]
    ds_read_b64_tr_b16 v[192:193], v8 offset:128
    v_mfma_f32_16x16x32_bf16 v[124:127], a[204:207], a[28:31], v[124:127]
    ds_read_b64_tr_b16 v[194:195], v8 offset:3200
    ds_read_b64_tr_b16 v[240:241], v8 offset:12416
    v_mfma_f32_16x16x32_bf16 v[120:123], a[204:207], a[24:27], v[120:123]
    ds_read_b64_tr_b16 v[242:243], v8 offset:15488
    v_mfma_f32_16x16x32_bf16 v[120:123], a[156:159], a[16:19], v[120:123]
    s_add_u32 s36, s44, 8192
    buffer_load_dwordx4 a[72:75], v26, s[24:27], s36 offen offset:1024 sc1
    v_mfma_f32_16x16x32_bf16 v[128:131], a[160:163], a[16:19], v[128:131]
    ds_read_b64_tr_b16 v[196:197], v8 offset:6272
    v_mfma_f32_16x16x32_bf16 v[128:131], a[208:211], a[24:27], v[128:131]
    ds_read_b64_tr_b16 v[198:199], v8 offset:9344
    v_mfma_f32_16x16x32_bf16 v[132:135], a[208:211], a[28:31], v[132:135]
    ds_read_b64_tr_b16 v[244:245], v8 offset:18560
    v_mfma_f32_16x16x32_bf16 v[132:135], a[160:163], a[20:23], v[132:135]
    ds_read_b64_tr_b16 v[246:247], v8 offset:21632
    v_mfma_f32_16x16x32_bf16 v[140:143], a[164:167], a[20:23], v[140:143]
    s_add_u32 s37, s44, 24576
    buffer_load_dwordx4 a[76:79], v26, s[24:27], s37 offen offset:1024 sc1
    v_mfma_f32_16x16x32_bf16 v[140:143], a[212:215], a[28:31], v[140:143]
    ds_read_b64_tr_b16 v[200:201], v9 offset:128
    v_mfma_f32_16x16x32_bf16 v[136:139], a[212:215], a[24:27], v[136:139]
    ds_read_b64_tr_b16 v[202:203], v9 offset:3200
    v_mfma_f32_16x16x32_bf16 v[136:139], a[164:167], a[16:19], v[136:139]
    ds_read_b64_tr_b16 v[248:249], v9 offset:12416
    v_mfma_f32_16x16x32_bf16 v[144:147], a[168:171], a[16:19], v[144:147]
    s_add_u32 s36, s44, 8192
    buffer_load_dwordx4 a[80:83], v26, s[24:27], s36 offen offset:2048 sc1
    v_mfma_f32_16x16x32_bf16 v[144:147], a[216:219], a[24:27], v[144:147]
    ds_read_b64_tr_b16 v[250:251], v9 offset:15488
    v_mfma_f32_16x16x32_bf16 v[148:151], a[216:219], a[28:31], v[148:151]
    ds_read_b64_tr_b16 v[204:205], v9 offset:6272
    v_mfma_f32_16x16x32_bf16 v[148:151], a[168:171], a[20:23], v[148:151]
    ds_read_b64_tr_b16 v[206:207], v9 offset:9344
    v_mfma_f32_16x16x32_bf16 v[156:159], a[172:175], a[20:23], v[156:159]
    ds_read_b64_tr_b16 v[252:253], v9 offset:18560
    v_mfma_f32_16x16x32_bf16 v[156:159], a[220:223], a[28:31], v[156:159]
    s_add_u32 s37, s44, 24576
    buffer_load_dwordx4 a[84:87], v26, s[24:27], s37 offen offset:2048 sc1
    v_mfma_f32_16x16x32_bf16 v[152:155], a[220:223], a[24:27], v[152:155]
    ds_read_b64_tr_b16 v[254:255], v9 offset:21632
    v_mfma_f32_16x16x32_bf16 v[152:155], a[172:175], a[16:19], v[152:155]
    s_waitcnt vmcnt(16) lgkmcnt(15)
    v_mfma_f32_16x16x32_bf16 v[64:67], v[160:163], a[32:35], v[64:67]
    s_barrier
    v_mfma_f32_16x16x32_bf16 v[64:67], v[208:211], a[40:43], v[64:67]
    ds_read_b64_tr_b16 a[128:129], v8 offset:24576
    ds_read_b64_tr_b16 a[130:131], v8 offset:27648
    v_mfma_f32_16x16x32_bf16 v[68:71], v[208:211], a[44:47], v[68:71]
    ds_read_b64_tr_b16 a[176:177], v8 offset:36864
    v_mfma_f32_16x16x32_bf16 v[68:71], v[160:163], a[36:39], v[68:71]
    s_add_u32 m0, s35, 122880
    s_mov_b32 s42, 1232896
    buffer_load_dwordx4 v20, s[12:15], s42 offen offset:0 lds
    v_mfma_f32_16x16x32_bf16 v[76:79], v[164:167], a[36:39], v[76:79]
    ds_read_b64_tr_b16 a[178:179], v8 offset:39936
    ds_read_b64_tr_b16 a[132:133], v8 offset:30720
    v_mfma_f32_16x16x32_bf16 v[76:79], v[212:215], a[44:47], v[76:79]
    ds_read_b64_tr_b16 a[134:135], v8 offset:33792
    v_mfma_f32_16x16x32_bf16 v[72:75], v[212:215], a[40:43], v[72:75]
    ds_read_b64_tr_b16 a[180:181], v8 offset:43008
    ds_read_b64_tr_b16 a[182:183], v8 offset:46080
    v_mfma_f32_16x16x32_bf16 v[72:75], v[164:167], a[32:35], v[72:75]
    ds_read_b64_tr_b16 a[136:137], v9 offset:24576
    v_mfma_f32_16x16x32_bf16 v[80:83], v[168:171], a[32:35], v[80:83]
    s_add_u32 m0, s35, 122880
    s_mov_b32 s42, 1232896
    buffer_load_dwordx4 v21, s[12:15], s42 offen offset:1024 lds
    v_mfma_f32_16x16x32_bf16 v[80:83], v[216:219], a[40:43], v[80:83]
    ds_read_b64_tr_b16 a[138:139], v9 offset:27648
    ds_read_b64_tr_b16 a[184:185], v9 offset:36864
    v_mfma_f32_16x16x32_bf16 v[84:87], v[216:219], a[44:47], v[84:87]
    ds_read_b64_tr_b16 a[186:187], v9 offset:39936
    v_mfma_f32_16x16x32_bf16 v[84:87], v[168:171], a[36:39], v[84:87]
    ds_read_b64_tr_b16 a[140:141], v9 offset:30720
    ds_read_b64_tr_b16 a[142:143], v9 offset:33792
    v_mfma_f32_16x16x32_bf16 v[92:95], v[172:175], a[36:39], v[92:95]
    s_add_u32 m0, s35, 122880
    s_mov_b32 s42, 1232896
    buffer_load_dwordx4 v22, s[12:15], s42 offen offset:2048 lds
    v_mfma_f32_16x16x32_bf16 v[92:95], v[220:223], a[44:47], v[92:95]
    ds_read_b64_tr_b16 a[188:189], v9 offset:43008
    v_mfma_f32_16x16x32_bf16 v[88:91], v[220:223], a[40:43], v[88:91]
    ds_read_b64_tr_b16 a[190:191], v9 offset:46080
    ds_read_b64_tr_b16 a[144:145], v8 offset:24640
    v_mfma_f32_16x16x32_bf16 v[88:91], v[172:175], a[32:35], v[88:91]
    ds_read_b64_tr_b16 a[146:147], v8 offset:27712
    v_mfma_f32_16x16x32_bf16 v[96:99], v[176:179], a[32:35], v[96:99]
    ds_read_b64_tr_b16 a[192:193], v8 offset:36928
    ds_read_b64_tr_b16 a[194:195], v8 offset:40000
    v_mfma_f32_16x16x32_bf16 v[96:99], v[224:227], a[40:43], v[96:99]
    s_add_u32 m0, s35, 135168
    s_mov_b32 s42, 1320960
    buffer_load_dwordx4 v20, s[12:15], s42 offen offset:0 lds
    v_mfma_f32_16x16x32_bf16 v[100:103], v[224:227], a[44:47], v[100:103]
    ds_read_b64_tr_b16 a[148:149], v8 offset:30784
    v_mfma_f32_16x16x32_bf16 v[100:103], v[176:179], a[36:39], v[100:103]
    ds_read_b64_tr_b16 a[150:151], v8 offset:33856
    ds_read_b64_tr_b16 a[196:197], v8 offset:43072
    v_mfma_f32_16x16x32_bf16 v[108:111], v[180:183], a[36:39], v[108:111]
    ds_read_b64_tr_b16 a[198:199], v8 offset:46144
    v_mfma_f32_16x16x32_bf16 v[108:111], v[228:231], a[44:47], v[108:111]
    ds_read_b64_tr_b16 a[152:153], v9 offset:24640
    ds_read_b64_tr_b16 a[154:155], v9 offset:27712
    v_mfma_f32_16x16x32_bf16 v[104:107], v[228:231], a[40:43], v[104:107]
    s_add_u32 m0, s35, 135168
    s_mov_b32 s42, 1320960
    buffer_load_dwordx4 v21, s[12:15], s42 offen offset:1024 lds
    v_mfma_f32_16x16x32_bf16 v[104:107], v[180:183], a[32:35], v[104:107]
    ds_read_b64_tr_b16 a[200:201], v9 offset:36928
    v_mfma_f32_16x16x32_bf16 v[112:115], v[184:187], a[32:35], v[112:115]
    ds_read_b64_tr_b16 a[202:203], v9 offset:40000
    ds_read_b64_tr_b16 a[156:157], v9 offset:30784
    v_mfma_f32_16x16x32_bf16 v[112:115], v[232:235], a[40:43], v[112:115]
    ds_read_b64_tr_b16 a[158:159], v9 offset:33856
    v_mfma_f32_16x16x32_bf16 v[116:119], v[232:235], a[44:47], v[116:119]
    s_waitcnt lgkmcnt(15)
    s_add_u32 m0, s35, 135168
    s_mov_b32 s42, 1320960
    buffer_load_dwordx4 v22, s[12:15], s42 offen offset:2048 lds
    v_mfma_f32_16x16x32_bf16 v[116:119], v[184:187], a[36:39], v[116:119]
    ds_read_b64_tr_b16 a[204:205], v9 offset:43072
    ds_read_b64_tr_b16 a[206:207], v9 offset:46144
    v_mfma_f32_16x16x32_bf16 v[124:127], v[188:191], a[36:39], v[124:127]
    ds_read_b64_tr_b16 a[160:161], v8 offset:24704
    v_mfma_f32_16x16x32_bf16 v[124:127], v[236:239], a[44:47], v[124:127]
    ds_read_b64_tr_b16 a[162:163], v8 offset:27776
    ds_read_b64_tr_b16 a[208:209], v8 offset:36992
    v_mfma_f32_16x16x32_bf16 v[120:123], v[236:239], a[40:43], v[120:123]
    ds_read_b64_tr_b16 a[210:211], v8 offset:40064
    v_mfma_f32_16x16x32_bf16 v[120:123], v[188:191], a[32:35], v[120:123]
    s_add_u32 s36, s44, 8192
    buffer_load_dwordx4 a[88:91], v26, s[24:27], s36 offen offset:3072 sc1
    v_mfma_f32_16x16x32_bf16 v[128:131], v[192:195], a[32:35], v[128:131]
    ds_read_b64_tr_b16 a[164:165], v8 offset:30848
    v_mfma_f32_16x16x32_bf16 v[128:131], v[240:243], a[40:43], v[128:131]
    ds_read_b64_tr_b16 a[166:167], v8 offset:33920
    v_mfma_f32_16x16x32_bf16 v[132:135], v[240:243], a[44:47], v[132:135]
    ds_read_b64_tr_b16 a[212:213], v8 offset:43136
    v_mfma_f32_16x16x32_bf16 v[132:135], v[192:195], a[36:39], v[132:135]
    ds_read_b64_tr_b16 a[214:215], v8 offset:46208
    v_mfma_f32_16x16x32_bf16 v[140:143], v[196:199], a[36:39], v[140:143]
    s_add_u32 s37, s44, 24576
    buffer_load_dwordx4 a[92:95], v26, s[24:27], s37 offen offset:3072 sc1
    v_mfma_f32_16x16x32_bf16 v[140:143], v[244:247], a[44:47], v[140:143]
    ds_read_b64_tr_b16 a[168:169], v9 offset:24704
    v_mfma_f32_16x16x32_bf16 v[136:139], v[244:247], a[40:43], v[136:139]
    ds_read_b64_tr_b16 a[170:171], v9 offset:27776
    v_mfma_f32_16x16x32_bf16 v[136:139], v[196:199], a[32:35], v[136:139]
    ds_read_b64_tr_b16 a[216:217], v9 offset:36992
    v_mfma_f32_16x16x32_bf16 v[144:147], v[200:203], a[32:35], v[144:147]
    s_add_u32 s36, s44, 12288
    buffer_load_dwordx4 a[96:99], v26, s[24:27], s36 offen offset:0 sc1
    v_mfma_f32_16x16x32_bf16 v[144:147], v[248:251], a[40:43], v[144:147]
    ds_read_b64_tr_b16 a[218:219], v9 offset:40064
    v_mfma_f32_16x16x32_bf16 v[148:151], v[248:251], a[44:47], v[148:151]
    ds_read_b64_tr_b16 a[172:173], v9 offset:30848
    v_mfma_f32_16x16x32_bf16 v[148:151], v[200:203], a[36:39], v[148:151]
    ds_read_b64_tr_b16 a[174:175], v9 offset:33920
    v_mfma_f32_16x16x32_bf16 v[156:159], v[204:207], a[36:39], v[156:159]
    ds_read_b64_tr_b16 a[220:221], v9 offset:43136
    v_mfma_f32_16x16x32_bf16 v[156:159], v[252:255], a[44:47], v[156:159]
    s_add_u32 s37, s44, 28672
    buffer_load_dwordx4 a[100:103], v26, s[24:27], s37 offen offset:0 sc1
    v_mfma_f32_16x16x32_bf16 v[152:155], v[252:255], a[40:43], v[152:155]
    ds_read_b64_tr_b16 a[222:223], v9 offset:46208
    v_mfma_f32_16x16x32_bf16 v[152:155], v[204:207], a[32:35], v[152:155]
    s_waitcnt vmcnt(22) lgkmcnt(15)
    v_mfma_f32_16x16x32_bf16 v[64:67], a[128:131], a[48:51], v[64:67]
    s_barrier
    v_mfma_f32_16x16x32_bf16 v[64:67], a[176:179], a[56:59], v[64:67]
    ds_read_b64_tr_b16 v[160:161], v8 offset:49152
    ds_read_b64_tr_b16 v[162:163], v8 offset:52224
    v_mfma_f32_16x16x32_bf16 v[68:71], a[176:179], a[60:63], v[68:71]
    ds_read_b64_tr_b16 v[208:209], v10 offset:0
    v_mfma_f32_16x16x32_bf16 v[68:71], a[128:131], a[52:55], v[68:71]
    s_add_u32 s36, s44, 12288
    buffer_load_dwordx4 a[104:107], v26, s[24:27], s36 offen offset:1024 sc1
    v_mfma_f32_16x16x32_bf16 v[76:79], a[132:135], a[52:55], v[76:79]
    ds_read_b64_tr_b16 v[210:211], v10 offset:3072
    ds_read_b64_tr_b16 v[164:165], v8 offset:55296
    v_mfma_f32_16x16x32_bf16 v[76:79], a[180:183], a[60:63], v[76:79]
    ds_read_b64_tr_b16 v[166:167], v8 offset:58368
    v_mfma_f32_16x16x32_bf16 v[72:75], a[180:183], a[56:59], v[72:75]
    ds_read_b64_tr_b16 v[212:213], v10 offset:6144
    ds_read_b64_tr_b16 v[214:215], v10 offset:9216
    v_mfma_f32_16x16x32_bf16 v[72:75], a[132:135], a[48:51], v[72:75]
    ds_read_b64_tr_b16 v[168:169], v9 offset:49152
    v_mfma_f32_16x16x32_bf16 v[80:83], a[136:139], a[48:51], v[80:83]
    s_add_u32 s37, s44, 28672
    buffer_load_dwordx4 a[108:111], v26, s[24:27], s37 offen offset:1024 sc1
    v_mfma_f32_16x16x32_bf16 v[80:83], a[184:187], a[56:59], v[80:83]
    ds_read_b64_tr_b16 v[170:171], v9 offset:52224
    ds_read_b64_tr_b16 v[216:217], v11 offset:0
    v_mfma_f32_16x16x32_bf16 v[84:87], a[184:187], a[60:63], v[84:87]
    ds_read_b64_tr_b16 v[218:219], v11 offset:3072
    v_mfma_f32_16x16x32_bf16 v[84:87], a[136:139], a[52:55], v[84:87]
    ds_read_b64_tr_b16 v[172:173], v9 offset:55296
    ds_read_b64_tr_b16 v[174:175], v9 offset:58368
    v_mfma_f32_16x16x32_bf16 v[92:95], a[140:143], a[52:55], v[92:95]
    s_add_u32 s36, s44, 12288
    buffer_load_dwordx4 a[112:115], v26, s[24:27], s36 offen offset:2048 sc1
    v_mfma_f32_16x16x32_bf16 v[92:95], a[188:191], a[60:63], v[92:95]
    ds_read_b64_tr_b16 v[220:221], v11 offset:6144
    v_mfma_f32_16x16x32_bf16 v[88:91], a[188:191], a[56:59], v[88:91]
    ds_read_b64_tr_b16 v[222:223], v11 offset:9216
    ds_read_b64_tr_b16 v[176:177], v8 offset:49216
    v_mfma_f32_16x16x32_bf16 v[88:91], a[140:143], a[48:51], v[88:91]
    ds_read_b64_tr_b16 v[178:179], v8 offset:52288
    v_mfma_f32_16x16x32_bf16 v[96:99], a[144:147], a[48:51], v[96:99]
    ds_read_b64_tr_b16 v[224:225], v10 offset:64
    ds_read_b64_tr_b16 v[226:227], v10 offset:3136
    v_mfma_f32_16x16x32_bf16 v[96:99], a[192:195], a[56:59], v[96:99]
    s_add_u32 s37, s44, 28672
    buffer_load_dwordx4 a[116:119], v26, s[24:27], s37 offen offset:2048 sc1
    v_mfma_f32_16x16x32_bf16 v[100:103], a[192:195], a[60:63], v[100:103]
    ds_read_b64_tr_b16 v[180:181], v8 offset:55360
    v_mfma_f32_16x16x32_bf16 v[100:103], a[144:147], a[52:55], v[100:103]
    ds_read_b64_tr_b16 v[182:183], v8 offset:58432
    ds_read_b64_tr_b16 v[228:229], v10 offset:6208
    v_mfma_f32_16x16x32_bf16 v[108:111], a[148:151], a[52:55], v[108:111]
    ds_read_b64_tr_b16 v[230:231], v10 offset:9280
    v_mfma_f32_16x16x32_bf16 v[108:111], a[196:199], a[60:63], v[108:111]
    ds_read_b64_tr_b16 v[184:185], v9 offset:49216
    ds_read_b64_tr_b16 v[186:187], v9 offset:52288
    v_mfma_f32_16x16x32_bf16 v[104:107], a[196:199], a[56:59], v[104:107]
    s_add_u32 s36, s44, 12288
    buffer_load_dwordx4 a[120:123], v26, s[24:27], s36 offen offset:3072 sc1
    v_mfma_f32_16x16x32_bf16 v[104:107], a[148:151], a[48:51], v[104:107]
    ds_read_b64_tr_b16 v[232:233], v11 offset:64
    v_mfma_f32_16x16x32_bf16 v[112:115], a[152:155], a[48:51], v[112:115]
    ds_read_b64_tr_b16 v[234:235], v11 offset:3136
    ds_read_b64_tr_b16 v[188:189], v9 offset:55360
    v_mfma_f32_16x16x32_bf16 v[112:115], a[200:203], a[56:59], v[112:115]
    ds_read_b64_tr_b16 v[190:191], v9 offset:58432
    v_mfma_f32_16x16x32_bf16 v[116:119], a[200:203], a[60:63], v[116:119]
    s_waitcnt lgkmcnt(15)
    s_add_u32 s37, s44, 28672
    buffer_load_dwordx4 a[124:127], v26, s[24:27], s37 offen offset:3072 sc1
    v_mfma_f32_16x16x32_bf16 v[116:119], a[152:155], a[52:55], v[116:119]
    ds_read_b64_tr_b16 v[236:237], v11 offset:6208
    ds_read_b64_tr_b16 v[238:239], v11 offset:9280
    v_mfma_f32_16x16x32_bf16 v[124:127], a[156:159], a[52:55], v[124:127]
    ds_read_b64_tr_b16 v[192:193], v8 offset:49280
    v_mfma_f32_16x16x32_bf16 v[124:127], a[204:207], a[60:63], v[124:127]
    ds_read_b64_tr_b16 v[194:195], v8 offset:52352
    ds_read_b64_tr_b16 v[240:241], v10 offset:128
    v_mfma_f32_16x16x32_bf16 v[120:123], a[204:207], a[56:59], v[120:123]
    ds_read_b64_tr_b16 v[242:243], v10 offset:3200
    v_mfma_f32_16x16x32_bf16 v[120:123], a[156:159], a[48:51], v[120:123]
    s_add_u32 m0, s32, 0
    s_mov_b32 s43, 0
    buffer_load_dwordx4 v23, s[48:51], s43 offen offset:0 lds
    v_mfma_f32_16x16x32_bf16 v[128:131], a[160:163], a[48:51], v[128:131]
    ds_read_b64_tr_b16 v[196:197], v8 offset:55424
    v_mfma_f32_16x16x32_bf16 v[128:131], a[208:211], a[56:59], v[128:131]
    ds_read_b64_tr_b16 v[198:199], v8 offset:58496
    v_mfma_f32_16x16x32_bf16 v[132:135], a[208:211], a[60:63], v[132:135]
    ds_read_b64_tr_b16 v[244:245], v10 offset:6272
    v_mfma_f32_16x16x32_bf16 v[132:135], a[160:163], a[52:55], v[132:135]
    ds_read_b64_tr_b16 v[246:247], v10 offset:9344
    v_mfma_f32_16x16x32_bf16 v[140:143], a[164:167], a[52:55], v[140:143]
    s_add_u32 m0, s32, 0
    s_mov_b32 s43, 7168
    buffer_load_dwordx4 v23, s[48:51], s43 offen offset:1024 lds
    v_mfma_f32_16x16x32_bf16 v[140:143], a[212:215], a[60:63], v[140:143]
    ds_read_b64_tr_b16 v[200:201], v9 offset:49280
    v_mfma_f32_16x16x32_bf16 v[136:139], a[212:215], a[56:59], v[136:139]
    ds_read_b64_tr_b16 v[202:203], v9 offset:52352
    v_mfma_f32_16x16x32_bf16 v[136:139], a[164:167], a[48:51], v[136:139]
    ds_read_b64_tr_b16 v[248:249], v11 offset:128
    v_mfma_f32_16x16x32_bf16 v[144:147], a[168:171], a[48:51], v[144:147]
    s_add_u32 m0, s32, 0
    s_mov_b32 s43, 14336
    buffer_load_dwordx4 v23, s[48:51], s43 offen offset:2048 lds
    v_mfma_f32_16x16x32_bf16 v[144:147], a[216:219], a[56:59], v[144:147]
    ds_read_b64_tr_b16 v[250:251], v11 offset:3200
    v_mfma_f32_16x16x32_bf16 v[148:151], a[216:219], a[60:63], v[148:151]
    ds_read_b64_tr_b16 v[204:205], v9 offset:55424
    v_mfma_f32_16x16x32_bf16 v[148:151], a[168:171], a[52:55], v[148:151]
    ds_read_b64_tr_b16 v[206:207], v9 offset:58496
    v_mfma_f32_16x16x32_bf16 v[156:159], a[172:175], a[52:55], v[156:159]
    ds_read_b64_tr_b16 v[252:253], v11 offset:6272
    v_mfma_f32_16x16x32_bf16 v[156:159], a[220:223], a[60:63], v[156:159]
    s_add_u32 m0, s32, 0
    s_mov_b32 s43, 21504
    buffer_load_dwordx4 v23, s[48:51], s43 offen offset:3072 lds
    v_mfma_f32_16x16x32_bf16 v[152:155], a[220:223], a[56:59], v[152:155]
    ds_read_b64_tr_b16 v[254:255], v11 offset:9344
    v_mfma_f32_16x16x32_bf16 v[152:155], a[172:175], a[48:51], v[152:155]
    s_waitcnt vmcnt(22) lgkmcnt(15)
    v_mfma_f32_16x16x32_bf16 v[64:67], v[160:163], a[64:67], v[64:67]
    s_barrier
    v_mfma_f32_16x16x32_bf16 v[64:67], v[208:211], a[72:75], v[64:67]
    ds_read_b64_tr_b16 a[128:129], v10 offset:12288
    ds_read_b64_tr_b16 a[130:131], v10 offset:15360
    v_mfma_f32_16x16x32_bf16 v[68:71], v[208:211], a[76:79], v[68:71]
    ds_read_b64_tr_b16 a[176:177], v10 offset:24576
    v_mfma_f32_16x16x32_bf16 v[68:71], v[160:163], a[68:71], v[68:71]
    s_add_u32 m0, s32, 16384
    s_mov_b32 s43, 131072
    buffer_load_dwordx4 v23, s[48:51], s43 offen offset:0 lds
    v_mfma_f32_16x16x32_bf16 v[76:79], v[164:167], a[68:71], v[76:79]
    ds_read_b64_tr_b16 a[178:179], v10 offset:27648
    ds_read_b64_tr_b16 a[132:133], v10 offset:18432
    v_mfma_f32_16x16x32_bf16 v[76:79], v[212:215], a[76:79], v[76:79]
    ds_read_b64_tr_b16 a[134:135], v10 offset:21504
    v_mfma_f32_16x16x32_bf16 v[72:75], v[212:215], a[72:75], v[72:75]
    ds_read_b64_tr_b16 a[180:181], v10 offset:30720
    ds_read_b64_tr_b16 a[182:183], v10 offset:33792
    v_mfma_f32_16x16x32_bf16 v[72:75], v[164:167], a[64:67], v[72:75]
    ds_read_b64_tr_b16 a[136:137], v11 offset:12288
    v_mfma_f32_16x16x32_bf16 v[80:83], v[168:171], a[64:67], v[80:83]
    ds_read_b64_tr_b16 a[138:139], v11 offset:15360
    ds_read_b64_tr_b16 a[184:185], v11 offset:24576
    v_mfma_f32_16x16x32_bf16 v[80:83], v[216:219], a[72:75], v[80:83]
    s_add_u32 m0, s32, 16384
    s_mov_b32 s43, 138240
    buffer_load_dwordx4 v23, s[48:51], s43 offen offset:1024 lds
    v_mfma_f32_16x16x32_bf16 v[84:87], v[216:219], a[76:79], v[84:87]
    ds_read_b64_tr_b16 a[186:187], v11 offset:27648
    v_mfma_f32_16x16x32_bf16 v[84:87], v[168:171], a[68:71], v[84:87]
    ds_read_b64_tr_b16 a[140:141], v11 offset:18432
    ds_read_b64_tr_b16 a[142:143], v11 offset:21504
    v_mfma_f32_16x16x32_bf16 v[92:95], v[172:175], a[68:71], v[92:95]
    ds_read_b64_tr_b16 a[188:189], v11 offset:30720
    v_mfma_f32_16x16x32_bf16 v[92:95], v[220:223], a[76:79], v[92:95]
    ds_read_b64_tr_b16 a[190:191], v11 offset:33792
    ds_read_b64_tr_b16 a[144:145], v10 offset:12352
    v_mfma_f32_16x16x32_bf16 v[88:91], v[220:223], a[72:75], v[88:91]
    ds_read_b64_tr_b16 a[146:147], v10 offset:15424
    v_mfma_f32_16x16x32_bf16 v[88:91], v[172:175], a[64:67], v[88:91]
    s_add_u32 m0, s32, 16384
    s_mov_b32 s43, 145408
    buffer_load_dwordx4 v23, s[48:51], s43 offen offset:2048 lds
    v_mfma_f32_16x16x32_bf16 v[96:99], v[176:179], a[64:67], v[96:99]
    ds_read_b64_tr_b16 a[192:193], v10 offset:24640
    ds_read_b64_tr_b16 a[194:195], v10 offset:27712
    v_mfma_f32_16x16x32_bf16 v[96:99], v[224:227], a[72:75], v[96:99]
    ds_read_b64_tr_b16 a[148:149], v10 offset:18496
    v_mfma_f32_16x16x32_bf16 v[100:103], v[224:227], a[76:79], v[100:103]
    ds_read_b64_tr_b16 a[150:151], v10 offset:21568
    ds_read_b64_tr_b16 a[196:197], v10 offset:30784
    v_mfma_f32_16x16x32_bf16 v[100:103], v[176:179], a[68:71], v[100:103]
    ds_read_b64_tr_b16 a[198:199], v10 offset:33856
    v_mfma_f32_16x16x32_bf16 v[108:111], v[180:183], a[68:71], v[108:111]
    ds_read_b64_tr_b16 a[152:153], v11 offset:12352
    ds_read_b64_tr_b16 a[154:155], v11 offset:15424
    v_mfma_f32_16x16x32_bf16 v[108:111], v[228:231], a[76:79], v[108:111]
    s_add_u32 m0, s32, 16384
    s_mov_b32 s43, 152576
    buffer_load_dwordx4 v23, s[48:51], s43 offen offset:3072 lds
    v_mfma_f32_16x16x32_bf16 v[104:107], v[228:231], a[72:75], v[104:107]
    ds_read_b64_tr_b16 a[200:201], v11 offset:24640
    v_mfma_f32_16x16x32_bf16 v[104:107], v[180:183], a[64:67], v[104:107]
    ds_read_b64_tr_b16 a[202:203], v11 offset:27712
    ds_read_b64_tr_b16 a[156:157], v11 offset:18496
    v_mfma_f32_16x16x32_bf16 v[112:115], v[184:187], a[64:67], v[112:115]
    ds_read_b64_tr_b16 a[158:159], v11 offset:21568
    v_mfma_f32_16x16x32_bf16 v[112:115], v[232:235], a[72:75], v[112:115]
    ds_read_b64_tr_b16 a[204:205], v11 offset:30784
    v_mfma_f32_16x16x32_bf16 v[116:119], v[232:235], a[76:79], v[116:119]
    s_waitcnt lgkmcnt(15)
    ds_read_b64_tr_b16 a[206:207], v11 offset:33856
    v_mfma_f32_16x16x32_bf16 v[116:119], v[184:187], a[68:71], v[116:119]
    s_add_u32 m0, s32, 32768
    s_mov_b32 s43, 262144
    buffer_load_dwordx4 v23, s[48:51], s43 offen offset:0 lds
    v_mfma_f32_16x16x32_bf16 v[124:127], v[188:191], a[68:71], v[124:127]
    ds_read_b64_tr_b16 a[160:161], v10 offset:12416
    v_mfma_f32_16x16x32_bf16 v[124:127], v[236:239], a[76:79], v[124:127]
    ds_read_b64_tr_b16 a[162:163], v10 offset:15488
    v_mfma_f32_16x16x32_bf16 v[120:123], v[236:239], a[72:75], v[120:123]
    ds_read_b64_tr_b16 a[208:209], v10 offset:24704
    v_mfma_f32_16x16x32_bf16 v[120:123], v[188:191], a[64:67], v[120:123]
    ds_read_b64_tr_b16 a[210:211], v10 offset:27776
    v_mfma_f32_16x16x32_bf16 v[128:131], v[192:195], a[64:67], v[128:131]
    ds_read_b64_tr_b16 a[164:165], v10 offset:18560
    v_mfma_f32_16x16x32_bf16 v[128:131], v[240:243], a[72:75], v[128:131]
    s_add_u32 m0, s32, 32768
    s_mov_b32 s43, 269312
    buffer_load_dwordx4 v23, s[48:51], s43 offen offset:1024 lds
    v_mfma_f32_16x16x32_bf16 v[132:135], v[240:243], a[76:79], v[132:135]
    ds_read_b64_tr_b16 a[166:167], v10 offset:21632
    v_mfma_f32_16x16x32_bf16 v[132:135], v[192:195], a[68:71], v[132:135]
    ds_read_b64_tr_b16 a[212:213], v10 offset:30848
    v_mfma_f32_16x16x32_bf16 v[140:143], v[196:199], a[68:71], v[140:143]
    ds_read_b64_tr_b16 a[214:215], v10 offset:33920
    v_mfma_f32_16x16x32_bf16 v[140:143], v[244:247], a[76:79], v[140:143]
    ds_read_b64_tr_b16 a[168:169], v11 offset:12416
    v_mfma_f32_16x16x32_bf16 v[136:139], v[244:247], a[72:75], v[136:139]
    ds_read_b64_tr_b16 a[170:171], v11 offset:15488
    v_mfma_f32_16x16x32_bf16 v[136:139], v[196:199], a[64:67], v[136:139]
    s_add_u32 m0, s32, 32768
    s_mov_b32 s43, 276480
    buffer_load_dwordx4 v23, s[48:51], s43 offen offset:2048 lds
    v_mfma_f32_16x16x32_bf16 v[144:147], v[200:203], a[64:67], v[144:147]
    ds_read_b64_tr_b16 a[216:217], v11 offset:24704
    v_mfma_f32_16x16x32_bf16 v[144:147], v[248:251], a[72:75], v[144:147]
    ds_read_b64_tr_b16 a[218:219], v11 offset:27776
    v_mfma_f32_16x16x32_bf16 v[148:151], v[248:251], a[76:79], v[148:151]
    ds_read_b64_tr_b16 a[172:173], v11 offset:18560
    v_mfma_f32_16x16x32_bf16 v[148:151], v[200:203], a[68:71], v[148:151]
    ds_read_b64_tr_b16 a[174:175], v11 offset:21632
    v_mfma_f32_16x16x32_bf16 v[156:159], v[204:207], a[68:71], v[156:159]
    ds_read_b64_tr_b16 a[220:221], v11 offset:30848
    v_mfma_f32_16x16x32_bf16 v[156:159], v[252:255], a[76:79], v[156:159]
    s_add_u32 m0, s32, 32768
    s_mov_b32 s43, 283648
    buffer_load_dwordx4 v23, s[48:51], s43 offen offset:3072 lds
    v_mfma_f32_16x16x32_bf16 v[152:155], v[252:255], a[72:75], v[152:155]
    ds_read_b64_tr_b16 a[222:223], v11 offset:33920
    v_mfma_f32_16x16x32_bf16 v[152:155], v[204:207], a[64:67], v[152:155]
    s_waitcnt vmcnt(20)
    v_mfma_f32_16x16x32_bf16 v[64:67], a[128:131], a[80:83], v[64:67]
    s_barrier
    v_mfma_f32_16x16x32_bf16 v[64:67], a[176:179], a[88:91], v[64:67]
    ds_read_b64_tr_b16 v[160:161], v10 offset:36864
    ds_read_b64_tr_b16 v[162:163], v10 offset:39936
    v_mfma_f32_16x16x32_bf16 v[68:71], a[176:179], a[92:95], v[68:71]
    ds_read_b64_tr_b16 v[208:209], v10 offset:49152
    v_mfma_f32_16x16x32_bf16 v[68:71], a[128:131], a[84:87], v[68:71]
    ds_read_b64_tr_b16 v[210:211], v10 offset:52224
    ds_read_b64_tr_b16 v[164:165], v10 offset:43008
    v_mfma_f32_16x16x32_bf16 v[76:79], a[132:135], a[84:87], v[76:79]
    ds_read_b64_tr_b16 v[166:167], v10 offset:46080
    v_mfma_f32_16x16x32_bf16 v[76:79], a[180:183], a[92:95], v[76:79]
    ds_read_b64_tr_b16 v[212:213], v10 offset:55296
    ds_read_b64_tr_b16 v[214:215], v10 offset:58368
    v_mfma_f32_16x16x32_bf16 v[72:75], a[180:183], a[88:91], v[72:75]
    s_add_u32 m0, s32, 49152
    s_mov_b32 s43, 393216
    buffer_load_dwordx4 v23, s[48:51], s43 offen offset:0 lds
    v_mfma_f32_16x16x32_bf16 v[72:75], a[132:135], a[80:83], v[72:75]
    ds_read_b64_tr_b16 v[168:169], v11 offset:36864
    v_mfma_f32_16x16x32_bf16 v[80:83], a[136:139], a[80:83], v[80:83]
    ds_read_b64_tr_b16 v[170:171], v11 offset:39936
    ds_read_b64_tr_b16 v[216:217], v11 offset:49152
    v_mfma_f32_16x16x32_bf16 v[80:83], a[184:187], a[88:91], v[80:83]
    ds_read_b64_tr_b16 v[218:219], v11 offset:52224
    v_mfma_f32_16x16x32_bf16 v[84:87], a[184:187], a[92:95], v[84:87]
    ds_read_b64_tr_b16 v[172:173], v11 offset:43008
    ds_read_b64_tr_b16 v[174:175], v11 offset:46080
    v_mfma_f32_16x16x32_bf16 v[84:87], a[136:139], a[84:87], v[84:87]
    ds_read_b64_tr_b16 v[220:221], v11 offset:55296
    v_mfma_f32_16x16x32_bf16 v[92:95], a[140:143], a[84:87], v[92:95]
    s_waitcnt lgkmcnt(15)
    ds_read_b64_tr_b16 v[222:223], v11 offset:58368
    ds_read_b64_tr_b16 v[176:177], v10 offset:36928
    v_mfma_f32_16x16x32_bf16 v[92:95], a[188:191], a[92:95], v[92:95]
    ds_read_b64_tr_b16 v[178:179], v10 offset:40000
    v_mfma_f32_16x16x32_bf16 v[88:91], a[188:191], a[88:91], v[88:91]
    ds_read_b64_tr_b16 v[224:225], v10 offset:49216
    v_mfma_f32_16x16x32_bf16 v[88:91], a[140:143], a[80:83], v[88:91]
    ds_read_b64_tr_b16 v[226:227], v10 offset:52288
    v_mfma_f32_16x16x32_bf16 v[96:99], a[144:147], a[80:83], v[96:99]
    ds_read_b64_tr_b16 v[180:181], v10 offset:43072
    v_mfma_f32_16x16x32_bf16 v[96:99], a[192:195], a[88:91], v[96:99]
    ds_read_b64_tr_b16 v[182:183], v10 offset:46144
    v_mfma_f32_16x16x32_bf16 v[100:103], a[192:195], a[92:95], v[100:103]
    s_add_u32 m0, s32, 49152
    s_mov_b32 s43, 400384
    buffer_load_dwordx4 v23, s[48:51], s43 offen offset:1024 lds
    v_mfma_f32_16x16x32_bf16 v[100:103], a[144:147], a[84:87], v[100:103]
    ds_read_b64_tr_b16 v[228:229], v10 offset:55360
    v_mfma_f32_16x16x32_bf16 v[108:111], a[148:151], a[84:87], v[108:111]
    ds_read_b64_tr_b16 v[230:231], v10 offset:58432
    v_mfma_f32_16x16x32_bf16 v[108:111], a[196:199], a[92:95], v[108:111]
    ds_read_b64_tr_b16 v[184:185], v11 offset:36928
    v_mfma_f32_16x16x32_bf16 v[104:107], a[196:199], a[88:91], v[104:107]
    ds_read_b64_tr_b16 v[186:187], v11 offset:40000
    v_mfma_f32_16x16x32_bf16 v[104:107], a[148:151], a[80:83], v[104:107]
    ds_read_b64_tr_b16 v[232:233], v11 offset:49216
    v_mfma_f32_16x16x32_bf16 v[112:115], a[152:155], a[80:83], v[112:115]
    ds_read_b64_tr_b16 v[234:235], v11 offset:52288
    v_mfma_f32_16x16x32_bf16 v[112:115], a[200:203], a[88:91], v[112:115]
    ds_read_b64_tr_b16 v[188:189], v11 offset:43072
    v_mfma_f32_16x16x32_bf16 v[116:119], a[200:203], a[92:95], v[116:119]
    ds_read_b64_tr_b16 v[190:191], v11 offset:46144
    v_mfma_f32_16x16x32_bf16 v[116:119], a[152:155], a[84:87], v[116:119]
    ds_read_b64_tr_b16 v[236:237], v11 offset:55360
    v_mfma_f32_16x16x32_bf16 v[124:127], a[156:159], a[84:87], v[124:127]
    ds_read_b64_tr_b16 v[238:239], v11 offset:58432
    v_mfma_f32_16x16x32_bf16 v[124:127], a[204:207], a[92:95], v[124:127]
    ds_read_b64_tr_b16 v[192:193], v10 offset:36992
    v_mfma_f32_16x16x32_bf16 v[120:123], a[204:207], a[88:91], v[120:123]
    s_add_u32 m0, s32, 49152
    s_mov_b32 s43, 407552
    buffer_load_dwordx4 v23, s[48:51], s43 offen offset:2048 lds
    v_mfma_f32_16x16x32_bf16 v[120:123], a[156:159], a[80:83], v[120:123]
    ds_read_b64_tr_b16 v[194:195], v10 offset:40064
    v_mfma_f32_16x16x32_bf16 v[128:131], a[160:163], a[80:83], v[128:131]
    ds_read_b64_tr_b16 v[240:241], v10 offset:49280
    v_mfma_f32_16x16x32_bf16 v[128:131], a[208:211], a[88:91], v[128:131]
    ds_read_b64_tr_b16 v[242:243], v10 offset:52352
    v_mfma_f32_16x16x32_bf16 v[132:135], a[208:211], a[92:95], v[132:135]
    ds_read_b64_tr_b16 v[196:197], v10 offset:43136
    v_mfma_f32_16x16x32_bf16 v[132:135], a[160:163], a[84:87], v[132:135]
    ds_read_b64_tr_b16 v[198:199], v10 offset:46208
    v_mfma_f32_16x16x32_bf16 v[140:143], a[164:167], a[84:87], v[140:143]
    ds_read_b64_tr_b16 v[244:245], v10 offset:55424
    v_mfma_f32_16x16x32_bf16 v[140:143], a[212:215], a[92:95], v[140:143]
    ds_read_b64_tr_b16 v[246:247], v10 offset:58496
    v_mfma_f32_16x16x32_bf16 v[136:139], a[212:215], a[88:91], v[136:139]
    ds_read_b64_tr_b16 v[200:201], v11 offset:36992
    v_mfma_f32_16x16x32_bf16 v[136:139], a[164:167], a[80:83], v[136:139]
    ds_read_b64_tr_b16 v[202:203], v11 offset:40064
    v_mfma_f32_16x16x32_bf16 v[144:147], a[168:171], a[80:83], v[144:147]
    ds_read_b64_tr_b16 v[248:249], v11 offset:49280
    v_mfma_f32_16x16x32_bf16 v[144:147], a[216:219], a[88:91], v[144:147]
    ds_read_b64_tr_b16 v[250:251], v11 offset:52352
    v_mfma_f32_16x16x32_bf16 v[148:151], a[216:219], a[92:95], v[148:151]
    s_add_u32 m0, s32, 49152
    s_mov_b32 s43, 414720
    buffer_load_dwordx4 v23, s[48:51], s43 offen offset:3072 lds
    v_mfma_f32_16x16x32_bf16 v[148:151], a[168:171], a[84:87], v[148:151]
    ds_read_b64_tr_b16 v[204:205], v11 offset:43136
    v_mfma_f32_16x16x32_bf16 v[156:159], a[172:175], a[84:87], v[156:159]
    ds_read_b64_tr_b16 v[206:207], v11 offset:46208
    v_mfma_f32_16x16x32_bf16 v[156:159], a[220:223], a[92:95], v[156:159]
    ds_read_b64_tr_b16 v[252:253], v11 offset:55424
    v_mfma_f32_16x16x32_bf16 v[152:155], a[220:223], a[88:91], v[152:155]
    ds_read_b64_tr_b16 v[254:255], v11 offset:58496
    v_mfma_f32_16x16x32_bf16 v[152:155], a[172:175], a[80:83], v[152:155]
    s_waitcnt vmcnt(20) lgkmcnt(15)
    v_mfma_f32_16x16x32_bf16 v[64:67], v[160:163], a[96:99], v[64:67]
    s_barrier
    v_mfma_f32_16x16x32_bf16 v[64:67], v[208:211], a[104:107], v[64:67]
    ds_read_b64_tr_b16 a[128:129], v12 offset:0
    ds_read_b64_tr_b16 a[130:131], v12 offset:3072
    v_mfma_f32_16x16x32_bf16 v[68:71], v[208:211], a[108:111], v[68:71]
    ds_read_b64_tr_b16 a[176:177], v12 offset:12288
    v_mfma_f32_16x16x32_bf16 v[68:71], v[160:163], a[100:103], v[68:71]
    s_add_u32 m0, s32, 65536
    s_mov_b32 s43, 524288
    buffer_load_dwordx4 v23, s[48:51], s43 offen offset:0 lds
    v_mfma_f32_16x16x32_bf16 v[76:79], v[164:167], a[100:103], v[76:79]
    ds_read_b64_tr_b16 a[178:179], v12 offset:15360
    ds_read_b64_tr_b16 a[132:133], v12 offset:6144
    v_mfma_f32_16x16x32_bf16 v[76:79], v[212:215], a[108:111], v[76:79]
    ds_read_b64_tr_b16 a[134:135], v12 offset:9216
    v_mfma_f32_16x16x32_bf16 v[72:75], v[212:215], a[104:107], v[72:75]
    ds_read_b64_tr_b16 a[180:181], v12 offset:18432
    ds_read_b64_tr_b16 a[182:183], v12 offset:21504
    v_mfma_f32_16x16x32_bf16 v[72:75], v[164:167], a[96:99], v[72:75]
    ds_read_b64_tr_b16 a[136:137], v13 offset:0
    v_mfma_f32_16x16x32_bf16 v[80:83], v[168:171], a[96:99], v[80:83]
    ds_read_b64_tr_b16 a[138:139], v13 offset:3072
    ds_read_b64_tr_b16 a[184:185], v13 offset:12288
    v_mfma_f32_16x16x32_bf16 v[80:83], v[216:219], a[104:107], v[80:83]
    s_add_u32 m0, s32, 65536
    s_mov_b32 s43, 531456
    buffer_load_dwordx4 v23, s[48:51], s43 offen offset:1024 lds
    v_mfma_f32_16x16x32_bf16 v[84:87], v[216:219], a[108:111], v[84:87]
    ds_read_b64_tr_b16 a[186:187], v13 offset:15360
    v_mfma_f32_16x16x32_bf16 v[84:87], v[168:171], a[100:103], v[84:87]
    ds_read_b64_tr_b16 a[140:141], v13 offset:6144
    ds_read_b64_tr_b16 a[142:143], v13 offset:9216
    v_mfma_f32_16x16x32_bf16 v[92:95], v[172:175], a[100:103], v[92:95]
    ds_read_b64_tr_b16 a[188:189], v13 offset:18432
    v_mfma_f32_16x16x32_bf16 v[92:95], v[220:223], a[108:111], v[92:95]
    ds_read_b64_tr_b16 a[190:191], v13 offset:21504
    ds_read_b64_tr_b16 a[144:145], v12 offset:64
    v_mfma_f32_16x16x32_bf16 v[88:91], v[220:223], a[104:107], v[88:91]
    ds_read_b64_tr_b16 a[146:147], v12 offset:3136
    v_mfma_f32_16x16x32_bf16 v[88:91], v[172:175], a[96:99], v[88:91]
    s_add_u32 m0, s32, 65536
    s_mov_b32 s43, 538624
    buffer_load_dwordx4 v23, s[48:51], s43 offen offset:2048 lds
    v_mfma_f32_16x16x32_bf16 v[96:99], v[176:179], a[96:99], v[96:99]
    ds_read_b64_tr_b16 a[192:193], v12 offset:12352
    ds_read_b64_tr_b16 a[194:195], v12 offset:15424
    v_mfma_f32_16x16x32_bf16 v[96:99], v[224:227], a[104:107], v[96:99]
    ds_read_b64_tr_b16 a[148:149], v12 offset:6208
    v_mfma_f32_16x16x32_bf16 v[100:103], v[224:227], a[108:111], v[100:103]
    ds_read_b64_tr_b16 a[150:151], v12 offset:9280
    ds_read_b64_tr_b16 a[196:197], v12 offset:18496
    v_mfma_f32_16x16x32_bf16 v[100:103], v[176:179], a[100:103], v[100:103]
    ds_read_b64_tr_b16 a[198:199], v12 offset:21568
    v_mfma_f32_16x16x32_bf16 v[108:111], v[180:183], a[100:103], v[108:111]
    ds_read_b64_tr_b16 a[152:153], v13 offset:64
    ds_read_b64_tr_b16 a[154:155], v13 offset:3136
    v_mfma_f32_16x16x32_bf16 v[108:111], v[228:231], a[108:111], v[108:111]
    s_add_u32 m0, s32, 65536
    s_mov_b32 s43, 545792
    buffer_load_dwordx4 v23, s[48:51], s43 offen offset:3072 lds
    v_mfma_f32_16x16x32_bf16 v[104:107], v[228:231], a[104:107], v[104:107]
    ds_read_b64_tr_b16 a[200:201], v13 offset:12352
    v_mfma_f32_16x16x32_bf16 v[104:107], v[180:183], a[96:99], v[104:107]
    ds_read_b64_tr_b16 a[202:203], v13 offset:15424
    ds_read_b64_tr_b16 a[156:157], v13 offset:6208
    v_mfma_f32_16x16x32_bf16 v[112:115], v[184:187], a[96:99], v[112:115]
    ds_read_b64_tr_b16 a[158:159], v13 offset:9280
    v_mfma_f32_16x16x32_bf16 v[112:115], v[232:235], a[104:107], v[112:115]
    ds_read_b64_tr_b16 a[204:205], v13 offset:18496
    v_mfma_f32_16x16x32_bf16 v[116:119], v[232:235], a[108:111], v[116:119]
    s_waitcnt lgkmcnt(15)
    ds_read_b64_tr_b16 a[206:207], v13 offset:21568
    v_mfma_f32_16x16x32_bf16 v[116:119], v[184:187], a[100:103], v[116:119]
    s_add_u32 m0, s32, 81920
    s_mov_b32 s43, 655360
    buffer_load_dwordx4 v23, s[48:51], s43 offen offset:0 lds
    v_mfma_f32_16x16x32_bf16 v[124:127], v[188:191], a[100:103], v[124:127]
    ds_read_b64_tr_b16 a[160:161], v12 offset:128
    v_mfma_f32_16x16x32_bf16 v[124:127], v[236:239], a[108:111], v[124:127]
    ds_read_b64_tr_b16 a[162:163], v12 offset:3200
    v_mfma_f32_16x16x32_bf16 v[120:123], v[236:239], a[104:107], v[120:123]
    ds_read_b64_tr_b16 a[208:209], v12 offset:12416
    v_mfma_f32_16x16x32_bf16 v[120:123], v[188:191], a[96:99], v[120:123]
    ds_read_b64_tr_b16 a[210:211], v12 offset:15488
    v_mfma_f32_16x16x32_bf16 v[128:131], v[192:195], a[96:99], v[128:131]
    ds_read_b64_tr_b16 a[164:165], v12 offset:6272
    v_mfma_f32_16x16x32_bf16 v[128:131], v[240:243], a[104:107], v[128:131]
    s_add_u32 m0, s32, 81920
    s_mov_b32 s43, 662528
    buffer_load_dwordx4 v23, s[48:51], s43 offen offset:1024 lds
    v_mfma_f32_16x16x32_bf16 v[132:135], v[240:243], a[108:111], v[132:135]
    ds_read_b64_tr_b16 a[166:167], v12 offset:9344
    v_mfma_f32_16x16x32_bf16 v[132:135], v[192:195], a[100:103], v[132:135]
    ds_read_b64_tr_b16 a[212:213], v12 offset:18560
    v_mfma_f32_16x16x32_bf16 v[140:143], v[196:199], a[100:103], v[140:143]
    ds_read_b64_tr_b16 a[214:215], v12 offset:21632
    v_mfma_f32_16x16x32_bf16 v[140:143], v[244:247], a[108:111], v[140:143]
    ds_read_b64_tr_b16 a[168:169], v13 offset:128
    v_mfma_f32_16x16x32_bf16 v[136:139], v[244:247], a[104:107], v[136:139]
    ds_read_b64_tr_b16 a[170:171], v13 offset:3200
    v_mfma_f32_16x16x32_bf16 v[136:139], v[196:199], a[96:99], v[136:139]
    s_add_u32 m0, s32, 81920
    s_mov_b32 s43, 669696
    buffer_load_dwordx4 v23, s[48:51], s43 offen offset:2048 lds
    v_mfma_f32_16x16x32_bf16 v[144:147], v[200:203], a[96:99], v[144:147]
    ds_read_b64_tr_b16 a[216:217], v13 offset:12416
    v_mfma_f32_16x16x32_bf16 v[144:147], v[248:251], a[104:107], v[144:147]
    ds_read_b64_tr_b16 a[218:219], v13 offset:15488
    v_mfma_f32_16x16x32_bf16 v[148:151], v[248:251], a[108:111], v[148:151]
    ds_read_b64_tr_b16 a[172:173], v13 offset:6272
    v_mfma_f32_16x16x32_bf16 v[148:151], v[200:203], a[100:103], v[148:151]
    ds_read_b64_tr_b16 a[174:175], v13 offset:9344
    v_mfma_f32_16x16x32_bf16 v[156:159], v[204:207], a[100:103], v[156:159]
    ds_read_b64_tr_b16 a[220:221], v13 offset:18560
    v_mfma_f32_16x16x32_bf16 v[156:159], v[252:255], a[108:111], v[156:159]
    s_add_u32 m0, s32, 81920
    s_mov_b32 s43, 676864
    buffer_load_dwordx4 v23, s[48:51], s43 offen offset:3072 lds
    v_mfma_f32_16x16x32_bf16 v[152:155], v[252:255], a[104:107], v[152:155]
    ds_read_b64_tr_b16 a[222:223], v13 offset:21632
    v_mfma_f32_16x16x32_bf16 v[152:155], v[204:207], a[96:99], v[152:155]
    s_waitcnt vmcnt(24)
    v_mfma_f32_16x16x32_bf16 v[64:67], a[128:131], a[112:115], v[64:67]
    s_mov_b32 s36, 0
    s_mov_b32 s37, 44032
    v_mfma_f32_16x16x32_bf16 v[64:67], a[176:179], a[120:123], v[64:67]
    v_mfma_f32_16x16x32_bf16 v[72:75], a[180:183], a[120:123], v[72:75]
    v_mfma_f32_16x16x32_bf16 v[72:75], a[132:135], a[112:115], v[72:75]
    v_mfma_f32_16x16x32_bf16 v[80:83], a[136:139], a[112:115], v[80:83]
    v_mfma_f32_16x16x32_bf16 v[80:83], a[184:187], a[120:123], v[80:83]
    v_mfma_f32_16x16x32_bf16 v[88:91], a[188:191], a[120:123], v[88:91]
    v_mfma_f32_16x16x32_bf16 v[88:91], a[140:143], a[112:115], v[88:91]
    s_waitcnt lgkmcnt(0)
    v_mfma_f32_16x16x32_bf16 v[68:71], a[128:131], a[116:119], v[68:71]
    v_mfma_f32_16x16x32_bf16 v[68:71], a[176:179], a[124:127], v[68:71]
    v_mfma_f32_16x16x32_bf16 v[76:79], a[180:183], a[124:127], v[76:79]
    v_mul_f32 v64, v64, v72
    v_mul_f32 v65, v65, v73
    v_mfma_f32_16x16x32_bf16 v[76:79], a[132:135], a[116:119], v[76:79]
    v_mul_f32 v66, v66, v74
    v_mul_f32 v67, v67, v75
    v_mfma_f32_16x16x32_bf16 v[84:87], a[136:139], a[116:119], v[84:87]
    v_cvt_pk_bf16_f32 v32, v64, v65
    v_cvt_pk_bf16_f32 v33, v66, v67
    v_mfma_f32_16x16x32_bf16 v[84:87], a[184:187], a[124:127], v[84:87]
    v_mul_f32 v80, v80, v88
    v_mul_f32 v81, v81, v89
    v_mfma_f32_16x16x32_bf16 v[92:95], a[188:191], a[124:127], v[92:95]
    v_mul_f32 v82, v82, v90
    v_mul_f32 v83, v83, v91
    v_mfma_f32_16x16x32_bf16 v[92:95], a[140:143], a[116:119], v[92:95]
    v_cvt_pk_bf16_f32 v34, v80, v81
    v_cvt_pk_bf16_f32 v35, v82, v83
    v_mfma_f32_16x16x32_bf16 v[96:99], a[144:147], a[112:115], v[96:99]
    buffer_store_dwordx4 v[32:35], v26, s[20:23], s36 offen offset:0 sc1
    v_mfma_f32_16x16x32_bf16 v[96:99], a[192:195], a[120:123], v[96:99]
    v_mul_f32 v68, v68, v76
    v_mul_f32 v69, v69, v77
    v_mfma_f32_16x16x32_bf16 v[104:107], a[196:199], a[120:123], v[104:107]
    v_mul_f32 v70, v70, v78
    v_mul_f32 v71, v71, v79
    v_mfma_f32_16x16x32_bf16 v[104:107], a[148:151], a[112:115], v[104:107]
    v_cvt_pk_bf16_f32 v36, v68, v69
    v_cvt_pk_bf16_f32 v37, v70, v71
    v_mfma_f32_16x16x32_bf16 v[112:115], a[152:155], a[112:115], v[112:115]
    v_mul_f32 v84, v84, v92
    v_mul_f32 v85, v85, v93
    v_mfma_f32_16x16x32_bf16 v[112:115], a[200:203], a[120:123], v[112:115]
    v_mul_f32 v86, v86, v94
    v_mul_f32 v87, v87, v95
    v_mfma_f32_16x16x32_bf16 v[120:123], a[204:207], a[120:123], v[120:123]
    v_cvt_pk_bf16_f32 v38, v84, v85
    v_cvt_pk_bf16_f32 v39, v86, v87
    v_mfma_f32_16x16x32_bf16 v[120:123], a[156:159], a[112:115], v[120:123]
    buffer_store_dwordx4 v[36:39], v26, s[20:23], s37 offen offset:0 sc1
    v_mfma_f32_16x16x32_bf16 v[100:103], a[144:147], a[116:119], v[100:103]
    v_mul_f32 v96, v96, v104
    v_mul_f32 v97, v97, v105
    v_mfma_f32_16x16x32_bf16 v[100:103], a[192:195], a[124:127], v[100:103]
    v_mul_f32 v98, v98, v106
    v_mul_f32 v99, v99, v107
    v_mfma_f32_16x16x32_bf16 v[108:111], a[196:199], a[124:127], v[108:111]
    v_cvt_pk_bf16_f32 v40, v96, v97
    v_cvt_pk_bf16_f32 v41, v98, v99
    v_mfma_f32_16x16x32_bf16 v[108:111], a[148:151], a[116:119], v[108:111]
    v_mul_f32 v112, v112, v120
    v_mul_f32 v113, v113, v121
    v_mfma_f32_16x16x32_bf16 v[116:119], a[152:155], a[116:119], v[116:119]
    v_mul_f32 v114, v114, v122
    v_mul_f32 v115, v115, v123
    v_mfma_f32_16x16x32_bf16 v[116:119], a[200:203], a[124:127], v[116:119]
    v_cvt_pk_bf16_f32 v42, v112, v113
    v_cvt_pk_bf16_f32 v43, v114, v115
    v_mfma_f32_16x16x32_bf16 v[124:127], a[204:207], a[124:127], v[124:127]
    buffer_store_dwordx4 v[40:43], v26, s[28:31], s36 offen offset:1024 sc1
    v_mfma_f32_16x16x32_bf16 v[124:127], a[156:159], a[116:119], v[124:127]
    v_mul_f32 v100, v100, v108
    v_mul_f32 v101, v101, v109
    v_mfma_f32_16x16x32_bf16 v[128:131], a[160:163], a[112:115], v[128:131]
    v_mul_f32 v102, v102, v110
    v_mul_f32 v103, v103, v111
    v_mfma_f32_16x16x32_bf16 v[128:131], a[208:211], a[120:123], v[128:131]
    v_cvt_pk_bf16_f32 v44, v100, v101
    v_cvt_pk_bf16_f32 v45, v102, v103
    v_mfma_f32_16x16x32_bf16 v[136:139], a[212:215], a[120:123], v[136:139]
    v_mul_f32 v116, v116, v124
    v_mul_f32 v117, v117, v125
    v_mfma_f32_16x16x32_bf16 v[136:139], a[164:167], a[112:115], v[136:139]
    v_mul_f32 v118, v118, v126
    v_mul_f32 v119, v119, v127
    v_mfma_f32_16x16x32_bf16 v[144:147], a[168:171], a[112:115], v[144:147]
    v_cvt_pk_bf16_f32 v46, v116, v117
    v_cvt_pk_bf16_f32 v47, v118, v119
    v_mfma_f32_16x16x32_bf16 v[144:147], a[216:219], a[120:123], v[144:147]
    buffer_store_dwordx4 v[44:47], v26, s[28:31], s37 offen offset:1024 sc1
    v_mfma_f32_16x16x32_bf16 v[152:155], a[220:223], a[120:123], v[152:155]
    v_mul_f32 v128, v128, v136
    v_mul_f32 v129, v129, v137
    v_mfma_f32_16x16x32_bf16 v[152:155], a[172:175], a[112:115], v[152:155]
    v_mul_f32 v130, v130, v138
    v_mul_f32 v131, v131, v139
    v_mfma_f32_16x16x32_bf16 v[132:135], a[160:163], a[116:119], v[132:135]
    v_cvt_pk_bf16_f32 v32, v128, v129
    v_cvt_pk_bf16_f32 v33, v130, v131
    v_mfma_f32_16x16x32_bf16 v[132:135], a[208:211], a[124:127], v[132:135]
    v_mfma_f32_16x16x32_bf16 v[140:143], a[212:215], a[124:127], v[140:143]
    v_mfma_f32_16x16x32_bf16 v[140:143], a[164:167], a[116:119], v[140:143]
    v_mul_f32 v144, v144, v152
    v_mul_f32 v145, v145, v153
    v_mfma_f32_16x16x32_bf16 v[148:151], a[168:171], a[116:119], v[148:151]
    v_mul_f32 v146, v146, v154
    v_mul_f32 v147, v147, v155
    v_mfma_f32_16x16x32_bf16 v[148:151], a[216:219], a[124:127], v[148:151]
    v_cvt_pk_bf16_f32 v34, v144, v145
    v_cvt_pk_bf16_f32 v35, v146, v147
    v_mfma_f32_16x16x32_bf16 v[156:159], a[220:223], a[124:127], v[156:159]
    buffer_store_dwordx4 v[32:35], v26, s[28:31], s36 offen offset:2048 sc1
    v_mfma_f32_16x16x32_bf16 v[156:159], a[172:175], a[116:119], v[156:159]
    v_mul_f32 v132, v132, v140
    v_mul_f32 v133, v133, v141
    v_mul_f32 v134, v134, v142
    v_mul_f32 v135, v135, v143
    v_cvt_pk_bf16_f32 v36, v132, v133
    v_cvt_pk_bf16_f32 v37, v134, v135
    s_nop 0
    s_nop 0
    v_mul_f32 v148, v148, v156
    v_mul_f32 v149, v149, v157
    v_mul_f32 v150, v150, v158
    v_mul_f32 v151, v151, v159
    v_cvt_pk_bf16_f32 v38, v148, v149
    v_cvt_pk_bf16_f32 v39, v150, v151
    buffer_store_dwordx4 v[36:39], v26, s[28:31], s37 offen offset:2048 sc1
    s_branch k1_c_done
k1_c15:
    s_add_u32 m0, s32, 0
    s_mov_b32 s43, 0
    buffer_load_dwordx4 v23, s[48:51], s43 offen offset:0 lds
    s_add_u32 m0, s32, 0
    s_mov_b32 s43, 7168
    buffer_load_dwordx4 v23, s[48:51], s43 offen offset:1024 lds
    s_add_u32 m0, s32, 0
    s_mov_b32 s43, 14336
    buffer_load_dwordx4 v23, s[48:51], s43 offen offset:2048 lds
    s_add_u32 m0, s32, 0
    s_mov_b32 s43, 21504
    buffer_load_dwordx4 v23, s[48:51], s43 offen offset:3072 lds
    s_add_u32 m0, s32, 16384
    s_mov_b32 s43, 131072
    buffer_load_dwordx4 v23, s[48:51], s43 offen offset:0 lds
    s_add_u32 m0, s32, 16384
    s_mov_b32 s43, 138240
    buffer_load_dwordx4 v23, s[48:51], s43 offen offset:1024 lds
    s_add_u32 m0, s32, 16384
    s_mov_b32 s43, 145408
    buffer_load_dwordx4 v23, s[48:51], s43 offen offset:2048 lds
    s_add_u32 m0, s32, 16384
    s_mov_b32 s43, 152576
    buffer_load_dwordx4 v23, s[48:51], s43 offen offset:3072 lds
    s_add_u32 m0, s32, 32768
    s_mov_b32 s43, 262144
    buffer_load_dwordx4 v23, s[48:51], s43 offen offset:0 lds
    s_add_u32 m0, s32, 32768
    s_mov_b32 s43, 269312
    buffer_load_dwordx4 v23, s[48:51], s43 offen offset:1024 lds
    s_add_u32 m0, s32, 32768
    s_mov_b32 s43, 276480
    buffer_load_dwordx4 v23, s[48:51], s43 offen offset:2048 lds
    s_add_u32 m0, s32, 32768
    s_mov_b32 s43, 283648
    buffer_load_dwordx4 v23, s[48:51], s43 offen offset:3072 lds
    s_add_u32 m0, s32, 49152
    s_mov_b32 s43, 393216
    buffer_load_dwordx4 v23, s[48:51], s43 offen offset:0 lds
    s_add_u32 m0, s32, 49152
    s_mov_b32 s43, 400384
    buffer_load_dwordx4 v23, s[48:51], s43 offen offset:1024 lds
    s_add_u32 m0, s32, 49152
    s_mov_b32 s43, 407552
    buffer_load_dwordx4 v23, s[48:51], s43 offen offset:2048 lds
    s_add_u32 m0, s32, 49152
    s_mov_b32 s43, 414720
    buffer_load_dwordx4 v23, s[48:51], s43 offen offset:3072 lds
    s_add_u32 m0, s32, 65536
    s_mov_b32 s43, 524288
    buffer_load_dwordx4 v23, s[48:51], s43 offen offset:0 lds
    s_add_u32 m0, s32, 65536
    s_mov_b32 s43, 531456
    buffer_load_dwordx4 v23, s[48:51], s43 offen offset:1024 lds
    s_add_u32 m0, s32, 65536
    s_mov_b32 s43, 538624
    buffer_load_dwordx4 v23, s[48:51], s43 offen offset:2048 lds
    s_add_u32 m0, s32, 65536
    s_mov_b32 s43, 545792
    buffer_load_dwordx4 v23, s[48:51], s43 offen offset:3072 lds
    s_add_u32 m0, s32, 81920
    s_mov_b32 s43, 655360
    buffer_load_dwordx4 v23, s[48:51], s43 offen offset:0 lds
    s_add_u32 m0, s32, 81920
    s_mov_b32 s43, 662528
    buffer_load_dwordx4 v23, s[48:51], s43 offen offset:1024 lds
    s_add_u32 m0, s32, 81920
    s_mov_b32 s43, 669696
    buffer_load_dwordx4 v23, s[48:51], s43 offen offset:2048 lds
    s_add_u32 m0, s32, 81920
    s_mov_b32 s43, 676864
    buffer_load_dwordx4 v23, s[48:51], s43 offen offset:3072 lds
k1_c_done:
    v_lshlrev_b32 v60, 7, v59
    v_lshl_add_u32 v60, v58, 3, v60
    v_bfe_u32 v61, v59, 1, 2
    v_lshrrev_b32 v62, 1, v1
    v_lshl_add_u32 v60, v62, 13, v60
    v_xor_b32 v62, 0, v61
    v_lshl_add_u32 v8, v62, 5, v60
    v_add_u32 v12, 0x10000, v8
    v_add_u32 v16, 0x20000, v8
    v_xor_b32 v62, 1, v61
    v_lshl_add_u32 v9, v62, 5, v60
    v_add_u32 v13, 0x10000, v9
    v_add_u32 v17, 0x20000, v9
    v_xor_b32 v62, 2, v61
    v_lshl_add_u32 v10, v62, 5, v60
    v_add_u32 v14, 0x10000, v10
    v_add_u32 v18, 0x20000, v10
    v_xor_b32 v62, 3, v61
    v_lshl_add_u32 v11, v62, 5, v60
    v_add_u32 v15, 0x10000, v11
    v_add_u32 v19, 0x20000, v11
    s_lshl_b32 s6, s33, 1
    s_lshr_b32 s7, s34, 3
    s_add_u32 s6, s6, s7
    s_lshl_b32 s6, s6, 1
    s_and_b32 s7, s45, 1
    s_add_u32 s6, s6, s7
    s_lshl_b32 s44, s6, 1
    s_lshr_b32 s46, s45, 1
    s_mul_i32 s6, s44, 44032
    s_lshl_b32 s7, s46, 11
    s_add_u32 s6, s6, s7
    s_add_u32 s6, s6, 0x2800000
    s_add_u32 s24, s54, s6
    s_addc_u32 s25, s55, 0
    s_sub_u32 s26, 88064, s7
    s_add_u32 s44, s44, s46
    s_mul_i32 s46, s46, 44032
    s_sub_u32 s47, 44032, s46
    s_lshl_b32 s44, s44, 14
    s_and_b32 s7, s34, 7
    s_lshl_b32 s6, s7, 7
    s_add_u32 s6, s6, s44
    s_add_u32 s12, s98, s6
    s_addc_u32 s13, s99, 0
    s_sub_u32 s14, 2097152, s6
    s_lshl_b32 s6, s7, 11
    s_add_u32 s44, s44, s6
    s_lshl_b32 s7, s7, 8
    s_add_u32 s7, s7, 161792
    v_bfe_u32 v57, v26, 4, 4
    v_lshlrev_b32 v24, 10, v57
    v_lshl_add_u32 v24, v56, 4, v24
    v_lshlrev_b32 v25, 4, v56
    v_add_u32 v25, s7, v25
    v_lshl_add_u32 v28, v1, 12, v26
    v_add_u32 v28, 32768, v28
    v_xor_b32 v29, 0x2000, v28
    s_lshl_b32 s63, s33, 11
    s_add_u32 s63, s63, 98304
    v_lshlrev_b32 v2, 3, v26
    s_lshl_b32 s6, s34, 2
    v_add_u32 v2, s6, v2
    v_mov_b32 v3, 0x5ac3e19b
    v_bfe_u32 v4, v26, 4, 4
    v_lshlrev_b32 v4, 2, v4
    s_lshl_b32 s6, s34, 7
    v_add_u32 v4, s6, v4
    s_waitcnt vmcnt(0)
    s_barrier
    s_cmp_eq_u32 s45, 1
    s_cbranch_scc0 k1_h3_a
    s_mov_b64 exec, 0xffff
    buffer_store_dword v3, v2, s[8:11], s63 offen sc1
    s_mov_b64 exec, -1
k1_h3_a:
    buffer_load_dwordx4 v[48:51], v26, s[16:19], s44 offen offset:0 sc1
    buffer_load_dwordx4 v[52:55], v26, s[16:19], s44 offen offset:1024 sc1
    s_add_u32 m0, s32, 98304
    s_mov_b32 s43, 786432
    buffer_load_dwordx4 v23, s[48:51], s43 offen offset:0 lds
    s_add_u32 m0, s32, 98304
    s_mov_b32 s43, 793600
    buffer_load_dwordx4 v23, s[48:51], s43 offen offset:1024 lds
    s_add_u32 m0, s32, 98304
    s_mov_b32 s43, 800768
    buffer_load_dwordx4 v23, s[48:51], s43 offen offset:2048 lds
    s_add_u32 m0, s32, 98304
    s_mov_b32 s43, 807936
    buffer_load_dwordx4 v23, s[48:51], s43 offen offset:3072 lds
    s_add_u32 m0, s32, 114688
    s_mov_b32 s43, 917504
    buffer_load_dwordx4 v23, s[48:51], s43 offen offset:0 lds
    s_add_u32 m0, s32, 114688
    s_mov_b32 s43, 924672
    buffer_load_dwordx4 v23, s[48:51], s43 offen offset:1024 lds
    s_add_u32 m0, s32, 114688
    s_mov_b32 s43, 931840
    buffer_load_dwordx4 v23, s[48:51], s43 offen offset:2048 lds
    s_add_u32 m0, s32, 114688
    s_mov_b32 s43, 939008
    buffer_load_dwordx4 v23, s[48:51], s43 offen offset:3072 lds
    ds_read_b128 v[32:35], v25 offset:0
    ds_read_b128 v[36:39], v25 offset:64
    ds_read_b128 v[40:43], v25 offset:128
    ds_read_b128 v[44:47], v25 offset:192
    ds_read_b64_tr_b16 v[128:129], v8 offset:0
    ds_read_b64_tr_b16 v[130:131], v8 offset:2048
    ds_read_b64_tr_b16 v[144:145], v8 offset:4096
    ds_read_b64_tr_b16 v[146:147], v8 offset:6144
    ds_read_b64_tr_b16 v[132:133], v9 offset:0
    ds_read_b64_tr_b16 v[134:135], v9 offset:2048
    ds_read_b64_tr_b16 v[148:149], v9 offset:4096
    ds_read_b64_tr_b16 v[150:151], v9 offset:6144
    ds_read_b64_tr_b16 v[136:137], v10 offset:0
    ds_read_b64_tr_b16 v[138:139], v10 offset:2048
    ds_read_b64_tr_b16 v[152:153], v10 offset:4096
    ds_read_b64_tr_b16 v[154:155], v10 offset:6144
    ds_read_b64_tr_b16 v[140:141], v11 offset:0
    ds_read_b64_tr_b16 v[142:143], v11 offset:2048
    ds_read_b64_tr_b16 v[156:157], v11 offset:4096
    ds_read_b64_tr_b16 v[158:159], v11 offset:6144
    s_cmp_eq_u32 s45, 0
    s_cbranch_scc0 k1_h3_c
    s_mov_b32 s7, 0
k1_h3_b:
    buffer_load_dword v3, v4, s[8:11], s63 offen sc1
    s_waitcnt vmcnt(0)
    v_cmp_ne_u32 vcc, 0x5ac3e19b, v3
    s_cbranch_vccz k1_h3_d
    s_add_u32 s7, s7, 1
    s_cmp_lt_u32 s7, 0x10000
    s_cbranch_scc1 k1_h3_b
k1_h3_c:
    s_waitcnt vmcnt(0)
k1_h3_d:
    s_barrier
    s_add_u32 s36, s46, 0
    buffer_load_dwordx4 a[0:3], v26, s[24:27], s36 offen offset:0 sc1
    s_add_u32 s36, s46, 0
    buffer_load_dwordx4 a[8:11], v26, s[24:27], s36 offen offset:1024 sc1
    s_add_u32 s37, s47, 0
    buffer_load_dwordx4 a[4:7], v26, s[24:27], s37 offen offset:0 sc1
    s_add_u32 s37, s47, 0
    buffer_load_dwordx4 a[12:15], v26, s[24:27], s37 offen offset:1024 sc1
    s_add_u32 s36, s46, 4096
    buffer_load_dwordx4 a[16:19], v26, s[24:27], s36 offen offset:0 sc1
    s_add_u32 s36, s46, 4096
    buffer_load_dwordx4 a[24:27], v26, s[24:27], s36 offen offset:1024 sc1
    s_add_u32 s37, s47, 4096
    buffer_load_dwordx4 a[20:23], v26, s[24:27], s37 offen offset:0 sc1
    s_add_u32 s37, s47, 4096
    buffer_load_dwordx4 a[28:31], v26, s[24:27], s37 offen offset:1024 sc1
    s_add_u32 s36, s46, 8192
    buffer_load_dwordx4 a[32:35], v26, s[24:27], s36 offen offset:0 sc1
    s_add_u32 s36, s46, 8192
    buffer_load_dwordx4 a[40:43], v26, s[24:27], s36 offen offset:1024 sc1
    s_add_u32 s37, s47, 8192
    buffer_load_dwordx4 a[36:39], v26, s[24:27], s37 offen offset:0 sc1
    s_add_u32 s37, s47, 8192
    buffer_load_dwordx4 a[44:47], v26, s[24:27], s37 offen offset:1024 sc1
    v_lshlrev_b32 v96, 16, v48
    v_and_b32 v97, 0xffff0000, v48
    v_lshlrev_b32 v98, 16, v49
    v_and_b32 v99, 0xffff0000, v49
    v_lshlrev_b32 v100, 16, v50
    v_and_b32 v101, 0xffff0000, v50
    v_lshlrev_b32 v102, 16, v51
    v_and_b32 v103, 0xffff0000, v51
    v_lshlrev_b32 v104, 16, v52
    v_and_b32 v105, 0xffff0000, v52
    v_lshlrev_b32 v106, 16, v53
    v_and_b32 v107, 0xffff0000, v53
    v_lshlrev_b32 v108, 16, v54
    v_and_b32 v109, 0xffff0000, v54
    v_lshlrev_b32 v110, 16, v55
    v_and_b32 v111, 0xffff0000, v55
    s_waitcnt vmcnt(8) lgkmcnt(8)
    v_mfma_f32_16x16x32_bf16 v[64:67], v[128:131], a[0:3], 0
    ds_read_b64_tr_b16 v[160:161], v8 offset:16384
    ds_read_b64_tr_b16 v[162:163], v8 offset:18432
    v_mfma_f32_16x16x32_bf16 v[64:67], v[144:147], a[8:11], v[64:67]
    s_add_u32 s36, s46, 12288
    buffer_load_dwordx4 a[48:51], v26, s[24:27], s36 offen offset:0 sc1
    v_mfma_f32_16x16x32_bf16 v[80:83], v[144:147], a[12:15], 0
    ds_read_b64_tr_b16 v[176:177], v8 offset:20480
    ds_read_b64_tr_b16 v[178:179], v8 offset:22528
    v_mfma_f32_16x16x32_bf16 v[80:83], v[128:131], a[4:7], v[80:83]
    s_add_u32 s36, s46, 12288
    buffer_load_dwordx4 a[56:59], v26, s[24:27], s36 offen offset:1024 sc1
    v_mfma_f32_16x16x32_bf16 v[84:87], v[132:135], a[4:7], 0
    ds_read_b64_tr_b16 v[164:165], v9 offset:16384
    ds_read_b64_tr_b16 v[166:167], v9 offset:18432
    v_mfma_f32_16x16x32_bf16 v[84:87], v[148:151], a[12:15], v[84:87]
    s_add_u32 m0, s32, 131072
    s_mov_b32 s43, 1048576
    buffer_load_dwordx4 v23, s[48:51], s43 offen offset:0 lds
    v_mfma_f32_16x16x32_bf16 v[68:71], v[148:151], a[8:11], 0
    s_waitcnt lgkmcnt(6)
    ds_read_b64_tr_b16 v[180:181], v9 offset:20480
    ds_read_b64_tr_b16 v[182:183], v9 offset:22528
    v_mfma_f32_16x16x32_bf16 v[68:71], v[132:135], a[0:3], v[68:71]
    s_add_u32 m0, s32, 131072
    s_mov_b32 s43, 1055744
    buffer_load_dwordx4 v23, s[48:51], s43 offen offset:1024 lds
    v_mfma_f32_16x16x32_bf16 v[72:75], v[136:139], a[0:3], 0
    ds_read_b64_tr_b16 v[168:169], v10 offset:16384
    ds_read_b64_tr_b16 v[170:171], v10 offset:18432
    v_mfma_f32_16x16x32_bf16 v[72:75], v[152:155], a[8:11], v[72:75]
    s_add_u32 m0, s32, 131072
    s_mov_b32 s43, 1062912
    buffer_load_dwordx4 v23, s[48:51], s43 offen offset:2048 lds
    v_mfma_f32_16x16x32_bf16 v[88:91], v[152:155], a[12:15], 0
    ds_read_b64_tr_b16 v[184:185], v10 offset:20480
    ds_read_b64_tr_b16 v[186:187], v10 offset:22528
    v_mfma_f32_16x16x32_bf16 v[88:91], v[136:139], a[4:7], v[88:91]
    s_add_u32 m0, s32, 131072
    s_mov_b32 s43, 1070080
    buffer_load_dwordx4 v23, s[48:51], s43 offen offset:3072 lds
    v_mfma_f32_16x16x32_bf16 v[92:95], v[140:143], a[4:7], 0
    ds_read_b64_tr_b16 v[172:173], v11 offset:16384
    ds_read_b64_tr_b16 v[174:175], v11 offset:18432
    v_mfma_f32_16x16x32_bf16 v[92:95], v[156:159], a[12:15], v[92:95]
    s_add_u32 s37, s47, 12288
    buffer_load_dwordx4 a[52:55], v26, s[24:27], s37 offen offset:0 sc1
    v_mfma_f32_16x16x32_bf16 v[76:79], v[156:159], a[8:11], 0
    ds_read_b64_tr_b16 v[188:189], v11 offset:20480
    ds_read_b64_tr_b16 v[190:191], v11 offset:22528
    v_mfma_f32_16x16x32_bf16 v[76:79], v[140:143], a[0:3], v[76:79]
    s_add_u32 s37, s47, 12288
    buffer_load_dwordx4 a[60:63], v26, s[24:27], s37 offen offset:1024 sc1
    s_waitcnt vmcnt(12) lgkmcnt(8)
    v_mfma_f32_16x16x32_bf16 v[64:67], v[160:163], a[16:19], v[64:67]
    ds_read_b64_tr_b16 v[128:129], v8 offset:32768
    ds_read_b64_tr_b16 v[130:131], v8 offset:34816
    v_mfma_f32_16x16x32_bf16 v[64:67], v[176:179], a[24:27], v[64:67]
    s_add_u32 s36, s46, 16384
    buffer_load_dwordx4 a[64:67], v26, s[24:27], s36 offen offset:0 sc1
    v_mfma_f32_16x16x32_bf16 v[80:83], v[176:179], a[28:31], v[80:83]
    ds_read_b64_tr_b16 v[144:145], v8 offset:36864
    ds_read_b64_tr_b16 v[146:147], v8 offset:38912
    v_mfma_f32_16x16x32_bf16 v[80:83], v[160:163], a[20:23], v[80:83]
    s_add_u32 s36, s46, 16384
    buffer_load_dwordx4 a[72:75], v26, s[24:27], s36 offen offset:1024 sc1
    v_mfma_f32_16x16x32_bf16 v[84:87], v[164:167], a[20:23], v[84:87]
    ds_read_b64_tr_b16 v[132:133], v9 offset:32768
    ds_read_b64_tr_b16 v[134:135], v9 offset:34816
    v_mfma_f32_16x16x32_bf16 v[84:87], v[180:183], a[28:31], v[84:87]
    s_add_u32 s37, s47, 16384
    buffer_load_dwordx4 a[68:71], v26, s[24:27], s37 offen offset:0 sc1
    v_mfma_f32_16x16x32_bf16 v[68:71], v[180:183], a[24:27], v[68:71]
    s_waitcnt lgkmcnt(6)
    ds_read_b64_tr_b16 v[148:149], v9 offset:36864
    ds_read_b64_tr_b16 v[150:151], v9 offset:38912
    v_mfma_f32_16x16x32_bf16 v[68:71], v[164:167], a[16:19], v[68:71]
    s_add_u32 s37, s47, 16384
    buffer_load_dwordx4 a[76:79], v26, s[24:27], s37 offen offset:1024 sc1
    v_mfma_f32_16x16x32_bf16 v[72:75], v[168:171], a[16:19], v[72:75]
    ds_read_b64_tr_b16 v[136:137], v10 offset:32768
    ds_read_b64_tr_b16 v[138:139], v10 offset:34816
    v_mfma_f32_16x16x32_bf16 v[72:75], v[184:187], a[24:27], v[72:75]
    ds_read_b64_tr_b16 v[152:153], v10 offset:36864
    ds_read_b64_tr_b16 v[154:155], v10 offset:38912
    v_mfma_f32_16x16x32_bf16 v[88:91], v[184:187], a[28:31], v[88:91]
    ds_read_b64_tr_b16 v[140:141], v11 offset:32768
    ds_read_b64_tr_b16 v[142:143], v11 offset:34816
    v_mfma_f32_16x16x32_bf16 v[88:91], v[168:171], a[20:23], v[88:91]
    ds_read_b64_tr_b16 v[156:157], v11 offset:36864
    ds_read_b64_tr_b16 v[158:159], v11 offset:38912
    v_mfma_f32_16x16x32_bf16 v[92:95], v[172:175], a[20:23], v[92:95]
    v_mfma_f32_16x16x32_bf16 v[92:95], v[188:191], a[28:31], v[92:95]
    v_mfma_f32_16x16x32_bf16 v[76:79], v[188:191], a[24:27], v[76:79]
    v_mfma_f32_16x16x32_bf16 v[76:79], v[172:175], a[16:19], v[76:79]
    s_waitcnt vmcnt(12) lgkmcnt(8)
    v_mfma_f32_16x16x32_bf16 v[64:67], v[128:131], a[32:35], v[64:67]
    s_barrier
    ds_read_b64_tr_b16 v[160:161], v8 offset:49152
    ds_read_b64_tr_b16 v[162:163], v8 offset:51200
    v_mfma_f32_16x16x32_bf16 v[64:67], v[144:147], a[40:43], v[64:67]
    s_add_u32 s36, s46, 20480
    buffer_load_dwordx4 a[80:83], v26, s[24:27], s36 offen offset:0 sc1
    v_mfma_f32_16x16x32_bf16 v[80:83], v[144:147], a[44:47], v[80:83]
    ds_read_b64_tr_b16 v[176:177], v8 offset:53248
    ds_read_b64_tr_b16 v[178:179], v8 offset:55296
    v_mfma_f32_16x16x32_bf16 v[80:83], v[128:131], a[36:39], v[80:83]
    s_add_u32 s36, s46, 20480
    buffer_load_dwordx4 a[88:91], v26, s[24:27], s36 offen offset:1024 sc1
    v_mfma_f32_16x16x32_bf16 v[84:87], v[132:135], a[36:39], v[84:87]
    ds_read_b64_tr_b16 v[164:165], v9 offset:49152
    ds_read_b64_tr_b16 v[166:167], v9 offset:51200
    v_mfma_f32_16x16x32_bf16 v[84:87], v[148:151], a[44:47], v[84:87]
    s_add_u32 m0, s32, 0
    s_mov_b32 s43, 1179648
    buffer_load_dwordx4 v23, s[48:51], s43 offen offset:0 lds
    v_mfma_f32_16x16x32_bf16 v[68:71], v[148:151], a[40:43], v[68:71]
    s_waitcnt lgkmcnt(6)
    ds_read_b64_tr_b16 v[180:181], v9 offset:53248
    ds_read_b64_tr_b16 v[182:183], v9 offset:55296
    v_mfma_f32_16x16x32_bf16 v[68:71], v[132:135], a[32:35], v[68:71]
    s_add_u32 m0, s32, 0
    s_mov_b32 s43, 1186816
    buffer_load_dwordx4 v23, s[48:51], s43 offen offset:1024 lds
    v_mfma_f32_16x16x32_bf16 v[72:75], v[136:139], a[32:35], v[72:75]
    ds_read_b64_tr_b16 v[168:169], v10 offset:49152
    ds_read_b64_tr_b16 v[170:171], v10 offset:51200
    v_mfma_f32_16x16x32_bf16 v[72:75], v[152:155], a[40:43], v[72:75]
    s_add_u32 m0, s32, 0
    s_mov_b32 s43, 1193984
    buffer_load_dwordx4 v23, s[48:51], s43 offen offset:2048 lds
    v_mfma_f32_16x16x32_bf16 v[88:91], v[152:155], a[44:47], v[88:91]
    ds_read_b64_tr_b16 v[184:185], v10 offset:53248
    ds_read_b64_tr_b16 v[186:187], v10 offset:55296
    v_mfma_f32_16x16x32_bf16 v[88:91], v[136:139], a[36:39], v[88:91]
    s_add_u32 m0, s32, 0
    s_mov_b32 s43, 1201152
    buffer_load_dwordx4 v23, s[48:51], s43 offen offset:3072 lds
    v_mfma_f32_16x16x32_bf16 v[92:95], v[140:143], a[36:39], v[92:95]
    ds_read_b64_tr_b16 v[172:173], v11 offset:49152
    ds_read_b64_tr_b16 v[174:175], v11 offset:51200
    v_mfma_f32_16x16x32_bf16 v[92:95], v[156:159], a[44:47], v[92:95]
    s_add_u32 s37, s47, 20480
    buffer_load_dwordx4 a[84:87], v26, s[24:27], s37 offen offset:0 sc1
    v_mfma_f32_16x16x32_bf16 v[76:79], v[156:159], a[40:43], v[76:79]
    ds_read_b64_tr_b16 v[188:189], v11 offset:53248
    ds_read_b64_tr_b16 v[190:191], v11 offset:55296
    v_mfma_f32_16x16x32_bf16 v[76:79], v[140:143], a[32:35], v[76:79]
    s_add_u32 s37, s47, 20480
    buffer_load_dwordx4 a[92:95], v26, s[24:27], s37 offen offset:1024 sc1
    s_waitcnt vmcnt(12) lgkmcnt(8)
    v_mfma_f32_16x16x32_bf16 v[64:67], v[160:163], a[48:51], v[64:67]
    s_barrier
    ds_read_b64_tr_b16 v[128:129], v12 offset:0
    ds_read_b64_tr_b16 v[130:131], v12 offset:2048
    v_mfma_f32_16x16x32_bf16 v[64:67], v[176:179], a[56:59], v[64:67]
    s_add_u32 s36, s46, 24576
    buffer_load_dwordx4 a[96:99], v26, s[24:27], s36 offen offset:0 sc1
    v_mfma_f32_16x16x32_bf16 v[80:83], v[176:179], a[60:63], v[80:83]
    ds_read_b64_tr_b16 v[144:145], v12 offset:4096
    ds_read_b64_tr_b16 v[146:147], v12 offset:6144
    v_mfma_f32_16x16x32_bf16 v[80:83], v[160:163], a[52:55], v[80:83]
    s_add_u32 s36, s46, 24576
    buffer_load_dwordx4 a[104:107], v26, s[24:27], s36 offen offset:1024 sc1
    v_mfma_f32_16x16x32_bf16 v[84:87], v[164:167], a[52:55], v[84:87]
    ds_read_b64_tr_b16 v[132:133], v13 offset:0
    ds_read_b64_tr_b16 v[134:135], v13 offset:2048
    v_mfma_f32_16x16x32_bf16 v[84:87], v[180:183], a[60:63], v[84:87]
    s_add_u32 m0, s32, 16384
    s_mov_b32 s43, 1310720
    buffer_load_dwordx4 v23, s[48:51], s43 offen offset:0 lds
    v_mfma_f32_16x16x32_bf16 v[68:71], v[180:183], a[56:59], v[68:71]
    s_waitcnt lgkmcnt(6)
    ds_read_b64_tr_b16 v[148:149], v13 offset:4096
    ds_read_b64_tr_b16 v[150:151], v13 offset:6144
    v_mfma_f32_16x16x32_bf16 v[68:71], v[164:167], a[48:51], v[68:71]
    s_add_u32 m0, s32, 16384
    s_mov_b32 s43, 1317888
    buffer_load_dwordx4 v23, s[48:51], s43 offen offset:1024 lds
    v_mfma_f32_16x16x32_bf16 v[72:75], v[168:171], a[48:51], v[72:75]
    ds_read_b64_tr_b16 v[136:137], v14 offset:0
    ds_read_b64_tr_b16 v[138:139], v14 offset:2048
    v_mfma_f32_16x16x32_bf16 v[72:75], v[184:187], a[56:59], v[72:75]
    s_add_u32 m0, s32, 16384
    s_mov_b32 s43, 1325056
    buffer_load_dwordx4 v23, s[48:51], s43 offen offset:2048 lds
    v_mfma_f32_16x16x32_bf16 v[88:91], v[184:187], a[60:63], v[88:91]
    ds_read_b64_tr_b16 v[152:153], v14 offset:4096
    ds_read_b64_tr_b16 v[154:155], v14 offset:6144
    v_mfma_f32_16x16x32_bf16 v[88:91], v[168:171], a[52:55], v[88:91]
    s_add_u32 m0, s32, 16384
    s_mov_b32 s43, 1332224
    buffer_load_dwordx4 v23, s[48:51], s43 offen offset:3072 lds
    v_mfma_f32_16x16x32_bf16 v[92:95], v[172:175], a[52:55], v[92:95]
    ds_read_b64_tr_b16 v[140:141], v15 offset:0
    ds_read_b64_tr_b16 v[142:143], v15 offset:2048
    v_mfma_f32_16x16x32_bf16 v[92:95], v[188:191], a[60:63], v[92:95]
    s_add_u32 s37, s47, 24576
    buffer_load_dwordx4 a[100:103], v26, s[24:27], s37 offen offset:0 sc1
    v_mfma_f32_16x16x32_bf16 v[76:79], v[188:191], a[56:59], v[76:79]
    ds_read_b64_tr_b16 v[156:157], v15 offset:4096
    ds_read_b64_tr_b16 v[158:159], v15 offset:6144
    v_mfma_f32_16x16x32_bf16 v[76:79], v[172:175], a[48:51], v[76:79]
    s_add_u32 s37, s47, 24576
    buffer_load_dwordx4 a[108:111], v26, s[24:27], s37 offen offset:1024 sc1
    s_waitcnt vmcnt(16) lgkmcnt(8)
    v_mfma_f32_16x16x32_bf16 v[64:67], v[128:131], a[64:67], v[64:67]
    ds_read_b64_tr_b16 v[160:161], v12 offset:16384
    ds_read_b64_tr_b16 v[162:163], v12 offset:18432
    v_mfma_f32_16x16x32_bf16 v[64:67], v[144:147], a[72:75], v[64:67]
    s_add_u32 s36, s46, 28672
    buffer_load_dwordx4 a[112:115], v26, s[24:27], s36 offen offset:0 sc1
    v_mfma_f32_16x16x32_bf16 v[80:83], v[144:147], a[76:79], v[80:83]
    ds_read_b64_tr_b16 v[176:177], v12 offset:20480
    ds_read_b64_tr_b16 v[178:179], v12 offset:22528
    v_mfma_f32_16x16x32_bf16 v[80:83], v[128:131], a[68:71], v[80:83]
    s_add_u32 s36, s46, 28672
    buffer_load_dwordx4 a[120:123], v26, s[24:27], s36 offen offset:1024 sc1
    v_mfma_f32_16x16x32_bf16 v[84:87], v[132:135], a[68:71], v[84:87]
    ds_read_b64_tr_b16 v[164:165], v13 offset:16384
    ds_read_b64_tr_b16 v[166:167], v13 offset:18432
    v_mfma_f32_16x16x32_bf16 v[84:87], v[148:151], a[76:79], v[84:87]
    s_add_u32 s37, s47, 28672
    buffer_load_dwordx4 a[116:119], v26, s[24:27], s37 offen offset:0 sc1
    v_mfma_f32_16x16x32_bf16 v[68:71], v[148:151], a[72:75], v[68:71]
    s_waitcnt lgkmcnt(6)
    ds_read_b64_tr_b16 v[180:181], v13 offset:20480
    ds_read_b64_tr_b16 v[182:183], v13 offset:22528
    v_mfma_f32_16x16x32_bf16 v[68:71], v[132:135], a[64:67], v[68:71]
    s_add_u32 s37, s47, 28672
    buffer_load_dwordx4 a[124:127], v26, s[24:27], s37 offen offset:1024 sc1
    v_mfma_f32_16x16x32_bf16 v[72:75], v[136:139], a[64:67], v[72:75]
    ds_read_b64_tr_b16 v[168:169], v14 offset:16384
    ds_read_b64_tr_b16 v[170:171], v14 offset:18432
    v_mfma_f32_16x16x32_bf16 v[72:75], v[152:155], a[72:75], v[72:75]
    ds_read_b64_tr_b16 v[184:185], v14 offset:20480
    ds_read_b64_tr_b16 v[186:187], v14 offset:22528
    v_mfma_f32_16x16x32_bf16 v[88:91], v[152:155], a[76:79], v[88:91]
    ds_read_b64_tr_b16 v[172:173], v15 offset:16384
    ds_read_b64_tr_b16 v[174:175], v15 offset:18432
    v_mfma_f32_16x16x32_bf16 v[88:91], v[136:139], a[68:71], v[88:91]
    ds_read_b64_tr_b16 v[188:189], v15 offset:20480
    ds_read_b64_tr_b16 v[190:191], v15 offset:22528
    v_mfma_f32_16x16x32_bf16 v[92:95], v[140:143], a[68:71], v[92:95]
    v_mfma_f32_16x16x32_bf16 v[92:95], v[156:159], a[76:79], v[92:95]
    v_mfma_f32_16x16x32_bf16 v[76:79], v[156:159], a[72:75], v[76:79]
    v_mfma_f32_16x16x32_bf16 v[76:79], v[140:143], a[64:67], v[76:79]
    s_waitcnt vmcnt(12) lgkmcnt(8)
    v_mfma_f32_16x16x32_bf16 v[64:67], v[160:163], a[80:83], v[64:67]
    ds_read_b64_tr_b16 v[128:129], v12 offset:32768
    ds_read_b64_tr_b16 v[130:131], v12 offset:34816
    v_mfma_f32_16x16x32_bf16 v[64:67], v[176:179], a[88:91], v[64:67]
    s_add_u32 s36, s46, 32768
    buffer_load_dwordx4 a[128:131], v26, s[24:27], s36 offen offset:0 sc1
    v_mfma_f32_16x16x32_bf16 v[80:83], v[176:179], a[92:95], v[80:83]
    ds_read_b64_tr_b16 v[144:145], v12 offset:36864
    ds_read_b64_tr_b16 v[146:147], v12 offset:38912
    v_mfma_f32_16x16x32_bf16 v[80:83], v[160:163], a[84:87], v[80:83]
    s_add_u32 s36, s46, 32768
    buffer_load_dwordx4 a[136:139], v26, s[24:27], s36 offen offset:1024 sc1
    v_mfma_f32_16x16x32_bf16 v[84:87], v[164:167], a[84:87], v[84:87]
    ds_read_b64_tr_b16 v[132:133], v13 offset:32768
    ds_read_b64_tr_b16 v[134:135], v13 offset:34816
    v_mfma_f32_16x16x32_bf16 v[84:87], v[180:183], a[92:95], v[84:87]
    s_add_u32 s37, s47, 32768
    buffer_load_dwordx4 a[132:135], v26, s[24:27], s37 offen offset:0 sc1
    v_mfma_f32_16x16x32_bf16 v[68:71], v[180:183], a[88:91], v[68:71]
    s_waitcnt lgkmcnt(6)
    ds_read_b64_tr_b16 v[148:149], v13 offset:36864
    ds_read_b64_tr_b16 v[150:151], v13 offset:38912
    v_mfma_f32_16x16x32_bf16 v[68:71], v[164:167], a[80:83], v[68:71]
    s_add_u32 s37, s47, 32768
    buffer_load_dwordx4 a[140:143], v26, s[24:27], s37 offen offset:1024 sc1
    v_mfma_f32_16x16x32_bf16 v[72:75], v[168:171], a[80:83], v[72:75]
    ds_read_b64_tr_b16 v[136:137], v14 offset:32768
    ds_read_b64_tr_b16 v[138:139], v14 offset:34816
    v_mfma_f32_16x16x32_bf16 v[72:75], v[184:187], a[88:91], v[72:75]
    ds_read_b64_tr_b16 v[152:153], v14 offset:36864
    ds_read_b64_tr_b16 v[154:155], v14 offset:38912
    v_mfma_f32_16x16x32_bf16 v[88:91], v[184:187], a[92:95], v[88:91]
    ds_read_b64_tr_b16 v[140:141], v15 offset:32768
    ds_read_b64_tr_b16 v[142:143], v15 offset:34816
    v_mfma_f32_16x16x32_bf16 v[88:91], v[168:171], a[84:87], v[88:91]
    ds_read_b64_tr_b16 v[156:157], v15 offset:36864
    ds_read_b64_tr_b16 v[158:159], v15 offset:38912
    v_mfma_f32_16x16x32_bf16 v[92:95], v[172:175], a[84:87], v[92:95]
    v_mfma_f32_16x16x32_bf16 v[92:95], v[188:191], a[92:95], v[92:95]
    v_mfma_f32_16x16x32_bf16 v[76:79], v[188:191], a[88:91], v[76:79]
    v_mfma_f32_16x16x32_bf16 v[76:79], v[172:175], a[80:83], v[76:79]
    s_waitcnt vmcnt(8) lgkmcnt(8)
    v_mfma_f32_16x16x32_bf16 v[64:67], v[128:131], a[96:99], v[64:67]
    ds_read_b64_tr_b16 v[160:161], v12 offset:49152
    ds_read_b64_tr_b16 v[162:163], v12 offset:51200
    v_mfma_f32_16x16x32_bf16 v[64:67], v[144:147], a[104:107], v[64:67]
    s_add_u32 s36, s46, 36864
    buffer_load_dwordx4 a[144:147], v26, s[24:27], s36 offen offset:0 sc1
    v_mfma_f32_16x16x32_bf16 v[80:83], v[144:147], a[108:111], v[80:83]
    ds_read_b64_tr_b16 v[176:177], v12 offset:53248
    ds_read_b64_tr_b16 v[178:179], v12 offset:55296
    v_mfma_f32_16x16x32_bf16 v[80:83], v[128:131], a[100:103], v[80:83]
    s_add_u32 s36, s46, 36864
    buffer_load_dwordx4 a[152:155], v26, s[24:27], s36 offen offset:1024 sc1
    v_mfma_f32_16x16x32_bf16 v[84:87], v[132:135], a[100:103], v[84:87]
    ds_read_b64_tr_b16 v[164:165], v13 offset:49152
    ds_read_b64_tr_b16 v[166:167], v13 offset:51200
    v_mfma_f32_16x16x32_bf16 v[84:87], v[148:151], a[108:111], v[84:87]
    s_add_u32 s37, s47, 36864
    buffer_load_dwordx4 a[148:151], v26, s[24:27], s37 offen offset:0 sc1
    v_mfma_f32_16x16x32_bf16 v[68:71], v[148:151], a[104:107], v[68:71]
    s_waitcnt lgkmcnt(6)
    ds_read_b64_tr_b16 v[180:181], v13 offset:53248
    ds_read_b64_tr_b16 v[182:183], v13 offset:55296
    v_mfma_f32_16x16x32_bf16 v[68:71], v[132:135], a[96:99], v[68:71]
    s_add_u32 s37, s47, 36864
    buffer_load_dwordx4 a[156:159], v26, s[24:27], s37 offen offset:1024 sc1
    v_mfma_f32_16x16x32_bf16 v[72:75], v[136:139], a[96:99], v[72:75]
    ds_read_b64_tr_b16 v[168:169], v14 offset:49152
    ds_read_b64_tr_b16 v[170:171], v14 offset:51200
    v_mfma_f32_16x16x32_bf16 v[72:75], v[152:155], a[104:107], v[72:75]
    ds_read_b64_tr_b16 v[184:185], v14 offset:53248
    ds_read_b64_tr_b16 v[186:187], v14 offset:55296
    v_mfma_f32_16x16x32_bf16 v[88:91], v[152:155], a[108:111], v[88:91]
    ds_read_b64_tr_b16 v[172:173], v15 offset:49152
    ds_read_b64_tr_b16 v[174:175], v15 offset:51200
    v_mfma_f32_16x16x32_bf16 v[88:91], v[136:139], a[100:103], v[88:91]
    ds_read_b64_tr_b16 v[188:189], v15 offset:53248
    ds_read_b64_tr_b16 v[190:191], v15 offset:55296
    v_mfma_f32_16x16x32_bf16 v[92:95], v[140:143], a[100:103], v[92:95]
    v_mfma_f32_16x16x32_bf16 v[92:95], v[156:159], a[108:111], v[92:95]
    v_mfma_f32_16x16x32_bf16 v[76:79], v[156:159], a[104:107], v[76:79]
    v_mfma_f32_16x16x32_bf16 v[76:79], v[140:143], a[96:99], v[76:79]
    s_waitcnt vmcnt(8) lgkmcnt(8)
    v_mfma_f32_16x16x32_bf16 v[64:67], v[160:163], a[112:115], v[64:67]
    s_barrier
    ds_read_b64_tr_b16 v[128:129], v16 offset:0
    ds_read_b64_tr_b16 v[130:131], v16 offset:2048
    v_mfma_f32_16x16x32_bf16 v[64:67], v[176:179], a[120:123], v[64:67]
    s_add_u32 s36, s46, 40960
    buffer_load_dwordx4 a[160:163], v26, s[24:27], s36 offen offset:0 sc1
    v_mfma_f32_16x16x32_bf16 v[80:83], v[176:179], a[124:127], v[80:83]
    ds_read_b64_tr_b16 v[144:145], v16 offset:4096
    ds_read_b64_tr_b16 v[146:147], v16 offset:6144
    v_mfma_f32_16x16x32_bf16 v[80:83], v[160:163], a[116:119], v[80:83]
    s_add_u32 s36, s46, 40960
    buffer_load_dwordx4 a[168:171], v26, s[24:27], s36 offen offset:1024 sc1
    v_mfma_f32_16x16x32_bf16 v[84:87], v[164:167], a[116:119], v[84:87]
    ds_read_b64_tr_b16 v[132:133], v17 offset:0
    ds_read_b64_tr_b16 v[134:135], v17 offset:2048
    v_mfma_f32_16x16x32_bf16 v[84:87], v[180:183], a[124:127], v[84:87]
    s_add_u32 s37, s47, 40960
    buffer_load_dwordx4 a[164:167], v26, s[24:27], s37 offen offset:0 sc1
    v_mfma_f32_16x16x32_bf16 v[68:71], v[180:183], a[120:123], v[68:71]
    s_waitcnt lgkmcnt(6)
    ds_read_b64_tr_b16 v[148:149], v17 offset:4096
    ds_read_b64_tr_b16 v[150:151], v17 offset:6144
    v_mfma_f32_16x16x32_bf16 v[68:71], v[164:167], a[112:115], v[68:71]
    s_add_u32 s37, s47, 40960
    buffer_load_dwordx4 a[172:175], v26, s[24:27], s37 offen offset:1024 sc1
    v_mfma_f32_16x16x32_bf16 v[72:75], v[168:171], a[112:115], v[72:75]
    ds_read_b64_tr_b16 v[136:137], v18 offset:0
    ds_read_b64_tr_b16 v[138:139], v18 offset:2048
    v_mfma_f32_16x16x32_bf16 v[72:75], v[184:187], a[120:123], v[72:75]
    ds_read_b64_tr_b16 v[152:153], v18 offset:4096
    ds_read_b64_tr_b16 v[154:155], v18 offset:6144
    v_mfma_f32_16x16x32_bf16 v[88:91], v[184:187], a[124:127], v[88:91]
    ds_read_b64_tr_b16 v[140:141], v19 offset:0
    ds_read_b64_tr_b16 v[142:143], v19 offset:2048
    v_mfma_f32_16x16x32_bf16 v[88:91], v[168:171], a[116:119], v[88:91]
    ds_read_b64_tr_b16 v[156:157], v19 offset:4096
    ds_read_b64_tr_b16 v[158:159], v19 offset:6144
    v_mfma_f32_16x16x32_bf16 v[92:95], v[172:175], a[116:119], v[92:95]
    v_mfma_f32_16x16x32_bf16 v[92:95], v[188:191], a[124:127], v[92:95]
    v_mfma_f32_16x16x32_bf16 v[76:79], v[188:191], a[120:123], v[76:79]
    v_mfma_f32_16x16x32_bf16 v[76:79], v[172:175], a[112:115], v[76:79]
    s_waitcnt vmcnt(8) lgkmcnt(8)
    v_mfma_f32_16x16x32_bf16 v[64:67], v[128:131], a[128:131], v[64:67]
    s_barrier
    ds_read_b64_tr_b16 v[160:161], v8 offset:0
    ds_read_b64_tr_b16 v[162:163], v8 offset:2048
    v_mfma_f32_16x16x32_bf16 v[64:67], v[144:147], a[136:139], v[64:67]
    ds_read_b64_tr_b16 v[176:177], v8 offset:4096
    ds_read_b64_tr_b16 v[178:179], v8 offset:6144
    v_mfma_f32_16x16x32_bf16 v[80:83], v[144:147], a[140:143], v[80:83]
    ds_read_b64_tr_b16 v[164:165], v9 offset:0
    ds_read_b64_tr_b16 v[166:167], v9 offset:2048
    v_mfma_f32_16x16x32_bf16 v[80:83], v[128:131], a[132:135], v[80:83]
    ds_read_b64_tr_b16 v[180:181], v9 offset:4096
    ds_read_b64_tr_b16 v[182:183], v9 offset:6144
    v_mfma_f32_16x16x32_bf16 v[84:87], v[132:135], a[132:135], v[84:87]
    ds_read_b64_tr_b16 v[168:169], v10 offset:0
    ds_read_b64_tr_b16 v[170:171], v10 offset:2048
    v_mfma_f32_16x16x32_bf16 v[84:87], v[148:151], a[140:143], v[84:87]
    ds_read_b64_tr_b16 v[184:185], v10 offset:4096
    ds_read_b64_tr_b16 v[186:187], v10 offset:6144
    v_mfma_f32_16x16x32_bf16 v[68:71], v[148:151], a[136:139], v[68:71]
    s_waitcnt lgkmcnt(12)
    ds_read_b64_tr_b16 v[172:173], v11 offset:0
    ds_read_b64_tr_b16 v[174:175], v11 offset:2048
    v_mfma_f32_16x16x32_bf16 v[68:71], v[132:135], a[128:131], v[68:71]
    ds_read_b64_tr_b16 v[188:189], v11 offset:4096
    ds_read_b64_tr_b16 v[190:191], v11 offset:6144
    v_mfma_f32_16x16x32_bf16 v[72:75], v[136:139], a[128:131], v[72:75]
    v_mfma_f32_16x16x32_bf16 v[72:75], v[152:155], a[136:139], v[72:75]
    v_mfma_f32_16x16x32_bf16 v[88:91], v[152:155], a[140:143], v[88:91]
    v_mfma_f32_16x16x32_bf16 v[88:91], v[136:139], a[132:135], v[88:91]
    v_mfma_f32_16x16x32_bf16 v[92:95], v[140:143], a[132:135], v[92:95]
    v_mfma_f32_16x16x32_bf16 v[92:95], v[156:159], a[140:143], v[92:95]
    v_mfma_f32_16x16x32_bf16 v[76:79], v[156:159], a[136:139], v[76:79]
    v_mfma_f32_16x16x32_bf16 v[76:79], v[140:143], a[128:131], v[76:79]
    s_waitcnt vmcnt(4) lgkmcnt(8)
    v_mfma_f32_16x16x32_bf16 v[64:67], v[160:163], a[144:147], v[64:67]
    s_barrier
    ds_read_b64_tr_b16 v[128:129], v8 offset:16384
    ds_read_b64_tr_b16 v[130:131], v8 offset:18432
    v_mfma_f32_16x16x32_bf16 v[64:67], v[176:179], a[152:155], v[64:67]
    ds_read_b64_tr_b16 v[144:145], v8 offset:20480
    ds_read_b64_tr_b16 v[146:147], v8 offset:22528
    v_mfma_f32_16x16x32_bf16 v[80:83], v[176:179], a[156:159], v[80:83]
    ds_read_b64_tr_b16 v[132:133], v9 offset:16384
    ds_read_b64_tr_b16 v[134:135], v9 offset:18432
    v_mfma_f32_16x16x32_bf16 v[80:83], v[160:163], a[148:151], v[80:83]
    ds_read_b64_tr_b16 v[148:149], v9 offset:20480
    ds_read_b64_tr_b16 v[150:151], v9 offset:22528
    v_mfma_f32_16x16x32_bf16 v[84:87], v[164:167], a[148:151], v[84:87]
    ds_read_b64_tr_b16 v[136:137], v10 offset:16384
    ds_read_b64_tr_b16 v[138:139], v10 offset:18432
    v_mfma_f32_16x16x32_bf16 v[84:87], v[180:183], a[156:159], v[84:87]
    ds_read_b64_tr_b16 v[152:153], v10 offset:20480
    ds_read_b64_tr_b16 v[154:155], v10 offset:22528
    v_mfma_f32_16x16x32_bf16 v[68:71], v[180:183], a[152:155], v[68:71]
    s_waitcnt lgkmcnt(12)
    ds_read_b64_tr_b16 v[140:141], v11 offset:16384
    ds_read_b64_tr_b16 v[142:143], v11 offset:18432
    v_mfma_f32_16x16x32_bf16 v[68:71], v[164:167], a[144:147], v[68:71]
    ds_read_b64_tr_b16 v[156:157], v11 offset:20480
    ds_read_b64_tr_b16 v[158:159], v11 offset:22528
    v_mfma_f32_16x16x32_bf16 v[72:75], v[168:171], a[144:147], v[72:75]
    v_mfma_f32_16x16x32_bf16 v[72:75], v[184:187], a[152:155], v[72:75]
    v_mfma_f32_16x16x32_bf16 v[88:91], v[184:187], a[156:159], v[88:91]
    v_mfma_f32_16x16x32_bf16 v[88:91], v[168:171], a[148:151], v[88:91]
    v_mfma_f32_16x16x32_bf16 v[92:95], v[172:175], a[148:151], v[92:95]
    v_mfma_f32_16x16x32_bf16 v[92:95], v[188:191], a[156:159], v[92:95]
    v_mfma_f32_16x16x32_bf16 v[76:79], v[188:191], a[152:155], v[76:79]
    v_mfma_f32_16x16x32_bf16 v[76:79], v[172:175], a[144:147], v[76:79]
    s_waitcnt vmcnt(0) lgkmcnt(0)
    s_cmp_ge_u32 s45, 2
    s_cbranch_scc1 k1_d_skip
    v_mfma_f32_16x16x32_bf16 v[80:83], v[144:147], a[172:175], v[80:83]
    v_mfma_f32_16x16x32_bf16 v[84:87], v[148:151], a[172:175], v[84:87]
    v_mfma_f32_16x16x32_bf16 v[88:91], v[152:155], a[172:175], v[88:91]
    v_mfma_f32_16x16x32_bf16 v[92:95], v[156:159], a[172:175], v[92:95]
    v_mfma_f32_16x16x32_bf16 v[64:67], v[144:147], a[168:171], v[64:67]
    v_mfma_f32_16x16x32_bf16 v[68:71], v[148:151], a[168:171], v[68:71]
    v_mfma_f32_16x16x32_bf16 v[72:75], v[152:155], a[168:171], v[72:75]
    v_mfma_f32_16x16x32_bf16 v[76:79], v[156:159], a[168:171], v[76:79]
k1_d_skip:
    v_mfma_f32_16x16x32_bf16 v[80:83], v[128:131], a[164:167], v[80:83]
    v_mfma_f32_16x16x32_bf16 v[84:87], v[132:135], a[164:167], v[84:87]
    v_mfma_f32_16x16x32_bf16 v[88:91], v[136:139], a[164:167], v[88:91]
    v_mfma_f32_16x16x32_bf16 v[92:95], v[140:143], a[164:167], v[92:95]
    v_mfma_f32_16x16x32_bf16 v[64:67], v[128:131], a[160:163], v[64:67]
    v_mfma_f32_16x16x32_bf16 v[68:71], v[132:135], a[160:163], v[68:71]
    v_mfma_f32_16x16x32_bf16 v[72:75], v[136:139], a[160:163], v[72:75]
    v_mfma_f32_16x16x32_bf16 v[76:79], v[140:143], a[160:163], v[76:79]
    s_nop 3
    ds_write_b128 v28, v[80:83] offset:0
    ds_write_b128 v28, v[84:87] offset:1024
    ds_write_b128 v28, v[88:91] offset:2048
    ds_write_b128 v28, v[92:95] offset:3072
    v_pk_fma_f32 v[96:97], v[64:65], v[32:33], v[96:97]
    v_pk_fma_f32 v[98:99], v[66:67], v[34:35], v[98:99]
    v_pk_fma_f32 v[100:101], v[68:69], v[36:37], v[100:101]
    v_pk_fma_f32 v[102:103], v[70:71], v[38:39], v[102:103]
    v_pk_fma_f32 v[104:105], v[72:73], v[40:41], v[104:105]
    v_pk_fma_f32 v[106:107], v[74:75], v[42:43], v[106:107]
    v_pk_fma_f32 v[108:109], v[76:77], v[44:45], v[108:109]
    v_pk_fma_f32 v[110:111], v[78:79], v[46:47], v[110:111]
    s_waitcnt lgkmcnt(0)
    s_barrier
    ds_read_b128 v[64:67], v29 offset:0
    ds_read_b128 v[68:71], v29 offset:1024
    ds_read_b128 v[72:75], v29 offset:2048
    ds_read_b128 v[76:79], v29 offset:3072
    s_waitcnt lgkmcnt(2)
    v_pk_fma_f32 v[64:65], v[64:65], v[32:33], v[96:97]
    v_pk_fma_f32 v[66:67], v[66:67], v[34:35], v[98:99]
    v_pk_fma_f32 v[68:69], v[68:69], v[36:37], v[100:101]
    v_pk_fma_f32 v[70:71], v[70:71], v[38:39], v[102:103]
    v_cvt_pk_bf16_f32 v112, v64, v65
    v_cvt_pk_bf16_f32 v113, v66, v67
    v_cvt_pk_bf16_f32 v114, v68, v69
    v_cvt_pk_bf16_f32 v115, v70, v71
    s_nop 1
    v_permlane32_swap_b32 v112, v114
    v_permlane32_swap_b32 v113, v115
    s_nop 1
    v_permlane16_swap_b32 v112, v114
    v_permlane16_swap_b32 v113, v115
    buffer_store_dwordx4 v[112:115], v24, s[12:15], 0 offen offset:0 sc1
    s_waitcnt lgkmcnt(0)
    v_pk_fma_f32 v[72:73], v[72:73], v[40:41], v[104:105]
    v_pk_fma_f32 v[74:75], v[74:75], v[42:43], v[106:107]
    v_pk_fma_f32 v[76:77], v[76:77], v[44:45], v[108:109]
    v_pk_fma_f32 v[78:79], v[78:79], v[46:47], v[110:111]
    v_cvt_pk_bf16_f32 v116, v72, v73
    v_cvt_pk_bf16_f32 v117, v74, v75
    v_cvt_pk_bf16_f32 v118, v76, v77
    v_cvt_pk_bf16_f32 v119, v78, v79
    s_nop 1
    v_permlane32_swap_b32 v116, v118
    v_permlane32_swap_b32 v117, v119
    s_nop 1
    v_permlane16_swap_b32 v116, v118
    v_permlane16_swap_b32 v117, v119
    buffer_store_dwordx4 v[116:119], v24, s[12:15], 0 offen offset:64 sc1
k1_end:
    s_endpgm
k1_spin1:
    s_mov_b32 s7, 0
k1_sp1_b:
    buffer_load_dword v3, v27, s[8:11], s63 offen sc1
    s_waitcnt vmcnt(0)
    v_cmp_ne_u32 vcc, 0x5ac3e19b, v3
    s_cbranch_vccz k1_sp1_d
    s_add_u32 s7, s7, 1
    s_cmp_lt_u32 s7, 0x10000
    s_cbranch_scc1 k1_sp1_b
k1_sp1_d:
    s_branch k1_spin1_ret
k1_fallback:
    s_mov_b32 s44, 1
    v_and_b32 v2, 63, v0
    v_lshrrev_b32 v3, 4, v2
    v_and_b32 v4, 15, v2
    v_lshlrev_b32 v5, 8, v4
    v_lshl_add_u32 v5, v3, 4, v5
    v_mov_b32 v208, 0xff800000
    v_mov_b32 v209, 0xff800000
    v_mov_b32 v210, 0xff800000
    v_mov_b32 v211, 0xff800000
    s_mov_b32 s6, 0
k1_fb_loop:
    buffer_load_dwordx4 a[144:147], v5, s[8:11], s6 offen offset:0
    buffer_load_dwordx4 a[148:151], v5, s[8:11], s6 offen offset:64
    buffer_load_dwordx4 a[152:155], v5, s[8:11], s6 offen offset:128
    buffer_load_dwordx4 a[156:159], v5, s[8:11], s6 offen offset:192
    s_waitcnt vmcnt(0)
    v_mfma_f32_16x16x32_bf16 v[64:67], a[144:147], v[128:131], 0
    v_mfma_f32_16x16x32_bf16 v[68:71], a[144:147], v[144:147], 0
    v_mfma_f32_16x16x32_bf16 v[72:75], a[144:147], v[160:163], 0
    v_mfma_f32_16x16x32_bf16 v[76:79], a[144:147], v[176:179], 0
    v_mfma_f32_16x16x32_bf16 v[64:67], a[148:151], v[132:135], v[64:67]
    v_mfma_f32_16x16x32_bf16 v[68:71], a[148:151], v[148:151], v[68:71]
    v_mfma_f32_16x16x32_bf16 v[72:75], a[148:151], v[164:167], v[72:75]
    v_mfma_f32_16x16x32_bf16 v[76:79], a[148:151], v[180:183], v[76:79]
    v_mfma_f32_16x16x32_bf16 v[64:67], a[152:155], v[136:139], v[64:67]
    v_mfma_f32_16x16x32_bf16 v[68:71], a[152:155], v[152:155], v[68:71]
    v_mfma_f32_16x16x32_bf16 v[72:75], a[152:155], v[168:171], v[72:75]
    v_mfma_f32_16x16x32_bf16 v[76:79], a[152:155], v[184:187], v[76:79]
    v_mfma_f32_16x16x32_bf16 v[64:67], a[156:159], v[140:143], v[64:67]
    v_mfma_f32_16x16x32_bf16 v[68:71], a[156:159], v[156:159], v[68:71]
    v_mfma_f32_16x16x32_bf16 v[72:75], a[156:159], v[172:175], v[72:75]
    v_mfma_f32_16x16x32_bf16 v[76:79], a[156:159], v[188:191], v[76:79]
    s_nop 15
    v_max3_f32 v208, v208, v64, v65
    v_max3_f32 v208, v208, v66, v67
    v_max3_f32 v209, v209, v68, v69
    v_max3_f32 v209, v209, v70, v71
    v_max3_f32 v210, v210, v72, v73
    v_max3_f32 v210, v210, v74, v75
    v_max3_f32 v211, v211, v76, v77
    v_max3_f32 v211, v211, v78, v79
    s_add_u32 s6, s6, 4096
    s_cmp_lt_u32 s6, 0x80000
    s_cbranch_scc1 k1_fb_loop
    v_mov_b32 v212, v208
    v_mov_b32 v213, v209
    v_mov_b32 v214, v210
    v_mov_b32 v215, v211
    s_nop 1
    v_permlane32_swap_b32 v212, v208
    v_permlane32_swap_b32 v213, v209
    v_permlane32_swap_b32 v214, v210
    v_permlane32_swap_b32 v215, v211
    s_nop 1
    v_max_f32 v208, v208, v212
    v_max_f32 v209, v209, v213
    v_max_f32 v210, v210, v214
    v_max_f32 v211, v211, v215
    v_mov_b32 v212, v208
    v_mov_b32 v213, v209
    v_mov_b32 v214, v210
    v_mov_b32 v215, v211
    s_nop 1
    v_permlane16_swap_b32 v212, v208
    v_permlane16_swap_b32 v213, v209
    v_permlane16_swap_b32 v214, v210
    v_permlane16_swap_b32 v215, v211
    s_nop 1
    v_max_f32 v208, v208, v212
    v_max_f32 v209, v209, v213
    v_max_f32 v210, v210, v214
    v_max_f32 v211, v211, v215
    v_lshrrev_b32 v5, 8, v26
    v_lshlrev_b32 v5, 24, v5
    v_lshl_add_u32 v2, v26, 3, v5
    v_and_b32 v6, 0x380, v2
    v_min_u32 v6, 764, v6
    v_bfe_u32 v3, v26, 7, 1
    v_mul_u32_u24 v3, 2752, v3
    v_add3_u32 v3, v3, v6, v5
    v_bfe_u32 v4, v26, 6, 2
    v_and_b32 v6, 0x180, v2
    v_lshl_add_u32 v4, v4, 10, v6
    v_add_u32 v4, v4, v5
    v_mov_b32 v28, 0
    v_sub_f32 v192, 0, v208
    v_sub_f32 v193, 0, v208
    v_sub_f32 v194, 0, v208
    v_sub_f32 v195, 0, v208
    v_mov_b32 v29, 0
    v_sub_f32 v196, 0, v209
    v_sub_f32 v197, 0, v209
    v_sub_f32 v198, 0, v209
    v_sub_f32 v199, 0, v209
    v_mov_b32 v30, 0
    v_sub_f32 v200, 0, v210
    v_sub_f32 v201, 0, v210
    v_sub_f32 v202, 0, v210
    v_sub_f32 v203, 0, v210
    v_mov_b32 v31, 0
    v_sub_f32 v204, 0, v211
    v_sub_f32 v205, 0, v211
    v_sub_f32 v206, 0, v211
    v_sub_f32 v207, 0, v211
    s_barrier
    s_add_u32 m0, s32, 0
    s_mov_b32 s33, 0
    buffer_load_dwordx4 v20, s[8:11], s33 offen offset:0 nt lds
    s_add_u32 m0, s32, 0
    s_mov_b32 s33, 0
    buffer_load_dwordx4 v21, s[8:11], s33 offen offset:1024 nt lds
    s_add_u32 m0, s32, 0
    s_mov_b32 s33, 0
    buffer_load_dwordx4 v22, s[8:11], s33 offen offset:2048 nt lds
    s_add_u32 m0, s32, 0
    s_mov_b32 s33, 0
    buffer_load_dwordx4 v23, s[8:11], s33 offen offset:3072 nt lds
    s_add_u32 m0, s32, 16384
    s_mov_b32 s33, 16384
    buffer_load_dwordx4 v20, s[8:11], s33 offen offset:0 nt lds
    s_add_u32 m0, s32, 16384
    s_mov_b32 s33, 16384
    buffer_load_dwordx4 v21, s[8:11], s33 offen offset:1024 nt lds
    s_add_u32 m0, s32, 16384
    s_mov_b32 s33, 16384
    buffer_load_dwordx4 v22, s[8:11], s33 offen offset:2048 nt lds
    s_add_u32 m0, s32, 16384
    s_mov_b32 s33, 16384
    buffer_load_dwordx4 v23, s[8:11], s33 offen offset:3072 nt lds
    s_add_u32 m0, s32, 65536
    s_mov_b32 s34, 0
    buffer_load_dwordx4 v24, s[12:15], s34 offen offset:0 nt lds
    s_add_u32 m0, s32, 65536
    s_mov_b32 s34, 0
    buffer_load_dwordx4 v25, s[12:15], s34 offen offset:1024 nt lds
    s_add_u32 m0, s32, 65536
    s_mov_b32 s34, 0
    buffer_load_dwordx4 v24, s[12:15], s34 offen offset:2048 nt lds
    s_add_u32 m0, s32, 65536
    s_mov_b32 s34, 0
    buffer_load_dwordx4 v25, s[12:15], s34 offen offset:3072 nt lds
    s_add_u32 m0, s32, 32768
    s_mov_b32 s33, 32768
    buffer_load_dwordx4 v20, s[8:11], s33 offen offset:0 nt lds
    s_add_u32 m0, s32, 32768
    s_mov_b32 s33, 32768
    buffer_load_dwordx4 v21, s[8:11], s33 offen offset:1024 nt lds
    s_add_u32 m0, s32, 32768
    s_mov_b32 s33, 32768
    buffer_load_dwordx4 v22, s[8:11], s33 offen offset:2048 nt lds
    s_add_u32 m0, s32, 32768
    s_mov_b32 s33, 32768
    buffer_load_dwordx4 v23, s[8:11], s33 offen offset:3072 nt lds
    s_add_u32 m0, s32, 81920
    s_mov_b32 s34, 16384
    buffer_load_dwordx4 v24, s[12:15], s34 offen offset:0 nt lds
    s_add_u32 m0, s32, 81920
    s_mov_b32 s34, 16384
    buffer_load_dwordx4 v25, s[12:15], s34 offen offset:1024 nt lds
    s_add_u32 m0, s32, 81920
    s_mov_b32 s34, 16384
    buffer_load_dwordx4 v24, s[12:15], s34 offen offset:2048 nt lds
    s_add_u32 m0, s32, 81920
    s_mov_b32 s34, 16384
    buffer_load_dwordx4 v25, s[12:15], s34 offen offset:3072 nt lds
    s_add_u32 m0, s32, 49152
    s_mov_b32 s33, 49152
    buffer_load_dwordx4 v20, s[8:11], s33 offen offset:0 nt lds
    s_add_u32 m0, s32, 49152
    s_mov_b32 s33, 49152
    buffer_load_dwordx4 v21, s[8:11], s33 offen offset:1024 nt lds
    s_add_u32 m0, s32, 49152
    s_mov_b32 s33, 49152
    buffer_load_dwordx4 v22, s[8:11], s33 offen offset:2048 nt lds
    s_add_u32 m0, s32, 49152
    s_mov_b32 s33, 49152
    buffer_load_dwordx4 v23, s[8:11], s33 offen offset:3072 nt lds
    s_waitcnt vmcnt(12)
    s_barrier
    ds_read_b128 a[64:67], v8 offset:0
    ds_read_b128 a[68:71], v9 offset:0
    ds_read_b128 a[72:75], v10 offset:0
    ds_read_b128 a[76:79], v11 offset:0
    ds_read_b128 a[80:83], v8 offset:4096
    ds_read_b128 a[84:87], v9 offset:4096
    ds_read_b128 a[88:91], v10 offset:4096
    ds_read_b128 a[92:95], v11 offset:4096
    s_waitcnt lgkmcnt(0)
    ds_read_b128 a[96:99], v8 offset:8192
    ds_read_b128 a[100:103], v9 offset:8192
    ds_read_b128 a[104:107], v10 offset:8192
    ds_read_b128 a[108:111], v11 offset:8192
    ds_read_b128 a[112:115], v8 offset:12288
    ds_read_b128 a[116:119], v9 offset:12288
    ds_read_b128 a[120:123], v10 offset:12288
    ds_read_b128 a[124:127], v11 offset:12288
    v_mfma_f32_16x16x32_bf16 v[64:67], a[64:67], v[128:131], v[192:195]
    v_mfma_f32_16x16x32_bf16 v[64:67], a[68:71], v[132:135], v[64:67]
    v_mfma_f32_16x16x32_bf16 v[64:67], a[72:75], v[136:139], v[64:67]
    v_mfma_f32_16x16x32_bf16 v[64:67], a[76:79], v[140:143], v[64:67]
    v_mfma_f32_16x16x32_bf16 v[68:71], a[76:79], v[156:159], v[196:199]
    v_mfma_f32_16x16x32_bf16 v[68:71], a[72:75], v[152:155], v[68:71]
    v_mfma_f32_16x16x32_bf16 v[68:71], a[68:71], v[148:151], v[68:71]
    v_mfma_f32_16x16x32_bf16 v[68:71], a[64:67], v[144:147], v[68:71]
    v_mfma_f32_16x16x32_bf16 v[72:75], a[64:67], v[160:163], v[200:203]
    v_mfma_f32_16x16x32_bf16 v[72:75], a[68:71], v[164:167], v[72:75]
    v_mfma_f32_16x16x32_bf16 v[72:75], a[72:75], v[168:171], v[72:75]
    v_mfma_f32_16x16x32_bf16 v[72:75], a[76:79], v[172:175], v[72:75]
    v_mfma_f32_16x16x32_bf16 v[76:79], a[76:79], v[188:191], v[204:207]
    v_mfma_f32_16x16x32_bf16 v[76:79], a[72:75], v[184:187], v[76:79]
    v_mfma_f32_16x16x32_bf16 v[76:79], a[68:71], v[180:183], v[76:79]
    v_mfma_f32_16x16x32_bf16 v[76:79], a[64:67], v[176:179], v[76:79]
    v_mfma_f32_16x16x32_bf16 v[80:83], a[80:83], v[128:131], v[192:195]
    v_mfma_f32_16x16x32_bf16 v[80:83], a[84:87], v[132:135], v[80:83]
    v_mfma_f32_16x16x32_bf16 v[80:83], a[88:91], v[136:139], v[80:83]
    v_mfma_f32_16x16x32_bf16 v[80:83], a[92:95], v[140:143], v[80:83]
    v_mfma_f32_16x16x32_bf16 v[84:87], a[92:95], v[156:159], v[196:199]
    v_mfma_f32_16x16x32_bf16 v[84:87], a[88:91], v[152:155], v[84:87]
    v_mfma_f32_16x16x32_bf16 v[84:87], a[84:87], v[148:151], v[84:87]
    v_mfma_f32_16x16x32_bf16 v[84:87], a[80:83], v[144:147], v[84:87]
    v_mfma_f32_16x16x32_bf16 v[88:91], a[80:83], v[160:163], v[200:203]
    v_mfma_f32_16x16x32_bf16 v[88:91], a[84:87], v[164:167], v[88:91]
    v_mfma_f32_16x16x32_bf16 v[88:91], a[88:91], v[168:171], v[88:91]
    v_mfma_f32_16x16x32_bf16 v[88:91], a[92:95], v[172:175], v[88:91]
    v_mfma_f32_16x16x32_bf16 v[92:95], a[92:95], v[188:191], v[204:207]
    v_mfma_f32_16x16x32_bf16 v[92:95], a[88:91], v[184:187], v[92:95]
    v_mfma_f32_16x16x32_bf16 v[92:95], a[84:87], v[180:183], v[92:95]
    v_mfma_f32_16x16x32_bf16 v[92:95], a[80:83], v[176:179], v[92:95]
    s_waitcnt lgkmcnt(0)
    s_barrier
    ds_read_b128 a[144:147], v8 offset:16384
    ds_read_b128 a[148:151], v9 offset:16384
    ds_read_b128 a[152:155], v10 offset:16384
    ds_read_b128 a[156:159], v11 offset:16384
    ds_read_b128 a[160:163], v8 offset:20480
    ds_read_b128 a[164:167], v9 offset:20480
    ds_read_b128 a[168:171], v10 offset:20480
    ds_read_b128 a[172:175], v11 offset:20480
    v_mfma_f32_16x16x32_bf16 v[96:99], a[96:99], v[128:131], v[192:195]
    v_mfma_f32_16x16x32_bf16 v[96:99], a[100:103], v[132:135], v[96:99]
    v_mfma_f32_16x16x32_bf16 v[96:99], a[104:107], v[136:139], v[96:99]
    v_mfma_f32_16x16x32_bf16 v[96:99], a[108:111], v[140:143], v[96:99]
    v_mfma_f32_16x16x32_bf16 v[100:103], a[108:111], v[156:159], v[196:199]
    v_mfma_f32_16x16x32_bf16 v[100:103], a[104:107], v[152:155], v[100:103]
    v_mfma_f32_16x16x32_bf16 v[100:103], a[100:103], v[148:151], v[100:103]
    v_mfma_f32_16x16x32_bf16 v[100:103], a[96:99], v[144:147], v[100:103]
    v_mfma_f32_16x16x32_bf16 v[104:107], a[96:99], v[160:163], v[200:203]
    v_mfma_f32_16x16x32_bf16 v[104:107], a[100:103], v[164:167], v[104:107]
    v_mfma_f32_16x16x32_bf16 v[104:107], a[104:107], v[168:171], v[104:107]
    v_mfma_f32_16x16x32_bf16 v[104:107], a[108:111], v[172:175], v[104:107]
    v_mfma_f32_16x16x32_bf16 v[108:111], a[108:111], v[188:191], v[204:207]
    v_mfma_f32_16x16x32_bf16 v[108:111], a[104:107], v[184:187], v[108:111]
    v_mfma_f32_16x16x32_bf16 v[108:111], a[100:103], v[180:183], v[108:111]
    v_mfma_f32_16x16x32_bf16 v[108:111], a[96:99], v[176:179], v[108:111]
    v_mfma_f32_16x16x32_bf16 v[112:115], a[112:115], v[128:131], v[192:195]
    v_mfma_f32_16x16x32_bf16 v[112:115], a[116:119], v[132:135], v[112:115]
    v_mfma_f32_16x16x32_bf16 v[112:115], a[120:123], v[136:139], v[112:115]
    v_mfma_f32_16x16x32_bf16 v[112:115], a[124:127], v[140:143], v[112:115]
    v_mfma_f32_16x16x32_bf16 v[116:119], a[124:127], v[156:159], v[196:199]
    v_mfma_f32_16x16x32_bf16 v[116:119], a[120:123], v[152:155], v[116:119]
    v_mfma_f32_16x16x32_bf16 v[116:119], a[116:119], v[148:151], v[116:119]
    v_mfma_f32_16x16x32_bf16 v[116:119], a[112:115], v[144:147], v[116:119]
    v_mfma_f32_16x16x32_bf16 v[120:123], a[112:115], v[160:163], v[200:203]
    v_mfma_f32_16x16x32_bf16 v[120:123], a[116:119], v[164:167], v[120:123]
    v_mfma_f32_16x16x32_bf16 v[120:123], a[120:123], v[168:171], v[120:123]
    v_mfma_f32_16x16x32_bf16 v[120:123], a[124:127], v[172:175], v[120:123]
    v_mfma_f32_16x16x32_bf16 v[124:127], a[124:127], v[188:191], v[204:207]
    v_mfma_f32_16x16x32_bf16 v[124:127], a[120:123], v[184:187], v[124:127]
    v_mfma_f32_16x16x32_bf16 v[124:127], a[116:119], v[180:183], v[124:127]
    v_mfma_f32_16x16x32_bf16 v[124:127], a[112:115], v[176:179], v[124:127]
    v_exp_f32 v64, v64
    v_exp_f32 v65, v65
    v_add_f32 v28, v64, v28
    v_exp_f32 v66, v66
    v_add_f32 v28, v65, v28
    v_cvt_pk_bf16_f32 v32, v64, v65
    v_exp_f32 v67, v67
    v_add_f32 v28, v66, v28
    v_exp_f32 v80, v80
    v_add_f32 v28, v67, v28
    v_cvt_pk_bf16_f32 v33, v66, v67
    v_exp_f32 v81, v81
    v_add_f32 v28, v80, v28
    v_exp_f32 v82, v82
    v_add_f32 v28, v81, v28
    v_cvt_pk_bf16_f32 v34, v80, v81
    v_exp_f32 v83, v83
    v_add_f32 v28, v82, v28
    v_exp_f32 v68, v68
    v_add_f32 v28, v83, v28
    v_cvt_pk_bf16_f32 v35, v82, v83
    v_exp_f32 v69, v69
    v_exp_f32 v70, v70
    v_cvt_pk_bf16_f32 v36, v68, v69
    v_exp_f32 v71, v71
    v_exp_f32 v84, v84
    v_cvt_pk_bf16_f32 v37, v70, v71
    v_exp_f32 v85, v85
    v_exp_f32 v86, v86
    v_cvt_pk_bf16_f32 v38, v84, v85
    v_exp_f32 v87, v87
    v_exp_f32 v72, v72
    v_cvt_pk_bf16_f32 v39, v86, v87
    v_exp_f32 v73, v73
    v_add_f32 v30, v72, v30
    v_exp_f32 v74, v74
    v_add_f32 v30, v73, v30
    v_cvt_pk_bf16_f32 v40, v72, v73
    v_exp_f32 v75, v75
    v_add_f32 v30, v74, v30
    v_exp_f32 v88, v88
    v_add_f32 v30, v75, v30
    v_cvt_pk_bf16_f32 v41, v74, v75
    v_exp_f32 v89, v89
    v_add_f32 v30, v88, v30
    v_exp_f32 v90, v90
    v_add_f32 v30, v89, v30
    v_cvt_pk_bf16_f32 v42, v88, v89
    v_exp_f32 v91, v91
    v_add_f32 v30, v90, v30
    v_exp_f32 v76, v76
    v_add_f32 v30, v91, v30
    v_cvt_pk_bf16_f32 v43, v90, v91
    v_exp_f32 v77, v77
    v_exp_f32 v78, v78
    v_cvt_pk_bf16_f32 v44, v76, v77
    v_exp_f32 v79, v79
    v_exp_f32 v92, v92
    v_cvt_pk_bf16_f32 v45, v78, v79
    v_exp_f32 v93, v93
    v_exp_f32 v94, v94
    v_cvt_pk_bf16_f32 v46, v92, v93
    v_exp_f32 v95, v95
    s_nop 0
    v_cvt_pk_bf16_f32 v47, v94, v95
    s_mov_b32 s35, 8
    s_branch k1_first
code_end_marker:
    s_endpgm
.section .rodata,"a"
.p2align 6
.amdhsa_kernel k0_prep_kernel
  .amdhsa_next_free_vgpr 64
  .amdhsa_next_free_sgpr 48
  .amdhsa_accum_offset 64
  .amdhsa_group_segment_fixed_size 0
  .amdhsa_kernarg_size 112
  .amdhsa_user_sgpr_count 2
  .amdhsa_user_sgpr_kernarg_segment_ptr 1
  .amdhsa_system_sgpr_workgroup_id_x 1
  .amdhsa_float_denorm_mode_32 3
  .amdhsa_float_denorm_mode_16_64 3
.end_amdhsa_kernel
.p2align 6
.amdhsa_kernel k1_attn_kernel
  .amdhsa_next_free_vgpr 512
  .amdhsa_next_free_sgpr 102
  .amdhsa_accum_offset 256
  .amdhsa_group_segment_fixed_size 0
  .amdhsa_kernarg_size 112
  .amdhsa_user_sgpr_count 2
  .amdhsa_user_sgpr_kernarg_segment_ptr 1
  .amdhsa_system_sgpr_workgroup_id_x 1
  .amdhsa_float_denorm_mode_32 3
  .amdhsa_float_denorm_mode_16_64 3
.end_amdhsa_kernel
```
